```python
import torch

def _softmax(x, axis=-1):
    return torch.softmax(x, dim=axis)
def _gelu(x):
    return torch.nn.functional.gelu(x, approximate="tanh")
def _silu(x):
    return torch.nn.functional.silu(x)
def _sigmoid(x):
    return torch.sigmoid(x)
def _layernorm(x, axis=-1, eps=1e-5):
    m = x.mean(dim=axis, keepdim=True)
    v = x.var(dim=axis, keepdim=True, unbiased=False)
    return (x - m) / torch.sqrt(v + eps)
def _scatter_add(tgt, idx, src, axis=0):
    return tgt.clone().index_add_(axis, idx, src)
def _segment_sum(src, seg, n):
    out = torch.zeros((n,) + src.shape[1:], dtype=src.dtype)
    return out.index_add_(0, seg, src)
def _pad(x, pw):
    flat = tuple(v for pair in reversed(pw) for v in pair)
    return torch.nn.functional.pad(x, flat)

kernel_name = 'concat_heads__gqa_block_cached__gqa_block_cached__near_ridge'

def setup_inputs():

    _w = (lambda a: (lambda t: t.to(torch.bfloat16) if t.is_floating_point() else t)(torch.as_tensor(a)))
    def _A_setup():
        B, Sq, D = 16, 144, 512
        Hq, Hkv, Sk, Dh = 32, 32, 512, 128
        assert Hq % Hkv == 0, (Hq, Hkv)
        return {
            "x": _w((lambda *s: torch.randn(*s, dtype=torch.bfloat16) * 0.8)(B, Sq, D)),
            "k_cache": _w((lambda *s: torch.randn(*s, dtype=torch.bfloat16) * 0.8)(B, Hkv, Sk, Dh)),
            "v_cache": _w((lambda *s: torch.randn(*s, dtype=torch.bfloat16) * 0.05)(B, Hkv, Sk, Dh)),
            "wq": _w((lambda *s: torch.randn(*s, dtype=torch.bfloat16) * 0.8)(D, Hq * Dh) * (D ** -0.5)),
            "wo": _w((lambda *s: torch.randn(*s, dtype=torch.bfloat16) * 0.05)(Hq * Dh, D) * ((Hq * Dh) ** -0.5)),
        }
    _A_in = _A_setup()

    def _B_setup():
        B, Sq, D = 16, 144, 512
        Hq, Hkv, Sk, Dh = 32, 32, 512, 128
        assert Hq % Hkv == 0, (Hq, Hkv)
        return {
            "x": _w((lambda *s: torch.randn(*s, dtype=torch.bfloat16) * 0.8)(B, Sq, D)),
            "k_cache": _w((lambda *s: torch.randn(*s, dtype=torch.bfloat16) * 0.8)(B, Hkv, Sk, Dh)),
            "v_cache": _w((lambda *s: torch.randn(*s, dtype=torch.bfloat16) * 0.05)(B, Hkv, Sk, Dh)),
            "wq": _w((lambda *s: torch.randn(*s, dtype=torch.bfloat16) * 0.8)(D, Hq * Dh) * (D ** -0.5)),
            "wo": _w((lambda *s: torch.randn(*s, dtype=torch.bfloat16) * 0.05)(Hq * Dh, D) * ((Hq * Dh) ** -0.5)),
        }
    _B_in = _B_setup()

    return {
        "A_x": _A_in["x"],
        "A_k_cache": _A_in["k_cache"],
        "A_v_cache": _A_in["v_cache"],
        "A_wq": _A_in["wq"],
        "A_wo": _A_in["wo"],
        "B_x": _B_in["x"],
        "B_k_cache": _B_in["k_cache"],
        "B_v_cache": _B_in["v_cache"],
        "B_wq": _B_in["wq"],
        "B_wo": _B_in["wo"],
    }

def reference(A_x, A_k_cache, A_v_cache, A_wq, A_wo, B_x, B_k_cache, B_v_cache, B_wq, B_wo):
    def _A_ref(x, k_cache, v_cache, wq, wo):
        B, Sq, D = x.shape
        Hq, Dh = 32, 128
        Hkv = k_cache.shape[1]
        rep = Hq // Hkv
        q = (lambda x, *d: x.permute(*d))((x @ wq).reshape(B, Sq, Hq, Dh), 0, 2, 1, 3)
        k = (lambda x, n, axis: torch.repeat_interleave(x, n, dim=axis))(k_cache, rep, axis=1)
        v = (lambda x, n, axis: torch.repeat_interleave(x, n, dim=axis))(v_cache, rep, axis=1)
        scores = torch.einsum("bhqd,bhkd->bhqk", q, k) * (Dh ** -0.5)
        p = _softmax(scores, axis=-1)
        o = torch.einsum("bhqk,bhkd->bhqd", p, v)
        return (lambda x, *d: x.permute(*d))(o, 0, 2, 1, 3).reshape(B, Sq, Hq * Dh) @ wo

    def _B_ref(x, k_cache, v_cache, wq, wo):
        B, Sq, D = x.shape
        Hq, Dh = 32, 128
        Hkv = k_cache.shape[1]
        rep = Hq // Hkv
        q = (lambda x, *d: x.permute(*d))((x @ wq).reshape(B, Sq, Hq, Dh), 0, 2, 1, 3)
        k = (lambda x, n, axis: torch.repeat_interleave(x, n, dim=axis))(k_cache, rep, axis=1)
        v = (lambda x, n, axis: torch.repeat_interleave(x, n, dim=axis))(v_cache, rep, axis=1)
        scores = torch.einsum("bhqd,bhkd->bhqk", q, k) * (Dh ** -0.5)
        p = _softmax(scores, axis=-1)
        o = torch.einsum("bhqk,bhkd->bhqd", p, v)
        return (lambda x, *d: x.permute(*d))(o, 0, 2, 1, 3).reshape(B, Sq, Hq * Dh) @ wo

    a = _A_ref(A_x, A_k_cache, A_v_cache, A_wq, A_wo)
    b = _B_ref(B_x, B_k_cache, B_v_cache, B_wq, B_wo)
    return torch.concatenate([a, b], axis=-1)
```

```asm
; @launch kernel=concat_heads__gqa_block_cached__gqa_block_cached__near_ridge_kernel grid=(256,1,1) block=(256,1,1) lds=161792
; @launch kernel=reduce_kernel grid=(1152,1,1) block=(256,1,1) lds=0
.amdgcn_target "amdgcn-amd-amdhsa--gfx950"
.text
.globl concat_heads__gqa_block_cached__gqa_block_cached__near_ridge_kernel
.p2align 8
.type concat_heads__gqa_block_cached__gqa_block_cached__near_ridge_kernel,@function
concat_heads__gqa_block_cached__gqa_block_cached__near_ridge_kernel:
    s_cmp_ge_u32 s2, 256
    s_cbranch_scc1 K1_done
    s_load_dwordx4 s[64:67], s[0:1], 0
    s_load_dwordx4 s[68:71], s[0:1], 16
    s_load_dwordx2 s[72:73], s[0:1], 32
    s_load_dwordx2 s[74:75], s[0:1], 40
    s_load_dwordx4 s[76:79], s[0:1], 48
    s_load_dwordx4 s[80:83], s[0:1], 64
    s_load_dwordx2 s[84:85], s[0:1], 96
    v_lshrrev_b32 v3, 6, v0
    v_and_b32 v217, 63, v0
    s_nop 0
    v_readfirstlane_b32 s54, v3
    s_and_b32 s51, s2, 1
    s_lshr_b32 s56, s2, 3
    s_and_b32 s32, s56, 7
    s_lshr_b32 s56, s56, 3
    s_lshr_b32 s58, s2, 1
    s_and_b32 s58, s58, 3
    s_lshl_b32 s58, s58, 2
    s_add_u32 s52, s58, s56
    s_and_b32 s34, s32, 1
    s_mov_b32 s34, 0
    s_mov_b32 s35, 0
    s_lshr_b32 s56, s54, 1
    s_and_b32 s57, s54, 1
    s_cmp_eq_u32 s34, 0
    s_cselect_b32 s59, s54, s56
    s_cselect_b32 s49, 0, s57
    s_lshl_b32 s58, s32, 2
    s_add_u32 s53, s58, s59
    v_and_b32 v1, 15, v217
    v_lshrrev_b32 v2, 4, v217
    v_lshlrev_b32 v219, 4, v217
    s_getpc_b64 s[60:61]
    s_lshl_b32 s58, s54, 13
    v_lshlrev_b32 v208, 7, v217
    v_add_u32 v208, s58, v208
    global_load_dword v209, v208, s[60:61]
    v_add_u32 v208, 0x8000, v208
    global_load_dword v209, v208, s[60:61]
    v_add_u32 v208, 0x8000, v208
    v_lshlrev_b32 v3, 8, v1
    v_lshl_add_u32 v212, v2, 5, v3
    v_add_u32 v213, 0x1000, v212
    v_and_b32 v3, 3, v1
    v_lshrrev_b32 v4, 2, v1
    v_lshl_add_u32 v4, v3, 2, v4
    v_lshlrev_b32 v4, 4, v4
    v_lshl_add_u32 v214, v2, 10, v4
    v_add_u32 v215, 0x1000, v214
    v_bfe_u32 v3, v1, 1, 1
    v_lshlrev_b32 v3, 3, v3
    v_lshrrev_b32 v7, 2, v1
    v_lshl_add_u32 v3, v7, 1, v3
    v_and_b32 v7, 1, v1
    v_add_u32 v3, v3, v7
    v_lshlrev_b32 v3, 4, v3
    v_lshl_add_u32 v220, v2, 16, v3
    v_bfe_u32 v222, v219, 6, 3
    v_lshlrev_b32 v222, 10, v222
    v_lshrrev_b32 v7, 9, v219
    v_lshl_add_u32 v222, v7, 6, v222
    v_lshrrev_b32 v7, 3, v219
    v_xor_b32 v7, v7, v219
    v_and_b32 v7, 32, v7
    v_add_u32 v222, v7, v222
    v_and_b32 v7, 16, v219
    v_add_u32 v222, v7, v222
    v_lshrrev_b32 v3, 3, v1
    v_lshlrev_b32 v3, 10, v3
    v_and_b32 v7, 7, v1
    v_lshl_add_u32 v3, v7, 6, v3
    v_lshrrev_b32 v7, 1, v1
    v_xor_b32 v7, v7, v2
    v_and_b32 v7, 2, v7
    v_lshl_add_u32 v3, v7, 4, v3
    v_and_b32 v7, 1, v2
    v_lshl_add_u32 v221, v7, 4, v3
    s_mul_i32 s58, s59, 36864
    v_add_u32 v216, s58, v219
    v_add_u32 v223, 147456, v219
    s_mul_i32 s4, s56, 18432
    s_mul_i32 s58, s57, 9216
    s_add_u32 s4, s4, s58
    s_lshl_b32 s5, s56, 7
    s_mul_i32 s58, s57, 73728
    s_add_u32 s5, s5, s58
    s_mov_b32 s36, 0
    s_mov_b32 s37, 8192
    s_mov_b32 s38, 16384
    s_mov_b32 s39, 24576
    s_mov_b32 s40, 32768
    s_mov_b32 s41, 40960
    s_mov_b32 s42, 49152
    s_mov_b32 s43, 57344
    s_mov_b32 s44, 0x05040100
    s_mov_b32 s45, 0x07060302
    s_mov_b32 s6, 0x3e0293ee
    s_mov_b32 s7, 0x3e0293ee
    s_mov_b32 s50, 0x41800000
    s_lshl_b32 s47, s49, 16
    s_mov_b32 s48, s47
    s_mov_b32 s33, 0
    v_mov_b32 v5, 0x3f803f80
    s_lshl_b32 s56, s54, 10
    v_add_u32 v6, s56, v223
    s_add_u32 s57, s54, 0
    v_cmp_eq_u32 vcc, s57, v1
    s_nop 1
    v_cndmask_b32 v8, 0, v5, vcc
    v_cndmask_b32 v9, 0, v5, vcc
    v_cndmask_b32 v10, 0, v5, vcc
    v_cndmask_b32 v11, 0, v5, vcc
    ds_write_b128 v6, v[8:11] offset:0
    s_add_u32 s57, s54, 4
    v_cmp_eq_u32 vcc, s57, v1
    s_nop 1
    v_cndmask_b32 v12, 0, v5, vcc
    v_cndmask_b32 v13, 0, v5, vcc
    v_cndmask_b32 v14, 0, v5, vcc
    v_cndmask_b32 v15, 0, v5, vcc
    ds_write_b128 v6, v[12:15] offset:4096
    s_add_u32 s57, s54, 8
    v_cmp_eq_u32 vcc, s57, v1
    s_nop 1
    v_cndmask_b32 v16, 0, v5, vcc
    v_cndmask_b32 v17, 0, v5, vcc
    v_cndmask_b32 v18, 0, v5, vcc
    v_cndmask_b32 v19, 0, v5, vcc
    s_cmp_lg_u32 s54, 0
    s_cbranch_scc1 K1_selskip
    ds_write_b128 v6, v[16:19] offset:8192
K1_selskip:
    s_waitcnt lgkmcnt(0)
    s_cmp_eq_u32 s51, 0
    s_cselect_b32 s64, s64, s74
    s_cselect_b32 s65, s65, s75
    s_cselect_b32 s66, s66, s76
    s_cselect_b32 s67, s67, s77
    s_cselect_b32 s68, s68, s78
    s_cselect_b32 s69, s69, s79
    s_cselect_b32 s70, s70, s80
    s_cselect_b32 s71, s71, s81
    s_cselect_b32 s72, s72, s82
    s_cselect_b32 s73, s73, s83
    s_mul_i32 s56, s52, 147456
    s_add_u32 s8, s64, s56
    s_addc_u32 s9, s65, 0
    s_mov_b32 s10, 147456
    s_mov_b32 s11, 0x00020000
    s_lshl_b32 s56, s53, 8
    s_lshl_b32 s57, s49, 7
    s_add_u32 s56, s56, s57
    s_sub_u32 s57, 4194304, s56
    s_add_u32 s12, s70, s56
    s_addc_u32 s13, s71, 0
    s_mov_b32 s14, s57
    s_mov_b32 s15, 0x00020000
    s_lshl_b32 s56, s52, 5
    s_add_u32 s56, s56, s53
    s_lshl_b32 s57, s56, 17
    s_add_u32 s16, s66, s57
    s_addc_u32 s17, s67, 0
    s_mov_b32 s18, 131072
    s_mov_b32 s19, 0x00020000
    s_add_u32 s20, s68, s57
    s_addc_u32 s21, s69, 0
    s_mov_b32 s22, 131072
    s_mov_b32 s23, 0x00020000
    s_lshl_b32 s57, s32, 19
    s_lshl_b32 s58, s54, 8
    s_add_u32 s57, s57, s58
    s_sub_u32 s58, 524288, s58
    s_add_u32 s24, s72, s57
    s_addc_u32 s25, s73, 0
    s_mov_b32 s26, s58
    s_mov_b32 s27, 0x00020000
    s_mov_b32 s56, s32
    s_lshl_b32 s57, s51, 4
    s_add_u32 s57, s57, s52
    s_mul_i32 s57, s57, 8
    s_add_u32 s57, s57, s56
    s_lshl_b32 s57, s57, 2
    s_add_u32 s57, s57, s54
    s_mul_i32 s57, s57, 36864
    s_add_u32 s28, s84, s57
    s_addc_u32 s29, s85, 0
    s_mov_b32 s30, 36864
    s_mov_b32 s31, 0x00020000
    s_add_u32 m0, s4, 0
    s_add_u32 s58, s5, 0
    buffer_load_dwordx4 v222, s[8:11], s58 offen lds
    s_add_u32 m0, s4, 1024
    s_add_u32 s58, s5, 8192
    buffer_load_dwordx4 v222, s[8:11], s58 offen lds
    s_add_u32 m0, s4, 2048
    s_add_u32 s58, s5, 16384
    buffer_load_dwordx4 v222, s[8:11], s58 offen lds
    s_add_u32 m0, s4, 3072
    s_add_u32 s58, s5, 24576
    buffer_load_dwordx4 v222, s[8:11], s58 offen lds
    s_add_u32 m0, s4, 4096
    s_add_u32 s58, s5, 32768
    buffer_load_dwordx4 v222, s[8:11], s58 offen lds
    s_add_u32 m0, s4, 5120
    s_add_u32 s58, s5, 40960
    buffer_load_dwordx4 v222, s[8:11], s58 offen lds
    s_add_u32 m0, s4, 6144
    s_add_u32 s58, s5, 49152
    buffer_load_dwordx4 v222, s[8:11], s58 offen lds
    s_add_u32 m0, s4, 7168
    s_add_u32 s58, s5, 57344
    buffer_load_dwordx4 v222, s[8:11], s58 offen lds
    s_add_u32 m0, s4, 8192
    s_add_u32 s58, s5, 65536
    buffer_load_dwordx4 v222, s[8:11], s58 offen lds
    buffer_load_dwordx4 v[0:3], v220, s[12:15], s36 offen
    buffer_load_dwordx4 v[4:7], v220, s[12:15], s37 offen
    buffer_load_dwordx4 v[8:11], v220, s[12:15], s38 offen
    buffer_load_dwordx4 v[12:15], v220, s[12:15], s39 offen
    buffer_load_dwordx4 v[16:19], v220, s[12:15], s40 offen
    buffer_load_dwordx4 v[20:23], v220, s[12:15], s41 offen
    buffer_load_dwordx4 v[24:27], v220, s[12:15], s42 offen
    buffer_load_dwordx4 v[28:31], v220, s[12:15], s43 offen
    v_add_u32 v220, 0x40000, v220
    buffer_load_dwordx4 v[32:35], v220, s[12:15], s36 offen
    buffer_load_dwordx4 v[36:39], v220, s[12:15], s37 offen
    buffer_load_dwordx4 v[40:43], v220, s[12:15], s38 offen
    buffer_load_dwordx4 v[44:47], v220, s[12:15], s39 offen
    buffer_load_dwordx4 v[48:51], v220, s[12:15], s40 offen
    buffer_load_dwordx4 v[52:55], v220, s[12:15], s41 offen
    buffer_load_dwordx4 v[56:59], v220, s[12:15], s42 offen
    buffer_load_dwordx4 v[60:63], v220, s[12:15], s43 offen
    v_add_u32 v220, 0x40000, v220
    buffer_load_dwordx4 v[168:171], v220, s[12:15], s36 offen
    buffer_load_dwordx4 v[172:175], v220, s[12:15], s37 offen
    buffer_load_dwordx4 v[176:179], v220, s[12:15], s38 offen
    buffer_load_dwordx4 v[180:183], v220, s[12:15], s39 offen
    buffer_load_dwordx4 v[184:187], v220, s[12:15], s40 offen
    buffer_load_dwordx4 v[188:191], v220, s[12:15], s41 offen
    buffer_load_dwordx4 v[192:195], v220, s[12:15], s42 offen
    buffer_load_dwordx4 v[196:199], v220, s[12:15], s43 offen
    v_add_u32 v220, 0x40000, v220
    s_add_u32 m0, s4, 36864
    s_add_u32 s58, s5, 256
    buffer_load_dwordx4 v222, s[8:11], s58 offen lds
    s_add_u32 m0, s4, 37888
    s_add_u32 s58, s5, 8448
    buffer_load_dwordx4 v222, s[8:11], s58 offen lds
    s_add_u32 m0, s4, 38912
    s_add_u32 s58, s5, 16640
    buffer_load_dwordx4 v222, s[8:11], s58 offen lds
    s_add_u32 m0, s4, 39936
    s_add_u32 s58, s5, 24832
    buffer_load_dwordx4 v222, s[8:11], s58 offen lds
    s_add_u32 m0, s4, 40960
    s_add_u32 s58, s5, 33024
    buffer_load_dwordx4 v222, s[8:11], s58 offen lds
    s_add_u32 m0, s4, 41984
    s_add_u32 s58, s5, 41216
    buffer_load_dwordx4 v222, s[8:11], s58 offen lds
    s_add_u32 m0, s4, 43008
    s_add_u32 s58, s5, 49408
    buffer_load_dwordx4 v222, s[8:11], s58 offen lds
    s_add_u32 m0, s4, 44032
    s_add_u32 s58, s5, 57600
    buffer_load_dwordx4 v222, s[8:11], s58 offen lds
    s_add_u32 m0, s4, 45056
    s_add_u32 s58, s5, 65792
    buffer_load_dwordx4 v222, s[8:11], s58 offen lds
    s_add_u32 m0, s4, 73728
    s_add_u32 s58, s5, 512
    buffer_load_dwordx4 v222, s[8:11], s58 offen lds
    s_add_u32 m0, s4, 74752
    s_add_u32 s58, s5, 8704
    buffer_load_dwordx4 v222, s[8:11], s58 offen lds
    s_add_u32 m0, s4, 75776
    s_add_u32 s58, s5, 16896
    buffer_load_dwordx4 v222, s[8:11], s58 offen lds
    s_add_u32 m0, s4, 76800
    s_add_u32 s58, s5, 25088
    buffer_load_dwordx4 v222, s[8:11], s58 offen lds
    s_add_u32 m0, s4, 77824
    s_add_u32 s58, s5, 33280
    buffer_load_dwordx4 v222, s[8:11], s58 offen lds
    s_add_u32 m0, s4, 78848
    s_add_u32 s58, s5, 41472
    buffer_load_dwordx4 v222, s[8:11], s58 offen lds
    s_add_u32 m0, s4, 79872
    s_add_u32 s58, s5, 49664
    buffer_load_dwordx4 v222, s[8:11], s58 offen lds
    s_add_u32 m0, s4, 80896
    s_add_u32 s58, s5, 57856
    buffer_load_dwordx4 v222, s[8:11], s58 offen lds
    s_add_u32 m0, s4, 81920
    s_add_u32 s58, s5, 66048
    buffer_load_dwordx4 v222, s[8:11], s58 offen lds
    s_add_u32 m0, s4, 110592
    s_add_u32 s58, s5, 768
    buffer_load_dwordx4 v222, s[8:11], s58 offen lds
    s_add_u32 m0, s4, 111616
    s_add_u32 s58, s5, 8960
    buffer_load_dwordx4 v222, s[8:11], s58 offen lds
    s_add_u32 m0, s4, 112640
    s_add_u32 s58, s5, 17152
    buffer_load_dwordx4 v222, s[8:11], s58 offen lds
    s_add_u32 m0, s4, 113664
    s_add_u32 s58, s5, 25344
    buffer_load_dwordx4 v222, s[8:11], s58 offen lds
    s_add_u32 m0, s4, 114688
    s_add_u32 s58, s5, 33536
    buffer_load_dwordx4 v222, s[8:11], s58 offen lds
    s_add_u32 m0, s4, 115712
    s_add_u32 s58, s5, 41728
    buffer_load_dwordx4 v222, s[8:11], s58 offen lds
    s_add_u32 m0, s4, 116736
    s_add_u32 s58, s5, 49920
    buffer_load_dwordx4 v222, s[8:11], s58 offen lds
    s_add_u32 m0, s4, 117760
    s_add_u32 s58, s5, 58112
    buffer_load_dwordx4 v222, s[8:11], s58 offen lds
    s_add_u32 m0, s4, 118784
    s_add_u32 s58, s5, 66304
    buffer_load_dwordx4 v222, s[8:11], s58 offen lds
    s_waitcnt vmcnt(43)
    v_perm_b32 v64, v4, v0, s44
    v_perm_b32 v68, v4, v0, s45
    v_perm_b32 v65, v12, v8, s44
    v_perm_b32 v69, v12, v8, s45
    v_perm_b32 v66, v20, v16, s44
    v_perm_b32 v70, v20, v16, s45
    v_perm_b32 v67, v28, v24, s44
    v_perm_b32 v71, v28, v24, s45
    v_perm_b32 v72, v5, v1, s44
    v_perm_b32 v76, v5, v1, s45
    v_perm_b32 v73, v13, v9, s44
    v_perm_b32 v77, v13, v9, s45
    v_perm_b32 v74, v21, v17, s44
    v_perm_b32 v78, v21, v17, s45
    v_perm_b32 v75, v29, v25, s44
    v_perm_b32 v79, v29, v25, s45
    v_perm_b32 v80, v6, v2, s44
    v_perm_b32 v84, v6, v2, s45
    v_perm_b32 v81, v14, v10, s44
    v_perm_b32 v85, v14, v10, s45
    v_perm_b32 v82, v22, v18, s44
    v_perm_b32 v86, v22, v18, s45
    v_perm_b32 v83, v30, v26, s44
    v_perm_b32 v87, v30, v26, s45
    s_barrier
    ds_read_b128 v[96:99], v221 offset:0
    ds_read_b128 v[100:103], v221 offset:2048
    ds_read_b128 v[104:107], v221 offset:4096
    ds_read_b128 v[108:111], v221 offset:6144
    ds_read_b128 v[112:115], v221 offset:8192
    ds_read_b128 v[116:119], v221 offset:10240
    ds_read_b128 v[120:123], v221 offset:12288
    ds_read_b128 v[124:127], v221 offset:14336
    ds_read_b128 v[128:131], v221 offset:16384
    s_waitcnt lgkmcnt(0)
    v_mfma_f32_16x16x32_bf16 a[0:3], v[64:67], v[96:99], 0
    v_perm_b32 v88, v7, v3, s44
    ds_read_b128 v[132:135], v221 offset:512
    v_mfma_f32_16x16x32_bf16 a[32:35], v[64:67], v[100:103], 0
    v_perm_b32 v92, v7, v3, s45
    ds_read_b128 v[136:139], v221 offset:2560
    v_mfma_f32_16x16x32_bf16 a[64:67], v[64:67], v[104:107], 0
    v_perm_b32 v89, v15, v11, s44
    ds_read_b128 v[140:143], v221 offset:4608
    v_mfma_f32_16x16x32_bf16 a[96:99], v[64:67], v[108:111], 0
    v_perm_b32 v93, v15, v11, s45
    ds_read_b128 v[144:147], v221 offset:6656
    v_mfma_f32_16x16x32_bf16 a[128:131], v[64:67], v[112:115], 0
    v_perm_b32 v90, v23, v19, s44
    ds_read_b128 v[148:151], v221 offset:8704
    v_mfma_f32_16x16x32_bf16 a[160:163], v[64:67], v[116:119], 0
    v_perm_b32 v94, v23, v19, s45
    ds_read_b128 v[152:155], v221 offset:10752
    v_mfma_f32_16x16x32_bf16 a[192:195], v[64:67], v[120:123], 0
    v_perm_b32 v91, v31, v27, s44
    ds_read_b128 v[156:159], v221 offset:12800
    v_mfma_f32_16x16x32_bf16 a[224:227], v[64:67], v[124:127], 0
    v_perm_b32 v95, v31, v27, s45
    ds_read_b128 v[160:163], v221 offset:14848
    v_mfma_f32_16x16x32_bf16 v[224:227], v[64:67], v[128:131], 0
    ds_read_b128 v[164:167], v221 offset:16896
    buffer_load_dwordx4 v[0:3], v220, s[12:15], s36 offen
    v_mfma_f32_16x16x32_bf16 a[4:7], v[68:71], v[96:99], 0
    v_add_u32 v221, 0x4800, v221
    buffer_load_dwordx4 v[4:7], v220, s[12:15], s37 offen
    v_mfma_f32_16x16x32_bf16 a[36:39], v[68:71], v[100:103], 0
    buffer_load_dwordx4 v[8:11], v220, s[12:15], s38 offen
    v_mfma_f32_16x16x32_bf16 a[68:71], v[68:71], v[104:107], 0
    buffer_load_dwordx4 v[12:15], v220, s[12:15], s39 offen
    v_mfma_f32_16x16x32_bf16 a[100:103], v[68:71], v[108:111], 0
    buffer_load_dwordx4 v[16:19], v220, s[12:15], s40 offen
    v_mfma_f32_16x16x32_bf16 a[132:135], v[68:71], v[112:115], 0
    buffer_load_dwordx4 v[20:23], v220, s[12:15], s41 offen
    v_mfma_f32_16x16x32_bf16 a[164:167], v[68:71], v[116:119], 0
    buffer_load_dwordx4 v[24:27], v220, s[12:15], s42 offen
    v_mfma_f32_16x16x32_bf16 a[196:199], v[68:71], v[120:123], 0
    buffer_load_dwordx4 v[28:31], v220, s[12:15], s43 offen
    v_mfma_f32_16x16x32_bf16 a[228:231], v[68:71], v[124:127], 0
    v_add_u32 v220, 0x40000, v220
    v_mfma_f32_16x16x32_bf16 v[228:231], v[68:71], v[128:131], 0
    s_waitcnt vmcnt(43)
    v_mfma_f32_16x16x32_bf16 a[8:11], v[72:75], v[96:99], 0
    v_perm_b32 v64, v36, v32, s44
    v_mfma_f32_16x16x32_bf16 a[40:43], v[72:75], v[100:103], 0
    v_perm_b32 v68, v36, v32, s45
    v_mfma_f32_16x16x32_bf16 a[72:75], v[72:75], v[104:107], 0
    v_perm_b32 v65, v44, v40, s44
    v_mfma_f32_16x16x32_bf16 a[104:107], v[72:75], v[108:111], 0
    v_perm_b32 v69, v44, v40, s45
    v_mfma_f32_16x16x32_bf16 a[136:139], v[72:75], v[112:115], 0
    v_perm_b32 v66, v52, v48, s44
    v_mfma_f32_16x16x32_bf16 a[168:171], v[72:75], v[116:119], 0
    v_perm_b32 v70, v52, v48, s45
    v_mfma_f32_16x16x32_bf16 a[200:203], v[72:75], v[120:123], 0
    v_perm_b32 v67, v60, v56, s44
    v_mfma_f32_16x16x32_bf16 a[232:235], v[72:75], v[124:127], 0
    v_perm_b32 v71, v60, v56, s45
    v_mfma_f32_16x16x32_bf16 v[232:235], v[72:75], v[128:131], 0
    v_mfma_f32_16x16x32_bf16 a[12:15], v[76:79], v[96:99], 0
    v_mfma_f32_16x16x32_bf16 a[44:47], v[76:79], v[100:103], 0
    v_mfma_f32_16x16x32_bf16 a[76:79], v[76:79], v[104:107], 0
    v_mfma_f32_16x16x32_bf16 a[108:111], v[76:79], v[108:111], 0
    v_mfma_f32_16x16x32_bf16 a[140:143], v[76:79], v[112:115], 0
    v_mfma_f32_16x16x32_bf16 a[172:175], v[76:79], v[116:119], 0
    v_mfma_f32_16x16x32_bf16 a[204:207], v[76:79], v[120:123], 0
    v_mfma_f32_16x16x32_bf16 a[236:239], v[76:79], v[124:127], 0
    v_mfma_f32_16x16x32_bf16 v[236:239], v[76:79], v[128:131], 0
    v_mfma_f32_16x16x32_bf16 a[16:19], v[80:83], v[96:99], 0
    v_perm_b32 v72, v37, v33, s44
    v_mfma_f32_16x16x32_bf16 a[48:51], v[80:83], v[100:103], 0
    v_perm_b32 v76, v37, v33, s45
    v_mfma_f32_16x16x32_bf16 a[80:83], v[80:83], v[104:107], 0
    v_perm_b32 v73, v45, v41, s44
    v_mfma_f32_16x16x32_bf16 a[112:115], v[80:83], v[108:111], 0
    v_perm_b32 v77, v45, v41, s45
    v_mfma_f32_16x16x32_bf16 a[144:147], v[80:83], v[112:115], 0
    v_perm_b32 v74, v53, v49, s44
    v_mfma_f32_16x16x32_bf16 a[176:179], v[80:83], v[116:119], 0
    v_perm_b32 v78, v53, v49, s45
    v_mfma_f32_16x16x32_bf16 a[208:211], v[80:83], v[120:123], 0
    v_perm_b32 v75, v61, v57, s44
    v_mfma_f32_16x16x32_bf16 a[240:243], v[80:83], v[124:127], 0
    v_perm_b32 v79, v61, v57, s45
    v_mfma_f32_16x16x32_bf16 v[240:243], v[80:83], v[128:131], 0
    v_mfma_f32_16x16x32_bf16 a[20:23], v[84:87], v[96:99], 0
    v_mfma_f32_16x16x32_bf16 a[52:55], v[84:87], v[100:103], 0
    v_mfma_f32_16x16x32_bf16 a[84:87], v[84:87], v[104:107], 0
    v_mfma_f32_16x16x32_bf16 a[116:119], v[84:87], v[108:111], 0
    v_mfma_f32_16x16x32_bf16 a[148:151], v[84:87], v[112:115], 0
    v_mfma_f32_16x16x32_bf16 a[180:183], v[84:87], v[116:119], 0
    v_mfma_f32_16x16x32_bf16 a[212:215], v[84:87], v[120:123], 0
    v_mfma_f32_16x16x32_bf16 a[244:247], v[84:87], v[124:127], 0
    v_mfma_f32_16x16x32_bf16 v[244:247], v[84:87], v[128:131], 0
    v_mfma_f32_16x16x32_bf16 a[24:27], v[88:91], v[96:99], 0
    v_perm_b32 v80, v38, v34, s44
    v_mfma_f32_16x16x32_bf16 a[56:59], v[88:91], v[100:103], 0
    v_perm_b32 v84, v38, v34, s45
    v_mfma_f32_16x16x32_bf16 a[88:91], v[88:91], v[104:107], 0
    v_perm_b32 v81, v46, v42, s44
    v_mfma_f32_16x16x32_bf16 a[120:123], v[88:91], v[108:111], 0
    v_perm_b32 v85, v46, v42, s45
    v_mfma_f32_16x16x32_bf16 a[152:155], v[88:91], v[112:115], 0
    v_perm_b32 v82, v54, v50, s44
    v_mfma_f32_16x16x32_bf16 a[184:187], v[88:91], v[116:119], 0
    v_perm_b32 v86, v54, v50, s45
    v_mfma_f32_16x16x32_bf16 a[216:219], v[88:91], v[120:123], 0
    v_perm_b32 v83, v62, v58, s44
    v_mfma_f32_16x16x32_bf16 a[248:251], v[88:91], v[124:127], 0
    v_perm_b32 v87, v62, v58, s45
    v_mfma_f32_16x16x32_bf16 v[248:251], v[88:91], v[128:131], 0
    v_mfma_f32_16x16x32_bf16 a[28:31], v[92:95], v[96:99], 0
    v_mfma_f32_16x16x32_bf16 a[60:63], v[92:95], v[100:103], 0
    v_mfma_f32_16x16x32_bf16 a[92:95], v[92:95], v[104:107], 0
    v_mfma_f32_16x16x32_bf16 a[124:127], v[92:95], v[108:111], 0
    v_mfma_f32_16x16x32_bf16 a[156:159], v[92:95], v[112:115], 0
    v_mfma_f32_16x16x32_bf16 a[188:191], v[92:95], v[116:119], 0
    v_mfma_f32_16x16x32_bf16 a[220:223], v[92:95], v[120:123], 0
    v_mfma_f32_16x16x32_bf16 a[252:255], v[92:95], v[124:127], 0
    v_mfma_f32_16x16x32_bf16 v[252:255], v[92:95], v[128:131], 0
    s_waitcnt lgkmcnt(0)
    v_mfma_f32_16x16x32_bf16 a[0:3], v[64:67], v[132:135], a[0:3]
    v_perm_b32 v88, v39, v35, s44
    ds_read_b128 v[96:99], v221 offset:0
    v_mfma_f32_16x16x32_bf16 a[32:35], v[64:67], v[136:139], a[32:35]
    v_perm_b32 v92, v39, v35, s45
    ds_read_b128 v[100:103], v221 offset:2048
    v_mfma_f32_16x16x32_bf16 a[64:67], v[64:67], v[140:143], a[64:67]
    v_perm_b32 v89, v47, v43, s44
    ds_read_b128 v[104:107], v221 offset:4096
    v_mfma_f32_16x16x32_bf16 a[96:99], v[64:67], v[144:147], a[96:99]
    v_perm_b32 v93, v47, v43, s45
    ds_read_b128 v[108:111], v221 offset:6144
    v_mfma_f32_16x16x32_bf16 a[128:131], v[64:67], v[148:151], a[128:131]
    v_perm_b32 v90, v55, v51, s44
    ds_read_b128 v[112:115], v221 offset:8192
    v_mfma_f32_16x16x32_bf16 a[160:163], v[64:67], v[152:155], a[160:163]
    v_perm_b32 v94, v55, v51, s45
    ds_read_b128 v[116:119], v221 offset:10240
    v_mfma_f32_16x16x32_bf16 a[192:195], v[64:67], v[156:159], a[192:195]
    v_perm_b32 v91, v63, v59, s44
    ds_read_b128 v[120:123], v221 offset:12288
    v_mfma_f32_16x16x32_bf16 a[224:227], v[64:67], v[160:163], a[224:227]
    v_perm_b32 v95, v63, v59, s45
    ds_read_b128 v[124:127], v221 offset:14336
    v_mfma_f32_16x16x32_bf16 v[224:227], v[64:67], v[164:167], v[224:227]
    ds_read_b128 v[128:131], v221 offset:16384
    buffer_load_dwordx4 v[32:35], v220, s[12:15], s36 offen
    v_mfma_f32_16x16x32_bf16 a[4:7], v[68:71], v[132:135], a[4:7]
    buffer_load_dwordx4 v[36:39], v220, s[12:15], s37 offen
    v_mfma_f32_16x16x32_bf16 a[36:39], v[68:71], v[136:139], a[36:39]
    buffer_load_dwordx4 v[40:43], v220, s[12:15], s38 offen
    v_mfma_f32_16x16x32_bf16 a[68:71], v[68:71], v[140:143], a[68:71]
    buffer_load_dwordx4 v[44:47], v220, s[12:15], s39 offen
    v_mfma_f32_16x16x32_bf16 a[100:103], v[68:71], v[144:147], a[100:103]
    buffer_load_dwordx4 v[48:51], v220, s[12:15], s40 offen
    v_mfma_f32_16x16x32_bf16 a[132:135], v[68:71], v[148:151], a[132:135]
    buffer_load_dwordx4 v[52:55], v220, s[12:15], s41 offen
    v_mfma_f32_16x16x32_bf16 a[164:167], v[68:71], v[152:155], a[164:167]
    buffer_load_dwordx4 v[56:59], v220, s[12:15], s42 offen
    v_mfma_f32_16x16x32_bf16 a[196:199], v[68:71], v[156:159], a[196:199]
    buffer_load_dwordx4 v[60:63], v220, s[12:15], s43 offen
    v_mfma_f32_16x16x32_bf16 a[228:231], v[68:71], v[160:163], a[228:231]
    v_add_u32 v220, 0x40000, v220
    v_mfma_f32_16x16x32_bf16 v[228:231], v[68:71], v[164:167], v[228:231]
    s_waitcnt vmcnt(43)
    v_mfma_f32_16x16x32_bf16 a[8:11], v[72:75], v[132:135], a[8:11]
    v_perm_b32 v64, v172, v168, s44
    v_mfma_f32_16x16x32_bf16 a[40:43], v[72:75], v[136:139], a[40:43]
    v_perm_b32 v68, v172, v168, s45
    v_mfma_f32_16x16x32_bf16 a[72:75], v[72:75], v[140:143], a[72:75]
    v_perm_b32 v65, v180, v176, s44
    v_mfma_f32_16x16x32_bf16 a[104:107], v[72:75], v[144:147], a[104:107]
    v_perm_b32 v69, v180, v176, s45
    v_mfma_f32_16x16x32_bf16 a[136:139], v[72:75], v[148:151], a[136:139]
    v_perm_b32 v66, v188, v184, s44
    v_mfma_f32_16x16x32_bf16 a[168:171], v[72:75], v[152:155], a[168:171]
    v_perm_b32 v70, v188, v184, s45
    v_mfma_f32_16x16x32_bf16 a[200:203], v[72:75], v[156:159], a[200:203]
    v_perm_b32 v67, v196, v192, s44
    v_mfma_f32_16x16x32_bf16 a[232:235], v[72:75], v[160:163], a[232:235]
    v_perm_b32 v71, v196, v192, s45
    v_mfma_f32_16x16x32_bf16 v[232:235], v[72:75], v[164:167], v[232:235]
    v_mfma_f32_16x16x32_bf16 a[12:15], v[76:79], v[132:135], a[12:15]
    v_mfma_f32_16x16x32_bf16 a[44:47], v[76:79], v[136:139], a[44:47]
    v_mfma_f32_16x16x32_bf16 a[76:79], v[76:79], v[140:143], a[76:79]
    v_mfma_f32_16x16x32_bf16 a[108:111], v[76:79], v[144:147], a[108:111]
    v_mfma_f32_16x16x32_bf16 a[140:143], v[76:79], v[148:151], a[140:143]
    v_mfma_f32_16x16x32_bf16 a[172:175], v[76:79], v[152:155], a[172:175]
    v_mfma_f32_16x16x32_bf16 a[204:207], v[76:79], v[156:159], a[204:207]
    v_mfma_f32_16x16x32_bf16 a[236:239], v[76:79], v[160:163], a[236:239]
    v_mfma_f32_16x16x32_bf16 v[236:239], v[76:79], v[164:167], v[236:239]
    v_mfma_f32_16x16x32_bf16 a[16:19], v[80:83], v[132:135], a[16:19]
    v_perm_b32 v72, v173, v169, s44
    v_mfma_f32_16x16x32_bf16 a[48:51], v[80:83], v[136:139], a[48:51]
    v_perm_b32 v76, v173, v169, s45
    v_mfma_f32_16x16x32_bf16 a[80:83], v[80:83], v[140:143], a[80:83]
    v_perm_b32 v73, v181, v177, s44
    v_mfma_f32_16x16x32_bf16 a[112:115], v[80:83], v[144:147], a[112:115]
    v_perm_b32 v77, v181, v177, s45
    v_mfma_f32_16x16x32_bf16 a[144:147], v[80:83], v[148:151], a[144:147]
    v_perm_b32 v74, v189, v185, s44
    v_mfma_f32_16x16x32_bf16 a[176:179], v[80:83], v[152:155], a[176:179]
    v_perm_b32 v78, v189, v185, s45
    v_mfma_f32_16x16x32_bf16 a[208:211], v[80:83], v[156:159], a[208:211]
    v_perm_b32 v75, v197, v193, s44
    v_mfma_f32_16x16x32_bf16 a[240:243], v[80:83], v[160:163], a[240:243]
    v_perm_b32 v79, v197, v193, s45
    v_mfma_f32_16x16x32_bf16 v[240:243], v[80:83], v[164:167], v[240:243]
    v_mfma_f32_16x16x32_bf16 a[20:23], v[84:87], v[132:135], a[20:23]
    v_mfma_f32_16x16x32_bf16 a[52:55], v[84:87], v[136:139], a[52:55]
    v_mfma_f32_16x16x32_bf16 a[84:87], v[84:87], v[140:143], a[84:87]
    v_mfma_f32_16x16x32_bf16 a[116:119], v[84:87], v[144:147], a[116:119]
    v_mfma_f32_16x16x32_bf16 a[148:151], v[84:87], v[148:151], a[148:151]
    v_mfma_f32_16x16x32_bf16 a[180:183], v[84:87], v[152:155], a[180:183]
    v_mfma_f32_16x16x32_bf16 a[212:215], v[84:87], v[156:159], a[212:215]
    v_mfma_f32_16x16x32_bf16 a[244:247], v[84:87], v[160:163], a[244:247]
    v_mfma_f32_16x16x32_bf16 v[244:247], v[84:87], v[164:167], v[244:247]
    v_mfma_f32_16x16x32_bf16 a[24:27], v[88:91], v[132:135], a[24:27]
    v_perm_b32 v80, v174, v170, s44
    v_mfma_f32_16x16x32_bf16 a[56:59], v[88:91], v[136:139], a[56:59]
    v_perm_b32 v84, v174, v170, s45
    v_mfma_f32_16x16x32_bf16 a[88:91], v[88:91], v[140:143], a[88:91]
    v_perm_b32 v81, v182, v178, s44
    v_mfma_f32_16x16x32_bf16 a[120:123], v[88:91], v[144:147], a[120:123]
    v_perm_b32 v85, v182, v178, s45
    v_mfma_f32_16x16x32_bf16 a[152:155], v[88:91], v[148:151], a[152:155]
    v_perm_b32 v82, v190, v186, s44
    v_mfma_f32_16x16x32_bf16 a[184:187], v[88:91], v[152:155], a[184:187]
    v_perm_b32 v86, v190, v186, s45
    v_mfma_f32_16x16x32_bf16 a[216:219], v[88:91], v[156:159], a[216:219]
    v_perm_b32 v83, v198, v194, s44
    v_mfma_f32_16x16x32_bf16 a[248:251], v[88:91], v[160:163], a[248:251]
    v_perm_b32 v87, v198, v194, s45
    v_mfma_f32_16x16x32_bf16 v[248:251], v[88:91], v[164:167], v[248:251]
    v_mfma_f32_16x16x32_bf16 a[28:31], v[92:95], v[132:135], a[28:31]
    v_mfma_f32_16x16x32_bf16 a[60:63], v[92:95], v[136:139], a[60:63]
    v_mfma_f32_16x16x32_bf16 a[92:95], v[92:95], v[140:143], a[92:95]
    v_mfma_f32_16x16x32_bf16 a[124:127], v[92:95], v[144:147], a[124:127]
    v_mfma_f32_16x16x32_bf16 a[156:159], v[92:95], v[148:151], a[156:159]
    v_mfma_f32_16x16x32_bf16 a[188:191], v[92:95], v[152:155], a[188:191]
    v_mfma_f32_16x16x32_bf16 a[220:223], v[92:95], v[156:159], a[220:223]
    v_mfma_f32_16x16x32_bf16 a[252:255], v[92:95], v[160:163], a[252:255]
    v_mfma_f32_16x16x32_bf16 v[252:255], v[92:95], v[164:167], v[252:255]
    s_waitcnt lgkmcnt(0)
    v_mfma_f32_16x16x32_bf16 a[0:3], v[64:67], v[96:99], a[0:3]
    v_perm_b32 v88, v175, v171, s44
    ds_read_b128 v[132:135], v221 offset:512
    v_mfma_f32_16x16x32_bf16 a[32:35], v[64:67], v[100:103], a[32:35]
    v_perm_b32 v92, v175, v171, s45
    ds_read_b128 v[136:139], v221 offset:2560
    v_mfma_f32_16x16x32_bf16 a[64:67], v[64:67], v[104:107], a[64:67]
    v_perm_b32 v89, v183, v179, s44
    ds_read_b128 v[140:143], v221 offset:4608
    v_mfma_f32_16x16x32_bf16 a[96:99], v[64:67], v[108:111], a[96:99]
    v_perm_b32 v93, v183, v179, s45
    ds_read_b128 v[144:147], v221 offset:6656
    v_mfma_f32_16x16x32_bf16 a[128:131], v[64:67], v[112:115], a[128:131]
    v_perm_b32 v90, v191, v187, s44
    ds_read_b128 v[148:151], v221 offset:8704
    v_mfma_f32_16x16x32_bf16 a[160:163], v[64:67], v[116:119], a[160:163]
    v_perm_b32 v94, v191, v187, s45
    ds_read_b128 v[152:155], v221 offset:10752
    v_mfma_f32_16x16x32_bf16 a[192:195], v[64:67], v[120:123], a[192:195]
    v_perm_b32 v91, v199, v195, s44
    ds_read_b128 v[156:159], v221 offset:12800
    v_mfma_f32_16x16x32_bf16 a[224:227], v[64:67], v[124:127], a[224:227]
    v_perm_b32 v95, v199, v195, s45
    ds_read_b128 v[160:163], v221 offset:14848
    v_mfma_f32_16x16x32_bf16 v[224:227], v[64:67], v[128:131], v[224:227]
    ds_read_b128 v[164:167], v221 offset:16896
    buffer_load_dwordx4 v[168:171], v220, s[12:15], s36 offen
    v_mfma_f32_16x16x32_bf16 a[4:7], v[68:71], v[96:99], a[4:7]
    v_add_u32 v221, 0x4800, v221
    buffer_load_dwordx4 v[172:175], v220, s[12:15], s37 offen
    v_mfma_f32_16x16x32_bf16 a[36:39], v[68:71], v[100:103], a[36:39]
    buffer_load_dwordx4 v[176:179], v220, s[12:15], s38 offen
    v_mfma_f32_16x16x32_bf16 a[68:71], v[68:71], v[104:107], a[68:71]
    buffer_load_dwordx4 v[180:183], v220, s[12:15], s39 offen
    v_mfma_f32_16x16x32_bf16 a[100:103], v[68:71], v[108:111], a[100:103]
    buffer_load_dwordx4 v[184:187], v220, s[12:15], s40 offen
    v_mfma_f32_16x16x32_bf16 a[132:135], v[68:71], v[112:115], a[132:135]
    buffer_load_dwordx4 v[188:191], v220, s[12:15], s41 offen
    v_mfma_f32_16x16x32_bf16 a[164:167], v[68:71], v[116:119], a[164:167]
    buffer_load_dwordx4 v[192:195], v220, s[12:15], s42 offen
    v_mfma_f32_16x16x32_bf16 a[196:199], v[68:71], v[120:123], a[196:199]
    buffer_load_dwordx4 v[196:199], v220, s[12:15], s43 offen
    v_mfma_f32_16x16x32_bf16 a[228:231], v[68:71], v[124:127], a[228:231]
    v_add_u32 v220, 0x40000, v220
    v_mfma_f32_16x16x32_bf16 v[228:231], v[68:71], v[128:131], v[228:231]
    s_waitcnt vmcnt(16)
    v_mfma_f32_16x16x32_bf16 a[8:11], v[72:75], v[96:99], a[8:11]
    v_perm_b32 v64, v4, v0, s44
    v_mfma_f32_16x16x32_bf16 a[40:43], v[72:75], v[100:103], a[40:43]
    v_perm_b32 v68, v4, v0, s45
    v_mfma_f32_16x16x32_bf16 a[72:75], v[72:75], v[104:107], a[72:75]
    v_perm_b32 v65, v12, v8, s44
    v_mfma_f32_16x16x32_bf16 a[104:107], v[72:75], v[108:111], a[104:107]
    v_perm_b32 v69, v12, v8, s45
    v_mfma_f32_16x16x32_bf16 a[136:139], v[72:75], v[112:115], a[136:139]
    v_perm_b32 v66, v20, v16, s44
    v_mfma_f32_16x16x32_bf16 a[168:171], v[72:75], v[116:119], a[168:171]
    v_perm_b32 v70, v20, v16, s45
    v_mfma_f32_16x16x32_bf16 a[200:203], v[72:75], v[120:123], a[200:203]
    v_perm_b32 v67, v28, v24, s44
    v_mfma_f32_16x16x32_bf16 a[232:235], v[72:75], v[124:127], a[232:235]
    v_perm_b32 v71, v28, v24, s45
    v_mfma_f32_16x16x32_bf16 v[232:235], v[72:75], v[128:131], v[232:235]
    v_mfma_f32_16x16x32_bf16 a[12:15], v[76:79], v[96:99], a[12:15]
    v_mfma_f32_16x16x32_bf16 a[44:47], v[76:79], v[100:103], a[44:47]
    v_mfma_f32_16x16x32_bf16 a[76:79], v[76:79], v[104:107], a[76:79]
    v_mfma_f32_16x16x32_bf16 a[108:111], v[76:79], v[108:111], a[108:111]
    v_mfma_f32_16x16x32_bf16 a[140:143], v[76:79], v[112:115], a[140:143]
    v_mfma_f32_16x16x32_bf16 a[172:175], v[76:79], v[116:119], a[172:175]
    v_mfma_f32_16x16x32_bf16 a[204:207], v[76:79], v[120:123], a[204:207]
    v_mfma_f32_16x16x32_bf16 a[236:239], v[76:79], v[124:127], a[236:239]
    v_mfma_f32_16x16x32_bf16 v[236:239], v[76:79], v[128:131], v[236:239]
    v_mfma_f32_16x16x32_bf16 a[16:19], v[80:83], v[96:99], a[16:19]
    v_perm_b32 v72, v5, v1, s44
    v_mfma_f32_16x16x32_bf16 a[48:51], v[80:83], v[100:103], a[48:51]
    v_perm_b32 v76, v5, v1, s45
    v_mfma_f32_16x16x32_bf16 a[80:83], v[80:83], v[104:107], a[80:83]
    v_perm_b32 v73, v13, v9, s44
    v_mfma_f32_16x16x32_bf16 a[112:115], v[80:83], v[108:111], a[112:115]
    v_perm_b32 v77, v13, v9, s45
    v_mfma_f32_16x16x32_bf16 a[144:147], v[80:83], v[112:115], a[144:147]
    v_perm_b32 v74, v21, v17, s44
    v_mfma_f32_16x16x32_bf16 a[176:179], v[80:83], v[116:119], a[176:179]
    v_perm_b32 v78, v21, v17, s45
    v_mfma_f32_16x16x32_bf16 a[208:211], v[80:83], v[120:123], a[208:211]
    v_perm_b32 v75, v29, v25, s44
    v_mfma_f32_16x16x32_bf16 a[240:243], v[80:83], v[124:127], a[240:243]
    v_perm_b32 v79, v29, v25, s45
    v_mfma_f32_16x16x32_bf16 v[240:243], v[80:83], v[128:131], v[240:243]
    v_mfma_f32_16x16x32_bf16 a[20:23], v[84:87], v[96:99], a[20:23]
    v_mfma_f32_16x16x32_bf16 a[52:55], v[84:87], v[100:103], a[52:55]
    v_mfma_f32_16x16x32_bf16 a[84:87], v[84:87], v[104:107], a[84:87]
    v_mfma_f32_16x16x32_bf16 a[116:119], v[84:87], v[108:111], a[116:119]
    v_mfma_f32_16x16x32_bf16 a[148:151], v[84:87], v[112:115], a[148:151]
    v_mfma_f32_16x16x32_bf16 a[180:183], v[84:87], v[116:119], a[180:183]
    v_mfma_f32_16x16x32_bf16 a[212:215], v[84:87], v[120:123], a[212:215]
    v_mfma_f32_16x16x32_bf16 a[244:247], v[84:87], v[124:127], a[244:247]
    v_mfma_f32_16x16x32_bf16 v[244:247], v[84:87], v[128:131], v[244:247]
    v_mfma_f32_16x16x32_bf16 a[24:27], v[88:91], v[96:99], a[24:27]
    v_perm_b32 v80, v6, v2, s44
    v_mfma_f32_16x16x32_bf16 a[56:59], v[88:91], v[100:103], a[56:59]
    v_perm_b32 v84, v6, v2, s45
    v_mfma_f32_16x16x32_bf16 a[88:91], v[88:91], v[104:107], a[88:91]
    v_perm_b32 v81, v14, v10, s44
    v_mfma_f32_16x16x32_bf16 a[120:123], v[88:91], v[108:111], a[120:123]
    v_perm_b32 v85, v14, v10, s45
    v_mfma_f32_16x16x32_bf16 a[152:155], v[88:91], v[112:115], a[152:155]
    v_perm_b32 v82, v22, v18, s44
    v_mfma_f32_16x16x32_bf16 a[184:187], v[88:91], v[116:119], a[184:187]
    v_perm_b32 v86, v22, v18, s45
    v_mfma_f32_16x16x32_bf16 a[216:219], v[88:91], v[120:123], a[216:219]
    v_perm_b32 v83, v30, v26, s44
    v_mfma_f32_16x16x32_bf16 a[248:251], v[88:91], v[124:127], a[248:251]
    v_perm_b32 v87, v30, v26, s45
    v_mfma_f32_16x16x32_bf16 v[248:251], v[88:91], v[128:131], v[248:251]
    v_mfma_f32_16x16x32_bf16 a[28:31], v[92:95], v[96:99], a[28:31]
    v_mfma_f32_16x16x32_bf16 a[60:63], v[92:95], v[100:103], a[60:63]
    v_mfma_f32_16x16x32_bf16 a[92:95], v[92:95], v[104:107], a[92:95]
    v_mfma_f32_16x16x32_bf16 a[124:127], v[92:95], v[108:111], a[124:127]
    v_mfma_f32_16x16x32_bf16 a[156:159], v[92:95], v[112:115], a[156:159]
    v_mfma_f32_16x16x32_bf16 a[188:191], v[92:95], v[116:119], a[188:191]
    v_mfma_f32_16x16x32_bf16 a[220:223], v[92:95], v[120:123], a[220:223]
    v_mfma_f32_16x16x32_bf16 a[252:255], v[92:95], v[124:127], a[252:255]
    v_mfma_f32_16x16x32_bf16 v[252:255], v[92:95], v[128:131], v[252:255]
    s_waitcnt lgkmcnt(0)
    s_waitcnt vmcnt(24)
    s_barrier
    v_mfma_f32_16x16x32_bf16 a[0:3], v[64:67], v[132:135], a[0:3]
    v_perm_b32 v88, v7, v3, s44
    ds_read_b128 v[96:99], v221 offset:0
    v_mfma_f32_16x16x32_bf16 a[32:35], v[64:67], v[136:139], a[32:35]
    v_perm_b32 v92, v7, v3, s45
    ds_read_b128 v[100:103], v221 offset:2048
    v_mfma_f32_16x16x32_bf16 a[64:67], v[64:67], v[140:143], a[64:67]
    v_perm_b32 v89, v15, v11, s44
    ds_read_b128 v[104:107], v221 offset:4096
    v_mfma_f32_16x16x32_bf16 a[96:99], v[64:67], v[144:147], a[96:99]
    v_perm_b32 v93, v15, v11, s45
    ds_read_b128 v[108:111], v221 offset:6144
    v_mfma_f32_16x16x32_bf16 a[128:131], v[64:67], v[148:151], a[128:131]
    v_perm_b32 v90, v23, v19, s44
    ds_read_b128 v[112:115], v221 offset:8192
    v_mfma_f32_16x16x32_bf16 a[160:163], v[64:67], v[152:155], a[160:163]
    v_perm_b32 v94, v23, v19, s45
    ds_read_b128 v[116:119], v221 offset:10240
    v_mfma_f32_16x16x32_bf16 a[192:195], v[64:67], v[156:159], a[192:195]
    v_perm_b32 v91, v31, v27, s44
    ds_read_b128 v[120:123], v221 offset:12288
    v_mfma_f32_16x16x32_bf16 a[224:227], v[64:67], v[160:163], a[224:227]
    v_perm_b32 v95, v31, v27, s45
    ds_read_b128 v[124:127], v221 offset:14336
    v_mfma_f32_16x16x32_bf16 v[224:227], v[64:67], v[164:167], v[224:227]
    ds_read_b128 v[128:131], v221 offset:16384
    buffer_load_dwordx4 v[0:3], v220, s[12:15], s36 offen
    v_mfma_f32_16x16x32_bf16 a[4:7], v[68:71], v[132:135], a[4:7]
    buffer_load_dwordx4 v[4:7], v220, s[12:15], s37 offen
    v_mfma_f32_16x16x32_bf16 a[36:39], v[68:71], v[136:139], a[36:39]
    buffer_load_dwordx4 v[8:11], v220, s[12:15], s38 offen
    v_mfma_f32_16x16x32_bf16 a[68:71], v[68:71], v[140:143], a[68:71]
    buffer_load_dwordx4 v[12:15], v220, s[12:15], s39 offen
    v_mfma_f32_16x16x32_bf16 a[100:103], v[68:71], v[144:147], a[100:103]
    buffer_load_dwordx4 v[16:19], v220, s[12:15], s40 offen
    v_mfma_f32_16x16x32_bf16 a[132:135], v[68:71], v[148:151], a[132:135]
    buffer_load_dwordx4 v[20:23], v220, s[12:15], s41 offen
    v_mfma_f32_16x16x32_bf16 a[164:167], v[68:71], v[152:155], a[164:167]
    buffer_load_dwordx4 v[24:27], v220, s[12:15], s42 offen
    v_mfma_f32_16x16x32_bf16 a[196:199], v[68:71], v[156:159], a[196:199]
    buffer_load_dwordx4 v[28:31], v220, s[12:15], s43 offen
    v_mfma_f32_16x16x32_bf16 a[228:231], v[68:71], v[160:163], a[228:231]
    v_add_u32 v220, 0x40000, v220
    v_mfma_f32_16x16x32_bf16 v[228:231], v[68:71], v[164:167], v[228:231]
    s_waitcnt vmcnt(16)
    v_mfma_f32_16x16x32_bf16 a[8:11], v[72:75], v[132:135], a[8:11]
    v_perm_b32 v64, v36, v32, s44
    v_mfma_f32_16x16x32_bf16 a[40:43], v[72:75], v[136:139], a[40:43]
    v_perm_b32 v68, v36, v32, s45
    v_mfma_f32_16x16x32_bf16 a[72:75], v[72:75], v[140:143], a[72:75]
    v_perm_b32 v65, v44, v40, s44
    v_mfma_f32_16x16x32_bf16 a[104:107], v[72:75], v[144:147], a[104:107]
    v_perm_b32 v69, v44, v40, s45
    v_mfma_f32_16x16x32_bf16 a[136:139], v[72:75], v[148:151], a[136:139]
    v_perm_b32 v66, v52, v48, s44
    v_mfma_f32_16x16x32_bf16 a[168:171], v[72:75], v[152:155], a[168:171]
    v_perm_b32 v70, v52, v48, s45
    v_mfma_f32_16x16x32_bf16 a[200:203], v[72:75], v[156:159], a[200:203]
    v_perm_b32 v67, v60, v56, s44
    v_mfma_f32_16x16x32_bf16 a[232:235], v[72:75], v[160:163], a[232:235]
    v_perm_b32 v71, v60, v56, s45
    v_mfma_f32_16x16x32_bf16 v[232:235], v[72:75], v[164:167], v[232:235]
    v_mfma_f32_16x16x32_bf16 a[12:15], v[76:79], v[132:135], a[12:15]
    v_mfma_f32_16x16x32_bf16 a[44:47], v[76:79], v[136:139], a[44:47]
    v_mfma_f32_16x16x32_bf16 a[76:79], v[76:79], v[140:143], a[76:79]
    v_mfma_f32_16x16x32_bf16 a[108:111], v[76:79], v[144:147], a[108:111]
    v_mfma_f32_16x16x32_bf16 a[140:143], v[76:79], v[148:151], a[140:143]
    v_mfma_f32_16x16x32_bf16 a[172:175], v[76:79], v[152:155], a[172:175]
    v_mfma_f32_16x16x32_bf16 a[204:207], v[76:79], v[156:159], a[204:207]
    v_mfma_f32_16x16x32_bf16 a[236:239], v[76:79], v[160:163], a[236:239]
    v_mfma_f32_16x16x32_bf16 v[236:239], v[76:79], v[164:167], v[236:239]
    v_mfma_f32_16x16x32_bf16 a[16:19], v[80:83], v[132:135], a[16:19]
    v_perm_b32 v72, v37, v33, s44
    v_mfma_f32_16x16x32_bf16 a[48:51], v[80:83], v[136:139], a[48:51]
    v_perm_b32 v76, v37, v33, s45
    v_mfma_f32_16x16x32_bf16 a[80:83], v[80:83], v[140:143], a[80:83]
    v_perm_b32 v73, v45, v41, s44
    v_mfma_f32_16x16x32_bf16 a[112:115], v[80:83], v[144:147], a[112:115]
    v_perm_b32 v77, v45, v41, s45
    v_mfma_f32_16x16x32_bf16 a[144:147], v[80:83], v[148:151], a[144:147]
    v_perm_b32 v74, v53, v49, s44
    v_mfma_f32_16x16x32_bf16 a[176:179], v[80:83], v[152:155], a[176:179]
    v_perm_b32 v78, v53, v49, s45
    v_mfma_f32_16x16x32_bf16 a[208:211], v[80:83], v[156:159], a[208:211]
    v_perm_b32 v75, v61, v57, s44
    v_mfma_f32_16x16x32_bf16 a[240:243], v[80:83], v[160:163], a[240:243]
    v_perm_b32 v79, v61, v57, s45
    v_mfma_f32_16x16x32_bf16 v[240:243], v[80:83], v[164:167], v[240:243]
    v_mfma_f32_16x16x32_bf16 a[20:23], v[84:87], v[132:135], a[20:23]
    v_mfma_f32_16x16x32_bf16 a[52:55], v[84:87], v[136:139], a[52:55]
    v_mfma_f32_16x16x32_bf16 a[84:87], v[84:87], v[140:143], a[84:87]
    v_mfma_f32_16x16x32_bf16 a[116:119], v[84:87], v[144:147], a[116:119]
    v_mfma_f32_16x16x32_bf16 a[148:151], v[84:87], v[148:151], a[148:151]
    v_mfma_f32_16x16x32_bf16 a[180:183], v[84:87], v[152:155], a[180:183]
    v_mfma_f32_16x16x32_bf16 a[212:215], v[84:87], v[156:159], a[212:215]
    v_mfma_f32_16x16x32_bf16 a[244:247], v[84:87], v[160:163], a[244:247]
    v_mfma_f32_16x16x32_bf16 v[244:247], v[84:87], v[164:167], v[244:247]
    v_mfma_f32_16x16x32_bf16 a[24:27], v[88:91], v[132:135], a[24:27]
    v_perm_b32 v80, v38, v34, s44
    v_mfma_f32_16x16x32_bf16 a[56:59], v[88:91], v[136:139], a[56:59]
    v_perm_b32 v84, v38, v34, s45
    v_mfma_f32_16x16x32_bf16 a[88:91], v[88:91], v[140:143], a[88:91]
    v_perm_b32 v81, v46, v42, s44
    v_mfma_f32_16x16x32_bf16 a[120:123], v[88:91], v[144:147], a[120:123]
    v_perm_b32 v85, v46, v42, s45
    v_mfma_f32_16x16x32_bf16 a[152:155], v[88:91], v[148:151], a[152:155]
    v_perm_b32 v82, v54, v50, s44
    v_mfma_f32_16x16x32_bf16 a[184:187], v[88:91], v[152:155], a[184:187]
    v_perm_b32 v86, v54, v50, s45
    v_mfma_f32_16x16x32_bf16 a[216:219], v[88:91], v[156:159], a[216:219]
    v_perm_b32 v83, v62, v58, s44
    v_mfma_f32_16x16x32_bf16 a[248:251], v[88:91], v[160:163], a[248:251]
    v_perm_b32 v87, v62, v58, s45
    v_mfma_f32_16x16x32_bf16 v[248:251], v[88:91], v[164:167], v[248:251]
    v_mfma_f32_16x16x32_bf16 a[28:31], v[92:95], v[132:135], a[28:31]
    v_mfma_f32_16x16x32_bf16 a[60:63], v[92:95], v[136:139], a[60:63]
    v_mfma_f32_16x16x32_bf16 a[92:95], v[92:95], v[140:143], a[92:95]
    v_mfma_f32_16x16x32_bf16 a[124:127], v[92:95], v[144:147], a[124:127]
    v_mfma_f32_16x16x32_bf16 a[156:159], v[92:95], v[148:151], a[156:159]
    v_mfma_f32_16x16x32_bf16 a[188:191], v[92:95], v[152:155], a[188:191]
    v_mfma_f32_16x16x32_bf16 a[220:223], v[92:95], v[156:159], a[220:223]
    v_mfma_f32_16x16x32_bf16 a[252:255], v[92:95], v[160:163], a[252:255]
    v_mfma_f32_16x16x32_bf16 v[252:255], v[92:95], v[164:167], v[252:255]
    s_waitcnt lgkmcnt(0)
    v_mfma_f32_16x16x32_bf16 a[0:3], v[64:67], v[96:99], a[0:3]
    v_perm_b32 v88, v39, v35, s44
    ds_read_b128 v[132:135], v221 offset:512
    v_mfma_f32_16x16x32_bf16 a[32:35], v[64:67], v[100:103], a[32:35]
    v_perm_b32 v92, v39, v35, s45
    ds_read_b128 v[136:139], v221 offset:2560
    v_mfma_f32_16x16x32_bf16 a[64:67], v[64:67], v[104:107], a[64:67]
    v_perm_b32 v89, v47, v43, s44
    ds_read_b128 v[140:143], v221 offset:4608
    v_mfma_f32_16x16x32_bf16 a[96:99], v[64:67], v[108:111], a[96:99]
    v_perm_b32 v93, v47, v43, s45
    ds_read_b128 v[144:147], v221 offset:6656
    v_mfma_f32_16x16x32_bf16 a[128:131], v[64:67], v[112:115], a[128:131]
    v_perm_b32 v90, v55, v51, s44
    ds_read_b128 v[148:151], v221 offset:8704
    v_mfma_f32_16x16x32_bf16 a[160:163], v[64:67], v[116:119], a[160:163]
    v_perm_b32 v94, v55, v51, s45
    ds_read_b128 v[152:155], v221 offset:10752
    v_mfma_f32_16x16x32_bf16 a[192:195], v[64:67], v[120:123], a[192:195]
    v_perm_b32 v91, v63, v59, s44
    ds_read_b128 v[156:159], v221 offset:12800
    v_mfma_f32_16x16x32_bf16 a[224:227], v[64:67], v[124:127], a[224:227]
    v_perm_b32 v95, v63, v59, s45
    ds_read_b128 v[160:163], v221 offset:14848
    v_mfma_f32_16x16x32_bf16 v[224:227], v[64:67], v[128:131], v[224:227]
    ds_read_b128 v[164:167], v221 offset:16896
    buffer_load_dwordx4 v[32:35], v220, s[12:15], s36 offen
    v_mfma_f32_16x16x32_bf16 a[4:7], v[68:71], v[96:99], a[4:7]
    v_add_u32 v221, 0x4800, v221
    buffer_load_dwordx4 v[36:39], v220, s[12:15], s37 offen
    v_mfma_f32_16x16x32_bf16 a[36:39], v[68:71], v[100:103], a[36:39]
    buffer_load_dwordx4 v[40:43], v220, s[12:15], s38 offen
    v_mfma_f32_16x16x32_bf16 a[68:71], v[68:71], v[104:107], a[68:71]
    buffer_load_dwordx4 v[44:47], v220, s[12:15], s39 offen
    v_mfma_f32_16x16x32_bf16 a[100:103], v[68:71], v[108:111], a[100:103]
    buffer_load_dwordx4 v[48:51], v220, s[12:15], s40 offen
    v_mfma_f32_16x16x32_bf16 a[132:135], v[68:71], v[112:115], a[132:135]
    buffer_load_dwordx4 v[52:55], v220, s[12:15], s41 offen
    v_mfma_f32_16x16x32_bf16 a[164:167], v[68:71], v[116:119], a[164:167]
    buffer_load_dwordx4 v[56:59], v220, s[12:15], s42 offen
    v_mfma_f32_16x16x32_bf16 a[196:199], v[68:71], v[120:123], a[196:199]
    buffer_load_dwordx4 v[60:63], v220, s[12:15], s43 offen
    v_mfma_f32_16x16x32_bf16 a[228:231], v[68:71], v[124:127], a[228:231]
    v_add_u32 v220, 0x40000, v220
    v_mfma_f32_16x16x32_bf16 v[228:231], v[68:71], v[128:131], v[228:231]
    s_waitcnt vmcnt(16)
    v_mfma_f32_16x16x32_bf16 a[8:11], v[72:75], v[96:99], a[8:11]
    v_perm_b32 v64, v172, v168, s44
    v_mfma_f32_16x16x32_bf16 a[40:43], v[72:75], v[100:103], a[40:43]
    v_perm_b32 v68, v172, v168, s45
    v_mfma_f32_16x16x32_bf16 a[72:75], v[72:75], v[104:107], a[72:75]
    v_perm_b32 v65, v180, v176, s44
    v_mfma_f32_16x16x32_bf16 a[104:107], v[72:75], v[108:111], a[104:107]
    v_perm_b32 v69, v180, v176, s45
    v_mfma_f32_16x16x32_bf16 a[136:139], v[72:75], v[112:115], a[136:139]
    v_perm_b32 v66, v188, v184, s44
    v_mfma_f32_16x16x32_bf16 a[168:171], v[72:75], v[116:119], a[168:171]
    v_perm_b32 v70, v188, v184, s45
    v_mfma_f32_16x16x32_bf16 a[200:203], v[72:75], v[120:123], a[200:203]
    v_perm_b32 v67, v196, v192, s44
    v_mfma_f32_16x16x32_bf16 a[232:235], v[72:75], v[124:127], a[232:235]
    v_perm_b32 v71, v196, v192, s45
    v_mfma_f32_16x16x32_bf16 v[232:235], v[72:75], v[128:131], v[232:235]
    v_mfma_f32_16x16x32_bf16 a[12:15], v[76:79], v[96:99], a[12:15]
    v_mfma_f32_16x16x32_bf16 a[44:47], v[76:79], v[100:103], a[44:47]
    v_mfma_f32_16x16x32_bf16 a[76:79], v[76:79], v[104:107], a[76:79]
    v_mfma_f32_16x16x32_bf16 a[108:111], v[76:79], v[108:111], a[108:111]
    v_mfma_f32_16x16x32_bf16 a[140:143], v[76:79], v[112:115], a[140:143]
    v_mfma_f32_16x16x32_bf16 a[172:175], v[76:79], v[116:119], a[172:175]
    v_mfma_f32_16x16x32_bf16 a[204:207], v[76:79], v[120:123], a[204:207]
    v_mfma_f32_16x16x32_bf16 a[236:239], v[76:79], v[124:127], a[236:239]
    v_mfma_f32_16x16x32_bf16 v[236:239], v[76:79], v[128:131], v[236:239]
    v_mfma_f32_16x16x32_bf16 a[16:19], v[80:83], v[96:99], a[16:19]
    v_perm_b32 v72, v173, v169, s44
    v_mfma_f32_16x16x32_bf16 a[48:51], v[80:83], v[100:103], a[48:51]
    v_perm_b32 v76, v173, v169, s45
    v_mfma_f32_16x16x32_bf16 a[80:83], v[80:83], v[104:107], a[80:83]
    v_perm_b32 v73, v181, v177, s44
    v_mfma_f32_16x16x32_bf16 a[112:115], v[80:83], v[108:111], a[112:115]
    v_perm_b32 v77, v181, v177, s45
    v_mfma_f32_16x16x32_bf16 a[144:147], v[80:83], v[112:115], a[144:147]
    v_perm_b32 v74, v189, v185, s44
    v_mfma_f32_16x16x32_bf16 a[176:179], v[80:83], v[116:119], a[176:179]
    v_perm_b32 v78, v189, v185, s45
    v_mfma_f32_16x16x32_bf16 a[208:211], v[80:83], v[120:123], a[208:211]
    v_perm_b32 v75, v197, v193, s44
    v_mfma_f32_16x16x32_bf16 a[240:243], v[80:83], v[124:127], a[240:243]
    v_perm_b32 v79, v197, v193, s45
    v_mfma_f32_16x16x32_bf16 v[240:243], v[80:83], v[128:131], v[240:243]
    v_mfma_f32_16x16x32_bf16 a[20:23], v[84:87], v[96:99], a[20:23]
    v_mfma_f32_16x16x32_bf16 a[52:55], v[84:87], v[100:103], a[52:55]
    v_mfma_f32_16x16x32_bf16 a[84:87], v[84:87], v[104:107], a[84:87]
    v_mfma_f32_16x16x32_bf16 a[116:119], v[84:87], v[108:111], a[116:119]
    v_mfma_f32_16x16x32_bf16 a[148:151], v[84:87], v[112:115], a[148:151]
    v_mfma_f32_16x16x32_bf16 a[180:183], v[84:87], v[116:119], a[180:183]
    v_mfma_f32_16x16x32_bf16 a[212:215], v[84:87], v[120:123], a[212:215]
    v_mfma_f32_16x16x32_bf16 a[244:247], v[84:87], v[124:127], a[244:247]
    v_mfma_f32_16x16x32_bf16 v[244:247], v[84:87], v[128:131], v[244:247]
    v_mfma_f32_16x16x32_bf16 a[24:27], v[88:91], v[96:99], a[24:27]
    v_perm_b32 v80, v174, v170, s44
    v_mfma_f32_16x16x32_bf16 a[56:59], v[88:91], v[100:103], a[56:59]
    v_perm_b32 v84, v174, v170, s45
    v_mfma_f32_16x16x32_bf16 a[88:91], v[88:91], v[104:107], a[88:91]
    v_perm_b32 v81, v182, v178, s44
    v_mfma_f32_16x16x32_bf16 a[120:123], v[88:91], v[108:111], a[120:123]
    v_perm_b32 v85, v182, v178, s45
    v_mfma_f32_16x16x32_bf16 a[152:155], v[88:91], v[112:115], a[152:155]
    v_perm_b32 v82, v190, v186, s44
    v_mfma_f32_16x16x32_bf16 a[184:187], v[88:91], v[116:119], a[184:187]
    v_perm_b32 v86, v190, v186, s45
    v_mfma_f32_16x16x32_bf16 a[216:219], v[88:91], v[120:123], a[216:219]
    v_perm_b32 v83, v198, v194, s44
    v_mfma_f32_16x16x32_bf16 a[248:251], v[88:91], v[124:127], a[248:251]
    v_perm_b32 v87, v198, v194, s45
    v_mfma_f32_16x16x32_bf16 v[248:251], v[88:91], v[128:131], v[248:251]
    v_mfma_f32_16x16x32_bf16 a[28:31], v[92:95], v[96:99], a[28:31]
    v_mfma_f32_16x16x32_bf16 a[60:63], v[92:95], v[100:103], a[60:63]
    v_mfma_f32_16x16x32_bf16 a[92:95], v[92:95], v[104:107], a[92:95]
    v_mfma_f32_16x16x32_bf16 a[124:127], v[92:95], v[108:111], a[124:127]
    v_mfma_f32_16x16x32_bf16 a[156:159], v[92:95], v[112:115], a[156:159]
    v_mfma_f32_16x16x32_bf16 a[188:191], v[92:95], v[116:119], a[188:191]
    v_mfma_f32_16x16x32_bf16 a[220:223], v[92:95], v[120:123], a[220:223]
    v_mfma_f32_16x16x32_bf16 a[252:255], v[92:95], v[124:127], a[252:255]
    v_mfma_f32_16x16x32_bf16 v[252:255], v[92:95], v[128:131], v[252:255]
    s_waitcnt lgkmcnt(0)
    v_mfma_f32_16x16x32_bf16 a[0:3], v[64:67], v[132:135], a[0:3]
    v_perm_b32 v88, v175, v171, s44
    ds_read_b128 v[96:99], v221 offset:0
    v_mfma_f32_16x16x32_bf16 a[32:35], v[64:67], v[136:139], a[32:35]
    v_perm_b32 v92, v175, v171, s45
    ds_read_b128 v[100:103], v221 offset:2048
    v_mfma_f32_16x16x32_bf16 a[64:67], v[64:67], v[140:143], a[64:67]
    v_perm_b32 v89, v183, v179, s44
    ds_read_b128 v[104:107], v221 offset:4096
    v_mfma_f32_16x16x32_bf16 a[96:99], v[64:67], v[144:147], a[96:99]
    v_perm_b32 v93, v183, v179, s45
    ds_read_b128 v[108:111], v221 offset:6144
    v_mfma_f32_16x16x32_bf16 a[128:131], v[64:67], v[148:151], a[128:131]
    v_perm_b32 v90, v191, v187, s44
    ds_read_b128 v[112:115], v221 offset:8192
    v_mfma_f32_16x16x32_bf16 a[160:163], v[64:67], v[152:155], a[160:163]
    v_perm_b32 v94, v191, v187, s45
    ds_read_b128 v[116:119], v221 offset:10240
    v_mfma_f32_16x16x32_bf16 a[192:195], v[64:67], v[156:159], a[192:195]
    v_perm_b32 v91, v199, v195, s44
    ds_read_b128 v[120:123], v221 offset:12288
    v_mfma_f32_16x16x32_bf16 a[224:227], v[64:67], v[160:163], a[224:227]
    v_perm_b32 v95, v199, v195, s45
    ds_read_b128 v[124:127], v221 offset:14336
    v_mfma_f32_16x16x32_bf16 v[224:227], v[64:67], v[164:167], v[224:227]
    ds_read_b128 v[128:131], v221 offset:16384
    buffer_load_dwordx4 v[168:171], v220, s[12:15], s36 offen
    v_mfma_f32_16x16x32_bf16 a[4:7], v[68:71], v[132:135], a[4:7]
    buffer_load_dwordx4 v[172:175], v220, s[12:15], s37 offen
    v_mfma_f32_16x16x32_bf16 a[36:39], v[68:71], v[136:139], a[36:39]
    buffer_load_dwordx4 v[176:179], v220, s[12:15], s38 offen
    v_mfma_f32_16x16x32_bf16 a[68:71], v[68:71], v[140:143], a[68:71]
    buffer_load_dwordx4 v[180:183], v220, s[12:15], s39 offen
    v_mfma_f32_16x16x32_bf16 a[100:103], v[68:71], v[144:147], a[100:103]
    buffer_load_dwordx4 v[184:187], v220, s[12:15], s40 offen
    v_mfma_f32_16x16x32_bf16 a[132:135], v[68:71], v[148:151], a[132:135]
    buffer_load_dwordx4 v[188:191], v220, s[12:15], s41 offen
    v_mfma_f32_16x16x32_bf16 a[164:167], v[68:71], v[152:155], a[164:167]
    buffer_load_dwordx4 v[192:195], v220, s[12:15], s42 offen
    v_mfma_f32_16x16x32_bf16 a[196:199], v[68:71], v[156:159], a[196:199]
    buffer_load_dwordx4 v[196:199], v220, s[12:15], s43 offen
    v_mfma_f32_16x16x32_bf16 a[228:231], v[68:71], v[160:163], a[228:231]
    v_add_u32 v220, 0x40000, v220
    v_mfma_f32_16x16x32_bf16 v[228:231], v[68:71], v[164:167], v[228:231]
    s_waitcnt vmcnt(16)
    v_mfma_f32_16x16x32_bf16 a[8:11], v[72:75], v[132:135], a[8:11]
    v_perm_b32 v64, v4, v0, s44
    v_mfma_f32_16x16x32_bf16 a[40:43], v[72:75], v[136:139], a[40:43]
    v_perm_b32 v68, v4, v0, s45
    v_mfma_f32_16x16x32_bf16 a[72:75], v[72:75], v[140:143], a[72:75]
    v_perm_b32 v65, v12, v8, s44
    v_mfma_f32_16x16x32_bf16 a[104:107], v[72:75], v[144:147], a[104:107]
    v_perm_b32 v69, v12, v8, s45
    v_mfma_f32_16x16x32_bf16 a[136:139], v[72:75], v[148:151], a[136:139]
    v_perm_b32 v66, v20, v16, s44
    v_mfma_f32_16x16x32_bf16 a[168:171], v[72:75], v[152:155], a[168:171]
    v_perm_b32 v70, v20, v16, s45
    v_mfma_f32_16x16x32_bf16 a[200:203], v[72:75], v[156:159], a[200:203]
    v_perm_b32 v67, v28, v24, s44
    v_mfma_f32_16x16x32_bf16 a[232:235], v[72:75], v[160:163], a[232:235]
    v_perm_b32 v71, v28, v24, s45
    v_mfma_f32_16x16x32_bf16 v[232:235], v[72:75], v[164:167], v[232:235]
    v_mfma_f32_16x16x32_bf16 a[12:15], v[76:79], v[132:135], a[12:15]
    v_mfma_f32_16x16x32_bf16 a[44:47], v[76:79], v[136:139], a[44:47]
    v_mfma_f32_16x16x32_bf16 a[76:79], v[76:79], v[140:143], a[76:79]
    v_mfma_f32_16x16x32_bf16 a[108:111], v[76:79], v[144:147], a[108:111]
    v_mfma_f32_16x16x32_bf16 a[140:143], v[76:79], v[148:151], a[140:143]
    v_mfma_f32_16x16x32_bf16 a[172:175], v[76:79], v[152:155], a[172:175]
    v_mfma_f32_16x16x32_bf16 a[204:207], v[76:79], v[156:159], a[204:207]
    v_mfma_f32_16x16x32_bf16 a[236:239], v[76:79], v[160:163], a[236:239]
    v_mfma_f32_16x16x32_bf16 v[236:239], v[76:79], v[164:167], v[236:239]
    v_mfma_f32_16x16x32_bf16 a[16:19], v[80:83], v[132:135], a[16:19]
    v_perm_b32 v72, v5, v1, s44
    v_mfma_f32_16x16x32_bf16 a[48:51], v[80:83], v[136:139], a[48:51]
    v_perm_b32 v76, v5, v1, s45
    v_mfma_f32_16x16x32_bf16 a[80:83], v[80:83], v[140:143], a[80:83]
    v_perm_b32 v73, v13, v9, s44
    v_mfma_f32_16x16x32_bf16 a[112:115], v[80:83], v[144:147], a[112:115]
    v_perm_b32 v77, v13, v9, s45
    v_mfma_f32_16x16x32_bf16 a[144:147], v[80:83], v[148:151], a[144:147]
    v_perm_b32 v74, v21, v17, s44
    v_mfma_f32_16x16x32_bf16 a[176:179], v[80:83], v[152:155], a[176:179]
    v_perm_b32 v78, v21, v17, s45
    v_mfma_f32_16x16x32_bf16 a[208:211], v[80:83], v[156:159], a[208:211]
    v_perm_b32 v75, v29, v25, s44
    v_mfma_f32_16x16x32_bf16 a[240:243], v[80:83], v[160:163], a[240:243]
    v_perm_b32 v79, v29, v25, s45
    v_mfma_f32_16x16x32_bf16 v[240:243], v[80:83], v[164:167], v[240:243]
    v_mfma_f32_16x16x32_bf16 a[20:23], v[84:87], v[132:135], a[20:23]
    v_mfma_f32_16x16x32_bf16 a[52:55], v[84:87], v[136:139], a[52:55]
    v_mfma_f32_16x16x32_bf16 a[84:87], v[84:87], v[140:143], a[84:87]
    v_mfma_f32_16x16x32_bf16 a[116:119], v[84:87], v[144:147], a[116:119]
    v_mfma_f32_16x16x32_bf16 a[148:151], v[84:87], v[148:151], a[148:151]
    v_mfma_f32_16x16x32_bf16 a[180:183], v[84:87], v[152:155], a[180:183]
    v_mfma_f32_16x16x32_bf16 a[212:215], v[84:87], v[156:159], a[212:215]
    v_mfma_f32_16x16x32_bf16 a[244:247], v[84:87], v[160:163], a[244:247]
    v_mfma_f32_16x16x32_bf16 v[244:247], v[84:87], v[164:167], v[244:247]
    v_mfma_f32_16x16x32_bf16 a[24:27], v[88:91], v[132:135], a[24:27]
    v_perm_b32 v80, v6, v2, s44
    v_mfma_f32_16x16x32_bf16 a[56:59], v[88:91], v[136:139], a[56:59]
    v_perm_b32 v84, v6, v2, s45
    v_mfma_f32_16x16x32_bf16 a[88:91], v[88:91], v[140:143], a[88:91]
    v_perm_b32 v81, v14, v10, s44
    v_mfma_f32_16x16x32_bf16 a[120:123], v[88:91], v[144:147], a[120:123]
    v_perm_b32 v85, v14, v10, s45
    v_mfma_f32_16x16x32_bf16 a[152:155], v[88:91], v[148:151], a[152:155]
    v_perm_b32 v82, v22, v18, s44
    v_mfma_f32_16x16x32_bf16 a[184:187], v[88:91], v[152:155], a[184:187]
    v_perm_b32 v86, v22, v18, s45
    v_mfma_f32_16x16x32_bf16 a[216:219], v[88:91], v[156:159], a[216:219]
    v_perm_b32 v83, v30, v26, s44
    v_mfma_f32_16x16x32_bf16 a[248:251], v[88:91], v[160:163], a[248:251]
    v_perm_b32 v87, v30, v26, s45
    v_mfma_f32_16x16x32_bf16 v[248:251], v[88:91], v[164:167], v[248:251]
    v_mfma_f32_16x16x32_bf16 a[28:31], v[92:95], v[132:135], a[28:31]
    v_mfma_f32_16x16x32_bf16 a[60:63], v[92:95], v[136:139], a[60:63]
    v_mfma_f32_16x16x32_bf16 a[92:95], v[92:95], v[140:143], a[92:95]
    v_mfma_f32_16x16x32_bf16 a[124:127], v[92:95], v[144:147], a[124:127]
    v_mfma_f32_16x16x32_bf16 a[156:159], v[92:95], v[148:151], a[156:159]
    v_mfma_f32_16x16x32_bf16 a[188:191], v[92:95], v[152:155], a[188:191]
    v_mfma_f32_16x16x32_bf16 a[220:223], v[92:95], v[156:159], a[220:223]
    v_mfma_f32_16x16x32_bf16 a[252:255], v[92:95], v[160:163], a[252:255]
    v_mfma_f32_16x16x32_bf16 v[252:255], v[92:95], v[164:167], v[252:255]
    s_waitcnt lgkmcnt(0)
    v_mfma_f32_16x16x32_bf16 a[0:3], v[64:67], v[96:99], a[0:3]
    v_perm_b32 v88, v7, v3, s44
    ds_read_b128 v[132:135], v221 offset:512
    v_mfma_f32_16x16x32_bf16 a[32:35], v[64:67], v[100:103], a[32:35]
    v_perm_b32 v92, v7, v3, s45
    ds_read_b128 v[136:139], v221 offset:2560
    v_mfma_f32_16x16x32_bf16 a[64:67], v[64:67], v[104:107], a[64:67]
    v_perm_b32 v89, v15, v11, s44
    ds_read_b128 v[140:143], v221 offset:4608
    v_mfma_f32_16x16x32_bf16 a[96:99], v[64:67], v[108:111], a[96:99]
    v_perm_b32 v93, v15, v11, s45
    ds_read_b128 v[144:147], v221 offset:6656
    v_mfma_f32_16x16x32_bf16 a[128:131], v[64:67], v[112:115], a[128:131]
    v_perm_b32 v90, v23, v19, s44
    ds_read_b128 v[148:151], v221 offset:8704
    v_mfma_f32_16x16x32_bf16 a[160:163], v[64:67], v[116:119], a[160:163]
    v_perm_b32 v94, v23, v19, s45
    ds_read_b128 v[152:155], v221 offset:10752
    v_mfma_f32_16x16x32_bf16 a[192:195], v[64:67], v[120:123], a[192:195]
    v_perm_b32 v91, v31, v27, s44
    ds_read_b128 v[156:159], v221 offset:12800
    v_mfma_f32_16x16x32_bf16 a[224:227], v[64:67], v[124:127], a[224:227]
    v_perm_b32 v95, v31, v27, s45
    ds_read_b128 v[160:163], v221 offset:14848
    v_mfma_f32_16x16x32_bf16 v[224:227], v[64:67], v[128:131], v[224:227]
    ds_read_b128 v[164:167], v221 offset:16896
    buffer_load_dwordx4 v[0:3], v220, s[12:15], s36 offen
    v_mfma_f32_16x16x32_bf16 a[4:7], v[68:71], v[96:99], a[4:7]
    v_add_u32 v221, 0x4800, v221
    buffer_load_dwordx4 v[4:7], v220, s[12:15], s37 offen
    v_mfma_f32_16x16x32_bf16 a[36:39], v[68:71], v[100:103], a[36:39]
    buffer_load_dwordx4 v[8:11], v220, s[12:15], s38 offen
    v_mfma_f32_16x16x32_bf16 a[68:71], v[68:71], v[104:107], a[68:71]
    buffer_load_dwordx4 v[12:15], v220, s[12:15], s39 offen
    v_mfma_f32_16x16x32_bf16 a[100:103], v[68:71], v[108:111], a[100:103]
    buffer_load_dwordx4 v[16:19], v220, s[12:15], s40 offen
    v_mfma_f32_16x16x32_bf16 a[132:135], v[68:71], v[112:115], a[132:135]
    buffer_load_dwordx4 v[20:23], v220, s[12:15], s41 offen
    v_mfma_f32_16x16x32_bf16 a[164:167], v[68:71], v[116:119], a[164:167]
    buffer_load_dwordx4 v[24:27], v220, s[12:15], s42 offen
    v_mfma_f32_16x16x32_bf16 a[196:199], v[68:71], v[120:123], a[196:199]
    buffer_load_dwordx4 v[28:31], v220, s[12:15], s43 offen
    v_mfma_f32_16x16x32_bf16 a[228:231], v[68:71], v[124:127], a[228:231]
    v_add_u32 v220, 0x40000, v220
    v_mfma_f32_16x16x32_bf16 v[228:231], v[68:71], v[128:131], v[228:231]
    s_waitcnt vmcnt(16)
    v_mfma_f32_16x16x32_bf16 a[8:11], v[72:75], v[96:99], a[8:11]
    v_perm_b32 v64, v36, v32, s44
    v_mfma_f32_16x16x32_bf16 a[40:43], v[72:75], v[100:103], a[40:43]
    v_perm_b32 v68, v36, v32, s45
    v_mfma_f32_16x16x32_bf16 a[72:75], v[72:75], v[104:107], a[72:75]
    v_perm_b32 v65, v44, v40, s44
    v_mfma_f32_16x16x32_bf16 a[104:107], v[72:75], v[108:111], a[104:107]
    v_perm_b32 v69, v44, v40, s45
    v_mfma_f32_16x16x32_bf16 a[136:139], v[72:75], v[112:115], a[136:139]
    v_perm_b32 v66, v52, v48, s44
    v_mfma_f32_16x16x32_bf16 a[168:171], v[72:75], v[116:119], a[168:171]
    v_perm_b32 v70, v52, v48, s45
    v_mfma_f32_16x16x32_bf16 a[200:203], v[72:75], v[120:123], a[200:203]
    v_perm_b32 v67, v60, v56, s44
    v_mfma_f32_16x16x32_bf16 a[232:235], v[72:75], v[124:127], a[232:235]
    v_perm_b32 v71, v60, v56, s45
    v_mfma_f32_16x16x32_bf16 v[232:235], v[72:75], v[128:131], v[232:235]
    v_mfma_f32_16x16x32_bf16 a[12:15], v[76:79], v[96:99], a[12:15]
    v_mfma_f32_16x16x32_bf16 a[44:47], v[76:79], v[100:103], a[44:47]
    v_mfma_f32_16x16x32_bf16 a[76:79], v[76:79], v[104:107], a[76:79]
    v_mfma_f32_16x16x32_bf16 a[108:111], v[76:79], v[108:111], a[108:111]
    v_mfma_f32_16x16x32_bf16 a[140:143], v[76:79], v[112:115], a[140:143]
    v_mfma_f32_16x16x32_bf16 a[172:175], v[76:79], v[116:119], a[172:175]
    v_mfma_f32_16x16x32_bf16 a[204:207], v[76:79], v[120:123], a[204:207]
    v_mfma_f32_16x16x32_bf16 a[236:239], v[76:79], v[124:127], a[236:239]
    v_mfma_f32_16x16x32_bf16 v[236:239], v[76:79], v[128:131], v[236:239]
    v_mfma_f32_16x16x32_bf16 a[16:19], v[80:83], v[96:99], a[16:19]
    v_perm_b32 v72, v37, v33, s44
    v_mfma_f32_16x16x32_bf16 a[48:51], v[80:83], v[100:103], a[48:51]
    v_perm_b32 v76, v37, v33, s45
    v_mfma_f32_16x16x32_bf16 a[80:83], v[80:83], v[104:107], a[80:83]
    v_perm_b32 v73, v45, v41, s44
    v_mfma_f32_16x16x32_bf16 a[112:115], v[80:83], v[108:111], a[112:115]
    v_perm_b32 v77, v45, v41, s45
    v_mfma_f32_16x16x32_bf16 a[144:147], v[80:83], v[112:115], a[144:147]
    v_perm_b32 v74, v53, v49, s44
    v_mfma_f32_16x16x32_bf16 a[176:179], v[80:83], v[116:119], a[176:179]
    v_perm_b32 v78, v53, v49, s45
    v_mfma_f32_16x16x32_bf16 a[208:211], v[80:83], v[120:123], a[208:211]
    v_perm_b32 v75, v61, v57, s44
    v_mfma_f32_16x16x32_bf16 a[240:243], v[80:83], v[124:127], a[240:243]
    v_perm_b32 v79, v61, v57, s45
    v_mfma_f32_16x16x32_bf16 v[240:243], v[80:83], v[128:131], v[240:243]
    v_mfma_f32_16x16x32_bf16 a[20:23], v[84:87], v[96:99], a[20:23]
    v_mfma_f32_16x16x32_bf16 a[52:55], v[84:87], v[100:103], a[52:55]
    v_mfma_f32_16x16x32_bf16 a[84:87], v[84:87], v[104:107], a[84:87]
    v_mfma_f32_16x16x32_bf16 a[116:119], v[84:87], v[108:111], a[116:119]
    v_mfma_f32_16x16x32_bf16 a[148:151], v[84:87], v[112:115], a[148:151]
    v_mfma_f32_16x16x32_bf16 a[180:183], v[84:87], v[116:119], a[180:183]
    v_mfma_f32_16x16x32_bf16 a[212:215], v[84:87], v[120:123], a[212:215]
    v_mfma_f32_16x16x32_bf16 a[244:247], v[84:87], v[124:127], a[244:247]
    v_mfma_f32_16x16x32_bf16 v[244:247], v[84:87], v[128:131], v[244:247]
    v_mfma_f32_16x16x32_bf16 a[24:27], v[88:91], v[96:99], a[24:27]
    v_perm_b32 v80, v38, v34, s44
    v_mfma_f32_16x16x32_bf16 a[56:59], v[88:91], v[100:103], a[56:59]
    v_perm_b32 v84, v38, v34, s45
    v_mfma_f32_16x16x32_bf16 a[88:91], v[88:91], v[104:107], a[88:91]
    v_perm_b32 v81, v46, v42, s44
    v_mfma_f32_16x16x32_bf16 a[120:123], v[88:91], v[108:111], a[120:123]
    v_perm_b32 v85, v46, v42, s45
    v_mfma_f32_16x16x32_bf16 a[152:155], v[88:91], v[112:115], a[152:155]
    v_perm_b32 v82, v54, v50, s44
    v_mfma_f32_16x16x32_bf16 a[184:187], v[88:91], v[116:119], a[184:187]
    v_perm_b32 v86, v54, v50, s45
    v_mfma_f32_16x16x32_bf16 a[216:219], v[88:91], v[120:123], a[216:219]
    v_perm_b32 v83, v62, v58, s44
    v_mfma_f32_16x16x32_bf16 a[248:251], v[88:91], v[124:127], a[248:251]
    v_perm_b32 v87, v62, v58, s45
    v_mfma_f32_16x16x32_bf16 v[248:251], v[88:91], v[128:131], v[248:251]
    v_mfma_f32_16x16x32_bf16 a[28:31], v[92:95], v[96:99], a[28:31]
    v_mfma_f32_16x16x32_bf16 a[60:63], v[92:95], v[100:103], a[60:63]
    v_mfma_f32_16x16x32_bf16 a[92:95], v[92:95], v[104:107], a[92:95]
    v_mfma_f32_16x16x32_bf16 a[124:127], v[92:95], v[108:111], a[124:127]
    v_mfma_f32_16x16x32_bf16 a[156:159], v[92:95], v[112:115], a[156:159]
    v_mfma_f32_16x16x32_bf16 a[188:191], v[92:95], v[116:119], a[188:191]
    v_mfma_f32_16x16x32_bf16 a[220:223], v[92:95], v[120:123], a[220:223]
    v_mfma_f32_16x16x32_bf16 a[252:255], v[92:95], v[124:127], a[252:255]
    v_mfma_f32_16x16x32_bf16 v[252:255], v[92:95], v[128:131], v[252:255]
    s_waitcnt lgkmcnt(0)
    v_mfma_f32_16x16x32_bf16 a[0:3], v[64:67], v[132:135], a[0:3]
    v_perm_b32 v88, v39, v35, s44
    ds_read_b128 v[96:99], v221 offset:0
    v_mfma_f32_16x16x32_bf16 a[32:35], v[64:67], v[136:139], a[32:35]
    v_perm_b32 v92, v39, v35, s45
    ds_read_b128 v[100:103], v221 offset:2048
    v_mfma_f32_16x16x32_bf16 a[64:67], v[64:67], v[140:143], a[64:67]
    v_perm_b32 v89, v47, v43, s44
    ds_read_b128 v[104:107], v221 offset:4096
    v_mfma_f32_16x16x32_bf16 a[96:99], v[64:67], v[144:147], a[96:99]
    v_perm_b32 v93, v47, v43, s45
    ds_read_b128 v[108:111], v221 offset:6144
    v_mfma_f32_16x16x32_bf16 a[128:131], v[64:67], v[148:151], a[128:131]
    v_perm_b32 v90, v55, v51, s44
    ds_read_b128 v[112:115], v221 offset:8192
    v_mfma_f32_16x16x32_bf16 a[160:163], v[64:67], v[152:155], a[160:163]
    v_perm_b32 v94, v55, v51, s45
    ds_read_b128 v[116:119], v221 offset:10240
    v_mfma_f32_16x16x32_bf16 a[192:195], v[64:67], v[156:159], a[192:195]
    v_perm_b32 v91, v63, v59, s44
    ds_read_b128 v[120:123], v221 offset:12288
    v_mfma_f32_16x16x32_bf16 a[224:227], v[64:67], v[160:163], a[224:227]
    v_perm_b32 v95, v63, v59, s45
    ds_read_b128 v[124:127], v221 offset:14336
    v_mfma_f32_16x16x32_bf16 v[224:227], v[64:67], v[164:167], v[224:227]
    ds_read_b128 v[128:131], v221 offset:16384
    buffer_load_dwordx4 v[32:35], v220, s[12:15], s36 offen
    v_mfma_f32_16x16x32_bf16 a[4:7], v[68:71], v[132:135], a[4:7]
    buffer_load_dwordx4 v[36:39], v220, s[12:15], s37 offen
    v_mfma_f32_16x16x32_bf16 a[36:39], v[68:71], v[136:139], a[36:39]
    buffer_load_dwordx4 v[40:43], v220, s[12:15], s38 offen
    v_mfma_f32_16x16x32_bf16 a[68:71], v[68:71], v[140:143], a[68:71]
    buffer_load_dwordx4 v[44:47], v220, s[12:15], s39 offen
    v_mfma_f32_16x16x32_bf16 a[100:103], v[68:71], v[144:147], a[100:103]
    buffer_load_dwordx4 v[48:51], v220, s[12:15], s40 offen
    v_mfma_f32_16x16x32_bf16 a[132:135], v[68:71], v[148:151], a[132:135]
    buffer_load_dwordx4 v[52:55], v220, s[12:15], s41 offen
    v_mfma_f32_16x16x32_bf16 a[164:167], v[68:71], v[152:155], a[164:167]
    buffer_load_dwordx4 v[56:59], v220, s[12:15], s42 offen
    v_mfma_f32_16x16x32_bf16 a[196:199], v[68:71], v[156:159], a[196:199]
    buffer_load_dwordx4 v[60:63], v220, s[12:15], s43 offen
    v_mfma_f32_16x16x32_bf16 a[228:231], v[68:71], v[160:163], a[228:231]
    v_add_u32 v220, 0x40000, v220
    v_mfma_f32_16x16x32_bf16 v[228:231], v[68:71], v[164:167], v[228:231]
    s_waitcnt vmcnt(16)
    v_mfma_f32_16x16x32_bf16 a[8:11], v[72:75], v[132:135], a[8:11]
    v_perm_b32 v64, v172, v168, s44
    v_mfma_f32_16x16x32_bf16 a[40:43], v[72:75], v[136:139], a[40:43]
    v_perm_b32 v68, v172, v168, s45
    v_mfma_f32_16x16x32_bf16 a[72:75], v[72:75], v[140:143], a[72:75]
    v_perm_b32 v65, v180, v176, s44
    v_mfma_f32_16x16x32_bf16 a[104:107], v[72:75], v[144:147], a[104:107]
    v_perm_b32 v69, v180, v176, s45
    v_mfma_f32_16x16x32_bf16 a[136:139], v[72:75], v[148:151], a[136:139]
    v_perm_b32 v66, v188, v184, s44
    v_mfma_f32_16x16x32_bf16 a[168:171], v[72:75], v[152:155], a[168:171]
    v_perm_b32 v70, v188, v184, s45
    v_mfma_f32_16x16x32_bf16 a[200:203], v[72:75], v[156:159], a[200:203]
    v_perm_b32 v67, v196, v192, s44
    v_mfma_f32_16x16x32_bf16 a[232:235], v[72:75], v[160:163], a[232:235]
    v_perm_b32 v71, v196, v192, s45
    v_mfma_f32_16x16x32_bf16 v[232:235], v[72:75], v[164:167], v[232:235]
    v_mfma_f32_16x16x32_bf16 a[12:15], v[76:79], v[132:135], a[12:15]
    v_mfma_f32_16x16x32_bf16 a[44:47], v[76:79], v[136:139], a[44:47]
    v_mfma_f32_16x16x32_bf16 a[76:79], v[76:79], v[140:143], a[76:79]
    v_mfma_f32_16x16x32_bf16 a[108:111], v[76:79], v[144:147], a[108:111]
    v_mfma_f32_16x16x32_bf16 a[140:143], v[76:79], v[148:151], a[140:143]
    v_mfma_f32_16x16x32_bf16 a[172:175], v[76:79], v[152:155], a[172:175]
    v_mfma_f32_16x16x32_bf16 a[204:207], v[76:79], v[156:159], a[204:207]
    v_mfma_f32_16x16x32_bf16 a[236:239], v[76:79], v[160:163], a[236:239]
    v_mfma_f32_16x16x32_bf16 v[236:239], v[76:79], v[164:167], v[236:239]
    v_mfma_f32_16x16x32_bf16 a[16:19], v[80:83], v[132:135], a[16:19]
    v_perm_b32 v72, v173, v169, s44
    v_mfma_f32_16x16x32_bf16 a[48:51], v[80:83], v[136:139], a[48:51]
    v_perm_b32 v76, v173, v169, s45
    v_mfma_f32_16x16x32_bf16 a[80:83], v[80:83], v[140:143], a[80:83]
    v_perm_b32 v73, v181, v177, s44
    v_mfma_f32_16x16x32_bf16 a[112:115], v[80:83], v[144:147], a[112:115]
    v_perm_b32 v77, v181, v177, s45
    v_mfma_f32_16x16x32_bf16 a[144:147], v[80:83], v[148:151], a[144:147]
    v_perm_b32 v74, v189, v185, s44
    v_mfma_f32_16x16x32_bf16 a[176:179], v[80:83], v[152:155], a[176:179]
    v_perm_b32 v78, v189, v185, s45
    v_mfma_f32_16x16x32_bf16 a[208:211], v[80:83], v[156:159], a[208:211]
    v_perm_b32 v75, v197, v193, s44
    v_mfma_f32_16x16x32_bf16 a[240:243], v[80:83], v[160:163], a[240:243]
    v_perm_b32 v79, v197, v193, s45
    v_mfma_f32_16x16x32_bf16 v[240:243], v[80:83], v[164:167], v[240:243]
    v_mfma_f32_16x16x32_bf16 a[20:23], v[84:87], v[132:135], a[20:23]
    v_mfma_f32_16x16x32_bf16 a[52:55], v[84:87], v[136:139], a[52:55]
    v_mfma_f32_16x16x32_bf16 a[84:87], v[84:87], v[140:143], a[84:87]
    v_mfma_f32_16x16x32_bf16 a[116:119], v[84:87], v[144:147], a[116:119]
    v_mfma_f32_16x16x32_bf16 a[148:151], v[84:87], v[148:151], a[148:151]
    v_mfma_f32_16x16x32_bf16 a[180:183], v[84:87], v[152:155], a[180:183]
    v_mfma_f32_16x16x32_bf16 a[212:215], v[84:87], v[156:159], a[212:215]
    v_mfma_f32_16x16x32_bf16 a[244:247], v[84:87], v[160:163], a[244:247]
    v_mfma_f32_16x16x32_bf16 v[244:247], v[84:87], v[164:167], v[244:247]
    v_mfma_f32_16x16x32_bf16 a[24:27], v[88:91], v[132:135], a[24:27]
    v_perm_b32 v80, v174, v170, s44
    v_mfma_f32_16x16x32_bf16 a[56:59], v[88:91], v[136:139], a[56:59]
    v_perm_b32 v84, v174, v170, s45
    v_mfma_f32_16x16x32_bf16 a[88:91], v[88:91], v[140:143], a[88:91]
    v_perm_b32 v81, v182, v178, s44
    v_mfma_f32_16x16x32_bf16 a[120:123], v[88:91], v[144:147], a[120:123]
    v_perm_b32 v85, v182, v178, s45
    v_mfma_f32_16x16x32_bf16 a[152:155], v[88:91], v[148:151], a[152:155]
    v_perm_b32 v82, v190, v186, s44
    v_mfma_f32_16x16x32_bf16 a[184:187], v[88:91], v[152:155], a[184:187]
    v_perm_b32 v86, v190, v186, s45
    v_mfma_f32_16x16x32_bf16 a[216:219], v[88:91], v[156:159], a[216:219]
    v_perm_b32 v83, v198, v194, s44
    v_mfma_f32_16x16x32_bf16 a[248:251], v[88:91], v[160:163], a[248:251]
    v_perm_b32 v87, v198, v194, s45
    v_mfma_f32_16x16x32_bf16 v[248:251], v[88:91], v[164:167], v[248:251]
    v_mfma_f32_16x16x32_bf16 a[28:31], v[92:95], v[132:135], a[28:31]
    v_mfma_f32_16x16x32_bf16 a[60:63], v[92:95], v[136:139], a[60:63]
    v_mfma_f32_16x16x32_bf16 a[92:95], v[92:95], v[140:143], a[92:95]
    v_mfma_f32_16x16x32_bf16 a[124:127], v[92:95], v[144:147], a[124:127]
    v_mfma_f32_16x16x32_bf16 a[156:159], v[92:95], v[148:151], a[156:159]
    v_mfma_f32_16x16x32_bf16 a[188:191], v[92:95], v[152:155], a[188:191]
    v_mfma_f32_16x16x32_bf16 a[220:223], v[92:95], v[156:159], a[220:223]
    v_mfma_f32_16x16x32_bf16 a[252:255], v[92:95], v[160:163], a[252:255]
    v_mfma_f32_16x16x32_bf16 v[252:255], v[92:95], v[164:167], v[252:255]
    s_waitcnt lgkmcnt(0)
    v_mfma_f32_16x16x32_bf16 a[0:3], v[64:67], v[96:99], a[0:3]
    v_perm_b32 v88, v175, v171, s44
    ds_read_b128 v[132:135], v221 offset:512
    v_mfma_f32_16x16x32_bf16 a[32:35], v[64:67], v[100:103], a[32:35]
    v_perm_b32 v92, v175, v171, s45
    ds_read_b128 v[136:139], v221 offset:2560
    v_mfma_f32_16x16x32_bf16 a[64:67], v[64:67], v[104:107], a[64:67]
    v_perm_b32 v89, v183, v179, s44
    ds_read_b128 v[140:143], v221 offset:4608
    v_mfma_f32_16x16x32_bf16 a[96:99], v[64:67], v[108:111], a[96:99]
    v_perm_b32 v93, v183, v179, s45
    ds_read_b128 v[144:147], v221 offset:6656
    v_mfma_f32_16x16x32_bf16 a[128:131], v[64:67], v[112:115], a[128:131]
    v_perm_b32 v90, v191, v187, s44
    ds_read_b128 v[148:151], v221 offset:8704
    v_mfma_f32_16x16x32_bf16 a[160:163], v[64:67], v[116:119], a[160:163]
    v_perm_b32 v94, v191, v187, s45
    ds_read_b128 v[152:155], v221 offset:10752
    v_mfma_f32_16x16x32_bf16 a[192:195], v[64:67], v[120:123], a[192:195]
    v_perm_b32 v91, v199, v195, s44
    ds_read_b128 v[156:159], v221 offset:12800
    v_mfma_f32_16x16x32_bf16 a[224:227], v[64:67], v[124:127], a[224:227]
    v_perm_b32 v95, v199, v195, s45
    ds_read_b128 v[160:163], v221 offset:14848
    v_mfma_f32_16x16x32_bf16 v[224:227], v[64:67], v[128:131], v[224:227]
    ds_read_b128 v[164:167], v221 offset:16896
    buffer_load_dwordx4 v[168:171], v220, s[12:15], s36 offen
    v_mfma_f32_16x16x32_bf16 a[4:7], v[68:71], v[96:99], a[4:7]
    v_add_u32 v221, 0x4800, v221
    buffer_load_dwordx4 v[172:175], v220, s[12:15], s37 offen
    v_mfma_f32_16x16x32_bf16 a[36:39], v[68:71], v[100:103], a[36:39]
    buffer_load_dwordx4 v[176:179], v220, s[12:15], s38 offen
    v_mfma_f32_16x16x32_bf16 a[68:71], v[68:71], v[104:107], a[68:71]
    buffer_load_dwordx4 v[180:183], v220, s[12:15], s39 offen
    v_mfma_f32_16x16x32_bf16 a[100:103], v[68:71], v[108:111], a[100:103]
    buffer_load_dwordx4 v[184:187], v220, s[12:15], s40 offen
    v_mfma_f32_16x16x32_bf16 a[132:135], v[68:71], v[112:115], a[132:135]
    buffer_load_dwordx4 v[188:191], v220, s[12:15], s41 offen
    v_mfma_f32_16x16x32_bf16 a[164:167], v[68:71], v[116:119], a[164:167]
    buffer_load_dwordx4 v[192:195], v220, s[12:15], s42 offen
    v_mfma_f32_16x16x32_bf16 a[196:199], v[68:71], v[120:123], a[196:199]
    buffer_load_dwordx4 v[196:199], v220, s[12:15], s43 offen
    v_mfma_f32_16x16x32_bf16 a[228:231], v[68:71], v[124:127], a[228:231]
    v_add_u32 v220, 0x40000, v220
    v_mfma_f32_16x16x32_bf16 v[228:231], v[68:71], v[128:131], v[228:231]
    s_waitcnt vmcnt(16)
    v_mfma_f32_16x16x32_bf16 a[8:11], v[72:75], v[96:99], a[8:11]
    v_perm_b32 v64, v4, v0, s44
    v_mfma_f32_16x16x32_bf16 a[40:43], v[72:75], v[100:103], a[40:43]
    v_perm_b32 v68, v4, v0, s45
    v_mfma_f32_16x16x32_bf16 a[72:75], v[72:75], v[104:107], a[72:75]
    v_perm_b32 v65, v12, v8, s44
    v_mfma_f32_16x16x32_bf16 a[104:107], v[72:75], v[108:111], a[104:107]
    v_perm_b32 v69, v12, v8, s45
    v_mfma_f32_16x16x32_bf16 a[136:139], v[72:75], v[112:115], a[136:139]
    v_perm_b32 v66, v20, v16, s44
    v_mfma_f32_16x16x32_bf16 a[168:171], v[72:75], v[116:119], a[168:171]
    v_perm_b32 v70, v20, v16, s45
    v_mfma_f32_16x16x32_bf16 a[200:203], v[72:75], v[120:123], a[200:203]
    v_perm_b32 v67, v28, v24, s44
    v_mfma_f32_16x16x32_bf16 a[232:235], v[72:75], v[124:127], a[232:235]
    v_perm_b32 v71, v28, v24, s45
    v_mfma_f32_16x16x32_bf16 v[232:235], v[72:75], v[128:131], v[232:235]
    v_mfma_f32_16x16x32_bf16 a[12:15], v[76:79], v[96:99], a[12:15]
    v_mfma_f32_16x16x32_bf16 a[44:47], v[76:79], v[100:103], a[44:47]
    v_mfma_f32_16x16x32_bf16 a[76:79], v[76:79], v[104:107], a[76:79]
    v_mfma_f32_16x16x32_bf16 a[108:111], v[76:79], v[108:111], a[108:111]
    v_mfma_f32_16x16x32_bf16 a[140:143], v[76:79], v[112:115], a[140:143]
    v_mfma_f32_16x16x32_bf16 a[172:175], v[76:79], v[116:119], a[172:175]
    v_mfma_f32_16x16x32_bf16 a[204:207], v[76:79], v[120:123], a[204:207]
    v_mfma_f32_16x16x32_bf16 a[236:239], v[76:79], v[124:127], a[236:239]
    v_mfma_f32_16x16x32_bf16 v[236:239], v[76:79], v[128:131], v[236:239]
    v_mfma_f32_16x16x32_bf16 a[16:19], v[80:83], v[96:99], a[16:19]
    v_perm_b32 v72, v5, v1, s44
    v_mfma_f32_16x16x32_bf16 a[48:51], v[80:83], v[100:103], a[48:51]
    v_perm_b32 v76, v5, v1, s45
    v_mfma_f32_16x16x32_bf16 a[80:83], v[80:83], v[104:107], a[80:83]
    v_perm_b32 v73, v13, v9, s44
    v_mfma_f32_16x16x32_bf16 a[112:115], v[80:83], v[108:111], a[112:115]
    v_perm_b32 v77, v13, v9, s45
    v_mfma_f32_16x16x32_bf16 a[144:147], v[80:83], v[112:115], a[144:147]
    v_perm_b32 v74, v21, v17, s44
    v_mfma_f32_16x16x32_bf16 a[176:179], v[80:83], v[116:119], a[176:179]
    v_perm_b32 v78, v21, v17, s45
    v_mfma_f32_16x16x32_bf16 a[208:211], v[80:83], v[120:123], a[208:211]
    v_perm_b32 v75, v29, v25, s44
    v_mfma_f32_16x16x32_bf16 a[240:243], v[80:83], v[124:127], a[240:243]
    v_perm_b32 v79, v29, v25, s45
    v_mfma_f32_16x16x32_bf16 v[240:243], v[80:83], v[128:131], v[240:243]
    v_mfma_f32_16x16x32_bf16 a[20:23], v[84:87], v[96:99], a[20:23]
    v_mfma_f32_16x16x32_bf16 a[52:55], v[84:87], v[100:103], a[52:55]
    v_mfma_f32_16x16x32_bf16 a[84:87], v[84:87], v[104:107], a[84:87]
    v_mfma_f32_16x16x32_bf16 a[116:119], v[84:87], v[108:111], a[116:119]
    v_mfma_f32_16x16x32_bf16 a[148:151], v[84:87], v[112:115], a[148:151]
    v_mfma_f32_16x16x32_bf16 a[180:183], v[84:87], v[116:119], a[180:183]
    v_mfma_f32_16x16x32_bf16 a[212:215], v[84:87], v[120:123], a[212:215]
    v_mfma_f32_16x16x32_bf16 a[244:247], v[84:87], v[124:127], a[244:247]
    v_mfma_f32_16x16x32_bf16 v[244:247], v[84:87], v[128:131], v[244:247]
    v_mfma_f32_16x16x32_bf16 a[24:27], v[88:91], v[96:99], a[24:27]
    v_perm_b32 v80, v6, v2, s44
    v_mfma_f32_16x16x32_bf16 a[56:59], v[88:91], v[100:103], a[56:59]
    v_perm_b32 v84, v6, v2, s45
    v_mfma_f32_16x16x32_bf16 a[88:91], v[88:91], v[104:107], a[88:91]
    v_perm_b32 v81, v14, v10, s44
    v_mfma_f32_16x16x32_bf16 a[120:123], v[88:91], v[108:111], a[120:123]
    v_perm_b32 v85, v14, v10, s45
    v_mfma_f32_16x16x32_bf16 a[152:155], v[88:91], v[112:115], a[152:155]
    v_perm_b32 v82, v22, v18, s44
    v_mfma_f32_16x16x32_bf16 a[184:187], v[88:91], v[116:119], a[184:187]
    v_perm_b32 v86, v22, v18, s45
    v_mfma_f32_16x16x32_bf16 a[216:219], v[88:91], v[120:123], a[216:219]
    v_perm_b32 v83, v30, v26, s44
    v_mfma_f32_16x16x32_bf16 a[248:251], v[88:91], v[124:127], a[248:251]
    v_perm_b32 v87, v30, v26, s45
    v_mfma_f32_16x16x32_bf16 v[248:251], v[88:91], v[128:131], v[248:251]
    v_mfma_f32_16x16x32_bf16 a[28:31], v[92:95], v[96:99], a[28:31]
    v_mfma_f32_16x16x32_bf16 a[60:63], v[92:95], v[100:103], a[60:63]
    v_mfma_f32_16x16x32_bf16 a[92:95], v[92:95], v[104:107], a[92:95]
    v_mfma_f32_16x16x32_bf16 a[124:127], v[92:95], v[108:111], a[124:127]
    v_mfma_f32_16x16x32_bf16 a[156:159], v[92:95], v[112:115], a[156:159]
    v_mfma_f32_16x16x32_bf16 a[188:191], v[92:95], v[116:119], a[188:191]
    v_mfma_f32_16x16x32_bf16 a[220:223], v[92:95], v[120:123], a[220:223]
    v_mfma_f32_16x16x32_bf16 a[252:255], v[92:95], v[124:127], a[252:255]
    v_mfma_f32_16x16x32_bf16 v[252:255], v[92:95], v[128:131], v[252:255]
    s_waitcnt lgkmcnt(0)
    v_mfma_f32_16x16x32_bf16 a[0:3], v[64:67], v[132:135], a[0:3]
    v_perm_b32 v88, v7, v3, s44
    ds_read_b128 v[96:99], v221 offset:0
    v_mfma_f32_16x16x32_bf16 a[32:35], v[64:67], v[136:139], a[32:35]
    v_perm_b32 v92, v7, v3, s45
    ds_read_b128 v[100:103], v221 offset:2048
    v_mfma_f32_16x16x32_bf16 a[64:67], v[64:67], v[140:143], a[64:67]
    v_perm_b32 v89, v15, v11, s44
    ds_read_b128 v[104:107], v221 offset:4096
    v_mfma_f32_16x16x32_bf16 a[96:99], v[64:67], v[144:147], a[96:99]
    v_perm_b32 v93, v15, v11, s45
    ds_read_b128 v[108:111], v221 offset:6144
    v_mfma_f32_16x16x32_bf16 a[128:131], v[64:67], v[148:151], a[128:131]
    v_perm_b32 v90, v23, v19, s44
    ds_read_b128 v[112:115], v221 offset:8192
    v_mfma_f32_16x16x32_bf16 a[160:163], v[64:67], v[152:155], a[160:163]
    v_perm_b32 v94, v23, v19, s45
    ds_read_b128 v[116:119], v221 offset:10240
    v_mfma_f32_16x16x32_bf16 a[192:195], v[64:67], v[156:159], a[192:195]
    v_perm_b32 v91, v31, v27, s44
    ds_read_b128 v[120:123], v221 offset:12288
    v_mfma_f32_16x16x32_bf16 a[224:227], v[64:67], v[160:163], a[224:227]
    v_perm_b32 v95, v31, v27, s45
    ds_read_b128 v[124:127], v221 offset:14336
    v_mfma_f32_16x16x32_bf16 v[224:227], v[64:67], v[164:167], v[224:227]
    ds_read_b128 v[128:131], v221 offset:16384
    buffer_load_dwordx4 v[0:3], v220, s[12:15], s36 offen
    v_mfma_f32_16x16x32_bf16 a[4:7], v[68:71], v[132:135], a[4:7]
    buffer_load_dwordx4 v[4:7], v220, s[12:15], s37 offen
    v_mfma_f32_16x16x32_bf16 a[36:39], v[68:71], v[136:139], a[36:39]
    buffer_load_dwordx4 v[8:11], v220, s[12:15], s38 offen
    v_mfma_f32_16x16x32_bf16 a[68:71], v[68:71], v[140:143], a[68:71]
    buffer_load_dwordx4 v[12:15], v220, s[12:15], s39 offen
    v_mfma_f32_16x16x32_bf16 a[100:103], v[68:71], v[144:147], a[100:103]
    buffer_load_dwordx4 v[16:19], v220, s[12:15], s40 offen
    v_mfma_f32_16x16x32_bf16 a[132:135], v[68:71], v[148:151], a[132:135]
    buffer_load_dwordx4 v[20:23], v220, s[12:15], s41 offen
    v_mfma_f32_16x16x32_bf16 a[164:167], v[68:71], v[152:155], a[164:167]
    buffer_load_dwordx4 v[24:27], v220, s[12:15], s42 offen
    v_mfma_f32_16x16x32_bf16 a[196:199], v[68:71], v[156:159], a[196:199]
    buffer_load_dwordx4 v[28:31], v220, s[12:15], s43 offen
    v_mfma_f32_16x16x32_bf16 a[228:231], v[68:71], v[160:163], a[228:231]
    v_add_u32 v220, 0x40000, v220
    v_mfma_f32_16x16x32_bf16 v[228:231], v[68:71], v[164:167], v[228:231]
    s_waitcnt vmcnt(16)
    v_mfma_f32_16x16x32_bf16 a[8:11], v[72:75], v[132:135], a[8:11]
    v_perm_b32 v64, v36, v32, s44
    v_mfma_f32_16x16x32_bf16 a[40:43], v[72:75], v[136:139], a[40:43]
    v_perm_b32 v68, v36, v32, s45
    v_mfma_f32_16x16x32_bf16 a[72:75], v[72:75], v[140:143], a[72:75]
    v_perm_b32 v65, v44, v40, s44
    v_mfma_f32_16x16x32_bf16 a[104:107], v[72:75], v[144:147], a[104:107]
    v_perm_b32 v69, v44, v40, s45
    v_mfma_f32_16x16x32_bf16 a[136:139], v[72:75], v[148:151], a[136:139]
    v_perm_b32 v66, v52, v48, s44
    v_mfma_f32_16x16x32_bf16 a[168:171], v[72:75], v[152:155], a[168:171]
    v_perm_b32 v70, v52, v48, s45
    v_mfma_f32_16x16x32_bf16 a[200:203], v[72:75], v[156:159], a[200:203]
    v_perm_b32 v67, v60, v56, s44
    v_mfma_f32_16x16x32_bf16 a[232:235], v[72:75], v[160:163], a[232:235]
    v_perm_b32 v71, v60, v56, s45
    v_mfma_f32_16x16x32_bf16 v[232:235], v[72:75], v[164:167], v[232:235]
    v_mfma_f32_16x16x32_bf16 a[12:15], v[76:79], v[132:135], a[12:15]
    v_mfma_f32_16x16x32_bf16 a[44:47], v[76:79], v[136:139], a[44:47]
    v_mfma_f32_16x16x32_bf16 a[76:79], v[76:79], v[140:143], a[76:79]
    v_mfma_f32_16x16x32_bf16 a[108:111], v[76:79], v[144:147], a[108:111]
    v_mfma_f32_16x16x32_bf16 a[140:143], v[76:79], v[148:151], a[140:143]
    v_mfma_f32_16x16x32_bf16 a[172:175], v[76:79], v[152:155], a[172:175]
    v_mfma_f32_16x16x32_bf16 a[204:207], v[76:79], v[156:159], a[204:207]
    v_mfma_f32_16x16x32_bf16 a[236:239], v[76:79], v[160:163], a[236:239]
    v_mfma_f32_16x16x32_bf16 v[236:239], v[76:79], v[164:167], v[236:239]
    v_mfma_f32_16x16x32_bf16 a[16:19], v[80:83], v[132:135], a[16:19]
    v_perm_b32 v72, v37, v33, s44
    v_mfma_f32_16x16x32_bf16 a[48:51], v[80:83], v[136:139], a[48:51]
    v_perm_b32 v76, v37, v33, s45
    v_mfma_f32_16x16x32_bf16 a[80:83], v[80:83], v[140:143], a[80:83]
    v_perm_b32 v73, v45, v41, s44
    v_mfma_f32_16x16x32_bf16 a[112:115], v[80:83], v[144:147], a[112:115]
    v_perm_b32 v77, v45, v41, s45
    v_mfma_f32_16x16x32_bf16 a[144:147], v[80:83], v[148:151], a[144:147]
    v_perm_b32 v74, v53, v49, s44
    v_mfma_f32_16x16x32_bf16 a[176:179], v[80:83], v[152:155], a[176:179]
    v_perm_b32 v78, v53, v49, s45
    v_mfma_f32_16x16x32_bf16 a[208:211], v[80:83], v[156:159], a[208:211]
    v_perm_b32 v75, v61, v57, s44
    v_mfma_f32_16x16x32_bf16 a[240:243], v[80:83], v[160:163], a[240:243]
    v_perm_b32 v79, v61, v57, s45
    v_mfma_f32_16x16x32_bf16 v[240:243], v[80:83], v[164:167], v[240:243]
    v_mfma_f32_16x16x32_bf16 a[20:23], v[84:87], v[132:135], a[20:23]
    v_mfma_f32_16x16x32_bf16 a[52:55], v[84:87], v[136:139], a[52:55]
    v_mfma_f32_16x16x32_bf16 a[84:87], v[84:87], v[140:143], a[84:87]
    v_mfma_f32_16x16x32_bf16 a[116:119], v[84:87], v[144:147], a[116:119]
    v_mfma_f32_16x16x32_bf16 a[148:151], v[84:87], v[148:151], a[148:151]
    v_mfma_f32_16x16x32_bf16 a[180:183], v[84:87], v[152:155], a[180:183]
    v_mfma_f32_16x16x32_bf16 a[212:215], v[84:87], v[156:159], a[212:215]
    v_mfma_f32_16x16x32_bf16 a[244:247], v[84:87], v[160:163], a[244:247]
    v_mfma_f32_16x16x32_bf16 v[244:247], v[84:87], v[164:167], v[244:247]
    v_mfma_f32_16x16x32_bf16 a[24:27], v[88:91], v[132:135], a[24:27]
    v_perm_b32 v80, v38, v34, s44
    v_mfma_f32_16x16x32_bf16 a[56:59], v[88:91], v[136:139], a[56:59]
    v_perm_b32 v84, v38, v34, s45
    v_mfma_f32_16x16x32_bf16 a[88:91], v[88:91], v[140:143], a[88:91]
    v_perm_b32 v81, v46, v42, s44
    v_mfma_f32_16x16x32_bf16 a[120:123], v[88:91], v[144:147], a[120:123]
    v_perm_b32 v85, v46, v42, s45
    v_mfma_f32_16x16x32_bf16 a[152:155], v[88:91], v[148:151], a[152:155]
    v_perm_b32 v82, v54, v50, s44
    v_mfma_f32_16x16x32_bf16 a[184:187], v[88:91], v[152:155], a[184:187]
    v_perm_b32 v86, v54, v50, s45
    v_mfma_f32_16x16x32_bf16 a[216:219], v[88:91], v[156:159], a[216:219]
    v_perm_b32 v83, v62, v58, s44
    v_mfma_f32_16x16x32_bf16 a[248:251], v[88:91], v[160:163], a[248:251]
    v_perm_b32 v87, v62, v58, s45
    v_mfma_f32_16x16x32_bf16 v[248:251], v[88:91], v[164:167], v[248:251]
    v_mfma_f32_16x16x32_bf16 a[28:31], v[92:95], v[132:135], a[28:31]
    v_mfma_f32_16x16x32_bf16 a[60:63], v[92:95], v[136:139], a[60:63]
    v_mfma_f32_16x16x32_bf16 a[92:95], v[92:95], v[140:143], a[92:95]
    v_mfma_f32_16x16x32_bf16 a[124:127], v[92:95], v[144:147], a[124:127]
    v_mfma_f32_16x16x32_bf16 a[156:159], v[92:95], v[148:151], a[156:159]
    v_mfma_f32_16x16x32_bf16 a[188:191], v[92:95], v[152:155], a[188:191]
    v_mfma_f32_16x16x32_bf16 a[220:223], v[92:95], v[156:159], a[220:223]
    v_mfma_f32_16x16x32_bf16 a[252:255], v[92:95], v[160:163], a[252:255]
    v_mfma_f32_16x16x32_bf16 v[252:255], v[92:95], v[164:167], v[252:255]
    s_waitcnt lgkmcnt(0)
    v_mfma_f32_16x16x32_bf16 a[0:3], v[64:67], v[96:99], a[0:3]
    v_perm_b32 v88, v39, v35, s44
    ds_read_b128 v[132:135], v221 offset:512
    v_mfma_f32_16x16x32_bf16 a[32:35], v[64:67], v[100:103], a[32:35]
    v_perm_b32 v92, v39, v35, s45
    ds_read_b128 v[136:139], v221 offset:2560
    v_mfma_f32_16x16x32_bf16 a[64:67], v[64:67], v[104:107], a[64:67]
    v_perm_b32 v89, v47, v43, s44
    ds_read_b128 v[140:143], v221 offset:4608
    v_mfma_f32_16x16x32_bf16 a[96:99], v[64:67], v[108:111], a[96:99]
    v_perm_b32 v93, v47, v43, s45
    ds_read_b128 v[144:147], v221 offset:6656
    v_mfma_f32_16x16x32_bf16 a[128:131], v[64:67], v[112:115], a[128:131]
    v_perm_b32 v90, v55, v51, s44
    ds_read_b128 v[148:151], v221 offset:8704
    v_mfma_f32_16x16x32_bf16 a[160:163], v[64:67], v[116:119], a[160:163]
    v_perm_b32 v94, v55, v51, s45
    ds_read_b128 v[152:155], v221 offset:10752
    v_mfma_f32_16x16x32_bf16 a[192:195], v[64:67], v[120:123], a[192:195]
    v_perm_b32 v91, v63, v59, s44
    ds_read_b128 v[156:159], v221 offset:12800
    v_mfma_f32_16x16x32_bf16 a[224:227], v[64:67], v[124:127], a[224:227]
    v_perm_b32 v95, v63, v59, s45
    ds_read_b128 v[160:163], v221 offset:14848
    v_mfma_f32_16x16x32_bf16 v[224:227], v[64:67], v[128:131], v[224:227]
    ds_read_b128 v[164:167], v221 offset:16896
    buffer_load_dwordx4 v[32:35], v220, s[12:15], s36 offen
    v_mfma_f32_16x16x32_bf16 a[4:7], v[68:71], v[96:99], a[4:7]
    v_add_u32 v221, 0x4800, v221
    buffer_load_dwordx4 v[36:39], v220, s[12:15], s37 offen
    v_mfma_f32_16x16x32_bf16 a[36:39], v[68:71], v[100:103], a[36:39]
    buffer_load_dwordx4 v[40:43], v220, s[12:15], s38 offen
    v_mfma_f32_16x16x32_bf16 a[68:71], v[68:71], v[104:107], a[68:71]
    buffer_load_dwordx4 v[44:47], v220, s[12:15], s39 offen
    v_mfma_f32_16x16x32_bf16 a[100:103], v[68:71], v[108:111], a[100:103]
    buffer_load_dwordx4 v[48:51], v220, s[12:15], s40 offen
    v_mfma_f32_16x16x32_bf16 a[132:135], v[68:71], v[112:115], a[132:135]
    buffer_load_dwordx4 v[52:55], v220, s[12:15], s41 offen
    v_mfma_f32_16x16x32_bf16 a[164:167], v[68:71], v[116:119], a[164:167]
    buffer_load_dwordx4 v[56:59], v220, s[12:15], s42 offen
    v_mfma_f32_16x16x32_bf16 a[196:199], v[68:71], v[120:123], a[196:199]
    buffer_load_dwordx4 v[60:63], v220, s[12:15], s43 offen
    v_mfma_f32_16x16x32_bf16 a[228:231], v[68:71], v[124:127], a[228:231]
    v_add_u32 v220, 0x40000, v220
    v_mfma_f32_16x16x32_bf16 v[228:231], v[68:71], v[128:131], v[228:231]
    s_waitcnt vmcnt(16)
    v_mfma_f32_16x16x32_bf16 a[8:11], v[72:75], v[96:99], a[8:11]
    v_perm_b32 v64, v172, v168, s44
    v_mfma_f32_16x16x32_bf16 a[40:43], v[72:75], v[100:103], a[40:43]
    v_perm_b32 v68, v172, v168, s45
    v_mfma_f32_16x16x32_bf16 a[72:75], v[72:75], v[104:107], a[72:75]
    v_perm_b32 v65, v180, v176, s44
    v_mfma_f32_16x16x32_bf16 a[104:107], v[72:75], v[108:111], a[104:107]
    v_perm_b32 v69, v180, v176, s45
    v_mfma_f32_16x16x32_bf16 a[136:139], v[72:75], v[112:115], a[136:139]
    v_perm_b32 v66, v188, v184, s44
    v_mfma_f32_16x16x32_bf16 a[168:171], v[72:75], v[116:119], a[168:171]
    v_perm_b32 v70, v188, v184, s45
    v_mfma_f32_16x16x32_bf16 a[200:203], v[72:75], v[120:123], a[200:203]
    v_perm_b32 v67, v196, v192, s44
    v_mfma_f32_16x16x32_bf16 a[232:235], v[72:75], v[124:127], a[232:235]
    v_perm_b32 v71, v196, v192, s45
    v_mfma_f32_16x16x32_bf16 v[232:235], v[72:75], v[128:131], v[232:235]
    v_mfma_f32_16x16x32_bf16 a[12:15], v[76:79], v[96:99], a[12:15]
    v_mfma_f32_16x16x32_bf16 a[44:47], v[76:79], v[100:103], a[44:47]
    v_mfma_f32_16x16x32_bf16 a[76:79], v[76:79], v[104:107], a[76:79]
    v_mfma_f32_16x16x32_bf16 a[108:111], v[76:79], v[108:111], a[108:111]
    v_mfma_f32_16x16x32_bf16 a[140:143], v[76:79], v[112:115], a[140:143]
    v_mfma_f32_16x16x32_bf16 a[172:175], v[76:79], v[116:119], a[172:175]
    v_mfma_f32_16x16x32_bf16 a[204:207], v[76:79], v[120:123], a[204:207]
    v_mfma_f32_16x16x32_bf16 a[236:239], v[76:79], v[124:127], a[236:239]
    v_mfma_f32_16x16x32_bf16 v[236:239], v[76:79], v[128:131], v[236:239]
    v_mfma_f32_16x16x32_bf16 a[16:19], v[80:83], v[96:99], a[16:19]
    v_perm_b32 v72, v173, v169, s44
    v_mfma_f32_16x16x32_bf16 a[48:51], v[80:83], v[100:103], a[48:51]
    v_perm_b32 v76, v173, v169, s45
    v_mfma_f32_16x16x32_bf16 a[80:83], v[80:83], v[104:107], a[80:83]
    v_perm_b32 v73, v181, v177, s44
    v_mfma_f32_16x16x32_bf16 a[112:115], v[80:83], v[108:111], a[112:115]
    v_perm_b32 v77, v181, v177, s45
    v_mfma_f32_16x16x32_bf16 a[144:147], v[80:83], v[112:115], a[144:147]
    v_perm_b32 v74, v189, v185, s44
    v_mfma_f32_16x16x32_bf16 a[176:179], v[80:83], v[116:119], a[176:179]
    v_perm_b32 v78, v189, v185, s45
    v_mfma_f32_16x16x32_bf16 a[208:211], v[80:83], v[120:123], a[208:211]
    v_perm_b32 v75, v197, v193, s44
    v_mfma_f32_16x16x32_bf16 a[240:243], v[80:83], v[124:127], a[240:243]
    v_perm_b32 v79, v197, v193, s45
    v_mfma_f32_16x16x32_bf16 v[240:243], v[80:83], v[128:131], v[240:243]
    v_mfma_f32_16x16x32_bf16 a[20:23], v[84:87], v[96:99], a[20:23]
    v_mfma_f32_16x16x32_bf16 a[52:55], v[84:87], v[100:103], a[52:55]
    v_mfma_f32_16x16x32_bf16 a[84:87], v[84:87], v[104:107], a[84:87]
    v_mfma_f32_16x16x32_bf16 a[116:119], v[84:87], v[108:111], a[116:119]
    v_mfma_f32_16x16x32_bf16 a[148:151], v[84:87], v[112:115], a[148:151]
    v_mfma_f32_16x16x32_bf16 a[180:183], v[84:87], v[116:119], a[180:183]
    v_mfma_f32_16x16x32_bf16 a[212:215], v[84:87], v[120:123], a[212:215]
    v_mfma_f32_16x16x32_bf16 a[244:247], v[84:87], v[124:127], a[244:247]
    v_mfma_f32_16x16x32_bf16 v[244:247], v[84:87], v[128:131], v[244:247]
    v_mfma_f32_16x16x32_bf16 a[24:27], v[88:91], v[96:99], a[24:27]
    v_perm_b32 v80, v174, v170, s44
    v_mfma_f32_16x16x32_bf16 a[56:59], v[88:91], v[100:103], a[56:59]
    v_perm_b32 v84, v174, v170, s45
    v_mfma_f32_16x16x32_bf16 a[88:91], v[88:91], v[104:107], a[88:91]
    v_perm_b32 v81, v182, v178, s44
    v_mfma_f32_16x16x32_bf16 a[120:123], v[88:91], v[108:111], a[120:123]
    v_perm_b32 v85, v182, v178, s45
    v_mfma_f32_16x16x32_bf16 a[152:155], v[88:91], v[112:115], a[152:155]
    v_perm_b32 v82, v190, v186, s44
    v_mfma_f32_16x16x32_bf16 a[184:187], v[88:91], v[116:119], a[184:187]
    v_perm_b32 v86, v190, v186, s45
    v_mfma_f32_16x16x32_bf16 a[216:219], v[88:91], v[120:123], a[216:219]
    v_perm_b32 v83, v198, v194, s44
    v_mfma_f32_16x16x32_bf16 a[248:251], v[88:91], v[124:127], a[248:251]
    v_perm_b32 v87, v198, v194, s45
    v_mfma_f32_16x16x32_bf16 v[248:251], v[88:91], v[128:131], v[248:251]
    v_mfma_f32_16x16x32_bf16 a[28:31], v[92:95], v[96:99], a[28:31]
    v_mfma_f32_16x16x32_bf16 a[60:63], v[92:95], v[100:103], a[60:63]
    v_mfma_f32_16x16x32_bf16 a[92:95], v[92:95], v[104:107], a[92:95]
    v_mfma_f32_16x16x32_bf16 a[124:127], v[92:95], v[108:111], a[124:127]
    v_mfma_f32_16x16x32_bf16 a[156:159], v[92:95], v[112:115], a[156:159]
    v_mfma_f32_16x16x32_bf16 a[188:191], v[92:95], v[116:119], a[188:191]
    v_mfma_f32_16x16x32_bf16 a[220:223], v[92:95], v[120:123], a[220:223]
    v_mfma_f32_16x16x32_bf16 a[252:255], v[92:95], v[124:127], a[252:255]
    v_mfma_f32_16x16x32_bf16 v[252:255], v[92:95], v[128:131], v[252:255]
    s_waitcnt lgkmcnt(0)
    v_mfma_f32_16x16x32_bf16 a[0:3], v[64:67], v[132:135], a[0:3]
    v_perm_b32 v88, v175, v171, s44
    ds_read_b128 v[96:99], v221 offset:0
    v_mfma_f32_16x16x32_bf16 a[32:35], v[64:67], v[136:139], a[32:35]
    v_perm_b32 v92, v175, v171, s45
    ds_read_b128 v[100:103], v221 offset:2048
    v_mfma_f32_16x16x32_bf16 a[64:67], v[64:67], v[140:143], a[64:67]
    v_perm_b32 v89, v183, v179, s44
    ds_read_b128 v[104:107], v221 offset:4096
    v_mfma_f32_16x16x32_bf16 a[96:99], v[64:67], v[144:147], a[96:99]
    v_perm_b32 v93, v183, v179, s45
    ds_read_b128 v[108:111], v221 offset:6144
    v_mfma_f32_16x16x32_bf16 a[128:131], v[64:67], v[148:151], a[128:131]
    v_perm_b32 v90, v191, v187, s44
    ds_read_b128 v[112:115], v221 offset:8192
    v_mfma_f32_16x16x32_bf16 a[160:163], v[64:67], v[152:155], a[160:163]
    v_perm_b32 v94, v191, v187, s45
    ds_read_b128 v[116:119], v221 offset:10240
    v_mfma_f32_16x16x32_bf16 a[192:195], v[64:67], v[156:159], a[192:195]
    v_perm_b32 v91, v199, v195, s44
    ds_read_b128 v[120:123], v221 offset:12288
    v_mfma_f32_16x16x32_bf16 a[224:227], v[64:67], v[160:163], a[224:227]
    v_perm_b32 v95, v199, v195, s45
    ds_read_b128 v[124:127], v221 offset:14336
    v_mfma_f32_16x16x32_bf16 v[224:227], v[64:67], v[164:167], v[224:227]
    ds_read_b128 v[128:131], v221 offset:16384
    buffer_load_dwordx4 v[168:171], v220, s[12:15], s36 offen
    v_mfma_f32_16x16x32_bf16 a[4:7], v[68:71], v[132:135], a[4:7]
    buffer_load_dwordx4 v[172:175], v220, s[12:15], s37 offen
    v_mfma_f32_16x16x32_bf16 a[36:39], v[68:71], v[136:139], a[36:39]
    buffer_load_dwordx4 v[176:179], v220, s[12:15], s38 offen
    v_mfma_f32_16x16x32_bf16 a[68:71], v[68:71], v[140:143], a[68:71]
    buffer_load_dwordx4 v[180:183], v220, s[12:15], s39 offen
    v_mfma_f32_16x16x32_bf16 a[100:103], v[68:71], v[144:147], a[100:103]
    buffer_load_dwordx4 v[184:187], v220, s[12:15], s40 offen
    v_mfma_f32_16x16x32_bf16 a[132:135], v[68:71], v[148:151], a[132:135]
    buffer_load_dwordx4 v[188:191], v220, s[12:15], s41 offen
    v_mfma_f32_16x16x32_bf16 a[164:167], v[68:71], v[152:155], a[164:167]
    buffer_load_dwordx4 v[192:195], v220, s[12:15], s42 offen
    v_mfma_f32_16x16x32_bf16 a[196:199], v[68:71], v[156:159], a[196:199]
    buffer_load_dwordx4 v[196:199], v220, s[12:15], s43 offen
    v_mfma_f32_16x16x32_bf16 a[228:231], v[68:71], v[160:163], a[228:231]
    v_add_u32 v220, 0x40000, v220
    v_mfma_f32_16x16x32_bf16 v[228:231], v[68:71], v[164:167], v[228:231]
    s_waitcnt vmcnt(16)
    v_mfma_f32_16x16x32_bf16 a[8:11], v[72:75], v[132:135], a[8:11]
    v_perm_b32 v64, v4, v0, s44
    v_mfma_f32_16x16x32_bf16 a[40:43], v[72:75], v[136:139], a[40:43]
    v_perm_b32 v68, v4, v0, s45
    v_mfma_f32_16x16x32_bf16 a[72:75], v[72:75], v[140:143], a[72:75]
    v_perm_b32 v65, v12, v8, s44
    v_mfma_f32_16x16x32_bf16 a[104:107], v[72:75], v[144:147], a[104:107]
    v_perm_b32 v69, v12, v8, s45
    v_mfma_f32_16x16x32_bf16 a[136:139], v[72:75], v[148:151], a[136:139]
    v_perm_b32 v66, v20, v16, s44
    v_mfma_f32_16x16x32_bf16 a[168:171], v[72:75], v[152:155], a[168:171]
    v_perm_b32 v70, v20, v16, s45
    v_mfma_f32_16x16x32_bf16 a[200:203], v[72:75], v[156:159], a[200:203]
    v_perm_b32 v67, v28, v24, s44
    v_mfma_f32_16x16x32_bf16 a[232:235], v[72:75], v[160:163], a[232:235]
    v_perm_b32 v71, v28, v24, s45
    v_mfma_f32_16x16x32_bf16 v[232:235], v[72:75], v[164:167], v[232:235]
    v_mfma_f32_16x16x32_bf16 a[12:15], v[76:79], v[132:135], a[12:15]
    v_mfma_f32_16x16x32_bf16 a[44:47], v[76:79], v[136:139], a[44:47]
    v_mfma_f32_16x16x32_bf16 a[76:79], v[76:79], v[140:143], a[76:79]
    v_mfma_f32_16x16x32_bf16 a[108:111], v[76:79], v[144:147], a[108:111]
    v_mfma_f32_16x16x32_bf16 a[140:143], v[76:79], v[148:151], a[140:143]
    v_mfma_f32_16x16x32_bf16 a[172:175], v[76:79], v[152:155], a[172:175]
    v_mfma_f32_16x16x32_bf16 a[204:207], v[76:79], v[156:159], a[204:207]
    v_mfma_f32_16x16x32_bf16 a[236:239], v[76:79], v[160:163], a[236:239]
    v_mfma_f32_16x16x32_bf16 v[236:239], v[76:79], v[164:167], v[236:239]
    v_mfma_f32_16x16x32_bf16 a[16:19], v[80:83], v[132:135], a[16:19]
    v_perm_b32 v72, v5, v1, s44
    v_mfma_f32_16x16x32_bf16 a[48:51], v[80:83], v[136:139], a[48:51]
    v_perm_b32 v76, v5, v1, s45
    v_mfma_f32_16x16x32_bf16 a[80:83], v[80:83], v[140:143], a[80:83]
    v_perm_b32 v73, v13, v9, s44
    v_mfma_f32_16x16x32_bf16 a[112:115], v[80:83], v[144:147], a[112:115]
    v_perm_b32 v77, v13, v9, s45
    v_mfma_f32_16x16x32_bf16 a[144:147], v[80:83], v[148:151], a[144:147]
    v_perm_b32 v74, v21, v17, s44
    v_mfma_f32_16x16x32_bf16 a[176:179], v[80:83], v[152:155], a[176:179]
    v_perm_b32 v78, v21, v17, s45
    v_mfma_f32_16x16x32_bf16 a[208:211], v[80:83], v[156:159], a[208:211]
    v_perm_b32 v75, v29, v25, s44
    v_mfma_f32_16x16x32_bf16 a[240:243], v[80:83], v[160:163], a[240:243]
    v_perm_b32 v79, v29, v25, s45
    v_mfma_f32_16x16x32_bf16 v[240:243], v[80:83], v[164:167], v[240:243]
    v_mfma_f32_16x16x32_bf16 a[20:23], v[84:87], v[132:135], a[20:23]
    v_mfma_f32_16x16x32_bf16 a[52:55], v[84:87], v[136:139], a[52:55]
    v_mfma_f32_16x16x32_bf16 a[84:87], v[84:87], v[140:143], a[84:87]
    v_mfma_f32_16x16x32_bf16 a[116:119], v[84:87], v[144:147], a[116:119]
    v_mfma_f32_16x16x32_bf16 a[148:151], v[84:87], v[148:151], a[148:151]
    v_mfma_f32_16x16x32_bf16 a[180:183], v[84:87], v[152:155], a[180:183]
    v_mfma_f32_16x16x32_bf16 a[212:215], v[84:87], v[156:159], a[212:215]
    v_mfma_f32_16x16x32_bf16 a[244:247], v[84:87], v[160:163], a[244:247]
    v_mfma_f32_16x16x32_bf16 v[244:247], v[84:87], v[164:167], v[244:247]
    v_mfma_f32_16x16x32_bf16 a[24:27], v[88:91], v[132:135], a[24:27]
    v_perm_b32 v80, v6, v2, s44
    v_mfma_f32_16x16x32_bf16 a[56:59], v[88:91], v[136:139], a[56:59]
    v_perm_b32 v84, v6, v2, s45
    v_mfma_f32_16x16x32_bf16 a[88:91], v[88:91], v[140:143], a[88:91]
    v_perm_b32 v81, v14, v10, s44
    v_mfma_f32_16x16x32_bf16 a[120:123], v[88:91], v[144:147], a[120:123]
    v_perm_b32 v85, v14, v10, s45
    v_mfma_f32_16x16x32_bf16 a[152:155], v[88:91], v[148:151], a[152:155]
    v_perm_b32 v82, v22, v18, s44
    v_mfma_f32_16x16x32_bf16 a[184:187], v[88:91], v[152:155], a[184:187]
    v_perm_b32 v86, v22, v18, s45
    v_mfma_f32_16x16x32_bf16 a[216:219], v[88:91], v[156:159], a[216:219]
    v_perm_b32 v83, v30, v26, s44
    v_mfma_f32_16x16x32_bf16 a[248:251], v[88:91], v[160:163], a[248:251]
    v_perm_b32 v87, v30, v26, s45
    v_mfma_f32_16x16x32_bf16 v[248:251], v[88:91], v[164:167], v[248:251]
    v_mfma_f32_16x16x32_bf16 a[28:31], v[92:95], v[132:135], a[28:31]
    v_mfma_f32_16x16x32_bf16 a[60:63], v[92:95], v[136:139], a[60:63]
    v_mfma_f32_16x16x32_bf16 a[92:95], v[92:95], v[140:143], a[92:95]
    v_mfma_f32_16x16x32_bf16 a[124:127], v[92:95], v[144:147], a[124:127]
    v_mfma_f32_16x16x32_bf16 a[156:159], v[92:95], v[148:151], a[156:159]
    v_mfma_f32_16x16x32_bf16 a[188:191], v[92:95], v[152:155], a[188:191]
    v_mfma_f32_16x16x32_bf16 a[220:223], v[92:95], v[156:159], a[220:223]
    v_mfma_f32_16x16x32_bf16 a[252:255], v[92:95], v[160:163], a[252:255]
    v_mfma_f32_16x16x32_bf16 v[252:255], v[92:95], v[164:167], v[252:255]
    s_waitcnt lgkmcnt(0)
    v_mfma_f32_16x16x32_bf16 a[0:3], v[64:67], v[96:99], a[0:3]
    v_perm_b32 v88, v7, v3, s44
    ds_read_b128 v[132:135], v221 offset:512
    v_mfma_f32_16x16x32_bf16 a[32:35], v[64:67], v[100:103], a[32:35]
    v_perm_b32 v92, v7, v3, s45
    ds_read_b128 v[136:139], v221 offset:2560
    v_mfma_f32_16x16x32_bf16 a[64:67], v[64:67], v[104:107], a[64:67]
    v_perm_b32 v89, v15, v11, s44
    ds_read_b128 v[140:143], v221 offset:4608
    v_mfma_f32_16x16x32_bf16 a[96:99], v[64:67], v[108:111], a[96:99]
    v_perm_b32 v93, v15, v11, s45
    ds_read_b128 v[144:147], v221 offset:6656
    v_mfma_f32_16x16x32_bf16 a[128:131], v[64:67], v[112:115], a[128:131]
    v_perm_b32 v90, v23, v19, s44
    ds_read_b128 v[148:151], v221 offset:8704
    v_mfma_f32_16x16x32_bf16 a[160:163], v[64:67], v[116:119], a[160:163]
    v_perm_b32 v94, v23, v19, s45
    ds_read_b128 v[152:155], v221 offset:10752
    v_mfma_f32_16x16x32_bf16 a[192:195], v[64:67], v[120:123], a[192:195]
    v_perm_b32 v91, v31, v27, s44
    ds_read_b128 v[156:159], v221 offset:12800
    v_mfma_f32_16x16x32_bf16 a[224:227], v[64:67], v[124:127], a[224:227]
    v_perm_b32 v95, v31, v27, s45
    ds_read_b128 v[160:163], v221 offset:14848
    v_mfma_f32_16x16x32_bf16 v[224:227], v[64:67], v[128:131], v[224:227]
    ds_read_b128 v[164:167], v221 offset:16896
    buffer_load_dwordx4 v[0:3], v220, s[12:15], s36 offen
    v_mfma_f32_16x16x32_bf16 a[4:7], v[68:71], v[96:99], a[4:7]
    v_add_u32 v221, 0x4800, v221
    buffer_load_dwordx4 v[4:7], v220, s[12:15], s37 offen
    v_mfma_f32_16x16x32_bf16 a[36:39], v[68:71], v[100:103], a[36:39]
    buffer_load_dwordx4 v[8:11], v220, s[12:15], s38 offen
    v_mfma_f32_16x16x32_bf16 a[68:71], v[68:71], v[104:107], a[68:71]
    buffer_load_dwordx4 v[12:15], v220, s[12:15], s39 offen
    v_mfma_f32_16x16x32_bf16 a[100:103], v[68:71], v[108:111], a[100:103]
    buffer_load_dwordx4 v[16:19], v220, s[12:15], s40 offen
    v_mfma_f32_16x16x32_bf16 a[132:135], v[68:71], v[112:115], a[132:135]
    buffer_load_dwordx4 v[20:23], v220, s[12:15], s41 offen
    v_mfma_f32_16x16x32_bf16 a[164:167], v[68:71], v[116:119], a[164:167]
    buffer_load_dwordx4 v[24:27], v220, s[12:15], s42 offen
    v_mfma_f32_16x16x32_bf16 a[196:199], v[68:71], v[120:123], a[196:199]
    buffer_load_dwordx4 v[28:31], v220, s[12:15], s43 offen
    v_mfma_f32_16x16x32_bf16 a[228:231], v[68:71], v[124:127], a[228:231]
    v_add_u32 v220, 0x40000, v220
    v_mfma_f32_16x16x32_bf16 v[228:231], v[68:71], v[128:131], v[228:231]
    s_waitcnt vmcnt(16)
    v_mfma_f32_16x16x32_bf16 a[8:11], v[72:75], v[96:99], a[8:11]
    v_perm_b32 v64, v36, v32, s44
    v_mfma_f32_16x16x32_bf16 a[40:43], v[72:75], v[100:103], a[40:43]
    v_perm_b32 v68, v36, v32, s45
    v_mfma_f32_16x16x32_bf16 a[72:75], v[72:75], v[104:107], a[72:75]
    v_perm_b32 v65, v44, v40, s44
    v_mfma_f32_16x16x32_bf16 a[104:107], v[72:75], v[108:111], a[104:107]
    v_perm_b32 v69, v44, v40, s45
    v_mfma_f32_16x16x32_bf16 a[136:139], v[72:75], v[112:115], a[136:139]
    v_perm_b32 v66, v52, v48, s44
    v_mfma_f32_16x16x32_bf16 a[168:171], v[72:75], v[116:119], a[168:171]
    v_perm_b32 v70, v52, v48, s45
    v_mfma_f32_16x16x32_bf16 a[200:203], v[72:75], v[120:123], a[200:203]
    v_perm_b32 v67, v60, v56, s44
    v_mfma_f32_16x16x32_bf16 a[232:235], v[72:75], v[124:127], a[232:235]
    v_perm_b32 v71, v60, v56, s45
    v_mfma_f32_16x16x32_bf16 v[232:235], v[72:75], v[128:131], v[232:235]
    v_mfma_f32_16x16x32_bf16 a[12:15], v[76:79], v[96:99], a[12:15]
    v_mfma_f32_16x16x32_bf16 a[44:47], v[76:79], v[100:103], a[44:47]
    v_mfma_f32_16x16x32_bf16 a[76:79], v[76:79], v[104:107], a[76:79]
    v_mfma_f32_16x16x32_bf16 a[108:111], v[76:79], v[108:111], a[108:111]
    v_mfma_f32_16x16x32_bf16 a[140:143], v[76:79], v[112:115], a[140:143]
    v_mfma_f32_16x16x32_bf16 a[172:175], v[76:79], v[116:119], a[172:175]
    v_mfma_f32_16x16x32_bf16 a[204:207], v[76:79], v[120:123], a[204:207]
    v_mfma_f32_16x16x32_bf16 a[236:239], v[76:79], v[124:127], a[236:239]
    v_mfma_f32_16x16x32_bf16 v[236:239], v[76:79], v[128:131], v[236:239]
    v_mfma_f32_16x16x32_bf16 a[16:19], v[80:83], v[96:99], a[16:19]
    v_perm_b32 v72, v37, v33, s44
    v_mfma_f32_16x16x32_bf16 a[48:51], v[80:83], v[100:103], a[48:51]
    v_perm_b32 v76, v37, v33, s45
    v_mfma_f32_16x16x32_bf16 a[80:83], v[80:83], v[104:107], a[80:83]
    v_perm_b32 v73, v45, v41, s44
    v_mfma_f32_16x16x32_bf16 a[112:115], v[80:83], v[108:111], a[112:115]
    v_perm_b32 v77, v45, v41, s45
    v_mfma_f32_16x16x32_bf16 a[144:147], v[80:83], v[112:115], a[144:147]
    v_perm_b32 v74, v53, v49, s44
    v_mfma_f32_16x16x32_bf16 a[176:179], v[80:83], v[116:119], a[176:179]
    v_perm_b32 v78, v53, v49, s45
    v_mfma_f32_16x16x32_bf16 a[208:211], v[80:83], v[120:123], a[208:211]
    v_perm_b32 v75, v61, v57, s44
    v_mfma_f32_16x16x32_bf16 a[240:243], v[80:83], v[124:127], a[240:243]
    v_perm_b32 v79, v61, v57, s45
    v_mfma_f32_16x16x32_bf16 v[240:243], v[80:83], v[128:131], v[240:243]
    v_mfma_f32_16x16x32_bf16 a[20:23], v[84:87], v[96:99], a[20:23]
    v_mfma_f32_16x16x32_bf16 a[52:55], v[84:87], v[100:103], a[52:55]
    v_mfma_f32_16x16x32_bf16 a[84:87], v[84:87], v[104:107], a[84:87]
    v_mfma_f32_16x16x32_bf16 a[116:119], v[84:87], v[108:111], a[116:119]
    v_mfma_f32_16x16x32_bf16 a[148:151], v[84:87], v[112:115], a[148:151]
    v_mfma_f32_16x16x32_bf16 a[180:183], v[84:87], v[116:119], a[180:183]
    v_mfma_f32_16x16x32_bf16 a[212:215], v[84:87], v[120:123], a[212:215]
    v_mfma_f32_16x16x32_bf16 a[244:247], v[84:87], v[124:127], a[244:247]
    v_mfma_f32_16x16x32_bf16 v[244:247], v[84:87], v[128:131], v[244:247]
    v_mfma_f32_16x16x32_bf16 a[24:27], v[88:91], v[96:99], a[24:27]
    v_perm_b32 v80, v38, v34, s44
    v_mfma_f32_16x16x32_bf16 a[56:59], v[88:91], v[100:103], a[56:59]
    v_perm_b32 v84, v38, v34, s45
    v_mfma_f32_16x16x32_bf16 a[88:91], v[88:91], v[104:107], a[88:91]
    v_perm_b32 v81, v46, v42, s44
    v_mfma_f32_16x16x32_bf16 a[120:123], v[88:91], v[108:111], a[120:123]
    v_perm_b32 v85, v46, v42, s45
    v_mfma_f32_16x16x32_bf16 a[152:155], v[88:91], v[112:115], a[152:155]
    v_perm_b32 v82, v54, v50, s44
    v_mfma_f32_16x16x32_bf16 a[184:187], v[88:91], v[116:119], a[184:187]
    v_perm_b32 v86, v54, v50, s45
    v_mfma_f32_16x16x32_bf16 a[216:219], v[88:91], v[120:123], a[216:219]
    v_perm_b32 v83, v62, v58, s44
    v_mfma_f32_16x16x32_bf16 a[248:251], v[88:91], v[124:127], a[248:251]
    v_perm_b32 v87, v62, v58, s45
    v_mfma_f32_16x16x32_bf16 v[248:251], v[88:91], v[128:131], v[248:251]
    v_mfma_f32_16x16x32_bf16 a[28:31], v[92:95], v[96:99], a[28:31]
    v_mfma_f32_16x16x32_bf16 a[60:63], v[92:95], v[100:103], a[60:63]
    v_mfma_f32_16x16x32_bf16 a[92:95], v[92:95], v[104:107], a[92:95]
    v_mfma_f32_16x16x32_bf16 a[124:127], v[92:95], v[108:111], a[124:127]
    v_mfma_f32_16x16x32_bf16 a[156:159], v[92:95], v[112:115], a[156:159]
    v_mfma_f32_16x16x32_bf16 a[188:191], v[92:95], v[116:119], a[188:191]
    v_mfma_f32_16x16x32_bf16 a[220:223], v[92:95], v[120:123], a[220:223]
    v_mfma_f32_16x16x32_bf16 a[252:255], v[92:95], v[124:127], a[252:255]
    v_mfma_f32_16x16x32_bf16 v[252:255], v[92:95], v[128:131], v[252:255]
    s_waitcnt lgkmcnt(0)
    v_mfma_f32_16x16x32_bf16 a[0:3], v[64:67], v[132:135], a[0:3]
    v_perm_b32 v88, v39, v35, s44
    ds_read_b128 v[96:99], v221 offset:0
    v_mfma_f32_16x16x32_bf16 a[32:35], v[64:67], v[136:139], a[32:35]
    v_perm_b32 v92, v39, v35, s45
    ds_read_b128 v[100:103], v221 offset:2048
    v_mfma_f32_16x16x32_bf16 a[64:67], v[64:67], v[140:143], a[64:67]
    v_perm_b32 v89, v47, v43, s44
    ds_read_b128 v[104:107], v221 offset:4096
    v_mfma_f32_16x16x32_bf16 a[96:99], v[64:67], v[144:147], a[96:99]
    v_perm_b32 v93, v47, v43, s45
    ds_read_b128 v[108:111], v221 offset:6144
    v_mfma_f32_16x16x32_bf16 a[128:131], v[64:67], v[148:151], a[128:131]
    v_perm_b32 v90, v55, v51, s44
    ds_read_b128 v[112:115], v221 offset:8192
    v_mfma_f32_16x16x32_bf16 a[160:163], v[64:67], v[152:155], a[160:163]
    v_perm_b32 v94, v55, v51, s45
    ds_read_b128 v[116:119], v221 offset:10240
    v_mfma_f32_16x16x32_bf16 a[192:195], v[64:67], v[156:159], a[192:195]
    v_perm_b32 v91, v63, v59, s44
    ds_read_b128 v[120:123], v221 offset:12288
    v_mfma_f32_16x16x32_bf16 a[224:227], v[64:67], v[160:163], a[224:227]
    v_perm_b32 v95, v63, v59, s45
    ds_read_b128 v[124:127], v221 offset:14336
    v_mfma_f32_16x16x32_bf16 v[224:227], v[64:67], v[164:167], v[224:227]
    ds_read_b128 v[128:131], v221 offset:16384
    buffer_load_dwordx4 v[32:35], v212, s[16:19], s47 offen offset:0 nt
    buffer_load_dwordx4 v[36:39], v212, s[16:19], s47 offen offset:16 nt
    v_mfma_f32_16x16x32_bf16 a[4:7], v[68:71], v[132:135], a[4:7]
    buffer_load_dwordx4 v[40:43], v212, s[16:19], s47 offen offset:128 nt
    v_mfma_f32_16x16x32_bf16 a[36:39], v[68:71], v[136:139], a[36:39]
    buffer_load_dwordx4 v[44:47], v212, s[16:19], s47 offen offset:144 nt
    v_mfma_f32_16x16x32_bf16 a[68:71], v[68:71], v[140:143], a[68:71]
    buffer_load_dwordx4 v[48:51], v213, s[16:19], s47 offen offset:0 nt
    v_mfma_f32_16x16x32_bf16 a[100:103], v[68:71], v[144:147], a[100:103]
    buffer_load_dwordx4 v[52:55], v213, s[16:19], s47 offen offset:16 nt
    v_mfma_f32_16x16x32_bf16 a[132:135], v[68:71], v[148:151], a[132:135]
    buffer_load_dwordx4 v[56:59], v213, s[16:19], s47 offen offset:128 nt
    v_mfma_f32_16x16x32_bf16 a[164:167], v[68:71], v[152:155], a[164:167]
    buffer_load_dwordx4 v[60:63], v213, s[16:19], s47 offen offset:144 nt
    v_mfma_f32_16x16x32_bf16 a[196:199], v[68:71], v[156:159], a[196:199]
    s_add_u32 s47, s47, 8192
    v_mfma_f32_16x16x32_bf16 a[228:231], v[68:71], v[160:163], a[228:231]
    s_and_b32 s47, s47, 0x1ffff
    v_mfma_f32_16x16x32_bf16 v[228:231], v[68:71], v[164:167], v[228:231]
    s_waitcnt vmcnt(16)
    v_mfma_f32_16x16x32_bf16 a[8:11], v[72:75], v[132:135], a[8:11]
    v_perm_b32 v64, v172, v168, s44
    v_mfma_f32_16x16x32_bf16 a[40:43], v[72:75], v[136:139], a[40:43]
    v_perm_b32 v68, v172, v168, s45
    v_mfma_f32_16x16x32_bf16 a[72:75], v[72:75], v[140:143], a[72:75]
    v_perm_b32 v65, v180, v176, s44
    v_mfma_f32_16x16x32_bf16 a[104:107], v[72:75], v[144:147], a[104:107]
    v_perm_b32 v69, v180, v176, s45
    v_mfma_f32_16x16x32_bf16 a[136:139], v[72:75], v[148:151], a[136:139]
    v_perm_b32 v66, v188, v184, s44
    v_mfma_f32_16x16x32_bf16 a[168:171], v[72:75], v[152:155], a[168:171]
    v_perm_b32 v70, v188, v184, s45
    v_mfma_f32_16x16x32_bf16 a[200:203], v[72:75], v[156:159], a[200:203]
    v_perm_b32 v67, v196, v192, s44
    v_mfma_f32_16x16x32_bf16 a[232:235], v[72:75], v[160:163], a[232:235]
    v_perm_b32 v71, v196, v192, s45
    v_mfma_f32_16x16x32_bf16 v[232:235], v[72:75], v[164:167], v[232:235]
    v_mfma_f32_16x16x32_bf16 a[12:15], v[76:79], v[132:135], a[12:15]
    v_mfma_f32_16x16x32_bf16 a[44:47], v[76:79], v[136:139], a[44:47]
    v_mfma_f32_16x16x32_bf16 a[76:79], v[76:79], v[140:143], a[76:79]
    v_mfma_f32_16x16x32_bf16 a[108:111], v[76:79], v[144:147], a[108:111]
    v_mfma_f32_16x16x32_bf16 a[140:143], v[76:79], v[148:151], a[140:143]
    v_mfma_f32_16x16x32_bf16 a[172:175], v[76:79], v[152:155], a[172:175]
    v_mfma_f32_16x16x32_bf16 a[204:207], v[76:79], v[156:159], a[204:207]
    v_mfma_f32_16x16x32_bf16 a[236:239], v[76:79], v[160:163], a[236:239]
    v_mfma_f32_16x16x32_bf16 v[236:239], v[76:79], v[164:167], v[236:239]
    v_mfma_f32_16x16x32_bf16 a[16:19], v[80:83], v[132:135], a[16:19]
    v_perm_b32 v72, v173, v169, s44
    v_mfma_f32_16x16x32_bf16 a[48:51], v[80:83], v[136:139], a[48:51]
    v_perm_b32 v76, v173, v169, s45
    v_mfma_f32_16x16x32_bf16 a[80:83], v[80:83], v[140:143], a[80:83]
    v_perm_b32 v73, v181, v177, s44
    v_mfma_f32_16x16x32_bf16 a[112:115], v[80:83], v[144:147], a[112:115]
    v_perm_b32 v77, v181, v177, s45
    v_mfma_f32_16x16x32_bf16 a[144:147], v[80:83], v[148:151], a[144:147]
    v_perm_b32 v74, v189, v185, s44
    v_mfma_f32_16x16x32_bf16 a[176:179], v[80:83], v[152:155], a[176:179]
    v_perm_b32 v78, v189, v185, s45
    v_mfma_f32_16x16x32_bf16 a[208:211], v[80:83], v[156:159], a[208:211]
    v_perm_b32 v75, v197, v193, s44
    v_mfma_f32_16x16x32_bf16 a[240:243], v[80:83], v[160:163], a[240:243]
    v_perm_b32 v79, v197, v193, s45
    v_mfma_f32_16x16x32_bf16 v[240:243], v[80:83], v[164:167], v[240:243]
    v_mfma_f32_16x16x32_bf16 a[20:23], v[84:87], v[132:135], a[20:23]
    v_mfma_f32_16x16x32_bf16 a[52:55], v[84:87], v[136:139], a[52:55]
    v_mfma_f32_16x16x32_bf16 a[84:87], v[84:87], v[140:143], a[84:87]
    v_mfma_f32_16x16x32_bf16 a[116:119], v[84:87], v[144:147], a[116:119]
    v_mfma_f32_16x16x32_bf16 a[148:151], v[84:87], v[148:151], a[148:151]
    v_mfma_f32_16x16x32_bf16 a[180:183], v[84:87], v[152:155], a[180:183]
    v_mfma_f32_16x16x32_bf16 a[212:215], v[84:87], v[156:159], a[212:215]
    v_mfma_f32_16x16x32_bf16 a[244:247], v[84:87], v[160:163], a[244:247]
    v_mfma_f32_16x16x32_bf16 v[244:247], v[84:87], v[164:167], v[244:247]
    v_mfma_f32_16x16x32_bf16 a[24:27], v[88:91], v[132:135], a[24:27]
    v_perm_b32 v80, v174, v170, s44
    v_mfma_f32_16x16x32_bf16 a[56:59], v[88:91], v[136:139], a[56:59]
    v_perm_b32 v84, v174, v170, s45
    v_mfma_f32_16x16x32_bf16 a[88:91], v[88:91], v[140:143], a[88:91]
    v_perm_b32 v81, v182, v178, s44
    v_mfma_f32_16x16x32_bf16 a[120:123], v[88:91], v[144:147], a[120:123]
    v_perm_b32 v85, v182, v178, s45
    v_mfma_f32_16x16x32_bf16 a[152:155], v[88:91], v[148:151], a[152:155]
    v_perm_b32 v82, v190, v186, s44
    v_mfma_f32_16x16x32_bf16 a[184:187], v[88:91], v[152:155], a[184:187]
    v_perm_b32 v86, v190, v186, s45
    v_mfma_f32_16x16x32_bf16 a[216:219], v[88:91], v[156:159], a[216:219]
    v_perm_b32 v83, v198, v194, s44
    v_mfma_f32_16x16x32_bf16 a[248:251], v[88:91], v[160:163], a[248:251]
    v_perm_b32 v87, v198, v194, s45
    v_mfma_f32_16x16x32_bf16 v[248:251], v[88:91], v[164:167], v[248:251]
    v_mfma_f32_16x16x32_bf16 a[28:31], v[92:95], v[132:135], a[28:31]
    v_mfma_f32_16x16x32_bf16 a[60:63], v[92:95], v[136:139], a[60:63]
    v_mfma_f32_16x16x32_bf16 a[92:95], v[92:95], v[140:143], a[92:95]
    v_mfma_f32_16x16x32_bf16 a[124:127], v[92:95], v[144:147], a[124:127]
    v_mfma_f32_16x16x32_bf16 a[156:159], v[92:95], v[148:151], a[156:159]
    v_mfma_f32_16x16x32_bf16 a[188:191], v[92:95], v[152:155], a[188:191]
    v_mfma_f32_16x16x32_bf16 a[220:223], v[92:95], v[156:159], a[220:223]
    v_mfma_f32_16x16x32_bf16 a[252:255], v[92:95], v[160:163], a[252:255]
    v_mfma_f32_16x16x32_bf16 v[252:255], v[92:95], v[164:167], v[252:255]
    s_waitcnt lgkmcnt(0)
    v_mfma_f32_16x16x32_bf16 a[0:3], v[64:67], v[96:99], a[0:3]
    v_perm_b32 v88, v175, v171, s44
    ds_read_b128 v[132:135], v221 offset:512
    v_mfma_f32_16x16x32_bf16 a[32:35], v[64:67], v[100:103], a[32:35]
    v_perm_b32 v92, v175, v171, s45
    ds_read_b128 v[136:139], v221 offset:2560
    v_mfma_f32_16x16x32_bf16 a[64:67], v[64:67], v[104:107], a[64:67]
    v_perm_b32 v89, v183, v179, s44
    ds_read_b128 v[140:143], v221 offset:4608
    v_mfma_f32_16x16x32_bf16 a[96:99], v[64:67], v[108:111], a[96:99]
    v_perm_b32 v93, v183, v179, s45
    ds_read_b128 v[144:147], v221 offset:6656
    v_mfma_f32_16x16x32_bf16 a[128:131], v[64:67], v[112:115], a[128:131]
    v_perm_b32 v90, v191, v187, s44
    ds_read_b128 v[148:151], v221 offset:8704
    v_mfma_f32_16x16x32_bf16 a[160:163], v[64:67], v[116:119], a[160:163]
    v_perm_b32 v94, v191, v187, s45
    ds_read_b128 v[152:155], v221 offset:10752
    v_mfma_f32_16x16x32_bf16 a[192:195], v[64:67], v[120:123], a[192:195]
    v_perm_b32 v91, v199, v195, s44
    ds_read_b128 v[156:159], v221 offset:12800
    v_mfma_f32_16x16x32_bf16 a[224:227], v[64:67], v[124:127], a[224:227]
    v_perm_b32 v95, v199, v195, s45
    ds_read_b128 v[160:163], v221 offset:14848
    v_mfma_f32_16x16x32_bf16 v[224:227], v[64:67], v[128:131], v[224:227]
    ds_read_b128 v[164:167], v221 offset:16896
    v_mfma_f32_16x16x32_bf16 a[4:7], v[68:71], v[96:99], a[4:7]
    v_add_u32 v221, 0x4800, v221
    v_mfma_f32_16x16x32_bf16 a[36:39], v[68:71], v[100:103], a[36:39]
    v_mfma_f32_16x16x32_bf16 a[68:71], v[68:71], v[104:107], a[68:71]
    v_mfma_f32_16x16x32_bf16 a[100:103], v[68:71], v[108:111], a[100:103]
    v_mfma_f32_16x16x32_bf16 a[132:135], v[68:71], v[112:115], a[132:135]
    v_mfma_f32_16x16x32_bf16 a[164:167], v[68:71], v[116:119], a[164:167]
    v_mfma_f32_16x16x32_bf16 a[196:199], v[68:71], v[120:123], a[196:199]
    v_mfma_f32_16x16x32_bf16 a[228:231], v[68:71], v[124:127], a[228:231]
    v_mfma_f32_16x16x32_bf16 v[228:231], v[68:71], v[128:131], v[228:231]
    s_waitcnt vmcnt(8)
    v_mfma_f32_16x16x32_bf16 a[8:11], v[72:75], v[96:99], a[8:11]
    v_perm_b32 v64, v4, v0, s44
    v_mfma_f32_16x16x32_bf16 a[40:43], v[72:75], v[100:103], a[40:43]
    v_perm_b32 v68, v4, v0, s45
    v_mfma_f32_16x16x32_bf16 a[72:75], v[72:75], v[104:107], a[72:75]
    v_perm_b32 v65, v12, v8, s44
    v_mfma_f32_16x16x32_bf16 a[104:107], v[72:75], v[108:111], a[104:107]
    v_perm_b32 v69, v12, v8, s45
    v_mfma_f32_16x16x32_bf16 a[136:139], v[72:75], v[112:115], a[136:139]
    v_perm_b32 v66, v20, v16, s44
    v_mfma_f32_16x16x32_bf16 a[168:171], v[72:75], v[116:119], a[168:171]
    v_perm_b32 v70, v20, v16, s45
    v_mfma_f32_16x16x32_bf16 a[200:203], v[72:75], v[120:123], a[200:203]
    v_perm_b32 v67, v28, v24, s44
    v_mfma_f32_16x16x32_bf16 a[232:235], v[72:75], v[124:127], a[232:235]
    v_perm_b32 v71, v28, v24, s45
    v_mfma_f32_16x16x32_bf16 v[232:235], v[72:75], v[128:131], v[232:235]
    v_mfma_f32_16x16x32_bf16 a[12:15], v[76:79], v[96:99], a[12:15]
    v_mfma_f32_16x16x32_bf16 a[44:47], v[76:79], v[100:103], a[44:47]
    v_mfma_f32_16x16x32_bf16 a[76:79], v[76:79], v[104:107], a[76:79]
    v_mfma_f32_16x16x32_bf16 a[108:111], v[76:79], v[108:111], a[108:111]
    v_mfma_f32_16x16x32_bf16 a[140:143], v[76:79], v[112:115], a[140:143]
    v_mfma_f32_16x16x32_bf16 a[172:175], v[76:79], v[116:119], a[172:175]
    v_mfma_f32_16x16x32_bf16 a[204:207], v[76:79], v[120:123], a[204:207]
    v_mfma_f32_16x16x32_bf16 a[236:239], v[76:79], v[124:127], a[236:239]
    v_mfma_f32_16x16x32_bf16 v[236:239], v[76:79], v[128:131], v[236:239]
    v_mfma_f32_16x16x32_bf16 a[16:19], v[80:83], v[96:99], a[16:19]
    v_perm_b32 v72, v5, v1, s44
    v_mfma_f32_16x16x32_bf16 a[48:51], v[80:83], v[100:103], a[48:51]
    v_perm_b32 v76, v5, v1, s45
    v_mfma_f32_16x16x32_bf16 a[80:83], v[80:83], v[104:107], a[80:83]
    v_perm_b32 v73, v13, v9, s44
    v_mfma_f32_16x16x32_bf16 a[112:115], v[80:83], v[108:111], a[112:115]
    v_perm_b32 v77, v13, v9, s45
    v_mfma_f32_16x16x32_bf16 a[144:147], v[80:83], v[112:115], a[144:147]
    v_perm_b32 v74, v21, v17, s44
    v_mfma_f32_16x16x32_bf16 a[176:179], v[80:83], v[116:119], a[176:179]
    v_perm_b32 v78, v21, v17, s45
    v_mfma_f32_16x16x32_bf16 a[208:211], v[80:83], v[120:123], a[208:211]
    v_perm_b32 v75, v29, v25, s44
    v_mfma_f32_16x16x32_bf16 a[240:243], v[80:83], v[124:127], a[240:243]
    v_perm_b32 v79, v29, v25, s45
    v_mfma_f32_16x16x32_bf16 v[240:243], v[80:83], v[128:131], v[240:243]
    v_mfma_f32_16x16x32_bf16 a[20:23], v[84:87], v[96:99], a[20:23]
    v_mfma_f32_16x16x32_bf16 a[52:55], v[84:87], v[100:103], a[52:55]
    v_mfma_f32_16x16x32_bf16 a[84:87], v[84:87], v[104:107], a[84:87]
    v_mfma_f32_16x16x32_bf16 a[116:119], v[84:87], v[108:111], a[116:119]
    v_mfma_f32_16x16x32_bf16 a[148:151], v[84:87], v[112:115], a[148:151]
    v_mfma_f32_16x16x32_bf16 a[180:183], v[84:87], v[116:119], a[180:183]
    v_mfma_f32_16x16x32_bf16 a[212:215], v[84:87], v[120:123], a[212:215]
    v_mfma_f32_16x16x32_bf16 a[244:247], v[84:87], v[124:127], a[244:247]
    v_mfma_f32_16x16x32_bf16 v[244:247], v[84:87], v[128:131], v[244:247]
    v_mfma_f32_16x16x32_bf16 a[24:27], v[88:91], v[96:99], a[24:27]
    v_perm_b32 v80, v6, v2, s44
    v_mfma_f32_16x16x32_bf16 a[56:59], v[88:91], v[100:103], a[56:59]
    v_perm_b32 v84, v6, v2, s45
    v_mfma_f32_16x16x32_bf16 a[88:91], v[88:91], v[104:107], a[88:91]
    v_perm_b32 v81, v14, v10, s44
    v_mfma_f32_16x16x32_bf16 a[120:123], v[88:91], v[108:111], a[120:123]
    v_perm_b32 v85, v14, v10, s45
    v_mfma_f32_16x16x32_bf16 a[152:155], v[88:91], v[112:115], a[152:155]
    v_perm_b32 v82, v22, v18, s44
    v_mfma_f32_16x16x32_bf16 a[184:187], v[88:91], v[116:119], a[184:187]
    v_perm_b32 v86, v22, v18, s45
    v_mfma_f32_16x16x32_bf16 a[216:219], v[88:91], v[120:123], a[216:219]
    v_perm_b32 v83, v30, v26, s44
    v_mfma_f32_16x16x32_bf16 a[248:251], v[88:91], v[124:127], a[248:251]
    v_perm_b32 v87, v30, v26, s45
    v_mfma_f32_16x16x32_bf16 v[248:251], v[88:91], v[128:131], v[248:251]
    v_mfma_f32_16x16x32_bf16 a[28:31], v[92:95], v[96:99], a[28:31]
    v_mfma_f32_16x16x32_bf16 a[60:63], v[92:95], v[100:103], a[60:63]
    v_mfma_f32_16x16x32_bf16 a[92:95], v[92:95], v[104:107], a[92:95]
    v_mfma_f32_16x16x32_bf16 a[124:127], v[92:95], v[108:111], a[124:127]
    v_mfma_f32_16x16x32_bf16 a[156:159], v[92:95], v[112:115], a[156:159]
    v_mfma_f32_16x16x32_bf16 a[188:191], v[92:95], v[116:119], a[188:191]
    v_mfma_f32_16x16x32_bf16 a[220:223], v[92:95], v[120:123], a[220:223]
    v_mfma_f32_16x16x32_bf16 a[252:255], v[92:95], v[124:127], a[252:255]
    v_mfma_f32_16x16x32_bf16 v[252:255], v[92:95], v[128:131], v[252:255]
    s_waitcnt lgkmcnt(0)
    v_perm_b32 v88, v7, v3, s44
    v_perm_b32 v92, v7, v3, s45
    s_barrier
    v_mfma_f32_16x16x32_bf16 a[0:3], v[64:67], v[132:135], a[0:3]
    v_perm_b32 v89, v15, v11, s44
    v_perm_b32 v93, v15, v11, s45
    buffer_load_dwordx4 v[96:99], v214, s[20:23], s48 offen offset:0 nt
    buffer_load_dwordx4 v[100:103], v214, s[20:23], s48 offen offset:256 nt
    v_mfma_f32_16x16x32_bf16 a[4:7], v[68:71], v[132:135], a[4:7]
    v_perm_b32 v90, v23, v19, s44
    v_perm_b32 v94, v23, v19, s45
    buffer_load_dwordx4 v[104:107], v214, s[20:23], s48 offen offset:512 nt
    v_mfma_f32_16x16x32_bf16 a[8:11], v[72:75], v[132:135], a[8:11]
    v_perm_b32 v91, v31, v27, s44
    v_perm_b32 v95, v31, v27, s45
    buffer_load_dwordx4 v[108:111], v214, s[20:23], s48 offen offset:768 nt
    v_mfma_f32_16x16x32_bf16 a[12:15], v[76:79], v[132:135], a[12:15]
    buffer_load_dwordx4 v[112:115], v215, s[20:23], s48 offen offset:0 nt
    v_mfma_f32_16x16x32_bf16 a[16:19], v[80:83], v[132:135], a[16:19]
    buffer_load_dwordx4 v[116:119], v215, s[20:23], s48 offen offset:256 nt
    buffer_load_dwordx4 v[120:123], v215, s[20:23], s48 offen offset:512 nt
    v_mfma_f32_16x16x32_bf16 a[20:23], v[84:87], v[132:135], a[20:23]
    buffer_load_dwordx4 v[124:127], v215, s[20:23], s48 offen offset:768 nt
    v_mfma_f32_16x16x32_bf16 a[24:27], v[88:91], v[132:135], a[24:27]
    s_add_u32 s48, s48, 8192
    v_mfma_f32_16x16x32_bf16 a[28:31], v[92:95], v[132:135], a[28:31]
    s_and_b32 s48, s48, 0x1ffff
    v_mfma_f32_16x16x32_bf16 a[32:35], v[64:67], v[136:139], a[32:35]
    v_mfma_f32_16x16x32_bf16 a[36:39], v[68:71], v[136:139], a[36:39]
    v_accvgpr_read_b32 v168, a0
    v_accvgpr_read_b32 v169, a4
    v_accvgpr_read_b32 v170, a8
    v_accvgpr_read_b32 v171, a12
    v_accvgpr_read_b32 v172, a16
    v_accvgpr_read_b32 v173, a20
    v_accvgpr_read_b32 v174, a24
    v_accvgpr_read_b32 v175, a28
    v_pk_mul_f32 v[168:169], v[168:169], s[6:7]
    v_mfma_f32_16x16x32_bf16 a[40:43], v[72:75], v[136:139], a[40:43]
    v_pk_mul_f32 v[170:171], v[170:171], s[6:7]
    v_pk_mul_f32 v[172:173], v[172:173], s[6:7]
    v_pk_mul_f32 v[174:175], v[174:175], s[6:7]
    v_cvt_pk_bf16_f32 v176, v168, v169
    v_cvt_pk_bf16_f32 v177, v170, v171
    v_cvt_pk_bf16_f32 v178, v172, v173
    v_cvt_pk_bf16_f32 v179, v174, v175
    ds_write_b128 v216, v[176:179] offset:0
    v_mfma_f32_16x16x32_bf16 a[44:47], v[76:79], v[136:139], a[44:47]
    v_accvgpr_read_b32 v180, a1
    v_accvgpr_read_b32 v181, a5
    v_accvgpr_read_b32 v182, a9
    v_accvgpr_read_b32 v183, a13
    v_accvgpr_read_b32 v184, a17
    v_accvgpr_read_b32 v185, a21
    v_accvgpr_read_b32 v186, a25
    v_accvgpr_read_b32 v187, a29
    v_pk_mul_f32 v[180:181], v[180:181], s[6:7]
    v_mfma_f32_16x16x32_bf16 a[48:51], v[80:83], v[136:139], a[48:51]
    v_pk_mul_f32 v[182:183], v[182:183], s[6:7]
    v_pk_mul_f32 v[184:185], v[184:185], s[6:7]
    v_pk_mul_f32 v[186:187], v[186:187], s[6:7]
    v_cvt_pk_bf16_f32 v188, v180, v181
    v_cvt_pk_bf16_f32 v189, v182, v183
    v_cvt_pk_bf16_f32 v190, v184, v185
    v_cvt_pk_bf16_f32 v191, v186, v187
    ds_write_b128 v216, v[188:191] offset:1024
    v_mfma_f32_16x16x32_bf16 a[52:55], v[84:87], v[136:139], a[52:55]
    v_accvgpr_read_b32 v192, a2
    v_accvgpr_read_b32 v193, a6
    v_accvgpr_read_b32 v194, a10
    v_accvgpr_read_b32 v195, a14
    v_accvgpr_read_b32 v196, a18
    v_accvgpr_read_b32 v197, a22
    v_accvgpr_read_b32 v198, a26
    v_accvgpr_read_b32 v199, a30
    v_pk_mul_f32 v[192:193], v[192:193], s[6:7]
    v_mfma_f32_16x16x32_bf16 a[56:59], v[88:91], v[136:139], a[56:59]
    v_pk_mul_f32 v[194:195], v[194:195], s[6:7]
    v_pk_mul_f32 v[196:197], v[196:197], s[6:7]
    v_pk_mul_f32 v[198:199], v[198:199], s[6:7]
    v_cvt_pk_bf16_f32 v200, v192, v193
    v_cvt_pk_bf16_f32 v201, v194, v195
    v_cvt_pk_bf16_f32 v202, v196, v197
    v_cvt_pk_bf16_f32 v203, v198, v199
    ds_write_b128 v216, v[200:203] offset:2048
    v_mfma_f32_16x16x32_bf16 a[60:63], v[92:95], v[136:139], a[60:63]
    v_accvgpr_read_b32 v0, a3
    v_accvgpr_read_b32 v1, a7
    v_accvgpr_read_b32 v2, a11
    v_accvgpr_read_b32 v3, a15
    v_accvgpr_read_b32 v4, a19
    v_accvgpr_read_b32 v5, a23
    v_accvgpr_read_b32 v6, a27
    v_accvgpr_read_b32 v7, a31
    v_pk_mul_f32 v[0:1], v[0:1], s[6:7]
    v_mfma_f32_16x16x32_bf16 a[64:67], v[64:67], v[140:143], a[64:67]
    v_pk_mul_f32 v[2:3], v[2:3], s[6:7]
    v_pk_mul_f32 v[4:5], v[4:5], s[6:7]
    v_pk_mul_f32 v[6:7], v[6:7], s[6:7]
    v_cvt_pk_bf16_f32 v8, v0, v1
    v_cvt_pk_bf16_f32 v9, v2, v3
    v_cvt_pk_bf16_f32 v10, v4, v5
    v_cvt_pk_bf16_f32 v11, v6, v7
    ds_write_b128 v216, v[8:11] offset:3072
    v_mfma_f32_16x16x32_bf16 a[68:71], v[68:71], v[140:143], a[68:71]
    v_accvgpr_read_b32 v12, a32
    v_accvgpr_read_b32 v13, a36
    v_accvgpr_read_b32 v14, a40
    v_accvgpr_read_b32 v15, a44
    v_accvgpr_read_b32 v16, a48
    v_accvgpr_read_b32 v17, a52
    v_accvgpr_read_b32 v18, a56
    v_accvgpr_read_b32 v19, a60
    v_pk_mul_f32 v[12:13], v[12:13], s[6:7]
    v_mfma_f32_16x16x32_bf16 a[72:75], v[72:75], v[140:143], a[72:75]
    v_pk_mul_f32 v[14:15], v[14:15], s[6:7]
    v_pk_mul_f32 v[16:17], v[16:17], s[6:7]
    v_pk_mul_f32 v[18:19], v[18:19], s[6:7]
    v_cvt_pk_bf16_f32 v20, v12, v13
    v_cvt_pk_bf16_f32 v21, v14, v15
    v_cvt_pk_bf16_f32 v22, v16, v17
    v_cvt_pk_bf16_f32 v23, v18, v19
    ds_write_b128 v216, v[20:23] offset:4096
    v_mfma_f32_16x16x32_bf16 a[76:79], v[76:79], v[140:143], a[76:79]
    v_accvgpr_read_b32 v168, a33
    v_accvgpr_read_b32 v169, a37
    v_accvgpr_read_b32 v170, a41
    v_accvgpr_read_b32 v171, a45
    v_accvgpr_read_b32 v172, a49
    v_accvgpr_read_b32 v173, a53
    v_accvgpr_read_b32 v174, a57
    v_accvgpr_read_b32 v175, a61
    v_pk_mul_f32 v[168:169], v[168:169], s[6:7]
    v_mfma_f32_16x16x32_bf16 a[80:83], v[80:83], v[140:143], a[80:83]
    v_pk_mul_f32 v[170:171], v[170:171], s[6:7]
    v_pk_mul_f32 v[172:173], v[172:173], s[6:7]
    v_pk_mul_f32 v[174:175], v[174:175], s[6:7]
    v_cvt_pk_bf16_f32 v176, v168, v169
    v_cvt_pk_bf16_f32 v177, v170, v171
    v_cvt_pk_bf16_f32 v178, v172, v173
    v_cvt_pk_bf16_f32 v179, v174, v175
    ds_write_b128 v216, v[176:179] offset:5120
    v_mfma_f32_16x16x32_bf16 a[84:87], v[84:87], v[140:143], a[84:87]
    v_accvgpr_read_b32 v180, a34
    v_accvgpr_read_b32 v181, a38
    v_accvgpr_read_b32 v182, a42
    v_accvgpr_read_b32 v183, a46
    v_accvgpr_read_b32 v184, a50
    v_accvgpr_read_b32 v185, a54
    v_accvgpr_read_b32 v186, a58
    v_accvgpr_read_b32 v187, a62
    v_pk_mul_f32 v[180:181], v[180:181], s[6:7]
    v_mfma_f32_16x16x32_bf16 a[88:91], v[88:91], v[140:143], a[88:91]
    v_pk_mul_f32 v[182:183], v[182:183], s[6:7]
    v_pk_mul_f32 v[184:185], v[184:185], s[6:7]
    v_pk_mul_f32 v[186:187], v[186:187], s[6:7]
    v_cvt_pk_bf16_f32 v188, v180, v181
    v_cvt_pk_bf16_f32 v189, v182, v183
    v_cvt_pk_bf16_f32 v190, v184, v185
    v_cvt_pk_bf16_f32 v191, v186, v187
    ds_write_b128 v216, v[188:191] offset:6144
    v_mfma_f32_16x16x32_bf16 a[92:95], v[92:95], v[140:143], a[92:95]
    v_accvgpr_read_b32 v192, a35
    v_accvgpr_read_b32 v193, a39
    v_accvgpr_read_b32 v194, a43
    v_accvgpr_read_b32 v195, a47
    v_accvgpr_read_b32 v196, a51
    v_accvgpr_read_b32 v197, a55
    v_accvgpr_read_b32 v198, a59
    v_accvgpr_read_b32 v199, a63
    v_pk_mul_f32 v[192:193], v[192:193], s[6:7]
    v_mfma_f32_16x16x32_bf16 a[96:99], v[64:67], v[144:147], a[96:99]
    v_pk_mul_f32 v[194:195], v[194:195], s[6:7]
    v_pk_mul_f32 v[196:197], v[196:197], s[6:7]
    v_pk_mul_f32 v[198:199], v[198:199], s[6:7]
    v_cvt_pk_bf16_f32 v200, v192, v193
    v_cvt_pk_bf16_f32 v201, v194, v195
    v_cvt_pk_bf16_f32 v202, v196, v197
    v_cvt_pk_bf16_f32 v203, v198, v199
    ds_write_b128 v216, v[200:203] offset:7168
    v_mfma_f32_16x16x32_bf16 a[100:103], v[68:71], v[144:147], a[100:103]
    v_accvgpr_read_b32 v0, a64
    v_accvgpr_read_b32 v1, a68
    v_accvgpr_read_b32 v2, a72
    v_accvgpr_read_b32 v3, a76
    v_accvgpr_read_b32 v4, a80
    v_accvgpr_read_b32 v5, a84
    v_accvgpr_read_b32 v6, a88
    v_accvgpr_read_b32 v7, a92
    v_pk_mul_f32 v[0:1], v[0:1], s[6:7]
    v_mfma_f32_16x16x32_bf16 a[104:107], v[72:75], v[144:147], a[104:107]
    v_pk_mul_f32 v[2:3], v[2:3], s[6:7]
    v_pk_mul_f32 v[4:5], v[4:5], s[6:7]
    v_pk_mul_f32 v[6:7], v[6:7], s[6:7]
    v_cvt_pk_bf16_f32 v8, v0, v1
    v_cvt_pk_bf16_f32 v9, v2, v3
    v_cvt_pk_bf16_f32 v10, v4, v5
    v_cvt_pk_bf16_f32 v11, v6, v7
    ds_write_b128 v216, v[8:11] offset:8192
    v_mfma_f32_16x16x32_bf16 a[108:111], v[76:79], v[144:147], a[108:111]
    v_accvgpr_read_b32 v12, a65
    v_accvgpr_read_b32 v13, a69
    v_accvgpr_read_b32 v14, a73
    v_accvgpr_read_b32 v15, a77
    v_accvgpr_read_b32 v16, a81
    v_accvgpr_read_b32 v17, a85
    v_accvgpr_read_b32 v18, a89
    v_accvgpr_read_b32 v19, a93
    v_pk_mul_f32 v[12:13], v[12:13], s[6:7]
    v_mfma_f32_16x16x32_bf16 a[112:115], v[80:83], v[144:147], a[112:115]
    v_pk_mul_f32 v[14:15], v[14:15], s[6:7]
    v_pk_mul_f32 v[16:17], v[16:17], s[6:7]
    v_pk_mul_f32 v[18:19], v[18:19], s[6:7]
    v_cvt_pk_bf16_f32 v20, v12, v13
    v_cvt_pk_bf16_f32 v21, v14, v15
    v_cvt_pk_bf16_f32 v22, v16, v17
    v_cvt_pk_bf16_f32 v23, v18, v19
    ds_write_b128 v216, v[20:23] offset:9216
    v_mfma_f32_16x16x32_bf16 a[116:119], v[84:87], v[144:147], a[116:119]
    v_accvgpr_read_b32 v168, a66
    v_accvgpr_read_b32 v169, a70
    v_accvgpr_read_b32 v170, a74
    v_accvgpr_read_b32 v171, a78
    v_accvgpr_read_b32 v172, a82
    v_accvgpr_read_b32 v173, a86
    v_accvgpr_read_b32 v174, a90
    v_accvgpr_read_b32 v175, a94
    v_pk_mul_f32 v[168:169], v[168:169], s[6:7]
    v_mfma_f32_16x16x32_bf16 a[120:123], v[88:91], v[144:147], a[120:123]
    v_pk_mul_f32 v[170:171], v[170:171], s[6:7]
    v_pk_mul_f32 v[172:173], v[172:173], s[6:7]
    v_pk_mul_f32 v[174:175], v[174:175], s[6:7]
    v_cvt_pk_bf16_f32 v176, v168, v169
    v_cvt_pk_bf16_f32 v177, v170, v171
    v_cvt_pk_bf16_f32 v178, v172, v173
    v_cvt_pk_bf16_f32 v179, v174, v175
    ds_write_b128 v216, v[176:179] offset:10240
    v_mfma_f32_16x16x32_bf16 a[124:127], v[92:95], v[144:147], a[124:127]
    v_accvgpr_read_b32 v180, a67
    v_accvgpr_read_b32 v181, a71
    v_accvgpr_read_b32 v182, a75
    v_accvgpr_read_b32 v183, a79
    v_accvgpr_read_b32 v184, a83
    v_accvgpr_read_b32 v185, a87
    v_accvgpr_read_b32 v186, a91
    v_accvgpr_read_b32 v187, a95
    v_pk_mul_f32 v[180:181], v[180:181], s[6:7]
    v_mfma_f32_16x16x32_bf16 a[128:131], v[64:67], v[148:151], a[128:131]
    v_pk_mul_f32 v[182:183], v[182:183], s[6:7]
    v_pk_mul_f32 v[184:185], v[184:185], s[6:7]
    v_pk_mul_f32 v[186:187], v[186:187], s[6:7]
    v_cvt_pk_bf16_f32 v188, v180, v181
    v_cvt_pk_bf16_f32 v189, v182, v183
    v_cvt_pk_bf16_f32 v190, v184, v185
    v_cvt_pk_bf16_f32 v191, v186, v187
    ds_write_b128 v216, v[188:191] offset:11264
    v_mfma_f32_16x16x32_bf16 a[132:135], v[68:71], v[148:151], a[132:135]
    v_accvgpr_read_b32 v192, a96
    v_accvgpr_read_b32 v193, a100
    v_accvgpr_read_b32 v194, a104
    v_accvgpr_read_b32 v195, a108
    v_accvgpr_read_b32 v196, a112
    v_accvgpr_read_b32 v197, a116
    v_accvgpr_read_b32 v198, a120
    v_accvgpr_read_b32 v199, a124
    v_pk_mul_f32 v[192:193], v[192:193], s[6:7]
    v_mfma_f32_16x16x32_bf16 a[136:139], v[72:75], v[148:151], a[136:139]
    v_pk_mul_f32 v[194:195], v[194:195], s[6:7]
    v_pk_mul_f32 v[196:197], v[196:197], s[6:7]
    v_pk_mul_f32 v[198:199], v[198:199], s[6:7]
    v_cvt_pk_bf16_f32 v200, v192, v193
    v_cvt_pk_bf16_f32 v201, v194, v195
    v_cvt_pk_bf16_f32 v202, v196, v197
    v_cvt_pk_bf16_f32 v203, v198, v199
    ds_write_b128 v216, v[200:203] offset:12288
    v_mfma_f32_16x16x32_bf16 a[140:143], v[76:79], v[148:151], a[140:143]
    v_accvgpr_read_b32 v0, a97
    v_accvgpr_read_b32 v1, a101
    v_accvgpr_read_b32 v2, a105
    v_accvgpr_read_b32 v3, a109
    v_accvgpr_read_b32 v4, a113
    v_accvgpr_read_b32 v5, a117
    v_accvgpr_read_b32 v6, a121
    v_accvgpr_read_b32 v7, a125
    v_pk_mul_f32 v[0:1], v[0:1], s[6:7]
    v_mfma_f32_16x16x32_bf16 a[144:147], v[80:83], v[148:151], a[144:147]
    v_pk_mul_f32 v[2:3], v[2:3], s[6:7]
    v_pk_mul_f32 v[4:5], v[4:5], s[6:7]
    v_pk_mul_f32 v[6:7], v[6:7], s[6:7]
    v_cvt_pk_bf16_f32 v8, v0, v1
    v_cvt_pk_bf16_f32 v9, v2, v3
    v_cvt_pk_bf16_f32 v10, v4, v5
    v_cvt_pk_bf16_f32 v11, v6, v7
    ds_write_b128 v216, v[8:11] offset:13312
    v_mfma_f32_16x16x32_bf16 a[148:151], v[84:87], v[148:151], a[148:151]
    v_accvgpr_read_b32 v12, a98
    v_accvgpr_read_b32 v13, a102
    v_accvgpr_read_b32 v14, a106
    v_accvgpr_read_b32 v15, a110
    v_accvgpr_read_b32 v16, a114
    v_accvgpr_read_b32 v17, a118
    v_accvgpr_read_b32 v18, a122
    v_accvgpr_read_b32 v19, a126
    v_pk_mul_f32 v[12:13], v[12:13], s[6:7]
    v_mfma_f32_16x16x32_bf16 a[152:155], v[88:91], v[148:151], a[152:155]
    v_pk_mul_f32 v[14:15], v[14:15], s[6:7]
    v_pk_mul_f32 v[16:17], v[16:17], s[6:7]
    v_pk_mul_f32 v[18:19], v[18:19], s[6:7]
    v_cvt_pk_bf16_f32 v20, v12, v13
    v_cvt_pk_bf16_f32 v21, v14, v15
    v_cvt_pk_bf16_f32 v22, v16, v17
    v_cvt_pk_bf16_f32 v23, v18, v19
    ds_write_b128 v216, v[20:23] offset:14336
    v_mfma_f32_16x16x32_bf16 a[156:159], v[92:95], v[148:151], a[156:159]
    v_accvgpr_read_b32 v168, a99
    v_accvgpr_read_b32 v169, a103
    v_accvgpr_read_b32 v170, a107
    v_accvgpr_read_b32 v171, a111
    v_accvgpr_read_b32 v172, a115
    v_accvgpr_read_b32 v173, a119
    v_accvgpr_read_b32 v174, a123
    v_accvgpr_read_b32 v175, a127
    v_pk_mul_f32 v[168:169], v[168:169], s[6:7]
    v_mfma_f32_16x16x32_bf16 a[160:163], v[64:67], v[152:155], a[160:163]
    v_pk_mul_f32 v[170:171], v[170:171], s[6:7]
    v_pk_mul_f32 v[172:173], v[172:173], s[6:7]
    v_pk_mul_f32 v[174:175], v[174:175], s[6:7]
    v_cvt_pk_bf16_f32 v176, v168, v169
    v_cvt_pk_bf16_f32 v177, v170, v171
    v_cvt_pk_bf16_f32 v178, v172, v173
    v_cvt_pk_bf16_f32 v179, v174, v175
    ds_write_b128 v216, v[176:179] offset:15360
    v_mfma_f32_16x16x32_bf16 a[164:167], v[68:71], v[152:155], a[164:167]
    v_accvgpr_read_b32 v180, a128
    v_accvgpr_read_b32 v181, a132
    v_accvgpr_read_b32 v182, a136
    v_accvgpr_read_b32 v183, a140
    v_accvgpr_read_b32 v184, a144
    v_accvgpr_read_b32 v185, a148
    v_accvgpr_read_b32 v186, a152
    v_accvgpr_read_b32 v187, a156
    v_pk_mul_f32 v[180:181], v[180:181], s[6:7]
    v_mfma_f32_16x16x32_bf16 a[168:171], v[72:75], v[152:155], a[168:171]
    v_pk_mul_f32 v[182:183], v[182:183], s[6:7]
    v_pk_mul_f32 v[184:185], v[184:185], s[6:7]
    v_pk_mul_f32 v[186:187], v[186:187], s[6:7]
    v_cvt_pk_bf16_f32 v188, v180, v181
    v_cvt_pk_bf16_f32 v189, v182, v183
    v_cvt_pk_bf16_f32 v190, v184, v185
    v_cvt_pk_bf16_f32 v191, v186, v187
    ds_write_b128 v216, v[188:191] offset:16384
    v_mfma_f32_16x16x32_bf16 a[172:175], v[76:79], v[152:155], a[172:175]
    v_accvgpr_read_b32 v192, a129
    v_accvgpr_read_b32 v193, a133
    v_accvgpr_read_b32 v194, a137
    v_accvgpr_read_b32 v195, a141
    v_accvgpr_read_b32 v196, a145
    v_accvgpr_read_b32 v197, a149
    v_accvgpr_read_b32 v198, a153
    v_accvgpr_read_b32 v199, a157
    v_pk_mul_f32 v[192:193], v[192:193], s[6:7]
    v_mfma_f32_16x16x32_bf16 a[176:179], v[80:83], v[152:155], a[176:179]
    v_pk_mul_f32 v[194:195], v[194:195], s[6:7]
    v_pk_mul_f32 v[196:197], v[196:197], s[6:7]
    v_pk_mul_f32 v[198:199], v[198:199], s[6:7]
    v_cvt_pk_bf16_f32 v200, v192, v193
    v_cvt_pk_bf16_f32 v201, v194, v195
    v_cvt_pk_bf16_f32 v202, v196, v197
    v_cvt_pk_bf16_f32 v203, v198, v199
    ds_write_b128 v216, v[200:203] offset:17408
    v_mfma_f32_16x16x32_bf16 a[180:183], v[84:87], v[152:155], a[180:183]
    v_accvgpr_read_b32 v0, a130
    v_accvgpr_read_b32 v1, a134
    v_accvgpr_read_b32 v2, a138
    v_accvgpr_read_b32 v3, a142
    v_accvgpr_read_b32 v4, a146
    v_accvgpr_read_b32 v5, a150
    v_accvgpr_read_b32 v6, a154
    v_accvgpr_read_b32 v7, a158
    v_pk_mul_f32 v[0:1], v[0:1], s[6:7]
    v_mfma_f32_16x16x32_bf16 a[184:187], v[88:91], v[152:155], a[184:187]
    v_pk_mul_f32 v[2:3], v[2:3], s[6:7]
    v_pk_mul_f32 v[4:5], v[4:5], s[6:7]
    v_pk_mul_f32 v[6:7], v[6:7], s[6:7]
    v_cvt_pk_bf16_f32 v8, v0, v1
    v_cvt_pk_bf16_f32 v9, v2, v3
    v_cvt_pk_bf16_f32 v10, v4, v5
    v_cvt_pk_bf16_f32 v11, v6, v7
    ds_write_b128 v216, v[8:11] offset:18432
    v_mfma_f32_16x16x32_bf16 a[188:191], v[92:95], v[152:155], a[188:191]
    v_accvgpr_read_b32 v12, a131
    v_accvgpr_read_b32 v13, a135
    v_accvgpr_read_b32 v14, a139
    v_accvgpr_read_b32 v15, a143
    v_accvgpr_read_b32 v16, a147
    v_accvgpr_read_b32 v17, a151
    v_accvgpr_read_b32 v18, a155
    v_accvgpr_read_b32 v19, a159
    v_pk_mul_f32 v[12:13], v[12:13], s[6:7]
    v_mfma_f32_16x16x32_bf16 a[192:195], v[64:67], v[156:159], a[192:195]
    v_pk_mul_f32 v[14:15], v[14:15], s[6:7]
    v_pk_mul_f32 v[16:17], v[16:17], s[6:7]
    v_pk_mul_f32 v[18:19], v[18:19], s[6:7]
    v_cvt_pk_bf16_f32 v20, v12, v13
    v_cvt_pk_bf16_f32 v21, v14, v15
    v_cvt_pk_bf16_f32 v22, v16, v17
    v_cvt_pk_bf16_f32 v23, v18, v19
    ds_write_b128 v216, v[20:23] offset:19456
    v_mfma_f32_16x16x32_bf16 a[196:199], v[68:71], v[156:159], a[196:199]
    v_accvgpr_read_b32 v168, a160
    v_accvgpr_read_b32 v169, a164
    v_accvgpr_read_b32 v170, a168
    v_accvgpr_read_b32 v171, a172
    v_accvgpr_read_b32 v172, a176
    v_accvgpr_read_b32 v173, a180
    v_accvgpr_read_b32 v174, a184
    v_accvgpr_read_b32 v175, a188
    v_pk_mul_f32 v[168:169], v[168:169], s[6:7]
    v_mfma_f32_16x16x32_bf16 a[200:203], v[72:75], v[156:159], a[200:203]
    v_pk_mul_f32 v[170:171], v[170:171], s[6:7]
    v_pk_mul_f32 v[172:173], v[172:173], s[6:7]
    v_pk_mul_f32 v[174:175], v[174:175], s[6:7]
    v_cvt_pk_bf16_f32 v176, v168, v169
    v_cvt_pk_bf16_f32 v177, v170, v171
    v_cvt_pk_bf16_f32 v178, v172, v173
    v_cvt_pk_bf16_f32 v179, v174, v175
    ds_write_b128 v216, v[176:179] offset:20480
    v_mfma_f32_16x16x32_bf16 a[204:207], v[76:79], v[156:159], a[204:207]
    v_accvgpr_read_b32 v180, a161
    v_accvgpr_read_b32 v181, a165
    v_accvgpr_read_b32 v182, a169
    v_accvgpr_read_b32 v183, a173
    v_accvgpr_read_b32 v184, a177
    v_accvgpr_read_b32 v185, a181
    v_accvgpr_read_b32 v186, a185
    v_accvgpr_read_b32 v187, a189
    v_pk_mul_f32 v[180:181], v[180:181], s[6:7]
    v_mfma_f32_16x16x32_bf16 a[208:211], v[80:83], v[156:159], a[208:211]
    v_pk_mul_f32 v[182:183], v[182:183], s[6:7]
    v_pk_mul_f32 v[184:185], v[184:185], s[6:7]
    v_pk_mul_f32 v[186:187], v[186:187], s[6:7]
    v_cvt_pk_bf16_f32 v188, v180, v181
    v_cvt_pk_bf16_f32 v189, v182, v183
    v_cvt_pk_bf16_f32 v190, v184, v185
    v_cvt_pk_bf16_f32 v191, v186, v187
    ds_write_b128 v216, v[188:191] offset:21504
    v_mfma_f32_16x16x32_bf16 a[212:215], v[84:87], v[156:159], a[212:215]
    v_accvgpr_read_b32 v192, a162
    v_accvgpr_read_b32 v193, a166
    v_accvgpr_read_b32 v194, a170
    v_accvgpr_read_b32 v195, a174
    v_accvgpr_read_b32 v196, a178
    v_accvgpr_read_b32 v197, a182
    v_accvgpr_read_b32 v198, a186
    v_accvgpr_read_b32 v199, a190
    v_pk_mul_f32 v[192:193], v[192:193], s[6:7]
    v_mfma_f32_16x16x32_bf16 a[216:219], v[88:91], v[156:159], a[216:219]
    v_pk_mul_f32 v[194:195], v[194:195], s[6:7]
    v_pk_mul_f32 v[196:197], v[196:197], s[6:7]
    v_pk_mul_f32 v[198:199], v[198:199], s[6:7]
    v_cvt_pk_bf16_f32 v200, v192, v193
    v_cvt_pk_bf16_f32 v201, v194, v195
    v_cvt_pk_bf16_f32 v202, v196, v197
    v_cvt_pk_bf16_f32 v203, v198, v199
    ds_write_b128 v216, v[200:203] offset:22528
    v_mfma_f32_16x16x32_bf16 a[220:223], v[92:95], v[156:159], a[220:223]
    v_accvgpr_read_b32 v0, a163
    v_accvgpr_read_b32 v1, a167
    v_accvgpr_read_b32 v2, a171
    v_accvgpr_read_b32 v3, a175
    v_accvgpr_read_b32 v4, a179
    v_accvgpr_read_b32 v5, a183
    v_accvgpr_read_b32 v6, a187
    v_accvgpr_read_b32 v7, a191
    v_pk_mul_f32 v[0:1], v[0:1], s[6:7]
    v_mfma_f32_16x16x32_bf16 a[224:227], v[64:67], v[160:163], a[224:227]
    v_pk_mul_f32 v[2:3], v[2:3], s[6:7]
    v_pk_mul_f32 v[4:5], v[4:5], s[6:7]
    v_pk_mul_f32 v[6:7], v[6:7], s[6:7]
    v_cvt_pk_bf16_f32 v8, v0, v1
    v_cvt_pk_bf16_f32 v9, v2, v3
    v_cvt_pk_bf16_f32 v10, v4, v5
    v_cvt_pk_bf16_f32 v11, v6, v7
    ds_write_b128 v216, v[8:11] offset:23552
    v_mfma_f32_16x16x32_bf16 a[228:231], v[68:71], v[160:163], a[228:231]
    v_accvgpr_read_b32 v12, a192
    v_accvgpr_read_b32 v13, a196
    v_accvgpr_read_b32 v14, a200
    v_accvgpr_read_b32 v15, a204
    v_accvgpr_read_b32 v16, a208
    v_accvgpr_read_b32 v17, a212
    v_accvgpr_read_b32 v18, a216
    v_accvgpr_read_b32 v19, a220
    v_pk_mul_f32 v[12:13], v[12:13], s[6:7]
    v_mfma_f32_16x16x32_bf16 a[232:235], v[72:75], v[160:163], a[232:235]
    v_pk_mul_f32 v[14:15], v[14:15], s[6:7]
    v_pk_mul_f32 v[16:17], v[16:17], s[6:7]
    v_pk_mul_f32 v[18:19], v[18:19], s[6:7]
    v_cvt_pk_bf16_f32 v20, v12, v13
    v_cvt_pk_bf16_f32 v21, v14, v15
    v_cvt_pk_bf16_f32 v22, v16, v17
    v_cvt_pk_bf16_f32 v23, v18, v19
    ds_write_b128 v216, v[20:23] offset:24576
    v_mfma_f32_16x16x32_bf16 a[236:239], v[76:79], v[160:163], a[236:239]
    v_accvgpr_read_b32 v168, a193
    v_accvgpr_read_b32 v169, a197
    v_accvgpr_read_b32 v170, a201
    v_accvgpr_read_b32 v171, a205
    v_accvgpr_read_b32 v172, a209
    v_accvgpr_read_b32 v173, a213
    v_accvgpr_read_b32 v174, a217
    v_accvgpr_read_b32 v175, a221
    v_pk_mul_f32 v[168:169], v[168:169], s[6:7]
    v_mfma_f32_16x16x32_bf16 a[240:243], v[80:83], v[160:163], a[240:243]
    v_pk_mul_f32 v[170:171], v[170:171], s[6:7]
    v_pk_mul_f32 v[172:173], v[172:173], s[6:7]
    v_pk_mul_f32 v[174:175], v[174:175], s[6:7]
    v_cvt_pk_bf16_f32 v176, v168, v169
    v_cvt_pk_bf16_f32 v177, v170, v171
    v_cvt_pk_bf16_f32 v178, v172, v173
    v_cvt_pk_bf16_f32 v179, v174, v175
    ds_write_b128 v216, v[176:179] offset:25600
    v_mfma_f32_16x16x32_bf16 a[244:247], v[84:87], v[160:163], a[244:247]
    v_accvgpr_read_b32 v180, a194
    v_accvgpr_read_b32 v181, a198
    v_accvgpr_read_b32 v182, a202
    v_accvgpr_read_b32 v183, a206
    v_accvgpr_read_b32 v184, a210
    v_accvgpr_read_b32 v185, a214
    v_accvgpr_read_b32 v186, a218
    v_accvgpr_read_b32 v187, a222
    v_pk_mul_f32 v[180:181], v[180:181], s[6:7]
    v_mfma_f32_16x16x32_bf16 a[248:251], v[88:91], v[160:163], a[248:251]
    v_pk_mul_f32 v[182:183], v[182:183], s[6:7]
    v_pk_mul_f32 v[184:185], v[184:185], s[6:7]
    v_pk_mul_f32 v[186:187], v[186:187], s[6:7]
    v_cvt_pk_bf16_f32 v188, v180, v181
    v_cvt_pk_bf16_f32 v189, v182, v183
    v_cvt_pk_bf16_f32 v190, v184, v185
    v_cvt_pk_bf16_f32 v191, v186, v187
    ds_write_b128 v216, v[188:191] offset:26624
    v_mfma_f32_16x16x32_bf16 a[252:255], v[92:95], v[160:163], a[252:255]
    v_accvgpr_read_b32 v192, a195
    v_accvgpr_read_b32 v193, a199
    v_accvgpr_read_b32 v194, a203
    v_accvgpr_read_b32 v195, a207
    v_accvgpr_read_b32 v196, a211
    v_accvgpr_read_b32 v197, a215
    v_accvgpr_read_b32 v198, a219
    v_accvgpr_read_b32 v199, a223
    v_pk_mul_f32 v[192:193], v[192:193], s[6:7]
    v_mfma_f32_16x16x32_bf16 v[224:227], v[64:67], v[164:167], v[224:227]
    v_pk_mul_f32 v[194:195], v[194:195], s[6:7]
    v_pk_mul_f32 v[196:197], v[196:197], s[6:7]
    v_pk_mul_f32 v[198:199], v[198:199], s[6:7]
    v_cvt_pk_bf16_f32 v200, v192, v193
    v_cvt_pk_bf16_f32 v201, v194, v195
    v_cvt_pk_bf16_f32 v202, v196, v197
    v_cvt_pk_bf16_f32 v203, v198, v199
    ds_write_b128 v216, v[200:203] offset:27648
    v_mfma_f32_16x16x32_bf16 v[228:231], v[68:71], v[164:167], v[228:231]
    v_accvgpr_read_b32 v0, a224
    v_accvgpr_read_b32 v1, a228
    v_accvgpr_read_b32 v2, a232
    v_accvgpr_read_b32 v3, a236
    v_accvgpr_read_b32 v4, a240
    v_accvgpr_read_b32 v5, a244
    v_accvgpr_read_b32 v6, a248
    v_accvgpr_read_b32 v7, a252
    v_pk_mul_f32 v[0:1], v[0:1], s[6:7]
    v_pk_mul_f32 v[2:3], v[2:3], s[6:7]
    v_mfma_f32_16x16x32_bf16 v[232:235], v[72:75], v[164:167], v[232:235]
    v_pk_mul_f32 v[4:5], v[4:5], s[6:7]
    v_pk_mul_f32 v[6:7], v[6:7], s[6:7]
    v_cvt_pk_bf16_f32 v8, v0, v1
    v_cvt_pk_bf16_f32 v9, v2, v3
    v_cvt_pk_bf16_f32 v10, v4, v5
    v_cvt_pk_bf16_f32 v11, v6, v7
    ds_write_b128 v216, v[8:11] offset:28672
    v_accvgpr_read_b32 v12, a225
    v_accvgpr_read_b32 v13, a229
    v_accvgpr_read_b32 v14, a233
    v_mfma_f32_16x16x32_bf16 v[236:239], v[76:79], v[164:167], v[236:239]
    v_accvgpr_read_b32 v15, a237
    v_accvgpr_read_b32 v16, a241
    v_accvgpr_read_b32 v17, a245
    v_accvgpr_read_b32 v18, a249
    v_accvgpr_read_b32 v19, a253
    v_pk_mul_f32 v[12:13], v[12:13], s[6:7]
    v_pk_mul_f32 v[14:15], v[14:15], s[6:7]
    v_pk_mul_f32 v[16:17], v[16:17], s[6:7]
    v_pk_mul_f32 v[18:19], v[18:19], s[6:7]
    v_cvt_pk_bf16_f32 v20, v12, v13
    v_mfma_f32_16x16x32_bf16 v[240:243], v[80:83], v[164:167], v[240:243]
    v_cvt_pk_bf16_f32 v21, v14, v15
    v_cvt_pk_bf16_f32 v22, v16, v17
    v_cvt_pk_bf16_f32 v23, v18, v19
    ds_write_b128 v216, v[20:23] offset:29696
    v_accvgpr_read_b32 v168, a226
    v_accvgpr_read_b32 v169, a230
    v_accvgpr_read_b32 v170, a234
    v_accvgpr_read_b32 v171, a238
    v_accvgpr_read_b32 v172, a242
    v_mfma_f32_16x16x32_bf16 v[244:247], v[84:87], v[164:167], v[244:247]
    v_accvgpr_read_b32 v173, a246
    v_accvgpr_read_b32 v174, a250
    v_accvgpr_read_b32 v175, a254
    v_pk_mul_f32 v[168:169], v[168:169], s[6:7]
    v_pk_mul_f32 v[170:171], v[170:171], s[6:7]
    v_pk_mul_f32 v[172:173], v[172:173], s[6:7]
    v_pk_mul_f32 v[174:175], v[174:175], s[6:7]
    v_cvt_pk_bf16_f32 v176, v168, v169
    v_cvt_pk_bf16_f32 v177, v170, v171
    v_cvt_pk_bf16_f32 v178, v172, v173
    v_mfma_f32_16x16x32_bf16 v[248:251], v[88:91], v[164:167], v[248:251]
    v_cvt_pk_bf16_f32 v179, v174, v175
    ds_write_b128 v216, v[176:179] offset:30720
    v_accvgpr_read_b32 v180, a227
    v_accvgpr_read_b32 v181, a231
    v_accvgpr_read_b32 v182, a235
    v_accvgpr_read_b32 v183, a239
    v_accvgpr_read_b32 v184, a243
    v_accvgpr_read_b32 v185, a247
    v_accvgpr_read_b32 v186, a251
    v_accvgpr_read_b32 v187, a255
    v_mfma_f32_16x16x32_bf16 v[252:255], v[92:95], v[164:167], v[252:255]
    v_pk_mul_f32 v[180:181], v[180:181], s[6:7]
    v_pk_mul_f32 v[182:183], v[182:183], s[6:7]
    v_pk_mul_f32 v[184:185], v[184:185], s[6:7]
    v_pk_mul_f32 v[186:187], v[186:187], s[6:7]
    v_cvt_pk_bf16_f32 v188, v180, v181
    v_cvt_pk_bf16_f32 v189, v182, v183
    v_cvt_pk_bf16_f32 v190, v184, v185
    v_cvt_pk_bf16_f32 v191, v186, v187
    ds_write_b128 v216, v[188:191] offset:31744
    v_mul_f32 v192, s6, v224
    v_mul_f32 v193, s6, v228
    v_mul_f32 v194, s6, v232
    v_mul_f32 v195, s6, v236
    v_mul_f32 v196, s6, v240
    v_mul_f32 v197, s6, v244
    v_mul_f32 v198, s6, v248
    v_mul_f32 v199, s6, v252
    v_cvt_pk_bf16_f32 v200, v192, v193
    v_cvt_pk_bf16_f32 v201, v194, v195
    v_cvt_pk_bf16_f32 v202, v196, v197
    v_cvt_pk_bf16_f32 v203, v198, v199
    ds_write_b128 v216, v[200:203] offset:32768
    v_mul_f32 v0, s6, v225
    v_mul_f32 v1, s6, v229
    v_mul_f32 v2, s6, v233
    v_mul_f32 v3, s6, v237
    v_mul_f32 v4, s6, v241
    v_mul_f32 v5, s6, v245
    v_mul_f32 v6, s6, v249
    v_mul_f32 v7, s6, v253
    v_cvt_pk_bf16_f32 v8, v0, v1
    v_cvt_pk_bf16_f32 v9, v2, v3
    v_cvt_pk_bf16_f32 v10, v4, v5
    v_cvt_pk_bf16_f32 v11, v6, v7
    ds_write_b128 v216, v[8:11] offset:33792
    v_mul_f32 v12, s6, v226
    v_mul_f32 v13, s6, v230
    v_mul_f32 v14, s6, v234
    v_mul_f32 v15, s6, v238
    v_mul_f32 v16, s6, v242
    v_mul_f32 v17, s6, v246
    v_mul_f32 v18, s6, v250
    v_mul_f32 v19, s6, v254
    v_cvt_pk_bf16_f32 v20, v12, v13
    v_cvt_pk_bf16_f32 v21, v14, v15
    v_cvt_pk_bf16_f32 v22, v16, v17
    v_cvt_pk_bf16_f32 v23, v18, v19
    ds_write_b128 v216, v[20:23] offset:34816
    v_mul_f32 v168, s6, v227
    v_mul_f32 v169, s6, v231
    v_mul_f32 v170, s6, v235
    v_mul_f32 v171, s6, v239
    v_mul_f32 v172, s6, v243
    v_mul_f32 v173, s6, v247
    v_mul_f32 v174, s6, v251
    v_mul_f32 v175, s6, v255
    v_cvt_pk_bf16_f32 v176, v168, v169
    v_cvt_pk_bf16_f32 v177, v170, v171
    v_cvt_pk_bf16_f32 v178, v172, v173
    v_cvt_pk_bf16_f32 v179, v174, v175
    ds_write_b128 v216, v[176:179] offset:35840
    buffer_load_dwordx4 v[0:3], v212, s[16:19], s47 offen offset:0 nt
    buffer_load_dwordx4 v[4:7], v212, s[16:19], s47 offen offset:16 nt
    buffer_load_dwordx4 v[8:11], v212, s[16:19], s47 offen offset:128 nt
    buffer_load_dwordx4 v[12:15], v212, s[16:19], s47 offen offset:144 nt
    buffer_load_dwordx4 v[16:19], v213, s[16:19], s47 offen offset:0 nt
    buffer_load_dwordx4 v[20:23], v213, s[16:19], s47 offen offset:16 nt
    buffer_load_dwordx4 v[24:27], v213, s[16:19], s47 offen offset:128 nt
    buffer_load_dwordx4 v[28:31], v213, s[16:19], s47 offen offset:144 nt
    s_add_u32 s47, s47, 8192
    s_and_b32 s47, s47, 0x1ffff
    v_mov_b32 v224, 0
    v_mov_b32 v225, 0
    v_mov_b32 v226, 0
    v_mov_b32 v227, 0
    v_mov_b32 v228, 0
    v_mov_b32 v229, 0
    v_mov_b32 v230, 0
    v_mov_b32 v231, 0
    v_mov_b32 v232, 0
    v_mov_b32 v233, 0
    v_mov_b32 v234, 0
    v_mov_b32 v235, 0
    v_mov_b32 v236, 0
    v_mov_b32 v237, 0
    v_mov_b32 v238, 0
    v_mov_b32 v239, 0
    v_mov_b32 v240, 0
    v_mov_b32 v241, 0
    v_mov_b32 v242, 0
    v_mov_b32 v243, 0
    v_mov_b32 v244, 0
    v_mov_b32 v245, 0
    v_mov_b32 v246, 0
    v_mov_b32 v247, 0
    v_mov_b32 v248, 0
    v_mov_b32 v249, 0
    v_mov_b32 v250, 0
    v_mov_b32 v251, 0
    v_mov_b32 v252, 0
    v_mov_b32 v253, 0
    v_mov_b32 v254, 0
    v_mov_b32 v255, 0
    v_lshlrev_b32 v220, 3, v219
    s_waitcnt lgkmcnt(0)
    v_mov_b32 v204, 0
    v_mov_b32 v205, 0
    v_mov_b32 v206, 0
    v_mov_b32 v207, 0
    s_mov_b32 s46, 7
K1_att:
    ds_read_b128 v[128:131], v216 offset:0
    ds_read_b128 v[132:135], v216 offset:1024
    ds_read_b128 v[136:139], v216 offset:2048
    ds_read_b128 v[140:143], v216 offset:3072
    s_waitcnt vmcnt(16) lgkmcnt(0)
    v_mfma_f32_16x16x32_bf16 v[144:147], v[32:35], v[128:131], 0
    v_mfma_f32_16x16x32_bf16 v[148:151], v[48:51], v[128:131], 0
    v_mfma_f32_16x16x32_bf16 v[144:147], v[36:39], v[132:135], v[144:147]
    v_mfma_f32_16x16x32_bf16 v[148:151], v[52:55], v[132:135], v[148:151]
    v_mfma_f32_16x16x32_bf16 v[144:147], v[40:43], v[136:139], v[144:147]
    v_mfma_f32_16x16x32_bf16 v[148:151], v[56:59], v[136:139], v[148:151]
    v_mfma_f32_16x16x32_bf16 v[144:147], v[44:47], v[140:143], v[144:147]
    v_mfma_f32_16x16x32_bf16 v[148:151], v[60:63], v[140:143], v[148:151]
    ds_read_b128 v[128:131], v216 offset:4096
    ds_read_b128 v[132:135], v216 offset:5120
    ds_read_b128 v[136:139], v216 offset:6144
    ds_read_b128 v[140:143], v216 offset:7168
    s_waitcnt vmcnt(8)
    v_perm_b32 v64, v100, v96, s44
    v_perm_b32 v68, v100, v96, s45
    v_perm_b32 v65, v108, v104, s44
    v_perm_b32 v69, v108, v104, s45
    v_perm_b32 v66, v116, v112, s44
    v_perm_b32 v70, v116, v112, s45
    v_perm_b32 v67, v124, v120, s44
    v_perm_b32 v71, v124, v120, s45
    v_perm_b32 v72, v101, v97, s44
    v_perm_b32 v76, v101, v97, s45
    v_perm_b32 v73, v109, v105, s44
    v_perm_b32 v77, v109, v105, s45
    v_perm_b32 v74, v117, v113, s44
    v_perm_b32 v78, v117, v113, s45
    v_perm_b32 v75, v125, v121, s44
    v_perm_b32 v79, v125, v121, s45
    v_perm_b32 v80, v102, v98, s44
    v_perm_b32 v84, v102, v98, s45
    v_perm_b32 v81, v110, v106, s44
    v_perm_b32 v85, v110, v106, s45
    v_perm_b32 v82, v118, v114, s44
    v_perm_b32 v86, v118, v114, s45
    v_perm_b32 v83, v126, v122, s44
    v_perm_b32 v87, v126, v122, s45
    v_perm_b32 v88, v103, v99, s44
    v_perm_b32 v92, v103, v99, s45
    v_perm_b32 v89, v111, v107, s44
    v_perm_b32 v93, v111, v107, s45
    v_perm_b32 v90, v119, v115, s44
    v_perm_b32 v94, v119, v115, s45
    v_perm_b32 v91, v127, v123, s44
    v_perm_b32 v95, v127, v123, s45
    buffer_load_dwordx4 v[96:99], v214, s[20:23], s48 offen offset:0 nt
    buffer_load_dwordx4 v[100:103], v214, s[20:23], s48 offen offset:256 nt
    buffer_load_dwordx4 v[104:107], v214, s[20:23], s48 offen offset:512 nt
    buffer_load_dwordx4 v[108:111], v214, s[20:23], s48 offen offset:768 nt
    buffer_load_dwordx4 v[112:115], v215, s[20:23], s48 offen offset:0 nt
    buffer_load_dwordx4 v[116:119], v215, s[20:23], s48 offen offset:256 nt
    buffer_load_dwordx4 v[120:123], v215, s[20:23], s48 offen offset:512 nt
    buffer_load_dwordx4 v[124:127], v215, s[20:23], s48 offen offset:768 nt
    s_add_u32 s48, s48, 8192
    s_and_b32 s48, s48, 0x1ffff
    s_waitcnt lgkmcnt(0)
    v_max3_f32 v217, v144, v145, v146
    v_max3_f32 v217, v217, v147, v148
    v_max3_f32 v217, v217, v149, v150
    v_max_f32 v217, v217, v151
    v_mov_b32 v218, v217
    s_nop 1
    v_mfma_f32_16x16x32_bf16 v[152:155], v[32:35], v[128:131], 0
    v_permlane16_swap_b32 v218, v217
    s_nop 1
    v_max_f32 v217, v217, v218
    v_mov_b32 v218, v217
    s_nop 1
    v_permlane32_swap_b32 v218, v217
    v_mfma_f32_16x16x32_bf16 v[156:159], v[48:51], v[128:131], 0
    s_nop 1
    v_max_f32 v217, v217, v218
    v_sub_f32 v168, 0, v217
    v_sub_f32 v169, 0, v217
    v_sub_f32 v170, 0, v217
    v_sub_f32 v171, 0, v217
    v_sub_f32 v144, v144, v217
    v_sub_f32 v145, v145, v217
    v_sub_f32 v146, v146, v217
    v_sub_f32 v147, v147, v217
    ds_read_b128 v[128:131], v216 offset:8192
    v_mfma_f32_16x16x32_bf16 v[152:155], v[36:39], v[132:135], v[152:155]
    v_sub_f32 v148, v148, v217
    v_sub_f32 v149, v149, v217
    v_sub_f32 v150, v150, v217
    v_sub_f32 v151, v151, v217
    v_mfma_f32_16x16x32_bf16 v[156:159], v[52:55], v[132:135], v[156:159]
    v_exp_f32 v144, v144
    v_exp_f32 v145, v145
    ds_read_b128 v[132:135], v216 offset:9216
    v_mfma_f32_16x16x32_bf16 v[152:155], v[40:43], v[136:139], v[152:155]
    v_exp_f32 v146, v146
    v_exp_f32 v147, v147
    v_mfma_f32_16x16x32_bf16 v[156:159], v[56:59], v[136:139], v[156:159]
    v_exp_f32 v148, v148
    v_exp_f32 v149, v149
    ds_read_b128 v[136:139], v216 offset:10240
    v_mfma_f32_16x16x32_bf16 v[152:155], v[44:47], v[140:143], v[152:155]
    v_exp_f32 v150, v150
    v_exp_f32 v151, v151
    s_nop 0
    v_cvt_pk_bf16_f32 v160, v144, v145
    v_cvt_pk_bf16_f32 v161, v146, v147
    v_mfma_f32_16x16x32_bf16 v[156:159], v[60:63], v[140:143], v[156:159]
    v_cvt_pk_bf16_f32 v162, v148, v149
    v_cvt_pk_bf16_f32 v163, v150, v151
    ds_read_b128 v[140:143], v216 offset:11264
    ds_read_b128 v[208:211], v223 offset:0
    s_nop 3
    s_waitcnt lgkmcnt(0)
    v_max3_f32 v217, v152, v153, v154
    v_max3_f32 v217, v217, v155, v156
    v_max3_f32 v217, v217, v157, v158
    v_mfma_f32_16x16x32_bf16 v[144:147], v[32:35], v[128:131], 0
    v_max_f32 v217, v217, v159
    v_mov_b32 v218, v217
    s_nop 1
    v_mfma_f32_16x16x32_bf16 v[148:151], v[48:51], v[128:131], 0
    v_permlane16_swap_b32 v218, v217
    s_nop 1
    v_max_f32 v217, v217, v218
    ds_read_b128 v[128:131], v216 offset:12288
    v_mfma_f32_16x16x32_bf16 v[144:147], v[36:39], v[132:135], v[144:147]
    v_mov_b32 v218, v217
    s_nop 1
    v_permlane32_swap_b32 v218, v217
    v_mfma_f32_16x16x32_bf16 v[148:151], v[52:55], v[132:135], v[148:151]
    s_nop 1
    v_max_f32 v217, v217, v218
    v_sub_f32 v172, 0, v217
    ds_read_b128 v[132:135], v216 offset:13312
    v_mfma_f32_16x16x32_bf16 v[144:147], v[40:43], v[136:139], v[144:147]
    v_sub_f32 v173, 0, v217
    v_sub_f32 v174, 0, v217
    v_sub_f32 v175, 0, v217
    v_mfma_f32_16x16x32_bf16 v[148:151], v[56:59], v[136:139], v[148:151]
    v_sub_f32 v152, v152, v217
    v_sub_f32 v153, v153, v217
    v_sub_f32 v154, v154, v217
    ds_read_b128 v[136:139], v216 offset:14336
    v_mfma_f32_16x16x32_bf16 v[144:147], v[44:47], v[140:143], v[144:147]
    v_sub_f32 v155, v155, v217
    v_sub_f32 v156, v156, v217
    v_sub_f32 v157, v157, v217
    v_mfma_f32_16x16x32_bf16 v[148:151], v[60:63], v[140:143], v[148:151]
    v_sub_f32 v158, v158, v217
    v_sub_f32 v159, v159, v217
    ds_read_b128 v[140:143], v216 offset:15360
    v_mfma_f32_16x16x32_bf16 v[204:207], v[208:211], v[160:163], v[204:207]
    v_exp_f32 v152, v152
    v_exp_f32 v153, v153
    v_mfma_f32_16x16x32_bf16 a[0:3], v[64:67], v[160:163], 0
    v_exp_f32 v154, v154
    ds_read_b128 v[208:211], v223 offset:1024
    v_mfma_f32_16x16x32_bf16 a[4:7], v[68:71], v[160:163], 0
    v_exp_f32 v155, v155
    v_mfma_f32_16x16x32_bf16 a[8:11], v[72:75], v[160:163], 0
    v_exp_f32 v156, v156
    v_mfma_f32_16x16x32_bf16 a[12:15], v[76:79], v[160:163], 0
    v_exp_f32 v157, v157
    v_mfma_f32_16x16x32_bf16 a[16:19], v[80:83], v[160:163], 0
    v_exp_f32 v158, v158
    v_mfma_f32_16x16x32_bf16 a[20:23], v[84:87], v[160:163], 0
    v_exp_f32 v159, v159
    v_mfma_f32_16x16x32_bf16 a[24:27], v[88:91], v[160:163], 0
    s_nop 0
    v_cvt_pk_bf16_f32 v164, v152, v153
    v_cvt_pk_bf16_f32 v165, v154, v155
    v_mfma_f32_16x16x32_bf16 a[28:31], v[92:95], v[160:163], 0
    v_cvt_pk_bf16_f32 v166, v156, v157
    v_cvt_pk_bf16_f32 v167, v158, v159
    s_waitcnt lgkmcnt(0)
    v_max3_f32 v217, v144, v145, v146
    v_max3_f32 v217, v217, v147, v148
    v_max3_f32 v217, v217, v149, v150
    v_mfma_f32_16x16x32_bf16 v[152:155], v[32:35], v[128:131], 0
    v_max_f32 v217, v217, v151
    v_mov_b32 v218, v217
    s_nop 1
    v_mfma_f32_16x16x32_bf16 v[156:159], v[48:51], v[128:131], 0
    v_permlane16_swap_b32 v218, v217
    s_nop 1
    v_max_f32 v217, v217, v218
    ds_read_b128 v[128:131], v216 offset:16384
    v_mfma_f32_16x16x32_bf16 v[152:155], v[36:39], v[132:135], v[152:155]
    v_mov_b32 v218, v217
    s_nop 1
    v_permlane32_swap_b32 v218, v217
    v_mfma_f32_16x16x32_bf16 v[156:159], v[52:55], v[132:135], v[156:159]
    s_nop 1
    v_max_f32 v217, v217, v218
    v_sub_f32 v176, 0, v217
    ds_read_b128 v[132:135], v216 offset:17408
    v_mfma_f32_16x16x32_bf16 v[152:155], v[40:43], v[136:139], v[152:155]
    v_sub_f32 v177, 0, v217
    v_sub_f32 v178, 0, v217
    v_sub_f32 v179, 0, v217
    v_mfma_f32_16x16x32_bf16 v[156:159], v[56:59], v[136:139], v[156:159]
    v_sub_f32 v144, v144, v217
    v_sub_f32 v145, v145, v217
    v_sub_f32 v146, v146, v217
    ds_read_b128 v[136:139], v216 offset:18432
    v_mfma_f32_16x16x32_bf16 v[152:155], v[44:47], v[140:143], v[152:155]
    v_sub_f32 v147, v147, v217
    v_sub_f32 v148, v148, v217
    v_sub_f32 v149, v149, v217
    v_mfma_f32_16x16x32_bf16 v[156:159], v[60:63], v[140:143], v[156:159]
    v_sub_f32 v150, v150, v217
    v_sub_f32 v151, v151, v217
    ds_read_b128 v[140:143], v216 offset:19456
    v_mfma_f32_16x16x32_bf16 v[204:207], v[208:211], v[164:167], v[204:207]
    v_exp_f32 v144, v144
    v_exp_f32 v145, v145
    v_mfma_f32_16x16x32_bf16 a[32:35], v[64:67], v[164:167], 0
    v_exp_f32 v146, v146
    ds_read_b128 v[208:211], v223 offset:2048
    v_mfma_f32_16x16x32_bf16 a[36:39], v[68:71], v[164:167], 0
    v_exp_f32 v147, v147
    v_mfma_f32_16x16x32_bf16 a[40:43], v[72:75], v[164:167], 0
    v_exp_f32 v148, v148
    v_mfma_f32_16x16x32_bf16 a[44:47], v[76:79], v[164:167], 0
    v_exp_f32 v149, v149
    v_mfma_f32_16x16x32_bf16 a[48:51], v[80:83], v[164:167], 0
    v_exp_f32 v150, v150
    v_mfma_f32_16x16x32_bf16 a[52:55], v[84:87], v[164:167], 0
    v_exp_f32 v151, v151
    v_mfma_f32_16x16x32_bf16 a[56:59], v[88:91], v[164:167], 0
    s_nop 0
    v_cvt_pk_bf16_f32 v160, v144, v145
    v_cvt_pk_bf16_f32 v161, v146, v147
    v_mfma_f32_16x16x32_bf16 a[60:63], v[92:95], v[164:167], 0
    v_cvt_pk_bf16_f32 v162, v148, v149
    v_cvt_pk_bf16_f32 v163, v150, v151
    s_waitcnt lgkmcnt(0)
    v_max3_f32 v217, v152, v153, v154
    v_max3_f32 v217, v217, v155, v156
    v_max3_f32 v217, v217, v157, v158
    v_mfma_f32_16x16x32_bf16 v[144:147], v[32:35], v[128:131], 0
    v_max_f32 v217, v217, v159
    v_mov_b32 v218, v217
    s_nop 1
    v_mfma_f32_16x16x32_bf16 v[148:151], v[48:51], v[128:131], 0
    v_permlane16_swap_b32 v218, v217
    s_nop 1
    v_max_f32 v217, v217, v218
    ds_read_b128 v[128:131], v216 offset:20480
    v_mfma_f32_16x16x32_bf16 v[144:147], v[36:39], v[132:135], v[144:147]
    v_mov_b32 v218, v217
    s_nop 1
    v_permlane32_swap_b32 v218, v217
    v_mfma_f32_16x16x32_bf16 v[148:151], v[52:55], v[132:135], v[148:151]
    s_nop 1
    v_max_f32 v217, v217, v218
    v_sub_f32 v180, 0, v217
    ds_read_b128 v[132:135], v216 offset:21504
    v_mfma_f32_16x16x32_bf16 v[144:147], v[40:43], v[136:139], v[144:147]
    v_sub_f32 v181, 0, v217
    v_sub_f32 v182, 0, v217
    v_sub_f32 v183, 0, v217
    v_mfma_f32_16x16x32_bf16 v[148:151], v[56:59], v[136:139], v[148:151]
    v_sub_f32 v152, v152, v217
    v_sub_f32 v153, v153, v217
    v_sub_f32 v154, v154, v217
    ds_read_b128 v[136:139], v216 offset:22528
    v_mfma_f32_16x16x32_bf16 v[144:147], v[44:47], v[140:143], v[144:147]
    v_sub_f32 v155, v155, v217
    v_sub_f32 v156, v156, v217
    v_sub_f32 v157, v157, v217
    v_mfma_f32_16x16x32_bf16 v[148:151], v[60:63], v[140:143], v[148:151]
    v_sub_f32 v158, v158, v217
    v_sub_f32 v159, v159, v217
    ds_read_b128 v[140:143], v216 offset:23552
    v_mfma_f32_16x16x32_bf16 v[204:207], v[208:211], v[160:163], v[204:207]
    v_exp_f32 v152, v152
    v_exp_f32 v153, v153
    v_mfma_f32_16x16x32_bf16 a[64:67], v[64:67], v[160:163], 0
    v_exp_f32 v154, v154
    ds_read_b128 v[208:211], v223 offset:3072
    v_mfma_f32_16x16x32_bf16 a[68:71], v[68:71], v[160:163], 0
    v_exp_f32 v155, v155
    v_mfma_f32_16x16x32_bf16 a[72:75], v[72:75], v[160:163], 0
    v_exp_f32 v156, v156
    v_mfma_f32_16x16x32_bf16 a[76:79], v[76:79], v[160:163], 0
    v_exp_f32 v157, v157
    v_mfma_f32_16x16x32_bf16 a[80:83], v[80:83], v[160:163], 0
    v_exp_f32 v158, v158
    v_mfma_f32_16x16x32_bf16 a[84:87], v[84:87], v[160:163], 0
    v_exp_f32 v159, v159
    v_mfma_f32_16x16x32_bf16 a[88:91], v[88:91], v[160:163], 0
    s_nop 0
    v_cvt_pk_bf16_f32 v164, v152, v153
    v_cvt_pk_bf16_f32 v165, v154, v155
    v_mfma_f32_16x16x32_bf16 a[92:95], v[92:95], v[160:163], 0
    v_cvt_pk_bf16_f32 v166, v156, v157
    v_cvt_pk_bf16_f32 v167, v158, v159
    s_waitcnt lgkmcnt(0)
    v_max3_f32 v217, v144, v145, v146
    v_max3_f32 v217, v217, v147, v148
    v_max3_f32 v217, v217, v149, v150
    v_mfma_f32_16x16x32_bf16 v[152:155], v[32:35], v[128:131], 0
    v_max_f32 v217, v217, v151
    v_mov_b32 v218, v217
    s_nop 1
    v_mfma_f32_16x16x32_bf16 v[156:159], v[48:51], v[128:131], 0
    v_permlane16_swap_b32 v218, v217
    s_nop 1
    v_max_f32 v217, v217, v218
    ds_read_b128 v[128:131], v216 offset:24576
    v_mfma_f32_16x16x32_bf16 v[152:155], v[36:39], v[132:135], v[152:155]
    v_mov_b32 v218, v217
    s_nop 1
    v_permlane32_swap_b32 v218, v217
    v_mfma_f32_16x16x32_bf16 v[156:159], v[52:55], v[132:135], v[156:159]
    s_nop 1
    v_max_f32 v217, v217, v218
    v_sub_f32 v184, 0, v217
    ds_read_b128 v[132:135], v216 offset:25600
    v_mfma_f32_16x16x32_bf16 v[152:155], v[40:43], v[136:139], v[152:155]
    v_sub_f32 v185, 0, v217
    v_sub_f32 v186, 0, v217
    v_sub_f32 v187, 0, v217
    v_mfma_f32_16x16x32_bf16 v[156:159], v[56:59], v[136:139], v[156:159]
    v_sub_f32 v144, v144, v217
    v_sub_f32 v145, v145, v217
    v_sub_f32 v146, v146, v217
    ds_read_b128 v[136:139], v216 offset:26624
    v_mfma_f32_16x16x32_bf16 v[152:155], v[44:47], v[140:143], v[152:155]
    v_sub_f32 v147, v147, v217
    v_sub_f32 v148, v148, v217
    v_sub_f32 v149, v149, v217
    v_mfma_f32_16x16x32_bf16 v[156:159], v[60:63], v[140:143], v[156:159]
    v_sub_f32 v150, v150, v217
    v_sub_f32 v151, v151, v217
    ds_read_b128 v[140:143], v216 offset:27648
    v_mfma_f32_16x16x32_bf16 v[204:207], v[208:211], v[164:167], v[204:207]
    v_exp_f32 v144, v144
    v_exp_f32 v145, v145
    v_mfma_f32_16x16x32_bf16 a[96:99], v[64:67], v[164:167], 0
    v_exp_f32 v146, v146
    ds_read_b128 v[208:211], v223 offset:4096
    v_mfma_f32_16x16x32_bf16 a[100:103], v[68:71], v[164:167], 0
    v_exp_f32 v147, v147
    v_mfma_f32_16x16x32_bf16 a[104:107], v[72:75], v[164:167], 0
    v_exp_f32 v148, v148
    v_mfma_f32_16x16x32_bf16 a[108:111], v[76:79], v[164:167], 0
    v_exp_f32 v149, v149
    v_mfma_f32_16x16x32_bf16 a[112:115], v[80:83], v[164:167], 0
    v_exp_f32 v150, v150
    v_mfma_f32_16x16x32_bf16 a[116:119], v[84:87], v[164:167], 0
    v_exp_f32 v151, v151
    v_mfma_f32_16x16x32_bf16 a[120:123], v[88:91], v[164:167], 0
    s_nop 0
    v_cvt_pk_bf16_f32 v160, v144, v145
    v_cvt_pk_bf16_f32 v161, v146, v147
    v_mfma_f32_16x16x32_bf16 a[124:127], v[92:95], v[164:167], 0
    v_cvt_pk_bf16_f32 v162, v148, v149
    v_cvt_pk_bf16_f32 v163, v150, v151
    s_waitcnt lgkmcnt(0)
    v_max3_f32 v217, v152, v153, v154
    v_max3_f32 v217, v217, v155, v156
    v_max3_f32 v217, v217, v157, v158
    v_mfma_f32_16x16x32_bf16 v[144:147], v[32:35], v[128:131], 0
    v_max_f32 v217, v217, v159
    v_mov_b32 v218, v217
    s_nop 1
    v_mfma_f32_16x16x32_bf16 v[148:151], v[48:51], v[128:131], 0
    v_permlane16_swap_b32 v218, v217
    s_nop 1
    v_max_f32 v217, v217, v218
    ds_read_b128 v[128:131], v216 offset:28672
    v_mfma_f32_16x16x32_bf16 v[144:147], v[36:39], v[132:135], v[144:147]
    v_mov_b32 v218, v217
    s_nop 1
    v_permlane32_swap_b32 v218, v217
    v_mfma_f32_16x16x32_bf16 v[148:151], v[52:55], v[132:135], v[148:151]
    s_nop 1
    v_max_f32 v217, v217, v218
    v_sub_f32 v188, 0, v217
    ds_read_b128 v[132:135], v216 offset:29696
    v_mfma_f32_16x16x32_bf16 v[144:147], v[40:43], v[136:139], v[144:147]
    v_sub_f32 v189, 0, v217
    v_sub_f32 v190, 0, v217
    v_sub_f32 v191, 0, v217
    v_mfma_f32_16x16x32_bf16 v[148:151], v[56:59], v[136:139], v[148:151]
    v_sub_f32 v152, v152, v217
    v_sub_f32 v153, v153, v217
    v_sub_f32 v154, v154, v217
    ds_read_b128 v[136:139], v216 offset:30720
    v_mfma_f32_16x16x32_bf16 v[144:147], v[44:47], v[140:143], v[144:147]
    v_sub_f32 v155, v155, v217
    v_sub_f32 v156, v156, v217
    v_sub_f32 v157, v157, v217
    v_mfma_f32_16x16x32_bf16 v[148:151], v[60:63], v[140:143], v[148:151]
    v_sub_f32 v158, v158, v217
    v_sub_f32 v159, v159, v217
    ds_read_b128 v[140:143], v216 offset:31744
    v_mfma_f32_16x16x32_bf16 v[204:207], v[208:211], v[160:163], v[204:207]
    v_exp_f32 v152, v152
    v_exp_f32 v153, v153
    v_mfma_f32_16x16x32_bf16 a[128:131], v[64:67], v[160:163], 0
    v_exp_f32 v154, v154
    ds_read_b128 v[208:211], v223 offset:5120
    v_mfma_f32_16x16x32_bf16 a[132:135], v[68:71], v[160:163], 0
    v_exp_f32 v155, v155
    v_mfma_f32_16x16x32_bf16 a[136:139], v[72:75], v[160:163], 0
    v_exp_f32 v156, v156
    v_mfma_f32_16x16x32_bf16 a[140:143], v[76:79], v[160:163], 0
    v_exp_f32 v157, v157
    v_mfma_f32_16x16x32_bf16 a[144:147], v[80:83], v[160:163], 0
    v_exp_f32 v158, v158
    v_mfma_f32_16x16x32_bf16 a[148:151], v[84:87], v[160:163], 0
    v_exp_f32 v159, v159
    v_mfma_f32_16x16x32_bf16 a[152:155], v[88:91], v[160:163], 0
    s_nop 0
    v_cvt_pk_bf16_f32 v164, v152, v153
    v_cvt_pk_bf16_f32 v165, v154, v155
    v_mfma_f32_16x16x32_bf16 a[156:159], v[92:95], v[160:163], 0
    v_cvt_pk_bf16_f32 v166, v156, v157
    v_cvt_pk_bf16_f32 v167, v158, v159
    s_waitcnt lgkmcnt(0)
    v_max3_f32 v217, v144, v145, v146
    v_max3_f32 v217, v217, v147, v148
    v_max3_f32 v217, v217, v149, v150
    v_mfma_f32_16x16x32_bf16 v[152:155], v[32:35], v[128:131], 0
    v_max_f32 v217, v217, v151
    v_mov_b32 v218, v217
    s_nop 1
    v_mfma_f32_16x16x32_bf16 v[156:159], v[48:51], v[128:131], 0
    v_permlane16_swap_b32 v218, v217
    s_nop 1
    v_max_f32 v217, v217, v218
    ds_read_b128 v[128:131], v216 offset:32768
    v_mfma_f32_16x16x32_bf16 v[152:155], v[36:39], v[132:135], v[152:155]
    v_mov_b32 v218, v217
    s_nop 1
    v_permlane32_swap_b32 v218, v217
    v_mfma_f32_16x16x32_bf16 v[156:159], v[52:55], v[132:135], v[156:159]
    s_nop 1
    v_max_f32 v217, v217, v218
    v_sub_f32 v192, 0, v217
    ds_read_b128 v[132:135], v216 offset:33792
    v_mfma_f32_16x16x32_bf16 v[152:155], v[40:43], v[136:139], v[152:155]
    v_sub_f32 v193, 0, v217
    v_sub_f32 v194, 0, v217
    v_sub_f32 v195, 0, v217
    v_mfma_f32_16x16x32_bf16 v[156:159], v[56:59], v[136:139], v[156:159]
    v_sub_f32 v144, v144, v217
    v_sub_f32 v145, v145, v217
    v_sub_f32 v146, v146, v217
    ds_read_b128 v[136:139], v216 offset:34816
    v_mfma_f32_16x16x32_bf16 v[152:155], v[44:47], v[140:143], v[152:155]
    v_sub_f32 v147, v147, v217
    v_sub_f32 v148, v148, v217
    v_sub_f32 v149, v149, v217
    v_mfma_f32_16x16x32_bf16 v[156:159], v[60:63], v[140:143], v[156:159]
    v_sub_f32 v150, v150, v217
    v_sub_f32 v151, v151, v217
    ds_read_b128 v[140:143], v216 offset:35840
    v_mfma_f32_16x16x32_bf16 v[204:207], v[208:211], v[164:167], v[204:207]
    v_exp_f32 v144, v144
    v_exp_f32 v145, v145
    v_mfma_f32_16x16x32_bf16 a[160:163], v[64:67], v[164:167], 0
    v_exp_f32 v146, v146
    ds_read_b128 v[208:211], v223 offset:6144
    v_mfma_f32_16x16x32_bf16 a[164:167], v[68:71], v[164:167], 0
    v_exp_f32 v147, v147
    v_mfma_f32_16x16x32_bf16 a[168:171], v[72:75], v[164:167], 0
    v_exp_f32 v148, v148
    v_mfma_f32_16x16x32_bf16 a[172:175], v[76:79], v[164:167], 0
    v_exp_f32 v149, v149
    v_mfma_f32_16x16x32_bf16 a[176:179], v[80:83], v[164:167], 0
    v_exp_f32 v150, v150
    v_mfma_f32_16x16x32_bf16 a[180:183], v[84:87], v[164:167], 0
    v_exp_f32 v151, v151
    v_mfma_f32_16x16x32_bf16 a[184:187], v[88:91], v[164:167], 0
    s_nop 0
    v_cvt_pk_bf16_f32 v160, v144, v145
    v_cvt_pk_bf16_f32 v161, v146, v147
    v_mfma_f32_16x16x32_bf16 a[188:191], v[92:95], v[164:167], 0
    v_cvt_pk_bf16_f32 v162, v148, v149
    v_cvt_pk_bf16_f32 v163, v150, v151
    s_waitcnt lgkmcnt(0)
    v_max3_f32 v217, v152, v153, v154
    v_max3_f32 v217, v217, v155, v156
    v_max3_f32 v217, v217, v157, v158
    v_mfma_f32_16x16x32_bf16 v[144:147], v[32:35], v[128:131], 0
    v_max_f32 v217, v217, v159
    v_mov_b32 v218, v217
    s_nop 1
    v_mfma_f32_16x16x32_bf16 v[148:151], v[48:51], v[128:131], 0
    v_permlane16_swap_b32 v218, v217
    s_nop 1
    v_max_f32 v217, v217, v218
    ds_read_b128 v[128:131], v216 offset:0
    v_mfma_f32_16x16x32_bf16 v[144:147], v[36:39], v[132:135], v[144:147]
    v_mov_b32 v218, v217
    s_nop 1
    v_permlane32_swap_b32 v218, v217
    v_mfma_f32_16x16x32_bf16 v[148:151], v[52:55], v[132:135], v[148:151]
    s_nop 1
    v_max_f32 v217, v217, v218
    v_sub_f32 v196, 0, v217
    ds_read_b128 v[132:135], v216 offset:1024
    v_mfma_f32_16x16x32_bf16 v[144:147], v[40:43], v[136:139], v[144:147]
    v_sub_f32 v197, 0, v217
    v_sub_f32 v198, 0, v217
    v_sub_f32 v199, 0, v217
    v_mfma_f32_16x16x32_bf16 v[148:151], v[56:59], v[136:139], v[148:151]
    v_sub_f32 v152, v152, v217
    v_sub_f32 v153, v153, v217
    v_sub_f32 v154, v154, v217
    ds_read_b128 v[136:139], v216 offset:2048
    v_mfma_f32_16x16x32_bf16 v[144:147], v[44:47], v[140:143], v[144:147]
    v_sub_f32 v155, v155, v217
    v_sub_f32 v156, v156, v217
    v_sub_f32 v157, v157, v217
    v_mfma_f32_16x16x32_bf16 v[148:151], v[60:63], v[140:143], v[148:151]
    v_sub_f32 v158, v158, v217
    v_sub_f32 v159, v159, v217
    ds_read_b128 v[140:143], v216 offset:3072
    v_mfma_f32_16x16x32_bf16 v[204:207], v[208:211], v[160:163], v[204:207]
    v_exp_f32 v152, v152
    v_exp_f32 v153, v153
    buffer_load_dwordx4 v[32:35], v212, s[16:19], s47 offen offset:0 nt
    buffer_load_dwordx4 v[36:39], v212, s[16:19], s47 offen offset:16 nt
    v_mfma_f32_16x16x32_bf16 a[192:195], v[64:67], v[160:163], 0
    v_exp_f32 v154, v154
    ds_read_b128 v[208:211], v223 offset:7168
    buffer_load_dwordx4 v[40:43], v212, s[16:19], s47 offen offset:128 nt
    v_mfma_f32_16x16x32_bf16 a[196:199], v[68:71], v[160:163], 0
    v_exp_f32 v155, v155
    buffer_load_dwordx4 v[44:47], v212, s[16:19], s47 offen offset:144 nt
    v_mfma_f32_16x16x32_bf16 a[200:203], v[72:75], v[160:163], 0
    v_exp_f32 v156, v156
    buffer_load_dwordx4 v[48:51], v213, s[16:19], s47 offen offset:0 nt
    v_mfma_f32_16x16x32_bf16 a[204:207], v[76:79], v[160:163], 0
    v_exp_f32 v157, v157
    buffer_load_dwordx4 v[52:55], v213, s[16:19], s47 offen offset:16 nt
    v_mfma_f32_16x16x32_bf16 a[208:211], v[80:83], v[160:163], 0
    v_exp_f32 v158, v158
    buffer_load_dwordx4 v[56:59], v213, s[16:19], s47 offen offset:128 nt
    v_mfma_f32_16x16x32_bf16 a[212:215], v[84:87], v[160:163], 0
    v_exp_f32 v159, v159
    buffer_load_dwordx4 v[60:63], v213, s[16:19], s47 offen offset:144 nt
    v_mfma_f32_16x16x32_bf16 a[216:219], v[88:91], v[160:163], 0
    s_nop 0
    v_cvt_pk_bf16_f32 v164, v152, v153
    v_cvt_pk_bf16_f32 v165, v154, v155
    s_add_u32 s47, s47, 8192
    v_mfma_f32_16x16x32_bf16 a[220:223], v[92:95], v[160:163], 0
    v_cvt_pk_bf16_f32 v166, v156, v157
    v_cvt_pk_bf16_f32 v167, v158, v159
    s_and_b32 s47, s47, 0x1ffff
    s_waitcnt vmcnt(16) lgkmcnt(0)
    v_max3_f32 v217, v144, v145, v146
    v_max3_f32 v217, v217, v147, v148
    v_max3_f32 v217, v217, v149, v150
    v_mfma_f32_16x16x32_bf16 v[152:155], v[0:3], v[128:131], v[168:171]
    v_max_f32 v217, v217, v151
    v_mov_b32 v218, v217
    s_nop 1
    v_mfma_f32_16x16x32_bf16 v[156:159], v[16:19], v[128:131], v[168:171]
    v_permlane16_swap_b32 v218, v217
    s_nop 1
    v_max_f32 v217, v217, v218
    ds_read_b128 v[128:131], v216 offset:4096
    v_mfma_f32_16x16x32_bf16 v[152:155], v[4:7], v[132:135], v[152:155]
    v_mov_b32 v218, v217
    s_nop 1
    v_permlane32_swap_b32 v218, v217
    v_mfma_f32_16x16x32_bf16 v[156:159], v[20:23], v[132:135], v[156:159]
    s_nop 1
    v_max_f32 v217, v217, v218
    v_sub_f32 v200, 0, v217
    ds_read_b128 v[132:135], v216 offset:5120
    v_mfma_f32_16x16x32_bf16 v[152:155], v[8:11], v[136:139], v[152:155]
    v_sub_f32 v201, 0, v217
    v_sub_f32 v202, 0, v217
    v_sub_f32 v203, 0, v217
    v_mfma_f32_16x16x32_bf16 v[156:159], v[24:27], v[136:139], v[156:159]
    v_sub_f32 v144, v144, v217
    v_sub_f32 v145, v145, v217
    v_sub_f32 v146, v146, v217
    ds_read_b128 v[136:139], v216 offset:6144
    v_mfma_f32_16x16x32_bf16 v[152:155], v[12:15], v[140:143], v[152:155]
    v_sub_f32 v147, v147, v217
    v_sub_f32 v148, v148, v217
    v_sub_f32 v149, v149, v217
    v_mfma_f32_16x16x32_bf16 v[156:159], v[28:31], v[140:143], v[156:159]
    v_sub_f32 v150, v150, v217
    v_sub_f32 v151, v151, v217
    ds_read_b128 v[140:143], v216 offset:7168
    v_mfma_f32_16x16x32_bf16 v[204:207], v[208:211], v[164:167], v[204:207]
    v_exp_f32 v144, v144
    v_exp_f32 v145, v145
    v_mfma_f32_16x16x32_bf16 a[224:227], v[64:67], v[164:167], 0
    v_exp_f32 v146, v146
    ds_read_b128 v[208:211], v223 offset:8192
    v_mfma_f32_16x16x32_bf16 a[228:231], v[68:71], v[164:167], 0
    v_exp_f32 v147, v147
    v_mfma_f32_16x16x32_bf16 a[232:235], v[72:75], v[164:167], 0
    v_exp_f32 v148, v148
    v_mfma_f32_16x16x32_bf16 a[236:239], v[76:79], v[164:167], 0
    v_exp_f32 v149, v149
    v_mfma_f32_16x16x32_bf16 a[240:243], v[80:83], v[164:167], 0
    v_exp_f32 v150, v150
    v_mfma_f32_16x16x32_bf16 a[244:247], v[84:87], v[164:167], 0
    v_exp_f32 v151, v151
    v_mfma_f32_16x16x32_bf16 a[248:251], v[88:91], v[164:167], 0
    s_nop 0
    v_cvt_pk_bf16_f32 v160, v144, v145
    v_cvt_pk_bf16_f32 v161, v146, v147
    v_mfma_f32_16x16x32_bf16 a[252:255], v[92:95], v[164:167], 0
    v_cvt_pk_bf16_f32 v162, v148, v149
    v_cvt_pk_bf16_f32 v163, v150, v151
K1_aloop:
    s_waitcnt lgkmcnt(0)
    v_max3_f32 v217, v152, v153, v154
    v_max3_f32 v217, v217, v155, v156
    v_mfma_f32_16x16x32_bf16 v[144:147], v[0:3], v[128:131], v[172:175]
    v_max3_f32 v217, v217, v157, v158
    v_max_f32 v217, v217, v159
    v_mfma_f32_16x16x32_bf16 v[148:151], v[16:19], v[128:131], v[172:175]
    v_cmp_lt_f32 vcc, s50, v217
    ds_read_b128 v[128:131], v216 offset:8192
    v_mfma_f32_16x16x32_bf16 v[144:147], v[4:7], v[132:135], v[144:147]
    v_mfma_f32_16x16x32_bf16 v[148:151], v[20:23], v[132:135], v[148:151]
    s_cbranch_vccnz K1_rare_o0
K1_back_o0:
    v_exp_f32 v152, v152
    ds_read_b128 v[132:135], v216 offset:9216
    v_mfma_f32_16x16x32_bf16 v[144:147], v[8:11], v[136:139], v[144:147]
    v_exp_f32 v153, v153
    v_mfma_f32_16x16x32_bf16 v[148:151], v[24:27], v[136:139], v[148:151]
    v_exp_f32 v154, v154
    ds_read_b128 v[136:139], v216 offset:10240
    v_mfma_f32_16x16x32_bf16 v[144:147], v[12:15], v[140:143], v[144:147]
    v_exp_f32 v155, v155
    v_mfma_f32_16x16x32_bf16 v[148:151], v[28:31], v[140:143], v[148:151]
    v_exp_f32 v156, v156
    ds_read_b128 v[140:143], v216 offset:11264
    v_mfma_f32_16x16x32_bf16 v[204:207], v[208:211], v[160:163], v[204:207]
    v_exp_f32 v157, v157
    v_mfma_f32_16x16x32_bf16 v[224:227], v[64:67], v[160:163], v[224:227]
    v_exp_f32 v158, v158
    ds_read_b128 v[208:211], v223 offset:0
    s_waitcnt vmcnt(8)
    v_mfma_f32_16x16x32_bf16 v[228:231], v[68:71], v[160:163], v[228:231]
    v_exp_f32 v159, v159
    v_perm_b32 v64, v100, v96, s44
    v_perm_b32 v68, v100, v96, s45
    v_perm_b32 v65, v108, v104, s44
    v_mfma_f32_16x16x32_bf16 v[232:235], v[72:75], v[160:163], v[232:235]
    v_perm_b32 v69, v108, v104, s45
    v_perm_b32 v66, v116, v112, s44
    v_perm_b32 v70, v116, v112, s45
    v_mfma_f32_16x16x32_bf16 v[236:239], v[76:79], v[160:163], v[236:239]
    v_cvt_pk_bf16_f32 v164, v152, v153
    v_perm_b32 v67, v124, v120, s44
    v_perm_b32 v71, v124, v120, s45
    v_perm_b32 v72, v101, v97, s44
    v_perm_b32 v76, v101, v97, s45
    v_perm_b32 v73, v109, v105, s44
    v_mfma_f32_16x16x32_bf16 v[240:243], v[80:83], v[160:163], v[240:243]
    v_cvt_pk_bf16_f32 v165, v154, v155
    v_perm_b32 v77, v109, v105, s45
    v_perm_b32 v74, v117, v113, s44
    v_perm_b32 v78, v117, v113, s45
    v_mfma_f32_16x16x32_bf16 v[244:247], v[84:87], v[160:163], v[244:247]
    v_cvt_pk_bf16_f32 v166, v156, v157
    v_perm_b32 v75, v125, v121, s44
    v_perm_b32 v79, v125, v121, s45
    v_perm_b32 v80, v102, v98, s44
    v_perm_b32 v84, v102, v98, s45
    v_perm_b32 v81, v110, v106, s44
    v_mfma_f32_16x16x32_bf16 v[248:251], v[88:91], v[160:163], v[248:251]
    v_cvt_pk_bf16_f32 v167, v158, v159
    v_perm_b32 v85, v110, v106, s45
    v_perm_b32 v82, v118, v114, s44
    v_perm_b32 v86, v118, v114, s45
    v_mfma_f32_16x16x32_bf16 v[252:255], v[92:95], v[160:163], v[252:255]
    v_perm_b32 v83, v126, v122, s44
    v_perm_b32 v87, v126, v122, s45
    s_waitcnt lgkmcnt(0)
    v_max3_f32 v217, v144, v145, v146
    v_max3_f32 v217, v217, v147, v148
    v_mfma_f32_16x16x32_bf16 v[152:155], v[0:3], v[128:131], v[176:179]
    v_max3_f32 v217, v217, v149, v150
    v_max_f32 v217, v217, v151
    v_perm_b32 v88, v103, v99, s44
    v_perm_b32 v92, v103, v99, s45
    v_mfma_f32_16x16x32_bf16 v[156:159], v[16:19], v[128:131], v[176:179]
    v_cmp_lt_f32 vcc, s50, v217
    ds_read_b128 v[128:131], v216 offset:12288
    v_perm_b32 v89, v111, v107, s44
    v_perm_b32 v93, v111, v107, s45
    v_mfma_f32_16x16x32_bf16 v[152:155], v[4:7], v[132:135], v[152:155]
    v_perm_b32 v90, v119, v115, s44
    v_perm_b32 v94, v119, v115, s45
    v_mfma_f32_16x16x32_bf16 v[156:159], v[20:23], v[132:135], v[156:159]
    s_cbranch_vccnz K1_rare_o1
K1_back_o1:
    v_exp_f32 v144, v144
    ds_read_b128 v[132:135], v216 offset:13312
    v_perm_b32 v91, v127, v123, s44
    v_perm_b32 v95, v127, v123, s45
    v_mfma_f32_16x16x32_bf16 v[152:155], v[8:11], v[136:139], v[152:155]
    v_exp_f32 v145, v145
    v_mfma_f32_16x16x32_bf16 v[156:159], v[24:27], v[136:139], v[156:159]
    v_exp_f32 v146, v146
    ds_read_b128 v[136:139], v216 offset:14336
    buffer_load_dwordx4 v[96:99], v214, s[20:23], s48 offen offset:0 nt
    v_mfma_f32_16x16x32_bf16 v[152:155], v[12:15], v[140:143], v[152:155]
    v_exp_f32 v147, v147
    buffer_load_dwordx4 v[100:103], v214, s[20:23], s48 offen offset:256 nt
    v_mfma_f32_16x16x32_bf16 v[156:159], v[28:31], v[140:143], v[156:159]
    v_exp_f32 v148, v148
    ds_read_b128 v[140:143], v216 offset:15360
    buffer_load_dwordx4 v[104:107], v214, s[20:23], s48 offen offset:512 nt
    v_mfma_f32_16x16x32_bf16 v[204:207], v[208:211], v[164:167], v[204:207]
    v_exp_f32 v149, v149
    buffer_load_dwordx4 v[108:111], v214, s[20:23], s48 offen offset:768 nt
    v_mfma_f32_16x16x32_bf16 a[0:3], v[64:67], v[164:167], a[0:3]
    v_exp_f32 v150, v150
    ds_read_b128 v[208:211], v223 offset:1024
    buffer_load_dwordx4 v[112:115], v215, s[20:23], s48 offen offset:0 nt
    v_mfma_f32_16x16x32_bf16 a[4:7], v[68:71], v[164:167], a[4:7]
    v_exp_f32 v151, v151
    buffer_load_dwordx4 v[116:119], v215, s[20:23], s48 offen offset:256 nt
    v_mfma_f32_16x16x32_bf16 a[8:11], v[72:75], v[164:167], a[8:11]
    buffer_load_dwordx4 v[120:123], v215, s[20:23], s48 offen offset:512 nt
    v_mfma_f32_16x16x32_bf16 a[12:15], v[76:79], v[164:167], a[12:15]
    v_cvt_pk_bf16_f32 v160, v144, v145
    buffer_load_dwordx4 v[124:127], v215, s[20:23], s48 offen offset:768 nt
    v_mfma_f32_16x16x32_bf16 a[16:19], v[80:83], v[164:167], a[16:19]
    v_cvt_pk_bf16_f32 v161, v146, v147
    s_add_u32 s48, s48, 8192
    v_mfma_f32_16x16x32_bf16 a[20:23], v[84:87], v[164:167], a[20:23]
    v_cvt_pk_bf16_f32 v162, v148, v149
    s_and_b32 s48, s48, 0x1ffff
    v_mfma_f32_16x16x32_bf16 a[24:27], v[88:91], v[164:167], a[24:27]
    v_cvt_pk_bf16_f32 v163, v150, v151
    v_mfma_f32_16x16x32_bf16 a[28:31], v[92:95], v[164:167], a[28:31]
    s_waitcnt lgkmcnt(0)
    v_max3_f32 v217, v152, v153, v154
    v_max3_f32 v217, v217, v155, v156
    v_mfma_f32_16x16x32_bf16 v[144:147], v[0:3], v[128:131], v[180:183]
    v_max3_f32 v217, v217, v157, v158
    v_max_f32 v217, v217, v159
    v_mfma_f32_16x16x32_bf16 v[148:151], v[16:19], v[128:131], v[180:183]
    v_cmp_lt_f32 vcc, s50, v217
    ds_read_b128 v[128:131], v216 offset:16384
    v_mfma_f32_16x16x32_bf16 v[144:147], v[4:7], v[132:135], v[144:147]
    v_mfma_f32_16x16x32_bf16 v[148:151], v[20:23], v[132:135], v[148:151]
    s_cbranch_vccnz K1_rare_o2
K1_back_o2:
    v_exp_f32 v152, v152
    ds_read_b128 v[132:135], v216 offset:17408
    v_mfma_f32_16x16x32_bf16 v[144:147], v[8:11], v[136:139], v[144:147]
    v_exp_f32 v153, v153
    v_mfma_f32_16x16x32_bf16 v[148:151], v[24:27], v[136:139], v[148:151]
    v_exp_f32 v154, v154
    ds_read_b128 v[136:139], v216 offset:18432
    v_mfma_f32_16x16x32_bf16 v[144:147], v[12:15], v[140:143], v[144:147]
    v_exp_f32 v155, v155
    v_mfma_f32_16x16x32_bf16 v[148:151], v[28:31], v[140:143], v[148:151]
    v_exp_f32 v156, v156
    ds_read_b128 v[140:143], v216 offset:19456
    v_mfma_f32_16x16x32_bf16 v[204:207], v[208:211], v[160:163], v[204:207]
    v_exp_f32 v157, v157
    v_mfma_f32_16x16x32_bf16 a[32:35], v[64:67], v[160:163], a[32:35]
    v_exp_f32 v158, v158
    ds_read_b128 v[208:211], v223 offset:2048
    v_mfma_f32_16x16x32_bf16 a[36:39], v[68:71], v[160:163], a[36:39]
    v_exp_f32 v159, v159
    v_mfma_f32_16x16x32_bf16 a[40:43], v[72:75], v[160:163], a[40:43]
    v_mfma_f32_16x16x32_bf16 a[44:47], v[76:79], v[160:163], a[44:47]
    v_cvt_pk_bf16_f32 v164, v152, v153
    v_mfma_f32_16x16x32_bf16 a[48:51], v[80:83], v[160:163], a[48:51]
    v_cvt_pk_bf16_f32 v165, v154, v155
    v_mfma_f32_16x16x32_bf16 a[52:55], v[84:87], v[160:163], a[52:55]
    v_cvt_pk_bf16_f32 v166, v156, v157
    v_mfma_f32_16x16x32_bf16 a[56:59], v[88:91], v[160:163], a[56:59]
    v_cvt_pk_bf16_f32 v167, v158, v159
    v_mfma_f32_16x16x32_bf16 a[60:63], v[92:95], v[160:163], a[60:63]
    s_waitcnt lgkmcnt(0)
    v_max3_f32 v217, v144, v145, v146
    v_max3_f32 v217, v217, v147, v148
    v_mfma_f32_16x16x32_bf16 v[152:155], v[0:3], v[128:131], v[184:187]
    v_max3_f32 v217, v217, v149, v150
    v_max_f32 v217, v217, v151
    v_mfma_f32_16x16x32_bf16 v[156:159], v[16:19], v[128:131], v[184:187]
    v_cmp_lt_f32 vcc, s50, v217
    ds_read_b128 v[128:131], v216 offset:20480
    v_mfma_f32_16x16x32_bf16 v[152:155], v[4:7], v[132:135], v[152:155]
    v_mfma_f32_16x16x32_bf16 v[156:159], v[20:23], v[132:135], v[156:159]
    s_cbranch_vccnz K1_rare_o3
K1_back_o3:
    v_exp_f32 v144, v144
    ds_read_b128 v[132:135], v216 offset:21504
    v_mfma_f32_16x16x32_bf16 v[152:155], v[8:11], v[136:139], v[152:155]
    v_exp_f32 v145, v145
    v_mfma_f32_16x16x32_bf16 v[156:159], v[24:27], v[136:139], v[156:159]
    v_exp_f32 v146, v146
    ds_read_b128 v[136:139], v216 offset:22528
    v_mfma_f32_16x16x32_bf16 v[152:155], v[12:15], v[140:143], v[152:155]
    v_exp_f32 v147, v147
    v_mfma_f32_16x16x32_bf16 v[156:159], v[28:31], v[140:143], v[156:159]
    v_exp_f32 v148, v148
    ds_read_b128 v[140:143], v216 offset:23552
    v_mfma_f32_16x16x32_bf16 v[204:207], v[208:211], v[164:167], v[204:207]
    v_exp_f32 v149, v149
    v_mfma_f32_16x16x32_bf16 a[64:67], v[64:67], v[164:167], a[64:67]
    v_exp_f32 v150, v150
    ds_read_b128 v[208:211], v223 offset:3072
    v_mfma_f32_16x16x32_bf16 a[68:71], v[68:71], v[164:167], a[68:71]
    v_exp_f32 v151, v151
    v_mfma_f32_16x16x32_bf16 a[72:75], v[72:75], v[164:167], a[72:75]
    v_mfma_f32_16x16x32_bf16 a[76:79], v[76:79], v[164:167], a[76:79]
    v_cvt_pk_bf16_f32 v160, v144, v145
    v_mfma_f32_16x16x32_bf16 a[80:83], v[80:83], v[164:167], a[80:83]
    v_cvt_pk_bf16_f32 v161, v146, v147
    v_mfma_f32_16x16x32_bf16 a[84:87], v[84:87], v[164:167], a[84:87]
    v_cvt_pk_bf16_f32 v162, v148, v149
    v_mfma_f32_16x16x32_bf16 a[88:91], v[88:91], v[164:167], a[88:91]
    v_cvt_pk_bf16_f32 v163, v150, v151
    v_mfma_f32_16x16x32_bf16 a[92:95], v[92:95], v[164:167], a[92:95]
    s_waitcnt lgkmcnt(0)
    v_max3_f32 v217, v152, v153, v154
    v_max3_f32 v217, v217, v155, v156
    v_mfma_f32_16x16x32_bf16 v[144:147], v[0:3], v[128:131], v[188:191]
    v_max3_f32 v217, v217, v157, v158
    v_max_f32 v217, v217, v159
    v_mfma_f32_16x16x32_bf16 v[148:151], v[16:19], v[128:131], v[188:191]
    v_cmp_lt_f32 vcc, s50, v217
    ds_read_b128 v[128:131], v216 offset:24576
    v_mfma_f32_16x16x32_bf16 v[144:147], v[4:7], v[132:135], v[144:147]
    v_mfma_f32_16x16x32_bf16 v[148:151], v[20:23], v[132:135], v[148:151]
    s_cbranch_vccnz K1_rare_o4
K1_back_o4:
    v_exp_f32 v152, v152
    ds_read_b128 v[132:135], v216 offset:25600
    v_mfma_f32_16x16x32_bf16 v[144:147], v[8:11], v[136:139], v[144:147]
    v_exp_f32 v153, v153
    v_mfma_f32_16x16x32_bf16 v[148:151], v[24:27], v[136:139], v[148:151]
    v_exp_f32 v154, v154
    ds_read_b128 v[136:139], v216 offset:26624
    v_mfma_f32_16x16x32_bf16 v[144:147], v[12:15], v[140:143], v[144:147]
    v_exp_f32 v155, v155
    v_mfma_f32_16x16x32_bf16 v[148:151], v[28:31], v[140:143], v[148:151]
    v_exp_f32 v156, v156
    ds_read_b128 v[140:143], v216 offset:27648
    v_mfma_f32_16x16x32_bf16 v[204:207], v[208:211], v[160:163], v[204:207]
    v_exp_f32 v157, v157
    v_mfma_f32_16x16x32_bf16 a[96:99], v[64:67], v[160:163], a[96:99]
    v_exp_f32 v158, v158
    ds_read_b128 v[208:211], v223 offset:4096
    v_mfma_f32_16x16x32_bf16 a[100:103], v[68:71], v[160:163], a[100:103]
    v_exp_f32 v159, v159
    v_mfma_f32_16x16x32_bf16 a[104:107], v[72:75], v[160:163], a[104:107]
    v_mfma_f32_16x16x32_bf16 a[108:111], v[76:79], v[160:163], a[108:111]
    v_cvt_pk_bf16_f32 v164, v152, v153
    v_mfma_f32_16x16x32_bf16 a[112:115], v[80:83], v[160:163], a[112:115]
    v_cvt_pk_bf16_f32 v165, v154, v155
    v_mfma_f32_16x16x32_bf16 a[116:119], v[84:87], v[160:163], a[116:119]
    v_cvt_pk_bf16_f32 v166, v156, v157
    v_mfma_f32_16x16x32_bf16 a[120:123], v[88:91], v[160:163], a[120:123]
    v_cvt_pk_bf16_f32 v167, v158, v159
    v_mfma_f32_16x16x32_bf16 a[124:127], v[92:95], v[160:163], a[124:127]
    s_waitcnt lgkmcnt(0)
    v_max3_f32 v217, v144, v145, v146
    v_max3_f32 v217, v217, v147, v148
    v_mfma_f32_16x16x32_bf16 v[152:155], v[0:3], v[128:131], v[192:195]
    v_max3_f32 v217, v217, v149, v150
    v_max_f32 v217, v217, v151
    v_mfma_f32_16x16x32_bf16 v[156:159], v[16:19], v[128:131], v[192:195]
    v_cmp_lt_f32 vcc, s50, v217
    ds_read_b128 v[128:131], v216 offset:28672
    v_mfma_f32_16x16x32_bf16 v[152:155], v[4:7], v[132:135], v[152:155]
    v_mfma_f32_16x16x32_bf16 v[156:159], v[20:23], v[132:135], v[156:159]
    s_cbranch_vccnz K1_rare_o5
K1_back_o5:
    v_exp_f32 v144, v144
    ds_read_b128 v[132:135], v216 offset:29696
    v_mfma_f32_16x16x32_bf16 v[152:155], v[8:11], v[136:139], v[152:155]
    v_exp_f32 v145, v145
    v_mfma_f32_16x16x32_bf16 v[156:159], v[24:27], v[136:139], v[156:159]
    v_exp_f32 v146, v146
    ds_read_b128 v[136:139], v216 offset:30720
    v_mfma_f32_16x16x32_bf16 v[152:155], v[12:15], v[140:143], v[152:155]
    v_exp_f32 v147, v147
    v_mfma_f32_16x16x32_bf16 v[156:159], v[28:31], v[140:143], v[156:159]
    v_exp_f32 v148, v148
    ds_read_b128 v[140:143], v216 offset:31744
    v_mfma_f32_16x16x32_bf16 v[204:207], v[208:211], v[164:167], v[204:207]
    v_exp_f32 v149, v149
    v_mfma_f32_16x16x32_bf16 a[128:131], v[64:67], v[164:167], a[128:131]
    v_exp_f32 v150, v150
    ds_read_b128 v[208:211], v223 offset:5120
    v_mfma_f32_16x16x32_bf16 a[132:135], v[68:71], v[164:167], a[132:135]
    v_exp_f32 v151, v151
    v_mfma_f32_16x16x32_bf16 a[136:139], v[72:75], v[164:167], a[136:139]
    v_mfma_f32_16x16x32_bf16 a[140:143], v[76:79], v[164:167], a[140:143]
    v_cvt_pk_bf16_f32 v160, v144, v145
    v_mfma_f32_16x16x32_bf16 a[144:147], v[80:83], v[164:167], a[144:147]
    v_cvt_pk_bf16_f32 v161, v146, v147
    v_mfma_f32_16x16x32_bf16 a[148:151], v[84:87], v[164:167], a[148:151]
    v_cvt_pk_bf16_f32 v162, v148, v149
    v_mfma_f32_16x16x32_bf16 a[152:155], v[88:91], v[164:167], a[152:155]
    v_cvt_pk_bf16_f32 v163, v150, v151
    v_mfma_f32_16x16x32_bf16 a[156:159], v[92:95], v[164:167], a[156:159]
    s_waitcnt lgkmcnt(0)
    v_max3_f32 v217, v152, v153, v154
    v_max3_f32 v217, v217, v155, v156
    v_mfma_f32_16x16x32_bf16 v[144:147], v[0:3], v[128:131], v[196:199]
    v_max3_f32 v217, v217, v157, v158
    v_max_f32 v217, v217, v159
    v_mfma_f32_16x16x32_bf16 v[148:151], v[16:19], v[128:131], v[196:199]
    v_cmp_lt_f32 vcc, s50, v217
    ds_read_b128 v[128:131], v216 offset:32768
    v_mfma_f32_16x16x32_bf16 v[144:147], v[4:7], v[132:135], v[144:147]
    v_mfma_f32_16x16x32_bf16 v[148:151], v[20:23], v[132:135], v[148:151]
    s_cbranch_vccnz K1_rare_o6
K1_back_o6:
    v_exp_f32 v152, v152
    ds_read_b128 v[132:135], v216 offset:33792
    v_mfma_f32_16x16x32_bf16 v[144:147], v[8:11], v[136:139], v[144:147]
    v_exp_f32 v153, v153
    v_mfma_f32_16x16x32_bf16 v[148:151], v[24:27], v[136:139], v[148:151]
    v_exp_f32 v154, v154
    ds_read_b128 v[136:139], v216 offset:34816
    v_mfma_f32_16x16x32_bf16 v[144:147], v[12:15], v[140:143], v[144:147]
    v_exp_f32 v155, v155
    v_mfma_f32_16x16x32_bf16 v[148:151], v[28:31], v[140:143], v[148:151]
    v_exp_f32 v156, v156
    ds_read_b128 v[140:143], v216 offset:35840
    v_mfma_f32_16x16x32_bf16 v[204:207], v[208:211], v[160:163], v[204:207]
    v_exp_f32 v157, v157
    v_mfma_f32_16x16x32_bf16 a[160:163], v[64:67], v[160:163], a[160:163]
    v_exp_f32 v158, v158
    ds_read_b128 v[208:211], v223 offset:6144
    v_mfma_f32_16x16x32_bf16 a[164:167], v[68:71], v[160:163], a[164:167]
    v_exp_f32 v159, v159
    v_mfma_f32_16x16x32_bf16 a[168:171], v[72:75], v[160:163], a[168:171]
    v_mfma_f32_16x16x32_bf16 a[172:175], v[76:79], v[160:163], a[172:175]
    v_cvt_pk_bf16_f32 v164, v152, v153
    v_mfma_f32_16x16x32_bf16 a[176:179], v[80:83], v[160:163], a[176:179]
    v_cvt_pk_bf16_f32 v165, v154, v155
    v_mfma_f32_16x16x32_bf16 a[180:183], v[84:87], v[160:163], a[180:183]
    v_cvt_pk_bf16_f32 v166, v156, v157
    v_mfma_f32_16x16x32_bf16 a[184:187], v[88:91], v[160:163], a[184:187]
    v_cvt_pk_bf16_f32 v167, v158, v159
    v_mfma_f32_16x16x32_bf16 a[188:191], v[92:95], v[160:163], a[188:191]
    s_waitcnt lgkmcnt(0)
    v_max3_f32 v217, v144, v145, v146
    v_max3_f32 v217, v217, v147, v148
    v_mfma_f32_16x16x32_bf16 v[152:155], v[0:3], v[128:131], v[200:203]
    v_max3_f32 v217, v217, v149, v150
    v_max_f32 v217, v217, v151
    v_mfma_f32_16x16x32_bf16 v[156:159], v[16:19], v[128:131], v[200:203]
    v_cmp_lt_f32 vcc, s50, v217
    ds_read_b128 v[128:131], v216 offset:0
    v_mfma_f32_16x16x32_bf16 v[152:155], v[4:7], v[132:135], v[152:155]
    v_mfma_f32_16x16x32_bf16 v[156:159], v[20:23], v[132:135], v[156:159]
    s_cbranch_vccnz K1_rare_o7
K1_back_o7:
    v_exp_f32 v144, v144
    ds_read_b128 v[132:135], v216 offset:1024
    v_mfma_f32_16x16x32_bf16 v[152:155], v[8:11], v[136:139], v[152:155]
    v_exp_f32 v145, v145
    v_mfma_f32_16x16x32_bf16 v[156:159], v[24:27], v[136:139], v[156:159]
    v_exp_f32 v146, v146
    ds_read_b128 v[136:139], v216 offset:2048
    v_mfma_f32_16x16x32_bf16 v[152:155], v[12:15], v[140:143], v[152:155]
    v_exp_f32 v147, v147
    v_mfma_f32_16x16x32_bf16 v[156:159], v[28:31], v[140:143], v[156:159]
    v_exp_f32 v148, v148
    ds_read_b128 v[140:143], v216 offset:3072
    v_mfma_f32_16x16x32_bf16 v[204:207], v[208:211], v[164:167], v[204:207]
    v_exp_f32 v149, v149
    buffer_load_dwordx4 v[0:3], v212, s[16:19], s47 offen offset:0 nt
    buffer_load_dwordx4 v[4:7], v212, s[16:19], s47 offen offset:16 nt
    v_mfma_f32_16x16x32_bf16 a[192:195], v[64:67], v[164:167], a[192:195]
    v_exp_f32 v150, v150
    ds_read_b128 v[208:211], v223 offset:7168
    buffer_load_dwordx4 v[8:11], v212, s[16:19], s47 offen offset:128 nt
    v_mfma_f32_16x16x32_bf16 a[196:199], v[68:71], v[164:167], a[196:199]
    v_exp_f32 v151, v151
    buffer_load_dwordx4 v[12:15], v212, s[16:19], s47 offen offset:144 nt
    v_mfma_f32_16x16x32_bf16 a[200:203], v[72:75], v[164:167], a[200:203]
    buffer_load_dwordx4 v[16:19], v213, s[16:19], s47 offen offset:0 nt
    v_mfma_f32_16x16x32_bf16 a[204:207], v[76:79], v[164:167], a[204:207]
    v_cvt_pk_bf16_f32 v160, v144, v145
    buffer_load_dwordx4 v[20:23], v213, s[16:19], s47 offen offset:16 nt
    v_mfma_f32_16x16x32_bf16 a[208:211], v[80:83], v[164:167], a[208:211]
    v_cvt_pk_bf16_f32 v161, v146, v147
    buffer_load_dwordx4 v[24:27], v213, s[16:19], s47 offen offset:128 nt
    v_mfma_f32_16x16x32_bf16 a[212:215], v[84:87], v[164:167], a[212:215]
    v_cvt_pk_bf16_f32 v162, v148, v149
    buffer_load_dwordx4 v[28:31], v213, s[16:19], s47 offen offset:144 nt
    v_mfma_f32_16x16x32_bf16 a[216:219], v[88:91], v[164:167], a[216:219]
    v_cvt_pk_bf16_f32 v163, v150, v151
    s_add_u32 s47, s47, 8192
    v_mfma_f32_16x16x32_bf16 a[220:223], v[92:95], v[164:167], a[220:223]
    s_and_b32 s47, s47, 0x1ffff
    s_waitcnt vmcnt(16) lgkmcnt(0)
    v_max3_f32 v217, v152, v153, v154
    v_max3_f32 v217, v217, v155, v156
    v_mfma_f32_16x16x32_bf16 v[144:147], v[32:35], v[128:131], v[168:171]
    v_max3_f32 v217, v217, v157, v158
    v_max_f32 v217, v217, v159
    v_mfma_f32_16x16x32_bf16 v[148:151], v[48:51], v[128:131], v[168:171]
    v_cmp_lt_f32 vcc, s50, v217
    ds_read_b128 v[128:131], v216 offset:4096
    v_mfma_f32_16x16x32_bf16 v[144:147], v[36:39], v[132:135], v[144:147]
    v_mfma_f32_16x16x32_bf16 v[148:151], v[52:55], v[132:135], v[148:151]
    s_cbranch_vccnz K1_rare_o8
K1_back_o8:
    v_exp_f32 v152, v152
    ds_read_b128 v[132:135], v216 offset:5120
    v_mfma_f32_16x16x32_bf16 v[144:147], v[40:43], v[136:139], v[144:147]
    v_exp_f32 v153, v153
    v_mfma_f32_16x16x32_bf16 v[148:151], v[56:59], v[136:139], v[148:151]
    v_exp_f32 v154, v154
    ds_read_b128 v[136:139], v216 offset:6144
    v_mfma_f32_16x16x32_bf16 v[144:147], v[44:47], v[140:143], v[144:147]
    v_exp_f32 v155, v155
    v_mfma_f32_16x16x32_bf16 v[148:151], v[60:63], v[140:143], v[148:151]
    v_exp_f32 v156, v156
    ds_read_b128 v[140:143], v216 offset:7168
    v_mfma_f32_16x16x32_bf16 v[204:207], v[208:211], v[160:163], v[204:207]
    v_exp_f32 v157, v157
    v_mfma_f32_16x16x32_bf16 a[224:227], v[64:67], v[160:163], a[224:227]
    v_exp_f32 v158, v158
    ds_read_b128 v[208:211], v223 offset:8192
    v_mfma_f32_16x16x32_bf16 a[228:231], v[68:71], v[160:163], a[228:231]
    v_exp_f32 v159, v159
    v_mfma_f32_16x16x32_bf16 a[232:235], v[72:75], v[160:163], a[232:235]
    v_mfma_f32_16x16x32_bf16 a[236:239], v[76:79], v[160:163], a[236:239]
    v_cvt_pk_bf16_f32 v164, v152, v153
    v_mfma_f32_16x16x32_bf16 a[240:243], v[80:83], v[160:163], a[240:243]
    v_cvt_pk_bf16_f32 v165, v154, v155
    v_mfma_f32_16x16x32_bf16 a[244:247], v[84:87], v[160:163], a[244:247]
    v_cvt_pk_bf16_f32 v166, v156, v157
    v_mfma_f32_16x16x32_bf16 a[248:251], v[88:91], v[160:163], a[248:251]
    v_cvt_pk_bf16_f32 v167, v158, v159
    v_mfma_f32_16x16x32_bf16 a[252:255], v[92:95], v[160:163], a[252:255]
    s_waitcnt lgkmcnt(0)
    v_max3_f32 v217, v144, v145, v146
    v_max3_f32 v217, v217, v147, v148
    v_mfma_f32_16x16x32_bf16 v[152:155], v[32:35], v[128:131], v[172:175]
    v_max3_f32 v217, v217, v149, v150
    v_max_f32 v217, v217, v151
    v_mfma_f32_16x16x32_bf16 v[156:159], v[48:51], v[128:131], v[172:175]
    v_cmp_lt_f32 vcc, s50, v217
    ds_read_b128 v[128:131], v216 offset:8192
    v_mfma_f32_16x16x32_bf16 v[152:155], v[36:39], v[132:135], v[152:155]
    v_mfma_f32_16x16x32_bf16 v[156:159], v[52:55], v[132:135], v[156:159]
    s_cbranch_vccnz K1_rare_e0
K1_back_e0:
    v_exp_f32 v144, v144
    ds_read_b128 v[132:135], v216 offset:9216
    v_mfma_f32_16x16x32_bf16 v[152:155], v[40:43], v[136:139], v[152:155]
    v_exp_f32 v145, v145
    v_mfma_f32_16x16x32_bf16 v[156:159], v[56:59], v[136:139], v[156:159]
    v_exp_f32 v146, v146
    ds_read_b128 v[136:139], v216 offset:10240
    v_mfma_f32_16x16x32_bf16 v[152:155], v[44:47], v[140:143], v[152:155]
    v_exp_f32 v147, v147
    v_mfma_f32_16x16x32_bf16 v[156:159], v[60:63], v[140:143], v[156:159]
    v_exp_f32 v148, v148
    ds_read_b128 v[140:143], v216 offset:11264
    v_mfma_f32_16x16x32_bf16 v[204:207], v[208:211], v[164:167], v[204:207]
    v_exp_f32 v149, v149
    v_mfma_f32_16x16x32_bf16 v[224:227], v[64:67], v[164:167], v[224:227]
    v_exp_f32 v150, v150
    ds_read_b128 v[208:211], v223 offset:0
    s_waitcnt vmcnt(8)
    v_mfma_f32_16x16x32_bf16 v[228:231], v[68:71], v[164:167], v[228:231]
    v_exp_f32 v151, v151
    v_perm_b32 v64, v100, v96, s44
    v_perm_b32 v68, v100, v96, s45
    v_perm_b32 v65, v108, v104, s44
    v_mfma_f32_16x16x32_bf16 v[232:235], v[72:75], v[164:167], v[232:235]
    v_perm_b32 v69, v108, v104, s45
    v_perm_b32 v66, v116, v112, s44
    v_perm_b32 v70, v116, v112, s45
    v_mfma_f32_16x16x32_bf16 v[236:239], v[76:79], v[164:167], v[236:239]
    v_cvt_pk_bf16_f32 v160, v144, v145
    v_perm_b32 v67, v124, v120, s44
    v_perm_b32 v71, v124, v120, s45
    v_perm_b32 v72, v101, v97, s44
    v_perm_b32 v76, v101, v97, s45
    v_perm_b32 v73, v109, v105, s44
    v_mfma_f32_16x16x32_bf16 v[240:243], v[80:83], v[164:167], v[240:243]
    v_cvt_pk_bf16_f32 v161, v146, v147
    v_perm_b32 v77, v109, v105, s45
    v_perm_b32 v74, v117, v113, s44
    v_perm_b32 v78, v117, v113, s45
    v_mfma_f32_16x16x32_bf16 v[244:247], v[84:87], v[164:167], v[244:247]
    v_cvt_pk_bf16_f32 v162, v148, v149
    v_perm_b32 v75, v125, v121, s44
    v_perm_b32 v79, v125, v121, s45
    v_perm_b32 v80, v102, v98, s44
    v_perm_b32 v84, v102, v98, s45
    v_perm_b32 v81, v110, v106, s44
    v_mfma_f32_16x16x32_bf16 v[248:251], v[88:91], v[164:167], v[248:251]
    v_cvt_pk_bf16_f32 v163, v150, v151
    v_perm_b32 v85, v110, v106, s45
    v_perm_b32 v82, v118, v114, s44
    v_perm_b32 v86, v118, v114, s45
    v_mfma_f32_16x16x32_bf16 v[252:255], v[92:95], v[164:167], v[252:255]
    v_perm_b32 v83, v126, v122, s44
    v_perm_b32 v87, v126, v122, s45
    s_waitcnt lgkmcnt(0)
    v_max3_f32 v217, v152, v153, v154
    v_max3_f32 v217, v217, v155, v156
    v_mfma_f32_16x16x32_bf16 v[144:147], v[32:35], v[128:131], v[176:179]
    v_max3_f32 v217, v217, v157, v158
    v_max_f32 v217, v217, v159
    v_perm_b32 v88, v103, v99, s44
    v_perm_b32 v92, v103, v99, s45
    v_mfma_f32_16x16x32_bf16 v[148:151], v[48:51], v[128:131], v[176:179]
    v_cmp_lt_f32 vcc, s50, v217
    ds_read_b128 v[128:131], v216 offset:12288
    v_perm_b32 v89, v111, v107, s44
    v_perm_b32 v93, v111, v107, s45
    v_mfma_f32_16x16x32_bf16 v[144:147], v[36:39], v[132:135], v[144:147]
    v_perm_b32 v90, v119, v115, s44
    v_perm_b32 v94, v119, v115, s45
    v_mfma_f32_16x16x32_bf16 v[148:151], v[52:55], v[132:135], v[148:151]
    s_cbranch_vccnz K1_rare_e1
K1_back_e1:
    v_exp_f32 v152, v152
    ds_read_b128 v[132:135], v216 offset:13312
    v_perm_b32 v91, v127, v123, s44
    v_perm_b32 v95, v127, v123, s45
    v_mfma_f32_16x16x32_bf16 v[144:147], v[40:43], v[136:139], v[144:147]
    v_exp_f32 v153, v153
    v_mfma_f32_16x16x32_bf16 v[148:151], v[56:59], v[136:139], v[148:151]
    v_exp_f32 v154, v154
    ds_read_b128 v[136:139], v216 offset:14336
    buffer_load_dwordx4 v[96:99], v214, s[20:23], s48 offen offset:0 nt
    v_mfma_f32_16x16x32_bf16 v[144:147], v[44:47], v[140:143], v[144:147]
    v_exp_f32 v155, v155
    buffer_load_dwordx4 v[100:103], v214, s[20:23], s48 offen offset:256 nt
    v_mfma_f32_16x16x32_bf16 v[148:151], v[60:63], v[140:143], v[148:151]
    v_exp_f32 v156, v156
    ds_read_b128 v[140:143], v216 offset:15360
    buffer_load_dwordx4 v[104:107], v214, s[20:23], s48 offen offset:512 nt
    v_mfma_f32_16x16x32_bf16 v[204:207], v[208:211], v[160:163], v[204:207]
    v_exp_f32 v157, v157
    buffer_load_dwordx4 v[108:111], v214, s[20:23], s48 offen offset:768 nt
    v_mfma_f32_16x16x32_bf16 a[0:3], v[64:67], v[160:163], a[0:3]
    v_exp_f32 v158, v158
    ds_read_b128 v[208:211], v223 offset:1024
    buffer_load_dwordx4 v[112:115], v215, s[20:23], s48 offen offset:0 nt
    v_mfma_f32_16x16x32_bf16 a[4:7], v[68:71], v[160:163], a[4:7]
    v_exp_f32 v159, v159
    buffer_load_dwordx4 v[116:119], v215, s[20:23], s48 offen offset:256 nt
    v_mfma_f32_16x16x32_bf16 a[8:11], v[72:75], v[160:163], a[8:11]
    buffer_load_dwordx4 v[120:123], v215, s[20:23], s48 offen offset:512 nt
    v_mfma_f32_16x16x32_bf16 a[12:15], v[76:79], v[160:163], a[12:15]
    v_cvt_pk_bf16_f32 v164, v152, v153
    buffer_load_dwordx4 v[124:127], v215, s[20:23], s48 offen offset:768 nt
    v_mfma_f32_16x16x32_bf16 a[16:19], v[80:83], v[160:163], a[16:19]
    v_cvt_pk_bf16_f32 v165, v154, v155
    s_add_u32 s48, s48, 8192
    v_mfma_f32_16x16x32_bf16 a[20:23], v[84:87], v[160:163], a[20:23]
    v_cvt_pk_bf16_f32 v166, v156, v157
    s_and_b32 s48, s48, 0x1ffff
    v_mfma_f32_16x16x32_bf16 a[24:27], v[88:91], v[160:163], a[24:27]
    v_cvt_pk_bf16_f32 v167, v158, v159
    v_mfma_f32_16x16x32_bf16 a[28:31], v[92:95], v[160:163], a[28:31]
    s_waitcnt lgkmcnt(0)
    v_max3_f32 v217, v144, v145, v146
    v_max3_f32 v217, v217, v147, v148
    v_mfma_f32_16x16x32_bf16 v[152:155], v[32:35], v[128:131], v[180:183]
    v_max3_f32 v217, v217, v149, v150
    v_max_f32 v217, v217, v151
    v_mfma_f32_16x16x32_bf16 v[156:159], v[48:51], v[128:131], v[180:183]
    v_cmp_lt_f32 vcc, s50, v217
    ds_read_b128 v[128:131], v216 offset:16384
    v_mfma_f32_16x16x32_bf16 v[152:155], v[36:39], v[132:135], v[152:155]
    v_mfma_f32_16x16x32_bf16 v[156:159], v[52:55], v[132:135], v[156:159]
    s_cbranch_vccnz K1_rare_e2
K1_back_e2:
    v_exp_f32 v144, v144
    ds_read_b128 v[132:135], v216 offset:17408
    v_mfma_f32_16x16x32_bf16 v[152:155], v[40:43], v[136:139], v[152:155]
    v_exp_f32 v145, v145
    v_mfma_f32_16x16x32_bf16 v[156:159], v[56:59], v[136:139], v[156:159]
    v_exp_f32 v146, v146
    ds_read_b128 v[136:139], v216 offset:18432
    v_mfma_f32_16x16x32_bf16 v[152:155], v[44:47], v[140:143], v[152:155]
    v_exp_f32 v147, v147
    v_mfma_f32_16x16x32_bf16 v[156:159], v[60:63], v[140:143], v[156:159]
    v_exp_f32 v148, v148
    ds_read_b128 v[140:143], v216 offset:19456
    v_mfma_f32_16x16x32_bf16 v[204:207], v[208:211], v[164:167], v[204:207]
    v_exp_f32 v149, v149
    v_mfma_f32_16x16x32_bf16 a[32:35], v[64:67], v[164:167], a[32:35]
    v_exp_f32 v150, v150
    ds_read_b128 v[208:211], v223 offset:2048
    v_mfma_f32_16x16x32_bf16 a[36:39], v[68:71], v[164:167], a[36:39]
    v_exp_f32 v151, v151
    v_mfma_f32_16x16x32_bf16 a[40:43], v[72:75], v[164:167], a[40:43]
    v_mfma_f32_16x16x32_bf16 a[44:47], v[76:79], v[164:167], a[44:47]
    v_cvt_pk_bf16_f32 v160, v144, v145
    v_mfma_f32_16x16x32_bf16 a[48:51], v[80:83], v[164:167], a[48:51]
    v_cvt_pk_bf16_f32 v161, v146, v147
    v_mfma_f32_16x16x32_bf16 a[52:55], v[84:87], v[164:167], a[52:55]
    v_cvt_pk_bf16_f32 v162, v148, v149
    v_mfma_f32_16x16x32_bf16 a[56:59], v[88:91], v[164:167], a[56:59]
    v_cvt_pk_bf16_f32 v163, v150, v151
    v_mfma_f32_16x16x32_bf16 a[60:63], v[92:95], v[164:167], a[60:63]
    s_waitcnt lgkmcnt(0)
    v_max3_f32 v217, v152, v153, v154
    v_max3_f32 v217, v217, v155, v156
    v_mfma_f32_16x16x32_bf16 v[144:147], v[32:35], v[128:131], v[184:187]
    v_max3_f32 v217, v217, v157, v158
    v_max_f32 v217, v217, v159
    v_mfma_f32_16x16x32_bf16 v[148:151], v[48:51], v[128:131], v[184:187]
    v_cmp_lt_f32 vcc, s50, v217
    ds_read_b128 v[128:131], v216 offset:20480
    v_mfma_f32_16x16x32_bf16 v[144:147], v[36:39], v[132:135], v[144:147]
    v_mfma_f32_16x16x32_bf16 v[148:151], v[52:55], v[132:135], v[148:151]
    s_cbranch_vccnz K1_rare_e3
K1_back_e3:
    v_exp_f32 v152, v152
    ds_read_b128 v[132:135], v216 offset:21504
    v_mfma_f32_16x16x32_bf16 v[144:147], v[40:43], v[136:139], v[144:147]
    v_exp_f32 v153, v153
    v_mfma_f32_16x16x32_bf16 v[148:151], v[56:59], v[136:139], v[148:151]
    v_exp_f32 v154, v154
    ds_read_b128 v[136:139], v216 offset:22528
    v_mfma_f32_16x16x32_bf16 v[144:147], v[44:47], v[140:143], v[144:147]
    v_exp_f32 v155, v155
    v_mfma_f32_16x16x32_bf16 v[148:151], v[60:63], v[140:143], v[148:151]
    v_exp_f32 v156, v156
    ds_read_b128 v[140:143], v216 offset:23552
    v_mfma_f32_16x16x32_bf16 v[204:207], v[208:211], v[160:163], v[204:207]
    v_exp_f32 v157, v157
    v_mfma_f32_16x16x32_bf16 a[64:67], v[64:67], v[160:163], a[64:67]
    v_exp_f32 v158, v158
    ds_read_b128 v[208:211], v223 offset:3072
    v_mfma_f32_16x16x32_bf16 a[68:71], v[68:71], v[160:163], a[68:71]
    v_exp_f32 v159, v159
    v_mfma_f32_16x16x32_bf16 a[72:75], v[72:75], v[160:163], a[72:75]
    v_mfma_f32_16x16x32_bf16 a[76:79], v[76:79], v[160:163], a[76:79]
    v_cvt_pk_bf16_f32 v164, v152, v153
    v_mfma_f32_16x16x32_bf16 a[80:83], v[80:83], v[160:163], a[80:83]
    v_cvt_pk_bf16_f32 v165, v154, v155
    v_mfma_f32_16x16x32_bf16 a[84:87], v[84:87], v[160:163], a[84:87]
    v_cvt_pk_bf16_f32 v166, v156, v157
    v_mfma_f32_16x16x32_bf16 a[88:91], v[88:91], v[160:163], a[88:91]
    v_cvt_pk_bf16_f32 v167, v158, v159
    v_mfma_f32_16x16x32_bf16 a[92:95], v[92:95], v[160:163], a[92:95]
    s_waitcnt lgkmcnt(0)
    v_max3_f32 v217, v144, v145, v146
    v_max3_f32 v217, v217, v147, v148
    v_mfma_f32_16x16x32_bf16 v[152:155], v[32:35], v[128:131], v[188:191]
    v_max3_f32 v217, v217, v149, v150
    v_max_f32 v217, v217, v151
    v_mfma_f32_16x16x32_bf16 v[156:159], v[48:51], v[128:131], v[188:191]
    v_cmp_lt_f32 vcc, s50, v217
    ds_read_b128 v[128:131], v216 offset:24576
    v_mfma_f32_16x16x32_bf16 v[152:155], v[36:39], v[132:135], v[152:155]
    v_mfma_f32_16x16x32_bf16 v[156:159], v[52:55], v[132:135], v[156:159]
    s_cbranch_vccnz K1_rare_e4
K1_back_e4:
    v_exp_f32 v144, v144
    ds_read_b128 v[132:135], v216 offset:25600
    v_mfma_f32_16x16x32_bf16 v[152:155], v[40:43], v[136:139], v[152:155]
    v_exp_f32 v145, v145
    v_mfma_f32_16x16x32_bf16 v[156:159], v[56:59], v[136:139], v[156:159]
    v_exp_f32 v146, v146
    ds_read_b128 v[136:139], v216 offset:26624
    v_mfma_f32_16x16x32_bf16 v[152:155], v[44:47], v[140:143], v[152:155]
    v_exp_f32 v147, v147
    v_mfma_f32_16x16x32_bf16 v[156:159], v[60:63], v[140:143], v[156:159]
    v_exp_f32 v148, v148
    ds_read_b128 v[140:143], v216 offset:27648
    v_mfma_f32_16x16x32_bf16 v[204:207], v[208:211], v[164:167], v[204:207]
    v_exp_f32 v149, v149
    v_mfma_f32_16x16x32_bf16 a[96:99], v[64:67], v[164:167], a[96:99]
    v_exp_f32 v150, v150
    ds_read_b128 v[208:211], v223 offset:4096
    v_mfma_f32_16x16x32_bf16 a[100:103], v[68:71], v[164:167], a[100:103]
    v_exp_f32 v151, v151
    v_mfma_f32_16x16x32_bf16 a[104:107], v[72:75], v[164:167], a[104:107]
    v_mfma_f32_16x16x32_bf16 a[108:111], v[76:79], v[164:167], a[108:111]
    v_cvt_pk_bf16_f32 v160, v144, v145
    v_mfma_f32_16x16x32_bf16 a[112:115], v[80:83], v[164:167], a[112:115]
    v_cvt_pk_bf16_f32 v161, v146, v147
    v_mfma_f32_16x16x32_bf16 a[116:119], v[84:87], v[164:167], a[116:119]
    v_cvt_pk_bf16_f32 v162, v148, v149
    v_mfma_f32_16x16x32_bf16 a[120:123], v[88:91], v[164:167], a[120:123]
    v_cvt_pk_bf16_f32 v163, v150, v151
    v_mfma_f32_16x16x32_bf16 a[124:127], v[92:95], v[164:167], a[124:127]
    s_waitcnt lgkmcnt(0)
    v_max3_f32 v217, v152, v153, v154
    v_max3_f32 v217, v217, v155, v156
    v_mfma_f32_16x16x32_bf16 v[144:147], v[32:35], v[128:131], v[192:195]
    v_max3_f32 v217, v217, v157, v158
    v_max_f32 v217, v217, v159
    v_mfma_f32_16x16x32_bf16 v[148:151], v[48:51], v[128:131], v[192:195]
    v_cmp_lt_f32 vcc, s50, v217
    ds_read_b128 v[128:131], v216 offset:28672
    v_mfma_f32_16x16x32_bf16 v[144:147], v[36:39], v[132:135], v[144:147]
    v_mfma_f32_16x16x32_bf16 v[148:151], v[52:55], v[132:135], v[148:151]
    s_cbranch_vccnz K1_rare_e5
K1_back_e5:
    v_exp_f32 v152, v152
    ds_read_b128 v[132:135], v216 offset:29696
    v_mfma_f32_16x16x32_bf16 v[144:147], v[40:43], v[136:139], v[144:147]
    v_exp_f32 v153, v153
    v_mfma_f32_16x16x32_bf16 v[148:151], v[56:59], v[136:139], v[148:151]
    v_exp_f32 v154, v154
    ds_read_b128 v[136:139], v216 offset:30720
    v_mfma_f32_16x16x32_bf16 v[144:147], v[44:47], v[140:143], v[144:147]
    v_exp_f32 v155, v155
    v_mfma_f32_16x16x32_bf16 v[148:151], v[60:63], v[140:143], v[148:151]
    v_exp_f32 v156, v156
    ds_read_b128 v[140:143], v216 offset:31744
    v_mfma_f32_16x16x32_bf16 v[204:207], v[208:211], v[160:163], v[204:207]
    v_exp_f32 v157, v157
    v_mfma_f32_16x16x32_bf16 a[128:131], v[64:67], v[160:163], a[128:131]
    v_exp_f32 v158, v158
    ds_read_b128 v[208:211], v223 offset:5120
    v_mfma_f32_16x16x32_bf16 a[132:135], v[68:71], v[160:163], a[132:135]
    v_exp_f32 v159, v159
    v_mfma_f32_16x16x32_bf16 a[136:139], v[72:75], v[160:163], a[136:139]
    v_mfma_f32_16x16x32_bf16 a[140:143], v[76:79], v[160:163], a[140:143]
    v_cvt_pk_bf16_f32 v164, v152, v153
    v_mfma_f32_16x16x32_bf16 a[144:147], v[80:83], v[160:163], a[144:147]
    v_cvt_pk_bf16_f32 v165, v154, v155
    v_mfma_f32_16x16x32_bf16 a[148:151], v[84:87], v[160:163], a[148:151]
    v_cvt_pk_bf16_f32 v166, v156, v157
    v_mfma_f32_16x16x32_bf16 a[152:155], v[88:91], v[160:163], a[152:155]
    v_cvt_pk_bf16_f32 v167, v158, v159
    v_mfma_f32_16x16x32_bf16 a[156:159], v[92:95], v[160:163], a[156:159]
    s_waitcnt lgkmcnt(0)
    v_max3_f32 v217, v144, v145, v146
    v_max3_f32 v217, v217, v147, v148
    v_mfma_f32_16x16x32_bf16 v[152:155], v[32:35], v[128:131], v[196:199]
    v_max3_f32 v217, v217, v149, v150
    v_max_f32 v217, v217, v151
    v_mfma_f32_16x16x32_bf16 v[156:159], v[48:51], v[128:131], v[196:199]
    v_cmp_lt_f32 vcc, s50, v217
    ds_read_b128 v[128:131], v216 offset:32768
    v_mfma_f32_16x16x32_bf16 v[152:155], v[36:39], v[132:135], v[152:155]
    v_mfma_f32_16x16x32_bf16 v[156:159], v[52:55], v[132:135], v[156:159]
    s_cbranch_vccnz K1_rare_e6
K1_back_e6:
    v_exp_f32 v144, v144
    ds_read_b128 v[132:135], v216 offset:33792
    v_mfma_f32_16x16x32_bf16 v[152:155], v[40:43], v[136:139], v[152:155]
    v_exp_f32 v145, v145
    v_mfma_f32_16x16x32_bf16 v[156:159], v[56:59], v[136:139], v[156:159]
    v_exp_f32 v146, v146
    ds_read_b128 v[136:139], v216 offset:34816
    v_mfma_f32_16x16x32_bf16 v[152:155], v[44:47], v[140:143], v[152:155]
    v_exp_f32 v147, v147
    v_mfma_f32_16x16x32_bf16 v[156:159], v[60:63], v[140:143], v[156:159]
    v_exp_f32 v148, v148
    ds_read_b128 v[140:143], v216 offset:35840
    v_mfma_f32_16x16x32_bf16 v[204:207], v[208:211], v[164:167], v[204:207]
    v_exp_f32 v149, v149
    v_mfma_f32_16x16x32_bf16 a[160:163], v[64:67], v[164:167], a[160:163]
    v_exp_f32 v150, v150
    ds_read_b128 v[208:211], v223 offset:6144
    v_mfma_f32_16x16x32_bf16 a[164:167], v[68:71], v[164:167], a[164:167]
    v_exp_f32 v151, v151
    v_mfma_f32_16x16x32_bf16 a[168:171], v[72:75], v[164:167], a[168:171]
    v_mfma_f32_16x16x32_bf16 a[172:175], v[76:79], v[164:167], a[172:175]
    v_cvt_pk_bf16_f32 v160, v144, v145
    v_mfma_f32_16x16x32_bf16 a[176:179], v[80:83], v[164:167], a[176:179]
    v_cvt_pk_bf16_f32 v161, v146, v147
    v_mfma_f32_16x16x32_bf16 a[180:183], v[84:87], v[164:167], a[180:183]
    v_cvt_pk_bf16_f32 v162, v148, v149
    v_mfma_f32_16x16x32_bf16 a[184:187], v[88:91], v[164:167], a[184:187]
    v_cvt_pk_bf16_f32 v163, v150, v151
    v_mfma_f32_16x16x32_bf16 a[188:191], v[92:95], v[164:167], a[188:191]
    s_waitcnt lgkmcnt(0)
    v_max3_f32 v217, v152, v153, v154
    v_max3_f32 v217, v217, v155, v156
    v_mfma_f32_16x16x32_bf16 v[144:147], v[32:35], v[128:131], v[200:203]
    v_max3_f32 v217, v217, v157, v158
    v_max_f32 v217, v217, v159
    v_mfma_f32_16x16x32_bf16 v[148:151], v[48:51], v[128:131], v[200:203]
    v_cmp_lt_f32 vcc, s50, v217
    ds_read_b128 v[128:131], v216 offset:0
    v_mfma_f32_16x16x32_bf16 v[144:147], v[36:39], v[132:135], v[144:147]
    v_mfma_f32_16x16x32_bf16 v[148:151], v[52:55], v[132:135], v[148:151]
    s_cbranch_vccnz K1_rare_e7
K1_back_e7:
    v_exp_f32 v152, v152
    ds_read_b128 v[132:135], v216 offset:1024
    v_mfma_f32_16x16x32_bf16 v[144:147], v[40:43], v[136:139], v[144:147]
    v_exp_f32 v153, v153
    v_mfma_f32_16x16x32_bf16 v[148:151], v[56:59], v[136:139], v[148:151]
    v_exp_f32 v154, v154
    ds_read_b128 v[136:139], v216 offset:2048
    v_mfma_f32_16x16x32_bf16 v[144:147], v[44:47], v[140:143], v[144:147]
    v_exp_f32 v155, v155
    v_mfma_f32_16x16x32_bf16 v[148:151], v[60:63], v[140:143], v[148:151]
    v_exp_f32 v156, v156
    ds_read_b128 v[140:143], v216 offset:3072
    v_mfma_f32_16x16x32_bf16 v[204:207], v[208:211], v[160:163], v[204:207]
    v_exp_f32 v157, v157
    buffer_load_dwordx4 v[32:35], v212, s[16:19], s47 offen offset:0 nt
    buffer_load_dwordx4 v[36:39], v212, s[16:19], s47 offen offset:16 nt
    v_mfma_f32_16x16x32_bf16 a[192:195], v[64:67], v[160:163], a[192:195]
    v_exp_f32 v158, v158
    ds_read_b128 v[208:211], v223 offset:7168
    buffer_load_dwordx4 v[40:43], v212, s[16:19], s47 offen offset:128 nt
    v_mfma_f32_16x16x32_bf16 a[196:199], v[68:71], v[160:163], a[196:199]
    v_exp_f32 v159, v159
    buffer_load_dwordx4 v[44:47], v212, s[16:19], s47 offen offset:144 nt
    v_mfma_f32_16x16x32_bf16 a[200:203], v[72:75], v[160:163], a[200:203]
    buffer_load_dwordx4 v[48:51], v213, s[16:19], s47 offen offset:0 nt
    v_mfma_f32_16x16x32_bf16 a[204:207], v[76:79], v[160:163], a[204:207]
    v_cvt_pk_bf16_f32 v164, v152, v153
    buffer_load_dwordx4 v[52:55], v213, s[16:19], s47 offen offset:16 nt
    v_mfma_f32_16x16x32_bf16 a[208:211], v[80:83], v[160:163], a[208:211]
    v_cvt_pk_bf16_f32 v165, v154, v155
    buffer_load_dwordx4 v[56:59], v213, s[16:19], s47 offen offset:128 nt
    v_mfma_f32_16x16x32_bf16 a[212:215], v[84:87], v[160:163], a[212:215]
    v_cvt_pk_bf16_f32 v166, v156, v157
    buffer_load_dwordx4 v[60:63], v213, s[16:19], s47 offen offset:144 nt
    v_mfma_f32_16x16x32_bf16 a[216:219], v[88:91], v[160:163], a[216:219]
    v_cvt_pk_bf16_f32 v167, v158, v159
    s_add_u32 s47, s47, 8192
    v_mfma_f32_16x16x32_bf16 a[220:223], v[92:95], v[160:163], a[220:223]
    s_and_b32 s47, s47, 0x1ffff
    s_waitcnt vmcnt(16) lgkmcnt(0)
    v_max3_f32 v217, v144, v145, v146
    v_max3_f32 v217, v217, v147, v148
    v_mfma_f32_16x16x32_bf16 v[152:155], v[0:3], v[128:131], v[168:171]
    v_max3_f32 v217, v217, v149, v150
    v_max_f32 v217, v217, v151
    v_mfma_f32_16x16x32_bf16 v[156:159], v[16:19], v[128:131], v[168:171]
    v_cmp_lt_f32 vcc, s50, v217
    ds_read_b128 v[128:131], v216 offset:4096
    v_mfma_f32_16x16x32_bf16 v[152:155], v[4:7], v[132:135], v[152:155]
    v_mfma_f32_16x16x32_bf16 v[156:159], v[20:23], v[132:135], v[156:159]
    s_cbranch_vccnz K1_rare_e8
K1_back_e8:
    v_exp_f32 v144, v144
    ds_read_b128 v[132:135], v216 offset:5120
    v_mfma_f32_16x16x32_bf16 v[152:155], v[8:11], v[136:139], v[152:155]
    v_exp_f32 v145, v145
    v_mfma_f32_16x16x32_bf16 v[156:159], v[24:27], v[136:139], v[156:159]
    v_exp_f32 v146, v146
    ds_read_b128 v[136:139], v216 offset:6144
    v_mfma_f32_16x16x32_bf16 v[152:155], v[12:15], v[140:143], v[152:155]
    v_exp_f32 v147, v147
    v_mfma_f32_16x16x32_bf16 v[156:159], v[28:31], v[140:143], v[156:159]
    v_exp_f32 v148, v148
    ds_read_b128 v[140:143], v216 offset:7168
    v_mfma_f32_16x16x32_bf16 v[204:207], v[208:211], v[164:167], v[204:207]
    v_exp_f32 v149, v149
    v_mfma_f32_16x16x32_bf16 a[224:227], v[64:67], v[164:167], a[224:227]
    v_exp_f32 v150, v150
    ds_read_b128 v[208:211], v223 offset:8192
    v_mfma_f32_16x16x32_bf16 a[228:231], v[68:71], v[164:167], a[228:231]
    v_exp_f32 v151, v151
    v_mfma_f32_16x16x32_bf16 a[232:235], v[72:75], v[164:167], a[232:235]
    v_mfma_f32_16x16x32_bf16 a[236:239], v[76:79], v[164:167], a[236:239]
    v_cvt_pk_bf16_f32 v160, v144, v145
    v_mfma_f32_16x16x32_bf16 a[240:243], v[80:83], v[164:167], a[240:243]
    v_cvt_pk_bf16_f32 v161, v146, v147
    v_mfma_f32_16x16x32_bf16 a[244:247], v[84:87], v[164:167], a[244:247]
    v_cvt_pk_bf16_f32 v162, v148, v149
    v_mfma_f32_16x16x32_bf16 a[248:251], v[88:91], v[164:167], a[248:251]
    v_cvt_pk_bf16_f32 v163, v150, v151
    v_mfma_f32_16x16x32_bf16 a[252:255], v[92:95], v[164:167], a[252:255]
    s_sub_u32 s46, s46, 1
    s_cmp_lg_u32 s46, 0
    s_cbranch_scc1 K1_aloop
    s_waitcnt lgkmcnt(0)
    v_max3_f32 v217, v152, v153, v154
    v_max3_f32 v217, v217, v155, v156
    v_mfma_f32_16x16x32_bf16 v[144:147], v[0:3], v[128:131], v[172:175]
    v_max3_f32 v217, v217, v157, v158
    v_max_f32 v217, v217, v159
    v_and_b32 v221, 0xf0, v219
    v_lshrrev_b32 v221, 2, v221
    v_mfma_f32_16x16x32_bf16 v[148:151], v[16:19], v[128:131], v[172:175]
    v_cmp_lt_f32 vcc, s50, v217
    ds_read_b128 v[128:131], v216 offset:8192
    v_mfma_f32_16x16x32_bf16 v[144:147], v[4:7], v[132:135], v[144:147]
    v_mfma_f32_16x16x32_bf16 v[148:151], v[20:23], v[132:135], v[148:151]
    s_cbranch_vccnz K1_rare_l0
K1_back_l0:
    v_exp_f32 v152, v152
    ds_read_b128 v[132:135], v216 offset:9216
    v_mfma_f32_16x16x32_bf16 v[144:147], v[8:11], v[136:139], v[144:147]
    v_exp_f32 v153, v153
    v_mfma_f32_16x16x32_bf16 v[148:151], v[24:27], v[136:139], v[148:151]
    v_exp_f32 v154, v154
    ds_read_b128 v[136:139], v216 offset:10240
    v_mfma_f32_16x16x32_bf16 v[144:147], v[12:15], v[140:143], v[144:147]
    v_exp_f32 v155, v155
    v_mfma_f32_16x16x32_bf16 v[148:151], v[28:31], v[140:143], v[148:151]
    v_exp_f32 v156, v156
    ds_read_b128 v[140:143], v216 offset:11264
    v_mfma_f32_16x16x32_bf16 v[204:207], v[208:211], v[160:163], v[204:207]
    v_exp_f32 v157, v157
    v_mfma_f32_16x16x32_bf16 v[224:227], v[64:67], v[160:163], v[224:227]
    v_exp_f32 v158, v158
    ds_read_b128 v[208:211], v223 offset:0
    s_waitcnt vmcnt(0)
    v_mfma_f32_16x16x32_bf16 v[228:231], v[68:71], v[160:163], v[228:231]
    v_exp_f32 v159, v159
    v_perm_b32 v64, v100, v96, s44
    v_perm_b32 v68, v100, v96, s45
    v_perm_b32 v65, v108, v104, s44
    v_mfma_f32_16x16x32_bf16 v[232:235], v[72:75], v[160:163], v[232:235]
    v_perm_b32 v69, v108, v104, s45
    v_perm_b32 v66, v116, v112, s44
    v_perm_b32 v70, v116, v112, s45
    v_mfma_f32_16x16x32_bf16 v[236:239], v[76:79], v[160:163], v[236:239]
    v_cvt_pk_bf16_f32 v164, v152, v153
    v_perm_b32 v67, v124, v120, s44
    v_perm_b32 v71, v124, v120, s45
    v_perm_b32 v72, v101, v97, s44
    v_perm_b32 v76, v101, v97, s45
    v_perm_b32 v73, v109, v105, s44
    v_mfma_f32_16x16x32_bf16 v[240:243], v[80:83], v[160:163], v[240:243]
    v_cvt_pk_bf16_f32 v165, v154, v155
    v_perm_b32 v77, v109, v105, s45
    v_perm_b32 v74, v117, v113, s44
    v_perm_b32 v78, v117, v113, s45
    v_mfma_f32_16x16x32_bf16 v[244:247], v[84:87], v[160:163], v[244:247]
    v_cvt_pk_bf16_f32 v166, v156, v157
    v_perm_b32 v75, v125, v121, s44
    v_perm_b32 v79, v125, v121, s45
    v_perm_b32 v80, v102, v98, s44
    v_perm_b32 v84, v102, v98, s45
    v_perm_b32 v81, v110, v106, s44
    v_mfma_f32_16x16x32_bf16 v[248:251], v[88:91], v[160:163], v[248:251]
    v_cvt_pk_bf16_f32 v167, v158, v159
    v_perm_b32 v85, v110, v106, s45
    v_perm_b32 v82, v118, v114, s44
    v_perm_b32 v86, v118, v114, s45
    v_mfma_f32_16x16x32_bf16 v[252:255], v[92:95], v[160:163], v[252:255]
    v_perm_b32 v83, v126, v122, s44
    v_perm_b32 v87, v126, v122, s45
    s_waitcnt lgkmcnt(0)
    v_max3_f32 v217, v144, v145, v146
    v_max3_f32 v217, v217, v147, v148
    v_mfma_f32_16x16x32_bf16 v[152:155], v[0:3], v[128:131], v[176:179]
    v_max3_f32 v217, v217, v149, v150
    v_max_f32 v217, v217, v151
    v_perm_b32 v88, v103, v99, s44
    v_perm_b32 v92, v103, v99, s45
    v_mfma_f32_16x16x32_bf16 v[156:159], v[16:19], v[128:131], v[176:179]
    v_cmp_lt_f32 vcc, s50, v217
    ds_read_b128 v[128:131], v216 offset:12288
    v_perm_b32 v89, v111, v107, s44
    v_perm_b32 v93, v111, v107, s45
    v_mfma_f32_16x16x32_bf16 v[152:155], v[4:7], v[132:135], v[152:155]
    v_perm_b32 v90, v119, v115, s44
    v_perm_b32 v94, v119, v115, s45
    v_mfma_f32_16x16x32_bf16 v[156:159], v[20:23], v[132:135], v[156:159]
    s_cbranch_vccnz K1_rare_l1
K1_back_l1:
    v_exp_f32 v144, v144
    ds_read_b128 v[132:135], v216 offset:13312
    v_perm_b32 v91, v127, v123, s44
    v_perm_b32 v95, v127, v123, s45
    v_mfma_f32_16x16x32_bf16 v[152:155], v[8:11], v[136:139], v[152:155]
    v_exp_f32 v145, v145
    v_mfma_f32_16x16x32_bf16 v[156:159], v[24:27], v[136:139], v[156:159]
    v_exp_f32 v146, v146
    ds_read_b128 v[136:139], v216 offset:14336
    v_bfe_u32 v220, v219, 4, 2
    v_mfma_f32_16x16x32_bf16 v[152:155], v[12:15], v[140:143], v[152:155]
    v_exp_f32 v147, v147
    v_lshlrev_b32 v220, 6, v220
    v_mfma_f32_16x16x32_bf16 v[156:159], v[28:31], v[140:143], v[156:159]
    v_exp_f32 v148, v148
    ds_read_b128 v[140:143], v216 offset:15360
    v_bfe_u32 v218, v219, 6, 2
    v_mfma_f32_16x16x32_bf16 v[204:207], v[208:211], v[164:167], v[204:207]
    v_exp_f32 v149, v149
    v_lshl_add_u32 v220, v218, 4, v220
    v_mfma_f32_16x16x32_bf16 a[0:3], v[64:67], v[164:167], a[0:3]
    v_exp_f32 v150, v150
    ds_read_b128 v[208:211], v223 offset:1024
    v_lshrrev_b32 v218, 8, v219
    v_mfma_f32_16x16x32_bf16 a[4:7], v[68:71], v[164:167], a[4:7]
    v_exp_f32 v151, v151
    v_lshl_add_u32 v220, v218, 13, v220
    v_mfma_f32_16x16x32_bf16 a[8:11], v[72:75], v[164:167], a[8:11]
    v_add_u32 v222, 0x1000, v220
    v_mfma_f32_16x16x32_bf16 a[12:15], v[76:79], v[164:167], a[12:15]
    v_cvt_pk_bf16_f32 v160, v144, v145
    v_mfma_f32_16x16x32_bf16 a[16:19], v[80:83], v[164:167], a[16:19]
    v_cvt_pk_bf16_f32 v161, v146, v147
    v_mfma_f32_16x16x32_bf16 a[20:23], v[84:87], v[164:167], a[20:23]
    v_cvt_pk_bf16_f32 v162, v148, v149
    v_mfma_f32_16x16x32_bf16 a[24:27], v[88:91], v[164:167], a[24:27]
    v_cvt_pk_bf16_f32 v163, v150, v151
    v_mfma_f32_16x16x32_bf16 a[28:31], v[92:95], v[164:167], a[28:31]
    ds_bpermute_b32 v170, v221, v204 offset:0
    s_waitcnt lgkmcnt(0)
    v_max3_f32 v217, v152, v153, v154
    v_max3_f32 v217, v217, v155, v156
    v_rcp_f32 v168, v170
    v_mfma_f32_16x16x32_bf16 v[144:147], v[0:3], v[128:131], v[180:183]
    v_max3_f32 v217, v217, v157, v158
    v_max_f32 v217, v217, v159
    v_mfma_f32_16x16x32_bf16 v[148:151], v[16:19], v[128:131], v[180:183]
    v_cmp_lt_f32 vcc, s50, v217
    ds_read_b128 v[128:131], v216 offset:16384
    buffer_load_dwordx4 v[96:99], v220, s[24:27], s33 offen offset:0
    v_accvgpr_read_b32 v32, a0
    v_accvgpr_read_b32 v33, a4
    v_accvgpr_read_b32 v34, a8
    v_accvgpr_read_b32 v35, a12
    v_accvgpr_read_b32 v36, a16
    v_mfma_f32_16x16x32_bf16 v[144:147], v[4:7], v[132:135], v[144:147]
    buffer_load_dwordx4 v[100:103], v220, s[24:27], s33 offen offset:1024
    v_accvgpr_read_b32 v37, a20
    v_accvgpr_read_b32 v38, a24
    v_accvgpr_read_b32 v39, a28
    v_pk_mul_f32 v[32:33], v[32:33], v[168:169] op_sel_hi:[1,0]
    v_mfma_f32_16x16x32_bf16 v[148:151], v[20:23], v[132:135], v[148:151]
    s_cbranch_vccnz K1_rare_l2
K1_back_l2:
    v_exp_f32 v152, v152
    ds_read_b128 v[132:135], v216 offset:17408
    buffer_load_dwordx4 v[104:107], v220, s[24:27], s33 offen offset:2048
    v_pk_mul_f32 v[34:35], v[34:35], v[168:169] op_sel_hi:[1,0]
    v_pk_mul_f32 v[36:37], v[36:37], v[168:169] op_sel_hi:[1,0]
    v_pk_mul_f32 v[38:39], v[38:39], v[168:169] op_sel_hi:[1,0]
    v_cvt_pk_bf16_f32 v40, v32, v33
    v_mfma_f32_16x16x32_bf16 v[144:147], v[8:11], v[136:139], v[144:147]
    v_exp_f32 v153, v153
    buffer_load_dwordx4 v[108:111], v220, s[24:27], s33 offen offset:3072
    v_cvt_pk_bf16_f32 v41, v34, v35
    v_cvt_pk_bf16_f32 v42, v36, v37
    v_cvt_pk_bf16_f32 v43, v38, v39
    ds_write_b128 v216, v[40:43] offset:0
    v_mfma_f32_16x16x32_bf16 v[148:151], v[24:27], v[136:139], v[148:151]
    v_exp_f32 v154, v154
    ds_read_b128 v[136:139], v216 offset:18432
    buffer_load_dwordx4 v[112:115], v222, s[24:27], s33 offen offset:0
    v_accvgpr_read_b32 v44, a1
    v_accvgpr_read_b32 v45, a5
    v_accvgpr_read_b32 v46, a9
    v_accvgpr_read_b32 v47, a13
    v_accvgpr_read_b32 v48, a17
    v_mfma_f32_16x16x32_bf16 v[144:147], v[12:15], v[140:143], v[144:147]
    v_exp_f32 v155, v155
    buffer_load_dwordx4 v[116:119], v222, s[24:27], s33 offen offset:1024
    v_accvgpr_read_b32 v49, a21
    v_accvgpr_read_b32 v50, a25
    v_accvgpr_read_b32 v51, a29
    v_pk_mul_f32 v[44:45], v[44:45], v[168:169] op_sel_hi:[1,0]
    v_mfma_f32_16x16x32_bf16 v[148:151], v[28:31], v[140:143], v[148:151]
    v_exp_f32 v156, v156
    ds_read_b128 v[140:143], v216 offset:19456
    buffer_load_dwordx4 v[120:123], v222, s[24:27], s33 offen offset:2048
    v_pk_mul_f32 v[46:47], v[46:47], v[168:169] op_sel_hi:[1,0]
    v_pk_mul_f32 v[48:49], v[48:49], v[168:169] op_sel_hi:[1,0]
    v_pk_mul_f32 v[50:51], v[50:51], v[168:169] op_sel_hi:[1,0]
    v_cvt_pk_bf16_f32 v52, v44, v45
    v_mfma_f32_16x16x32_bf16 v[204:207], v[208:211], v[160:163], v[204:207]
    v_exp_f32 v157, v157
    buffer_load_dwordx4 v[124:127], v222, s[24:27], s33 offen offset:3072
    v_cvt_pk_bf16_f32 v53, v46, v47
    v_cvt_pk_bf16_f32 v54, v48, v49
    v_cvt_pk_bf16_f32 v55, v50, v51
    ds_write_b128 v216, v[52:55] offset:1024
    v_mfma_f32_16x16x32_bf16 a[32:35], v[64:67], v[160:163], a[32:35]
    v_exp_f32 v158, v158
    ds_read_b128 v[208:211], v223 offset:2048
    s_add_u32 s33, s33, 32768
    v_accvgpr_read_b32 v32, a2
    v_accvgpr_read_b32 v33, a6
    v_accvgpr_read_b32 v34, a10
    v_accvgpr_read_b32 v35, a14
    v_accvgpr_read_b32 v36, a18
    v_mfma_f32_16x16x32_bf16 a[36:39], v[68:71], v[160:163], a[36:39]
    v_exp_f32 v159, v159
    v_accvgpr_read_b32 v37, a22
    v_accvgpr_read_b32 v38, a26
    v_accvgpr_read_b32 v39, a30
    v_pk_mul_f32 v[32:33], v[32:33], v[168:169] op_sel_hi:[1,0]
    v_mfma_f32_16x16x32_bf16 a[40:43], v[72:75], v[160:163], a[40:43]
    v_pk_mul_f32 v[34:35], v[34:35], v[168:169] op_sel_hi:[1,0]
    v_pk_mul_f32 v[36:37], v[36:37], v[168:169] op_sel_hi:[1,0]
    v_pk_mul_f32 v[38:39], v[38:39], v[168:169] op_sel_hi:[1,0]
    v_cvt_pk_bf16_f32 v40, v32, v33
    v_mfma_f32_16x16x32_bf16 a[44:47], v[76:79], v[160:163], a[44:47]
    v_cvt_pk_bf16_f32 v164, v152, v153
    v_cvt_pk_bf16_f32 v41, v34, v35
    v_cvt_pk_bf16_f32 v42, v36, v37
    v_cvt_pk_bf16_f32 v43, v38, v39
    ds_write_b128 v216, v[40:43] offset:2048
    v_mfma_f32_16x16x32_bf16 a[48:51], v[80:83], v[160:163], a[48:51]
    v_cvt_pk_bf16_f32 v165, v154, v155
    v_accvgpr_read_b32 v44, a3
    v_accvgpr_read_b32 v45, a7
    v_accvgpr_read_b32 v46, a11
    v_accvgpr_read_b32 v47, a15
    v_accvgpr_read_b32 v48, a19
    v_mfma_f32_16x16x32_bf16 a[52:55], v[84:87], v[160:163], a[52:55]
    v_cvt_pk_bf16_f32 v166, v156, v157
    v_accvgpr_read_b32 v49, a23
    v_accvgpr_read_b32 v50, a27
    v_accvgpr_read_b32 v51, a31
    v_pk_mul_f32 v[44:45], v[44:45], v[168:169] op_sel_hi:[1,0]
    v_mfma_f32_16x16x32_bf16 a[56:59], v[88:91], v[160:163], a[56:59]
    v_cvt_pk_bf16_f32 v167, v158, v159
    v_pk_mul_f32 v[46:47], v[46:47], v[168:169] op_sel_hi:[1,0]
    v_pk_mul_f32 v[48:49], v[48:49], v[168:169] op_sel_hi:[1,0]
    v_pk_mul_f32 v[50:51], v[50:51], v[168:169] op_sel_hi:[1,0]
    v_cvt_pk_bf16_f32 v52, v44, v45
    v_mfma_f32_16x16x32_bf16 a[60:63], v[92:95], v[160:163], a[60:63]
    ds_bpermute_b32 v174, v221, v205 offset:0
    v_cvt_pk_bf16_f32 v53, v46, v47
    v_cvt_pk_bf16_f32 v54, v48, v49
    v_cvt_pk_bf16_f32 v55, v50, v51
    ds_write_b128 v216, v[52:55] offset:3072
    s_waitcnt lgkmcnt(0)
    v_max3_f32 v217, v144, v145, v146
    v_max3_f32 v217, v217, v147, v148
    v_rcp_f32 v172, v174
    v_mfma_f32_16x16x32_bf16 v[152:155], v[0:3], v[128:131], v[184:187]
    v_max3_f32 v217, v217, v149, v150
    v_max_f32 v217, v217, v151
    v_mfma_f32_16x16x32_bf16 v[156:159], v[16:19], v[128:131], v[184:187]
    v_cmp_lt_f32 vcc, s50, v217
    ds_read_b128 v[128:131], v216 offset:20480
    v_accvgpr_read_b32 v32, a32
    v_accvgpr_read_b32 v33, a36
    v_accvgpr_read_b32 v34, a40
    v_accvgpr_read_b32 v35, a44
    v_accvgpr_read_b32 v36, a48
    v_mfma_f32_16x16x32_bf16 v[152:155], v[4:7], v[132:135], v[152:155]
    v_accvgpr_read_b32 v37, a52
    v_accvgpr_read_b32 v38, a56
    v_accvgpr_read_b32 v39, a60
    v_pk_mul_f32 v[32:33], v[32:33], v[172:173] op_sel_hi:[1,0]
    v_mfma_f32_16x16x32_bf16 v[156:159], v[20:23], v[132:135], v[156:159]
    s_cbranch_vccnz K1_rare_l3
K1_back_l3:
    v_exp_f32 v144, v144
    ds_read_b128 v[132:135], v216 offset:21504
    v_pk_mul_f32 v[34:35], v[34:35], v[172:173] op_sel_hi:[1,0]
    v_pk_mul_f32 v[36:37], v[36:37], v[172:173] op_sel_hi:[1,0]
    v_pk_mul_f32 v[38:39], v[38:39], v[172:173] op_sel_hi:[1,0]
    v_cvt_pk_bf16_f32 v40, v32, v33
    v_mfma_f32_16x16x32_bf16 v[152:155], v[8:11], v[136:139], v[152:155]
    v_exp_f32 v145, v145
    v_cvt_pk_bf16_f32 v41, v34, v35
    v_cvt_pk_bf16_f32 v42, v36, v37
    v_cvt_pk_bf16_f32 v43, v38, v39
    ds_write_b128 v216, v[40:43] offset:4096
    v_mfma_f32_16x16x32_bf16 v[156:159], v[24:27], v[136:139], v[156:159]
    v_exp_f32 v146, v146
    ds_read_b128 v[136:139], v216 offset:22528
    v_accvgpr_read_b32 v44, a33
    v_accvgpr_read_b32 v45, a37
    v_accvgpr_read_b32 v46, a41
    v_accvgpr_read_b32 v47, a45
    v_accvgpr_read_b32 v48, a49
    v_mfma_f32_16x16x32_bf16 v[152:155], v[12:15], v[140:143], v[152:155]
    v_exp_f32 v147, v147
    v_accvgpr_read_b32 v49, a53
    v_accvgpr_read_b32 v50, a57
    v_accvgpr_read_b32 v51, a61
    v_pk_mul_f32 v[44:45], v[44:45], v[172:173] op_sel_hi:[1,0]
    v_mfma_f32_16x16x32_bf16 v[156:159], v[28:31], v[140:143], v[156:159]
    v_exp_f32 v148, v148
    ds_read_b128 v[140:143], v216 offset:23552
    v_pk_mul_f32 v[46:47], v[46:47], v[172:173] op_sel_hi:[1,0]
    v_pk_mul_f32 v[48:49], v[48:49], v[172:173] op_sel_hi:[1,0]
    v_pk_mul_f32 v[50:51], v[50:51], v[172:173] op_sel_hi:[1,0]
    v_cvt_pk_bf16_f32 v52, v44, v45
    v_mfma_f32_16x16x32_bf16 v[204:207], v[208:211], v[164:167], v[204:207]
    v_exp_f32 v149, v149
    v_cvt_pk_bf16_f32 v53, v46, v47
    v_cvt_pk_bf16_f32 v54, v48, v49
    v_cvt_pk_bf16_f32 v55, v50, v51
    ds_write_b128 v216, v[52:55] offset:5120
    v_mfma_f32_16x16x32_bf16 a[64:67], v[64:67], v[164:167], a[64:67]
    v_exp_f32 v150, v150
    ds_read_b128 v[208:211], v223 offset:3072
    v_accvgpr_read_b32 v32, a34
    v_accvgpr_read_b32 v33, a38
    v_accvgpr_read_b32 v34, a42
    v_accvgpr_read_b32 v35, a46
    v_accvgpr_read_b32 v36, a50
    v_mfma_f32_16x16x32_bf16 a[68:71], v[68:71], v[164:167], a[68:71]
    v_exp_f32 v151, v151
    v_accvgpr_read_b32 v37, a54
    v_accvgpr_read_b32 v38, a58
    v_accvgpr_read_b32 v39, a62
    v_pk_mul_f32 v[32:33], v[32:33], v[172:173] op_sel_hi:[1,0]
    v_mfma_f32_16x16x32_bf16 a[72:75], v[72:75], v[164:167], a[72:75]
    v_pk_mul_f32 v[34:35], v[34:35], v[172:173] op_sel_hi:[1,0]
    v_pk_mul_f32 v[36:37], v[36:37], v[172:173] op_sel_hi:[1,0]
    v_pk_mul_f32 v[38:39], v[38:39], v[172:173] op_sel_hi:[1,0]
    v_cvt_pk_bf16_f32 v40, v32, v33
    v_mfma_f32_16x16x32_bf16 a[76:79], v[76:79], v[164:167], a[76:79]
    v_cvt_pk_bf16_f32 v160, v144, v145
    v_cvt_pk_bf16_f32 v41, v34, v35
    v_cvt_pk_bf16_f32 v42, v36, v37
    v_cvt_pk_bf16_f32 v43, v38, v39
    ds_write_b128 v216, v[40:43] offset:6144
    v_mfma_f32_16x16x32_bf16 a[80:83], v[80:83], v[164:167], a[80:83]
    v_cvt_pk_bf16_f32 v161, v146, v147
    v_accvgpr_read_b32 v44, a35
    v_accvgpr_read_b32 v45, a39
    v_accvgpr_read_b32 v46, a43
    v_accvgpr_read_b32 v47, a47
    v_accvgpr_read_b32 v48, a51
    v_mfma_f32_16x16x32_bf16 a[84:87], v[84:87], v[164:167], a[84:87]
    v_cvt_pk_bf16_f32 v162, v148, v149
    v_accvgpr_read_b32 v49, a55
    v_accvgpr_read_b32 v50, a59
    v_accvgpr_read_b32 v51, a63
    v_pk_mul_f32 v[44:45], v[44:45], v[172:173] op_sel_hi:[1,0]
    v_mfma_f32_16x16x32_bf16 a[88:91], v[88:91], v[164:167], a[88:91]
    v_cvt_pk_bf16_f32 v163, v150, v151
    v_pk_mul_f32 v[46:47], v[46:47], v[172:173] op_sel_hi:[1,0]
    v_pk_mul_f32 v[48:49], v[48:49], v[172:173] op_sel_hi:[1,0]
    v_pk_mul_f32 v[50:51], v[50:51], v[172:173] op_sel_hi:[1,0]
    v_cvt_pk_bf16_f32 v52, v44, v45
    v_mfma_f32_16x16x32_bf16 a[92:95], v[92:95], v[164:167], a[92:95]
    ds_bpermute_b32 v178, v221, v206 offset:0
    v_cvt_pk_bf16_f32 v53, v46, v47
    v_cvt_pk_bf16_f32 v54, v48, v49
    v_cvt_pk_bf16_f32 v55, v50, v51
    ds_write_b128 v216, v[52:55] offset:7168
    s_waitcnt lgkmcnt(0)
    v_max3_f32 v217, v152, v153, v154
    v_max3_f32 v217, v217, v155, v156
    v_rcp_f32 v176, v178
    v_mfma_f32_16x16x32_bf16 v[144:147], v[0:3], v[128:131], v[188:191]
    v_max3_f32 v217, v217, v157, v158
    v_max_f32 v217, v217, v159
    v_mfma_f32_16x16x32_bf16 v[148:151], v[16:19], v[128:131], v[188:191]
    v_cmp_lt_f32 vcc, s50, v217
    ds_read_b128 v[128:131], v216 offset:24576
    v_accvgpr_read_b32 v32, a64
    v_accvgpr_read_b32 v33, a68
    v_accvgpr_read_b32 v34, a72
    v_accvgpr_read_b32 v35, a76
    v_accvgpr_read_b32 v36, a80
    v_mfma_f32_16x16x32_bf16 v[144:147], v[4:7], v[132:135], v[144:147]
    v_accvgpr_read_b32 v37, a84
    v_accvgpr_read_b32 v38, a88
    v_accvgpr_read_b32 v39, a92
    v_pk_mul_f32 v[32:33], v[32:33], v[176:177] op_sel_hi:[1,0]
    v_mfma_f32_16x16x32_bf16 v[148:151], v[20:23], v[132:135], v[148:151]
    s_cbranch_vccnz K1_rare_l4
K1_back_l4:
    v_exp_f32 v152, v152
    ds_read_b128 v[132:135], v216 offset:25600
    v_pk_mul_f32 v[34:35], v[34:35], v[176:177] op_sel_hi:[1,0]
    v_pk_mul_f32 v[36:37], v[36:37], v[176:177] op_sel_hi:[1,0]
    v_pk_mul_f32 v[38:39], v[38:39], v[176:177] op_sel_hi:[1,0]
    v_cvt_pk_bf16_f32 v40, v32, v33
    v_mfma_f32_16x16x32_bf16 v[144:147], v[8:11], v[136:139], v[144:147]
    v_exp_f32 v153, v153
    v_cvt_pk_bf16_f32 v41, v34, v35
    v_cvt_pk_bf16_f32 v42, v36, v37
    v_cvt_pk_bf16_f32 v43, v38, v39
    ds_write_b128 v216, v[40:43] offset:8192
    v_mfma_f32_16x16x32_bf16 v[148:151], v[24:27], v[136:139], v[148:151]
    v_exp_f32 v154, v154
    ds_read_b128 v[136:139], v216 offset:26624
    v_accvgpr_read_b32 v44, a65
    v_accvgpr_read_b32 v45, a69
    v_accvgpr_read_b32 v46, a73
    v_accvgpr_read_b32 v47, a77
    v_accvgpr_read_b32 v48, a81
    v_mfma_f32_16x16x32_bf16 v[144:147], v[12:15], v[140:143], v[144:147]
    v_exp_f32 v155, v155
    v_accvgpr_read_b32 v49, a85
    v_accvgpr_read_b32 v50, a89
    v_accvgpr_read_b32 v51, a93
    v_pk_mul_f32 v[44:45], v[44:45], v[176:177] op_sel_hi:[1,0]
    v_mfma_f32_16x16x32_bf16 v[148:151], v[28:31], v[140:143], v[148:151]
    v_exp_f32 v156, v156
    ds_read_b128 v[140:143], v216 offset:27648
    v_pk_mul_f32 v[46:47], v[46:47], v[176:177] op_sel_hi:[1,0]
    v_pk_mul_f32 v[48:49], v[48:49], v[176:177] op_sel_hi:[1,0]
    v_pk_mul_f32 v[50:51], v[50:51], v[176:177] op_sel_hi:[1,0]
    v_cvt_pk_bf16_f32 v52, v44, v45
    v_mfma_f32_16x16x32_bf16 v[204:207], v[208:211], v[160:163], v[204:207]
    v_exp_f32 v157, v157
    v_cvt_pk_bf16_f32 v53, v46, v47
    v_cvt_pk_bf16_f32 v54, v48, v49
    v_cvt_pk_bf16_f32 v55, v50, v51
    ds_write_b128 v216, v[52:55] offset:9216
    v_mfma_f32_16x16x32_bf16 a[96:99], v[64:67], v[160:163], a[96:99]
    v_exp_f32 v158, v158
    ds_read_b128 v[208:211], v223 offset:4096
    v_accvgpr_read_b32 v32, a66
    v_accvgpr_read_b32 v33, a70
    v_accvgpr_read_b32 v34, a74
    v_accvgpr_read_b32 v35, a78
    v_accvgpr_read_b32 v36, a82
    v_mfma_f32_16x16x32_bf16 a[100:103], v[68:71], v[160:163], a[100:103]
    v_exp_f32 v159, v159
    v_accvgpr_read_b32 v37, a86
    v_accvgpr_read_b32 v38, a90
    v_accvgpr_read_b32 v39, a94
    v_pk_mul_f32 v[32:33], v[32:33], v[176:177] op_sel_hi:[1,0]
    v_mfma_f32_16x16x32_bf16 a[104:107], v[72:75], v[160:163], a[104:107]
    v_pk_mul_f32 v[34:35], v[34:35], v[176:177] op_sel_hi:[1,0]
    v_pk_mul_f32 v[36:37], v[36:37], v[176:177] op_sel_hi:[1,0]
    v_pk_mul_f32 v[38:39], v[38:39], v[176:177] op_sel_hi:[1,0]
    v_cvt_pk_bf16_f32 v40, v32, v33
    v_mfma_f32_16x16x32_bf16 a[108:111], v[76:79], v[160:163], a[108:111]
    v_cvt_pk_bf16_f32 v164, v152, v153
    v_cvt_pk_bf16_f32 v41, v34, v35
    v_cvt_pk_bf16_f32 v42, v36, v37
    v_cvt_pk_bf16_f32 v43, v38, v39
    ds_write_b128 v216, v[40:43] offset:10240
    v_mfma_f32_16x16x32_bf16 a[112:115], v[80:83], v[160:163], a[112:115]
    v_cvt_pk_bf16_f32 v165, v154, v155
    v_accvgpr_read_b32 v44, a67
    v_accvgpr_read_b32 v45, a71
    v_accvgpr_read_b32 v46, a75
    v_accvgpr_read_b32 v47, a79
    v_accvgpr_read_b32 v48, a83
    v_mfma_f32_16x16x32_bf16 a[116:119], v[84:87], v[160:163], a[116:119]
    v_cvt_pk_bf16_f32 v166, v156, v157
    v_accvgpr_read_b32 v49, a87
    v_accvgpr_read_b32 v50, a91
    v_accvgpr_read_b32 v51, a95
    v_pk_mul_f32 v[44:45], v[44:45], v[176:177] op_sel_hi:[1,0]
    v_mfma_f32_16x16x32_bf16 a[120:123], v[88:91], v[160:163], a[120:123]
    v_cvt_pk_bf16_f32 v167, v158, v159
    v_pk_mul_f32 v[46:47], v[46:47], v[176:177] op_sel_hi:[1,0]
    v_pk_mul_f32 v[48:49], v[48:49], v[176:177] op_sel_hi:[1,0]
    v_pk_mul_f32 v[50:51], v[50:51], v[176:177] op_sel_hi:[1,0]
    v_cvt_pk_bf16_f32 v52, v44, v45
    v_mfma_f32_16x16x32_bf16 a[124:127], v[92:95], v[160:163], a[124:127]
    ds_bpermute_b32 v182, v221, v207 offset:0
    v_cvt_pk_bf16_f32 v53, v46, v47
    v_cvt_pk_bf16_f32 v54, v48, v49
    v_cvt_pk_bf16_f32 v55, v50, v51
    ds_write_b128 v216, v[52:55] offset:11264
    s_waitcnt lgkmcnt(0)
    v_max3_f32 v217, v144, v145, v146
    v_max3_f32 v217, v217, v147, v148
    v_rcp_f32 v180, v182
    v_mfma_f32_16x16x32_bf16 v[152:155], v[0:3], v[128:131], v[192:195]
    v_max3_f32 v217, v217, v149, v150
    v_max_f32 v217, v217, v151
    v_mfma_f32_16x16x32_bf16 v[156:159], v[16:19], v[128:131], v[192:195]
    v_cmp_lt_f32 vcc, s50, v217
    ds_read_b128 v[128:131], v216 offset:28672
    v_accvgpr_read_b32 v32, a96
    v_accvgpr_read_b32 v33, a100
    v_accvgpr_read_b32 v34, a104
    v_accvgpr_read_b32 v35, a108
    v_accvgpr_read_b32 v36, a112
    v_mfma_f32_16x16x32_bf16 v[152:155], v[4:7], v[132:135], v[152:155]
    v_accvgpr_read_b32 v37, a116
    v_accvgpr_read_b32 v38, a120
    v_accvgpr_read_b32 v39, a124
    v_pk_mul_f32 v[32:33], v[32:33], v[180:181] op_sel_hi:[1,0]
    v_mfma_f32_16x16x32_bf16 v[156:159], v[20:23], v[132:135], v[156:159]
    s_cbranch_vccnz K1_rare_l5
K1_back_l5:
    v_exp_f32 v144, v144
    ds_read_b128 v[132:135], v216 offset:29696
    v_pk_mul_f32 v[34:35], v[34:35], v[180:181] op_sel_hi:[1,0]
    v_pk_mul_f32 v[36:37], v[36:37], v[180:181] op_sel_hi:[1,0]
    v_pk_mul_f32 v[38:39], v[38:39], v[180:181] op_sel_hi:[1,0]
    v_cvt_pk_bf16_f32 v40, v32, v33
    v_mfma_f32_16x16x32_bf16 v[152:155], v[8:11], v[136:139], v[152:155]
    v_exp_f32 v145, v145
    v_cvt_pk_bf16_f32 v41, v34, v35
    v_cvt_pk_bf16_f32 v42, v36, v37
    v_cvt_pk_bf16_f32 v43, v38, v39
    ds_write_b128 v216, v[40:43] offset:12288
    v_mfma_f32_16x16x32_bf16 v[156:159], v[24:27], v[136:139], v[156:159]
    v_exp_f32 v146, v146
    ds_read_b128 v[136:139], v216 offset:30720
    v_accvgpr_read_b32 v44, a97
    v_accvgpr_read_b32 v45, a101
    v_accvgpr_read_b32 v46, a105
    v_accvgpr_read_b32 v47, a109
    v_accvgpr_read_b32 v48, a113
    v_mfma_f32_16x16x32_bf16 v[152:155], v[12:15], v[140:143], v[152:155]
    v_exp_f32 v147, v147
    v_accvgpr_read_b32 v49, a117
    v_accvgpr_read_b32 v50, a121
    v_accvgpr_read_b32 v51, a125
    v_pk_mul_f32 v[44:45], v[44:45], v[180:181] op_sel_hi:[1,0]
    v_mfma_f32_16x16x32_bf16 v[156:159], v[28:31], v[140:143], v[156:159]
    v_exp_f32 v148, v148
    ds_read_b128 v[140:143], v216 offset:31744
    v_pk_mul_f32 v[46:47], v[46:47], v[180:181] op_sel_hi:[1,0]
    v_pk_mul_f32 v[48:49], v[48:49], v[180:181] op_sel_hi:[1,0]
    v_pk_mul_f32 v[50:51], v[50:51], v[180:181] op_sel_hi:[1,0]
    v_cvt_pk_bf16_f32 v52, v44, v45
    v_mfma_f32_16x16x32_bf16 v[204:207], v[208:211], v[164:167], v[204:207]
    v_exp_f32 v149, v149
    v_cvt_pk_bf16_f32 v53, v46, v47
    v_cvt_pk_bf16_f32 v54, v48, v49
    v_cvt_pk_bf16_f32 v55, v50, v51
    ds_write_b128 v216, v[52:55] offset:13312
    v_mfma_f32_16x16x32_bf16 a[128:131], v[64:67], v[164:167], a[128:131]
    v_exp_f32 v150, v150
    ds_read_b128 v[208:211], v223 offset:5120
    v_accvgpr_read_b32 v32, a98
    v_accvgpr_read_b32 v33, a102
    v_accvgpr_read_b32 v34, a106
    v_accvgpr_read_b32 v35, a110
    v_accvgpr_read_b32 v36, a114
    v_mfma_f32_16x16x32_bf16 a[132:135], v[68:71], v[164:167], a[132:135]
    v_exp_f32 v151, v151
    v_accvgpr_read_b32 v37, a118
    v_accvgpr_read_b32 v38, a122
    v_accvgpr_read_b32 v39, a126
    v_pk_mul_f32 v[32:33], v[32:33], v[180:181] op_sel_hi:[1,0]
    v_mfma_f32_16x16x32_bf16 a[136:139], v[72:75], v[164:167], a[136:139]
    v_pk_mul_f32 v[34:35], v[34:35], v[180:181] op_sel_hi:[1,0]
    v_pk_mul_f32 v[36:37], v[36:37], v[180:181] op_sel_hi:[1,0]
    v_pk_mul_f32 v[38:39], v[38:39], v[180:181] op_sel_hi:[1,0]
    v_cvt_pk_bf16_f32 v40, v32, v33
    v_mfma_f32_16x16x32_bf16 a[140:143], v[76:79], v[164:167], a[140:143]
    v_cvt_pk_bf16_f32 v160, v144, v145
    v_cvt_pk_bf16_f32 v41, v34, v35
    v_cvt_pk_bf16_f32 v42, v36, v37
    v_cvt_pk_bf16_f32 v43, v38, v39
    ds_write_b128 v216, v[40:43] offset:14336
    v_mfma_f32_16x16x32_bf16 a[144:147], v[80:83], v[164:167], a[144:147]
    v_cvt_pk_bf16_f32 v161, v146, v147
    v_accvgpr_read_b32 v44, a99
    v_accvgpr_read_b32 v45, a103
    v_accvgpr_read_b32 v46, a107
    v_accvgpr_read_b32 v47, a111
    v_accvgpr_read_b32 v48, a115
    v_mfma_f32_16x16x32_bf16 a[148:151], v[84:87], v[164:167], a[148:151]
    v_cvt_pk_bf16_f32 v162, v148, v149
    v_accvgpr_read_b32 v49, a119
    v_accvgpr_read_b32 v50, a123
    v_accvgpr_read_b32 v51, a127
    v_pk_mul_f32 v[44:45], v[44:45], v[180:181] op_sel_hi:[1,0]
    v_mfma_f32_16x16x32_bf16 a[152:155], v[88:91], v[164:167], a[152:155]
    v_cvt_pk_bf16_f32 v163, v150, v151
    v_pk_mul_f32 v[46:47], v[46:47], v[180:181] op_sel_hi:[1,0]
    v_pk_mul_f32 v[48:49], v[48:49], v[180:181] op_sel_hi:[1,0]
    v_pk_mul_f32 v[50:51], v[50:51], v[180:181] op_sel_hi:[1,0]
    v_cvt_pk_bf16_f32 v52, v44, v45
    v_mfma_f32_16x16x32_bf16 a[156:159], v[92:95], v[164:167], a[156:159]
    ds_bpermute_b32 v186, v221, v204 offset:64
    v_cvt_pk_bf16_f32 v53, v46, v47
    v_cvt_pk_bf16_f32 v54, v48, v49
    v_cvt_pk_bf16_f32 v55, v50, v51
    ds_write_b128 v216, v[52:55] offset:15360
    s_waitcnt lgkmcnt(0)
    v_max3_f32 v217, v152, v153, v154
    v_max3_f32 v217, v217, v155, v156
    v_rcp_f32 v184, v186
    v_mfma_f32_16x16x32_bf16 v[144:147], v[0:3], v[128:131], v[196:199]
    v_max3_f32 v217, v217, v157, v158
    v_max_f32 v217, v217, v159
    v_mfma_f32_16x16x32_bf16 v[148:151], v[16:19], v[128:131], v[196:199]
    v_cmp_lt_f32 vcc, s50, v217
    ds_read_b128 v[128:131], v216 offset:32768
    v_accvgpr_read_b32 v32, a128
    v_accvgpr_read_b32 v33, a132
    v_accvgpr_read_b32 v34, a136
    v_accvgpr_read_b32 v35, a140
    v_accvgpr_read_b32 v36, a144
    v_mfma_f32_16x16x32_bf16 v[144:147], v[4:7], v[132:135], v[144:147]
    v_accvgpr_read_b32 v37, a148
    v_accvgpr_read_b32 v38, a152
    v_accvgpr_read_b32 v39, a156
    v_pk_mul_f32 v[32:33], v[32:33], v[184:185] op_sel_hi:[1,0]
    v_mfma_f32_16x16x32_bf16 v[148:151], v[20:23], v[132:135], v[148:151]
    s_cbranch_vccnz K1_rare_l6
K1_back_l6:
    v_exp_f32 v152, v152
    ds_read_b128 v[132:135], v216 offset:33792
    v_pk_mul_f32 v[34:35], v[34:35], v[184:185] op_sel_hi:[1,0]
    v_pk_mul_f32 v[36:37], v[36:37], v[184:185] op_sel_hi:[1,0]
    v_pk_mul_f32 v[38:39], v[38:39], v[184:185] op_sel_hi:[1,0]
    v_cvt_pk_bf16_f32 v40, v32, v33
    v_mfma_f32_16x16x32_bf16 v[144:147], v[8:11], v[136:139], v[144:147]
    v_exp_f32 v153, v153
    v_cvt_pk_bf16_f32 v41, v34, v35
    v_cvt_pk_bf16_f32 v42, v36, v37
    v_cvt_pk_bf16_f32 v43, v38, v39
    ds_write_b128 v216, v[40:43] offset:16384
    v_mfma_f32_16x16x32_bf16 v[148:151], v[24:27], v[136:139], v[148:151]
    v_exp_f32 v154, v154
    ds_read_b128 v[136:139], v216 offset:34816
    v_accvgpr_read_b32 v44, a129
    v_accvgpr_read_b32 v45, a133
    v_accvgpr_read_b32 v46, a137
    v_accvgpr_read_b32 v47, a141
    v_accvgpr_read_b32 v48, a145
    v_mfma_f32_16x16x32_bf16 v[144:147], v[12:15], v[140:143], v[144:147]
    v_exp_f32 v155, v155
    v_accvgpr_read_b32 v49, a149
    v_accvgpr_read_b32 v50, a153
    v_accvgpr_read_b32 v51, a157
    v_pk_mul_f32 v[44:45], v[44:45], v[184:185] op_sel_hi:[1,0]
    v_mfma_f32_16x16x32_bf16 v[148:151], v[28:31], v[140:143], v[148:151]
    v_exp_f32 v156, v156
    ds_read_b128 v[140:143], v216 offset:35840
    v_pk_mul_f32 v[46:47], v[46:47], v[184:185] op_sel_hi:[1,0]
    v_pk_mul_f32 v[48:49], v[48:49], v[184:185] op_sel_hi:[1,0]
    v_pk_mul_f32 v[50:51], v[50:51], v[184:185] op_sel_hi:[1,0]
    v_cvt_pk_bf16_f32 v52, v44, v45
    v_mfma_f32_16x16x32_bf16 v[204:207], v[208:211], v[160:163], v[204:207]
    v_exp_f32 v157, v157
    v_cvt_pk_bf16_f32 v53, v46, v47
    v_cvt_pk_bf16_f32 v54, v48, v49
    v_cvt_pk_bf16_f32 v55, v50, v51
    ds_write_b128 v216, v[52:55] offset:17408
    v_mfma_f32_16x16x32_bf16 a[160:163], v[64:67], v[160:163], a[160:163]
    v_exp_f32 v158, v158
    ds_read_b128 v[208:211], v223 offset:6144
    v_accvgpr_read_b32 v32, a130
    v_accvgpr_read_b32 v33, a134
    v_accvgpr_read_b32 v34, a138
    v_accvgpr_read_b32 v35, a142
    v_accvgpr_read_b32 v36, a146
    v_mfma_f32_16x16x32_bf16 a[164:167], v[68:71], v[160:163], a[164:167]
    v_exp_f32 v159, v159
    v_accvgpr_read_b32 v37, a150
    v_accvgpr_read_b32 v38, a154
    v_accvgpr_read_b32 v39, a158
    v_pk_mul_f32 v[32:33], v[32:33], v[184:185] op_sel_hi:[1,0]
    v_mfma_f32_16x16x32_bf16 a[168:171], v[72:75], v[160:163], a[168:171]
    v_pk_mul_f32 v[34:35], v[34:35], v[184:185] op_sel_hi:[1,0]
    v_pk_mul_f32 v[36:37], v[36:37], v[184:185] op_sel_hi:[1,0]
    v_pk_mul_f32 v[38:39], v[38:39], v[184:185] op_sel_hi:[1,0]
    v_cvt_pk_bf16_f32 v40, v32, v33
    v_mfma_f32_16x16x32_bf16 a[172:175], v[76:79], v[160:163], a[172:175]
    v_cvt_pk_bf16_f32 v164, v152, v153
    v_cvt_pk_bf16_f32 v41, v34, v35
    v_cvt_pk_bf16_f32 v42, v36, v37
    v_cvt_pk_bf16_f32 v43, v38, v39
    ds_write_b128 v216, v[40:43] offset:18432
    v_mfma_f32_16x16x32_bf16 a[176:179], v[80:83], v[160:163], a[176:179]
    v_cvt_pk_bf16_f32 v165, v154, v155
    v_accvgpr_read_b32 v44, a131
    v_accvgpr_read_b32 v45, a135
    v_accvgpr_read_b32 v46, a139
    v_accvgpr_read_b32 v47, a143
    v_accvgpr_read_b32 v48, a147
    v_mfma_f32_16x16x32_bf16 a[180:183], v[84:87], v[160:163], a[180:183]
    v_cvt_pk_bf16_f32 v166, v156, v157
    v_accvgpr_read_b32 v49, a151
    v_accvgpr_read_b32 v50, a155
    v_accvgpr_read_b32 v51, a159
    v_pk_mul_f32 v[44:45], v[44:45], v[184:185] op_sel_hi:[1,0]
    v_mfma_f32_16x16x32_bf16 a[184:187], v[88:91], v[160:163], a[184:187]
    v_cvt_pk_bf16_f32 v167, v158, v159
    v_pk_mul_f32 v[46:47], v[46:47], v[184:185] op_sel_hi:[1,0]
    v_pk_mul_f32 v[48:49], v[48:49], v[184:185] op_sel_hi:[1,0]
    v_pk_mul_f32 v[50:51], v[50:51], v[184:185] op_sel_hi:[1,0]
    v_cvt_pk_bf16_f32 v52, v44, v45
    v_mfma_f32_16x16x32_bf16 a[188:191], v[92:95], v[160:163], a[188:191]
    ds_bpermute_b32 v190, v221, v205 offset:64
    v_cvt_pk_bf16_f32 v53, v46, v47
    v_cvt_pk_bf16_f32 v54, v48, v49
    v_cvt_pk_bf16_f32 v55, v50, v51
    ds_write_b128 v216, v[52:55] offset:19456
    s_waitcnt lgkmcnt(0)
    v_max3_f32 v217, v144, v145, v146
    v_max3_f32 v217, v217, v147, v148
    v_rcp_f32 v188, v190
    v_mfma_f32_16x16x32_bf16 v[152:155], v[0:3], v[128:131], v[200:203]
    v_max3_f32 v217, v217, v149, v150
    v_max_f32 v217, v217, v151
    v_mfma_f32_16x16x32_bf16 v[156:159], v[16:19], v[128:131], v[200:203]
    v_cmp_lt_f32 vcc, s50, v217
    v_accvgpr_read_b32 v32, a160
    v_accvgpr_read_b32 v33, a164
    v_accvgpr_read_b32 v34, a168
    v_accvgpr_read_b32 v35, a172
    v_accvgpr_read_b32 v36, a176
    v_mfma_f32_16x16x32_bf16 v[152:155], v[4:7], v[132:135], v[152:155]
    v_accvgpr_read_b32 v37, a180
    v_accvgpr_read_b32 v38, a184
    v_accvgpr_read_b32 v39, a188
    v_pk_mul_f32 v[32:33], v[32:33], v[188:189] op_sel_hi:[1,0]
    v_mfma_f32_16x16x32_bf16 v[156:159], v[20:23], v[132:135], v[156:159]
    s_cbranch_vccnz K1_rare_l7
K1_back_l7:
    v_exp_f32 v144, v144
    v_pk_mul_f32 v[34:35], v[34:35], v[188:189] op_sel_hi:[1,0]
    v_pk_mul_f32 v[36:37], v[36:37], v[188:189] op_sel_hi:[1,0]
    v_pk_mul_f32 v[38:39], v[38:39], v[188:189] op_sel_hi:[1,0]
    v_cvt_pk_bf16_f32 v40, v32, v33
    v_mfma_f32_16x16x32_bf16 v[152:155], v[8:11], v[136:139], v[152:155]
    v_exp_f32 v145, v145
    v_cvt_pk_bf16_f32 v41, v34, v35
    v_cvt_pk_bf16_f32 v42, v36, v37
    v_cvt_pk_bf16_f32 v43, v38, v39
    ds_write_b128 v216, v[40:43] offset:20480
    v_mfma_f32_16x16x32_bf16 v[156:159], v[24:27], v[136:139], v[156:159]
    v_exp_f32 v146, v146
    v_accvgpr_read_b32 v44, a161
    v_accvgpr_read_b32 v45, a165
    v_accvgpr_read_b32 v46, a169
    v_accvgpr_read_b32 v47, a173
    v_accvgpr_read_b32 v48, a177
    v_mfma_f32_16x16x32_bf16 v[152:155], v[12:15], v[140:143], v[152:155]
    v_exp_f32 v147, v147
    v_accvgpr_read_b32 v49, a181
    v_accvgpr_read_b32 v50, a185
    v_accvgpr_read_b32 v51, a189
    v_pk_mul_f32 v[44:45], v[44:45], v[188:189] op_sel_hi:[1,0]
    v_mfma_f32_16x16x32_bf16 v[156:159], v[28:31], v[140:143], v[156:159]
    v_exp_f32 v148, v148
    v_pk_mul_f32 v[46:47], v[46:47], v[188:189] op_sel_hi:[1,0]
    v_pk_mul_f32 v[48:49], v[48:49], v[188:189] op_sel_hi:[1,0]
    v_pk_mul_f32 v[50:51], v[50:51], v[188:189] op_sel_hi:[1,0]
    v_cvt_pk_bf16_f32 v52, v44, v45
    v_mfma_f32_16x16x32_bf16 v[204:207], v[208:211], v[164:167], v[204:207]
    v_exp_f32 v149, v149
    v_cvt_pk_bf16_f32 v53, v46, v47
    v_cvt_pk_bf16_f32 v54, v48, v49
    v_cvt_pk_bf16_f32 v55, v50, v51
    ds_write_b128 v216, v[52:55] offset:21504
    v_mfma_f32_16x16x32_bf16 a[192:195], v[64:67], v[164:167], a[192:195]
    v_exp_f32 v150, v150
    ds_read_b128 v[208:211], v223 offset:7168
    v_accvgpr_read_b32 v32, a162
    v_accvgpr_read_b32 v33, a166
    v_accvgpr_read_b32 v34, a170
    v_accvgpr_read_b32 v35, a174
    v_accvgpr_read_b32 v36, a178
    v_mfma_f32_16x16x32_bf16 a[196:199], v[68:71], v[164:167], a[196:199]
    v_exp_f32 v151, v151
    v_accvgpr_read_b32 v37, a182
    v_accvgpr_read_b32 v38, a186
    v_accvgpr_read_b32 v39, a190
    v_pk_mul_f32 v[32:33], v[32:33], v[188:189] op_sel_hi:[1,0]
    v_mfma_f32_16x16x32_bf16 a[200:203], v[72:75], v[164:167], a[200:203]
    v_pk_mul_f32 v[34:35], v[34:35], v[188:189] op_sel_hi:[1,0]
    v_pk_mul_f32 v[36:37], v[36:37], v[188:189] op_sel_hi:[1,0]
    v_pk_mul_f32 v[38:39], v[38:39], v[188:189] op_sel_hi:[1,0]
    v_cvt_pk_bf16_f32 v40, v32, v33
    v_mfma_f32_16x16x32_bf16 a[204:207], v[76:79], v[164:167], a[204:207]
    v_cvt_pk_bf16_f32 v160, v144, v145
    v_cvt_pk_bf16_f32 v41, v34, v35
    v_cvt_pk_bf16_f32 v42, v36, v37
    v_cvt_pk_bf16_f32 v43, v38, v39
    ds_write_b128 v216, v[40:43] offset:22528
    v_mfma_f32_16x16x32_bf16 a[208:211], v[80:83], v[164:167], a[208:211]
    v_cvt_pk_bf16_f32 v161, v146, v147
    v_accvgpr_read_b32 v44, a163
    v_accvgpr_read_b32 v45, a167
    v_accvgpr_read_b32 v46, a171
    v_accvgpr_read_b32 v47, a175
    v_accvgpr_read_b32 v48, a179
    v_mfma_f32_16x16x32_bf16 a[212:215], v[84:87], v[164:167], a[212:215]
    v_cvt_pk_bf16_f32 v162, v148, v149
    v_accvgpr_read_b32 v49, a183
    v_accvgpr_read_b32 v50, a187
    v_accvgpr_read_b32 v51, a191
    v_pk_mul_f32 v[44:45], v[44:45], v[188:189] op_sel_hi:[1,0]
    v_mfma_f32_16x16x32_bf16 a[216:219], v[88:91], v[164:167], a[216:219]
    v_cvt_pk_bf16_f32 v163, v150, v151
    v_pk_mul_f32 v[46:47], v[46:47], v[188:189] op_sel_hi:[1,0]
    v_pk_mul_f32 v[48:49], v[48:49], v[188:189] op_sel_hi:[1,0]
    v_pk_mul_f32 v[50:51], v[50:51], v[188:189] op_sel_hi:[1,0]
    v_cvt_pk_bf16_f32 v52, v44, v45
    v_mfma_f32_16x16x32_bf16 a[220:223], v[92:95], v[164:167], a[220:223]
    ds_bpermute_b32 v194, v221, v206 offset:64
    v_cvt_pk_bf16_f32 v53, v46, v47
    v_cvt_pk_bf16_f32 v54, v48, v49
    v_cvt_pk_bf16_f32 v55, v50, v51
    ds_write_b128 v216, v[52:55] offset:23552
    s_waitcnt lgkmcnt(0)
    v_max3_f32 v217, v152, v153, v154
    v_max3_f32 v217, v217, v155, v156
    v_max3_f32 v217, v217, v157, v158
    v_rcp_f32 v192, v194
    v_mfma_f32_16x16x32_bf16 v[204:207], v[208:211], v[160:163], v[204:207]
    v_max_f32 v217, v217, v159
    v_cmp_lt_f32 vcc, s50, v217
    buffer_load_dwordx4 v[0:3], v220, s[24:27], s33 offen offset:0
    buffer_load_dwordx4 v[4:7], v220, s[24:27], s33 offen offset:1024
    buffer_load_dwordx4 v[8:11], v220, s[24:27], s33 offen offset:2048
    v_mfma_f32_16x16x32_bf16 a[224:227], v[64:67], v[160:163], a[224:227]
    s_cbranch_vccnz K1_rare_l8
K1_back_l8:
    v_exp_f32 v152, v152
    v_exp_f32 v153, v153
    ds_read_b128 v[208:211], v223 offset:8192
    buffer_load_dwordx4 v[12:15], v220, s[24:27], s33 offen offset:3072
    buffer_load_dwordx4 v[16:19], v222, s[24:27], s33 offen offset:0
    v_accvgpr_read_b32 v32, a192
    v_accvgpr_read_b32 v33, a196
    v_accvgpr_read_b32 v34, a200
    v_accvgpr_read_b32 v35, a204
    v_accvgpr_read_b32 v36, a208
    v_accvgpr_read_b32 v37, a212
    v_accvgpr_read_b32 v38, a216
    v_accvgpr_read_b32 v39, a220
    v_pk_mul_f32 v[32:33], v[32:33], v[192:193] op_sel_hi:[1,0]
    v_mfma_f32_16x16x32_bf16 a[228:231], v[68:71], v[160:163], a[228:231]
    v_exp_f32 v154, v154
    v_exp_f32 v155, v155
    buffer_load_dwordx4 v[20:23], v222, s[24:27], s33 offen offset:1024
    buffer_load_dwordx4 v[24:27], v222, s[24:27], s33 offen offset:2048
    v_pk_mul_f32 v[34:35], v[34:35], v[192:193] op_sel_hi:[1,0]
    v_pk_mul_f32 v[36:37], v[36:37], v[192:193] op_sel_hi:[1,0]
    v_pk_mul_f32 v[38:39], v[38:39], v[192:193] op_sel_hi:[1,0]
    v_cvt_pk_bf16_f32 v40, v32, v33
    v_cvt_pk_bf16_f32 v41, v34, v35
    v_cvt_pk_bf16_f32 v42, v36, v37
    v_cvt_pk_bf16_f32 v43, v38, v39
    ds_write_b128 v216, v[40:43] offset:24576
    v_mfma_f32_16x16x32_bf16 a[232:235], v[72:75], v[160:163], a[232:235]
    v_exp_f32 v156, v156
    buffer_load_dwordx4 v[28:31], v222, s[24:27], s33 offen offset:3072
    s_add_u32 s33, s33, 32768
    v_accvgpr_read_b32 v44, a193
    v_accvgpr_read_b32 v45, a197
    v_accvgpr_read_b32 v46, a201
    v_accvgpr_read_b32 v47, a205
    v_accvgpr_read_b32 v48, a209
    v_accvgpr_read_b32 v49, a213
    v_accvgpr_read_b32 v50, a217
    v_accvgpr_read_b32 v51, a221
    v_pk_mul_f32 v[44:45], v[44:45], v[192:193] op_sel_hi:[1,0]
    v_mfma_f32_16x16x32_bf16 a[236:239], v[76:79], v[160:163], a[236:239]
    v_exp_f32 v157, v157
    v_exp_f32 v158, v158
    v_pk_mul_f32 v[46:47], v[46:47], v[192:193] op_sel_hi:[1,0]
    v_pk_mul_f32 v[48:49], v[48:49], v[192:193] op_sel_hi:[1,0]
    v_pk_mul_f32 v[50:51], v[50:51], v[192:193] op_sel_hi:[1,0]
    v_cvt_pk_bf16_f32 v52, v44, v45
    v_cvt_pk_bf16_f32 v53, v46, v47
    v_cvt_pk_bf16_f32 v54, v48, v49
    v_cvt_pk_bf16_f32 v55, v50, v51
    ds_write_b128 v216, v[52:55] offset:25600
    v_mfma_f32_16x16x32_bf16 a[240:243], v[80:83], v[160:163], a[240:243]
    v_exp_f32 v159, v159
    v_cvt_pk_bf16_f32 v164, v152, v153
    v_cvt_pk_bf16_f32 v165, v154, v155
    v_accvgpr_read_b32 v32, a194
    v_accvgpr_read_b32 v33, a198
    v_accvgpr_read_b32 v34, a202
    v_accvgpr_read_b32 v35, a206
    v_accvgpr_read_b32 v36, a210
    v_accvgpr_read_b32 v37, a214
    v_accvgpr_read_b32 v38, a218
    v_accvgpr_read_b32 v39, a222
    v_pk_mul_f32 v[32:33], v[32:33], v[192:193] op_sel_hi:[1,0]
    v_mfma_f32_16x16x32_bf16 a[244:247], v[84:87], v[160:163], a[244:247]
    v_cvt_pk_bf16_f32 v166, v156, v157
    v_pk_mul_f32 v[34:35], v[34:35], v[192:193] op_sel_hi:[1,0]
    v_pk_mul_f32 v[36:37], v[36:37], v[192:193] op_sel_hi:[1,0]
    v_pk_mul_f32 v[38:39], v[38:39], v[192:193] op_sel_hi:[1,0]
    v_cvt_pk_bf16_f32 v40, v32, v33
    v_cvt_pk_bf16_f32 v41, v34, v35
    v_cvt_pk_bf16_f32 v42, v36, v37
    v_cvt_pk_bf16_f32 v43, v38, v39
    ds_write_b128 v216, v[40:43] offset:26624
    v_mfma_f32_16x16x32_bf16 a[248:251], v[88:91], v[160:163], a[248:251]
    v_cvt_pk_bf16_f32 v167, v158, v159
    v_accvgpr_read_b32 v44, a195
    v_accvgpr_read_b32 v45, a199
    v_accvgpr_read_b32 v46, a203
    v_accvgpr_read_b32 v47, a207
    v_accvgpr_read_b32 v48, a211
    v_accvgpr_read_b32 v49, a215
    v_accvgpr_read_b32 v50, a219
    v_accvgpr_read_b32 v51, a223
    v_pk_mul_f32 v[44:45], v[44:45], v[192:193] op_sel_hi:[1,0]
    v_mfma_f32_16x16x32_bf16 a[252:255], v[92:95], v[160:163], a[252:255]
    ds_bpermute_b32 v198, v221, v207 offset:64
    v_pk_mul_f32 v[46:47], v[46:47], v[192:193] op_sel_hi:[1,0]
    v_pk_mul_f32 v[48:49], v[48:49], v[192:193] op_sel_hi:[1,0]
    v_pk_mul_f32 v[50:51], v[50:51], v[192:193] op_sel_hi:[1,0]
    v_cvt_pk_bf16_f32 v52, v44, v45
    v_cvt_pk_bf16_f32 v53, v46, v47
    v_cvt_pk_bf16_f32 v54, v48, v49
    v_cvt_pk_bf16_f32 v55, v50, v51
    ds_write_b128 v216, v[52:55] offset:27648
    s_waitcnt lgkmcnt(0)
    v_rcp_f32 v196, v198
    v_mfma_f32_16x16x32_bf16 v[204:207], v[208:211], v[164:167], v[204:207]
    v_mfma_f32_16x16x32_bf16 v[224:227], v[64:67], v[164:167], v[224:227]
    v_accvgpr_read_b32 v32, a224
    v_accvgpr_read_b32 v33, a228
    v_accvgpr_read_b32 v34, a232
    v_accvgpr_read_b32 v35, a236
    v_accvgpr_read_b32 v36, a240
    v_accvgpr_read_b32 v37, a244
    v_accvgpr_read_b32 v38, a248
    v_accvgpr_read_b32 v39, a252
    v_pk_mul_f32 v[32:33], v[32:33], v[196:197] op_sel_hi:[1,0]
    v_mfma_f32_16x16x32_bf16 v[228:231], v[68:71], v[164:167], v[228:231]
    v_pk_mul_f32 v[34:35], v[34:35], v[196:197] op_sel_hi:[1,0]
    v_pk_mul_f32 v[36:37], v[36:37], v[196:197] op_sel_hi:[1,0]
    v_pk_mul_f32 v[38:39], v[38:39], v[196:197] op_sel_hi:[1,0]
    v_cvt_pk_bf16_f32 v40, v32, v33
    v_cvt_pk_bf16_f32 v41, v34, v35
    v_cvt_pk_bf16_f32 v42, v36, v37
    v_cvt_pk_bf16_f32 v43, v38, v39
    ds_write_b128 v216, v[40:43] offset:28672
    v_mfma_f32_16x16x32_bf16 v[232:235], v[72:75], v[164:167], v[232:235]
    v_accvgpr_read_b32 v44, a225
    v_accvgpr_read_b32 v45, a229
    v_accvgpr_read_b32 v46, a233
    v_accvgpr_read_b32 v47, a237
    v_accvgpr_read_b32 v48, a241
    v_accvgpr_read_b32 v49, a245
    v_accvgpr_read_b32 v50, a249
    v_accvgpr_read_b32 v51, a253
    v_pk_mul_f32 v[44:45], v[44:45], v[196:197] op_sel_hi:[1,0]
    v_mfma_f32_16x16x32_bf16 v[236:239], v[76:79], v[164:167], v[236:239]
    v_pk_mul_f32 v[46:47], v[46:47], v[196:197] op_sel_hi:[1,0]
    v_pk_mul_f32 v[48:49], v[48:49], v[196:197] op_sel_hi:[1,0]
    v_pk_mul_f32 v[50:51], v[50:51], v[196:197] op_sel_hi:[1,0]
    v_cvt_pk_bf16_f32 v52, v44, v45
    v_cvt_pk_bf16_f32 v53, v46, v47
    v_cvt_pk_bf16_f32 v54, v48, v49
    v_cvt_pk_bf16_f32 v55, v50, v51
    ds_write_b128 v216, v[52:55] offset:29696
    v_mfma_f32_16x16x32_bf16 v[240:243], v[80:83], v[164:167], v[240:243]
    v_accvgpr_read_b32 v32, a226
    v_accvgpr_read_b32 v33, a230
    v_accvgpr_read_b32 v34, a234
    v_accvgpr_read_b32 v35, a238
    v_accvgpr_read_b32 v36, a242
    v_accvgpr_read_b32 v37, a246
    v_accvgpr_read_b32 v38, a250
    v_accvgpr_read_b32 v39, a254
    v_pk_mul_f32 v[32:33], v[32:33], v[196:197] op_sel_hi:[1,0]
    v_mfma_f32_16x16x32_bf16 v[244:247], v[84:87], v[164:167], v[244:247]
    v_pk_mul_f32 v[34:35], v[34:35], v[196:197] op_sel_hi:[1,0]
    v_pk_mul_f32 v[36:37], v[36:37], v[196:197] op_sel_hi:[1,0]
    v_pk_mul_f32 v[38:39], v[38:39], v[196:197] op_sel_hi:[1,0]
    v_cvt_pk_bf16_f32 v40, v32, v33
    v_cvt_pk_bf16_f32 v41, v34, v35
    v_cvt_pk_bf16_f32 v42, v36, v37
    v_cvt_pk_bf16_f32 v43, v38, v39
    ds_write_b128 v216, v[40:43] offset:30720
    v_mfma_f32_16x16x32_bf16 v[248:251], v[88:91], v[164:167], v[248:251]
    v_accvgpr_read_b32 v44, a227
    v_accvgpr_read_b32 v45, a231
    v_accvgpr_read_b32 v46, a235
    v_accvgpr_read_b32 v47, a239
    v_accvgpr_read_b32 v48, a243
    v_accvgpr_read_b32 v49, a247
    v_accvgpr_read_b32 v50, a251
    v_accvgpr_read_b32 v51, a255
    v_pk_mul_f32 v[44:45], v[44:45], v[196:197] op_sel_hi:[1,0]
    v_mfma_f32_16x16x32_bf16 v[252:255], v[92:95], v[164:167], v[252:255]
    ds_bpermute_b32 v202, v221, v204 offset:128
    v_pk_mul_f32 v[46:47], v[46:47], v[196:197] op_sel_hi:[1,0]
    v_pk_mul_f32 v[48:49], v[48:49], v[196:197] op_sel_hi:[1,0]
    v_pk_mul_f32 v[50:51], v[50:51], v[196:197] op_sel_hi:[1,0]
    v_cvt_pk_bf16_f32 v52, v44, v45
    v_cvt_pk_bf16_f32 v53, v46, v47
    v_cvt_pk_bf16_f32 v54, v48, v49
    v_cvt_pk_bf16_f32 v55, v50, v51
    ds_write_b128 v216, v[52:55] offset:31744
    s_waitcnt lgkmcnt(0)
    v_rcp_f32 v200, v202
    s_nop 0
    v_mul_f32 v32, v200, v224
    v_mul_f32 v33, v200, v228
    v_mul_f32 v34, v200, v232
    v_mul_f32 v35, v200, v236
    v_mul_f32 v36, v200, v240
    v_mul_f32 v37, v200, v244
    v_mul_f32 v38, v200, v248
    v_mul_f32 v39, v200, v252
    v_cvt_pk_bf16_f32 v40, v32, v33
    v_cvt_pk_bf16_f32 v41, v34, v35
    v_cvt_pk_bf16_f32 v42, v36, v37
    v_cvt_pk_bf16_f32 v43, v38, v39
    ds_write_b128 v216, v[40:43] offset:32768
    v_mul_f32 v44, v200, v225
    v_mul_f32 v45, v200, v229
    v_mul_f32 v46, v200, v233
    v_mul_f32 v47, v200, v237
    v_mul_f32 v48, v200, v241
    v_mul_f32 v49, v200, v245
    v_mul_f32 v50, v200, v249
    v_mul_f32 v51, v200, v253
    v_cvt_pk_bf16_f32 v52, v44, v45
    v_cvt_pk_bf16_f32 v53, v46, v47
    v_cvt_pk_bf16_f32 v54, v48, v49
    v_cvt_pk_bf16_f32 v55, v50, v51
    ds_write_b128 v216, v[52:55] offset:33792
    v_mul_f32 v32, v200, v226
    v_mul_f32 v33, v200, v230
    v_mul_f32 v34, v200, v234
    v_mul_f32 v35, v200, v238
    v_mul_f32 v36, v200, v242
    v_mul_f32 v37, v200, v246
    v_mul_f32 v38, v200, v250
    v_mul_f32 v39, v200, v254
    v_cvt_pk_bf16_f32 v40, v32, v33
    v_cvt_pk_bf16_f32 v41, v34, v35
    v_cvt_pk_bf16_f32 v42, v36, v37
    v_cvt_pk_bf16_f32 v43, v38, v39
    ds_write_b128 v216, v[40:43] offset:34816
    v_mul_f32 v44, v200, v227
    v_mul_f32 v45, v200, v231
    v_mul_f32 v46, v200, v235
    v_mul_f32 v47, v200, v239
    v_mul_f32 v48, v200, v243
    v_mul_f32 v49, v200, v247
    v_mul_f32 v50, v200, v251
    v_mul_f32 v51, v200, v255
    v_cvt_pk_bf16_f32 v52, v44, v45
    v_cvt_pk_bf16_f32 v53, v46, v47
    v_cvt_pk_bf16_f32 v54, v48, v49
    v_cvt_pk_bf16_f32 v55, v50, v51
    ds_write_b128 v216, v[52:55] offset:35840
    buffer_load_dwordx4 v[32:35], v220, s[24:27], s33 offen offset:0
    buffer_load_dwordx4 v[36:39], v220, s[24:27], s33 offen offset:1024
    buffer_load_dwordx4 v[40:43], v220, s[24:27], s33 offen offset:2048
    buffer_load_dwordx4 v[44:47], v220, s[24:27], s33 offen offset:3072
    buffer_load_dwordx4 v[48:51], v222, s[24:27], s33 offen offset:0
    buffer_load_dwordx4 v[52:55], v222, s[24:27], s33 offen offset:1024
    buffer_load_dwordx4 v[56:59], v222, s[24:27], s33 offen offset:2048
    buffer_load_dwordx4 v[60:63], v222, s[24:27], s33 offen offset:3072
    s_add_u32 s33, s33, 32768
    v_mov_b32 v211, v219
    s_waitcnt vmcnt(16)
    v_perm_b32 v64, v100, v96, s44
    v_perm_b32 v68, v100, v96, s45
    v_perm_b32 v65, v108, v104, s44
    v_perm_b32 v69, v108, v104, s45
    v_perm_b32 v66, v116, v112, s44
    v_perm_b32 v70, v116, v112, s45
    v_perm_b32 v67, v124, v120, s44
    v_perm_b32 v71, v124, v120, s45
    v_perm_b32 v72, v101, v97, s44
    v_perm_b32 v76, v101, v97, s45
    v_perm_b32 v73, v109, v105, s44
    v_perm_b32 v77, v109, v105, s45
    v_perm_b32 v74, v117, v113, s44
    v_perm_b32 v78, v117, v113, s45
    v_perm_b32 v75, v125, v121, s44
    v_perm_b32 v79, v125, v121, s45
    v_perm_b32 v80, v102, v98, s44
    v_perm_b32 v84, v102, v98, s45
    v_perm_b32 v81, v110, v106, s44
    v_perm_b32 v85, v110, v106, s45
    v_perm_b32 v82, v118, v114, s44
    v_perm_b32 v86, v118, v114, s45
    v_perm_b32 v83, v126, v122, s44
    v_perm_b32 v87, v126, v122, s45
    s_waitcnt lgkmcnt(0)
    s_barrier
    ds_read_b128 v[128:131], v211 offset:0
    ds_read_b128 v[132:135], v211 offset:4096
    ds_read_b128 v[136:139], v211 offset:8192
    ds_read_b128 v[140:143], v211 offset:12288
    ds_read_b128 v[144:147], v211 offset:16384
    ds_read_b128 v[148:151], v211 offset:20480
    ds_read_b128 v[152:155], v211 offset:24576
    ds_read_b128 v[156:159], v211 offset:28672
    ds_read_b128 v[160:163], v211 offset:32768
    s_waitcnt lgkmcnt(0)
    v_mfma_f32_16x16x32_bf16 a[0:3], v[64:67], v[128:131], 0
    v_perm_b32 v88, v103, v99, s44
    ds_read_b128 v[164:167], v211 offset:1024
    v_mfma_f32_16x16x32_bf16 a[32:35], v[64:67], v[132:135], 0
    v_perm_b32 v92, v103, v99, s45
    ds_read_b128 v[168:171], v211 offset:5120
    v_mfma_f32_16x16x32_bf16 a[64:67], v[64:67], v[136:139], 0
    v_perm_b32 v89, v111, v107, s44
    ds_read_b128 v[172:175], v211 offset:9216
    v_mfma_f32_16x16x32_bf16 a[96:99], v[64:67], v[140:143], 0
    v_perm_b32 v93, v111, v107, s45
    ds_read_b128 v[176:179], v211 offset:13312
    v_mfma_f32_16x16x32_bf16 a[128:131], v[64:67], v[144:147], 0
    v_perm_b32 v90, v119, v115, s44
    ds_read_b128 v[180:183], v211 offset:17408
    v_mfma_f32_16x16x32_bf16 a[160:163], v[64:67], v[148:151], 0
    v_perm_b32 v94, v119, v115, s45
    ds_read_b128 v[184:187], v211 offset:21504
    v_mfma_f32_16x16x32_bf16 a[192:195], v[64:67], v[152:155], 0
    v_perm_b32 v91, v127, v123, s44
    ds_read_b128 v[188:191], v211 offset:25600
    v_mfma_f32_16x16x32_bf16 a[224:227], v[64:67], v[156:159], 0
    v_perm_b32 v95, v127, v123, s45
    ds_read_b128 v[192:195], v211 offset:29696
    v_mfma_f32_16x16x32_bf16 v[224:227], v[64:67], v[160:163], 0
    ds_read_b128 v[196:199], v211 offset:33792
    buffer_load_dwordx4 v[96:99], v220, s[24:27], s33 offen offset:0
    v_mfma_f32_16x16x32_bf16 a[4:7], v[68:71], v[128:131], 0
    buffer_load_dwordx4 v[100:103], v220, s[24:27], s33 offen offset:1024
    v_mfma_f32_16x16x32_bf16 a[36:39], v[68:71], v[132:135], 0
    buffer_load_dwordx4 v[104:107], v220, s[24:27], s33 offen offset:2048
    v_mfma_f32_16x16x32_bf16 a[68:71], v[68:71], v[136:139], 0
    buffer_load_dwordx4 v[108:111], v220, s[24:27], s33 offen offset:3072
    v_mfma_f32_16x16x32_bf16 a[100:103], v[68:71], v[140:143], 0
    buffer_load_dwordx4 v[112:115], v222, s[24:27], s33 offen offset:0
    v_mfma_f32_16x16x32_bf16 a[132:135], v[68:71], v[144:147], 0
    buffer_load_dwordx4 v[116:119], v222, s[24:27], s33 offen offset:1024
    v_mfma_f32_16x16x32_bf16 a[164:167], v[68:71], v[148:151], 0
    buffer_load_dwordx4 v[120:123], v222, s[24:27], s33 offen offset:2048
    v_mfma_f32_16x16x32_bf16 a[196:199], v[68:71], v[152:155], 0
    buffer_load_dwordx4 v[124:127], v222, s[24:27], s33 offen offset:3072
    v_mfma_f32_16x16x32_bf16 a[228:231], v[68:71], v[156:159], 0
    s_add_u32 s33, s33, 32768
    v_mfma_f32_16x16x32_bf16 v[228:231], v[68:71], v[160:163], 0
    s_waitcnt vmcnt(16)
    v_mfma_f32_16x16x32_bf16 a[8:11], v[72:75], v[128:131], 0
    v_perm_b32 v64, v4, v0, s44
    v_mfma_f32_16x16x32_bf16 a[40:43], v[72:75], v[132:135], 0
    v_perm_b32 v68, v4, v0, s45
    v_mfma_f32_16x16x32_bf16 a[72:75], v[72:75], v[136:139], 0
    v_perm_b32 v65, v12, v8, s44
    v_mfma_f32_16x16x32_bf16 a[104:107], v[72:75], v[140:143], 0
    v_perm_b32 v69, v12, v8, s45
    v_mfma_f32_16x16x32_bf16 a[136:139], v[72:75], v[144:147], 0
    v_perm_b32 v66, v20, v16, s44
    v_mfma_f32_16x16x32_bf16 a[168:171], v[72:75], v[148:151], 0
    v_perm_b32 v70, v20, v16, s45
    v_mfma_f32_16x16x32_bf16 a[200:203], v[72:75], v[152:155], 0
    v_perm_b32 v67, v28, v24, s44
    v_mfma_f32_16x16x32_bf16 a[232:235], v[72:75], v[156:159], 0
    v_perm_b32 v71, v28, v24, s45
    v_mfma_f32_16x16x32_bf16 v[232:235], v[72:75], v[160:163], 0
    v_mfma_f32_16x16x32_bf16 a[12:15], v[76:79], v[128:131], 0
    v_mfma_f32_16x16x32_bf16 a[44:47], v[76:79], v[132:135], 0
    v_mfma_f32_16x16x32_bf16 a[76:79], v[76:79], v[136:139], 0
    v_mfma_f32_16x16x32_bf16 a[108:111], v[76:79], v[140:143], 0
    v_mfma_f32_16x16x32_bf16 a[140:143], v[76:79], v[144:147], 0
    v_mfma_f32_16x16x32_bf16 a[172:175], v[76:79], v[148:151], 0
    v_mfma_f32_16x16x32_bf16 a[204:207], v[76:79], v[152:155], 0
    v_mfma_f32_16x16x32_bf16 a[236:239], v[76:79], v[156:159], 0
    v_mfma_f32_16x16x32_bf16 v[236:239], v[76:79], v[160:163], 0
    v_mfma_f32_16x16x32_bf16 a[16:19], v[80:83], v[128:131], 0
    v_perm_b32 v72, v5, v1, s44
    v_mfma_f32_16x16x32_bf16 a[48:51], v[80:83], v[132:135], 0
    v_perm_b32 v76, v5, v1, s45
    v_mfma_f32_16x16x32_bf16 a[80:83], v[80:83], v[136:139], 0
    v_perm_b32 v73, v13, v9, s44
    v_mfma_f32_16x16x32_bf16 a[112:115], v[80:83], v[140:143], 0
    v_perm_b32 v77, v13, v9, s45
    v_mfma_f32_16x16x32_bf16 a[144:147], v[80:83], v[144:147], 0
    v_perm_b32 v74, v21, v17, s44
    v_mfma_f32_16x16x32_bf16 a[176:179], v[80:83], v[148:151], 0
    v_perm_b32 v78, v21, v17, s45
    v_mfma_f32_16x16x32_bf16 a[208:211], v[80:83], v[152:155], 0
    v_perm_b32 v75, v29, v25, s44
    v_mfma_f32_16x16x32_bf16 a[240:243], v[80:83], v[156:159], 0
    v_perm_b32 v79, v29, v25, s45
    v_mfma_f32_16x16x32_bf16 v[240:243], v[80:83], v[160:163], 0
    v_mfma_f32_16x16x32_bf16 a[20:23], v[84:87], v[128:131], 0
    v_mfma_f32_16x16x32_bf16 a[52:55], v[84:87], v[132:135], 0
    v_mfma_f32_16x16x32_bf16 a[84:87], v[84:87], v[136:139], 0
    v_mfma_f32_16x16x32_bf16 a[116:119], v[84:87], v[140:143], 0
    v_mfma_f32_16x16x32_bf16 a[148:151], v[84:87], v[144:147], 0
    v_mfma_f32_16x16x32_bf16 a[180:183], v[84:87], v[148:151], 0
    v_mfma_f32_16x16x32_bf16 a[212:215], v[84:87], v[152:155], 0
    v_mfma_f32_16x16x32_bf16 a[244:247], v[84:87], v[156:159], 0
    v_mfma_f32_16x16x32_bf16 v[244:247], v[84:87], v[160:163], 0
    v_mfma_f32_16x16x32_bf16 a[24:27], v[88:91], v[128:131], 0
    v_perm_b32 v80, v6, v2, s44
    v_mfma_f32_16x16x32_bf16 a[56:59], v[88:91], v[132:135], 0
    v_perm_b32 v84, v6, v2, s45
    v_mfma_f32_16x16x32_bf16 a[88:91], v[88:91], v[136:139], 0
    v_perm_b32 v81, v14, v10, s44
    v_mfma_f32_16x16x32_bf16 a[120:123], v[88:91], v[140:143], 0
    v_perm_b32 v85, v14, v10, s45
    v_mfma_f32_16x16x32_bf16 a[152:155], v[88:91], v[144:147], 0
    v_perm_b32 v82, v22, v18, s44
    v_mfma_f32_16x16x32_bf16 a[184:187], v[88:91], v[148:151], 0
    v_perm_b32 v86, v22, v18, s45
    v_mfma_f32_16x16x32_bf16 a[216:219], v[88:91], v[152:155], 0
    v_perm_b32 v83, v30, v26, s44
    v_mfma_f32_16x16x32_bf16 a[248:251], v[88:91], v[156:159], 0
    v_perm_b32 v87, v30, v26, s45
    v_mfma_f32_16x16x32_bf16 v[248:251], v[88:91], v[160:163], 0
    v_mfma_f32_16x16x32_bf16 a[28:31], v[92:95], v[128:131], 0
    v_mfma_f32_16x16x32_bf16 a[60:63], v[92:95], v[132:135], 0
    v_mfma_f32_16x16x32_bf16 a[92:95], v[92:95], v[136:139], 0
    v_mfma_f32_16x16x32_bf16 a[124:127], v[92:95], v[140:143], 0
    v_mfma_f32_16x16x32_bf16 a[156:159], v[92:95], v[144:147], 0
    v_mfma_f32_16x16x32_bf16 a[188:191], v[92:95], v[148:151], 0
    v_mfma_f32_16x16x32_bf16 a[220:223], v[92:95], v[152:155], 0
    v_mfma_f32_16x16x32_bf16 a[252:255], v[92:95], v[156:159], 0
    v_mfma_f32_16x16x32_bf16 v[252:255], v[92:95], v[160:163], 0
    s_waitcnt lgkmcnt(0)
    v_mfma_f32_16x16x32_bf16 a[0:3], v[64:67], v[164:167], a[0:3]
    v_perm_b32 v88, v7, v3, s44
    ds_read_b128 v[128:131], v211 offset:2048
    v_mfma_f32_16x16x32_bf16 a[32:35], v[64:67], v[168:171], a[32:35]
    v_perm_b32 v92, v7, v3, s45
    ds_read_b128 v[132:135], v211 offset:6144
    v_mfma_f32_16x16x32_bf16 a[64:67], v[64:67], v[172:175], a[64:67]
    v_perm_b32 v89, v15, v11, s44
    ds_read_b128 v[136:139], v211 offset:10240
    v_mfma_f32_16x16x32_bf16 a[96:99], v[64:67], v[176:179], a[96:99]
    v_perm_b32 v93, v15, v11, s45
    ds_read_b128 v[140:143], v211 offset:14336
    v_mfma_f32_16x16x32_bf16 a[128:131], v[64:67], v[180:183], a[128:131]
    v_perm_b32 v90, v23, v19, s44
    ds_read_b128 v[144:147], v211 offset:18432
    v_mfma_f32_16x16x32_bf16 a[160:163], v[64:67], v[184:187], a[160:163]
    v_perm_b32 v94, v23, v19, s45
    ds_read_b128 v[148:151], v211 offset:22528
    v_mfma_f32_16x16x32_bf16 a[192:195], v[64:67], v[188:191], a[192:195]
    v_perm_b32 v91, v31, v27, s44
    ds_read_b128 v[152:155], v211 offset:26624
    v_mfma_f32_16x16x32_bf16 a[224:227], v[64:67], v[192:195], a[224:227]
    v_perm_b32 v95, v31, v27, s45
    ds_read_b128 v[156:159], v211 offset:30720
    v_mfma_f32_16x16x32_bf16 v[224:227], v[64:67], v[196:199], v[224:227]
    ds_read_b128 v[160:163], v211 offset:34816
    buffer_load_dwordx4 v[0:3], v220, s[24:27], s33 offen offset:0
    v_mfma_f32_16x16x32_bf16 a[4:7], v[68:71], v[164:167], a[4:7]
    buffer_load_dwordx4 v[4:7], v220, s[24:27], s33 offen offset:1024
    v_mfma_f32_16x16x32_bf16 a[36:39], v[68:71], v[168:171], a[36:39]
    buffer_load_dwordx4 v[8:11], v220, s[24:27], s33 offen offset:2048
    v_mfma_f32_16x16x32_bf16 a[68:71], v[68:71], v[172:175], a[68:71]
    buffer_load_dwordx4 v[12:15], v220, s[24:27], s33 offen offset:3072
    v_mfma_f32_16x16x32_bf16 a[100:103], v[68:71], v[176:179], a[100:103]
    buffer_load_dwordx4 v[16:19], v222, s[24:27], s33 offen offset:0
    v_mfma_f32_16x16x32_bf16 a[132:135], v[68:71], v[180:183], a[132:135]
    buffer_load_dwordx4 v[20:23], v222, s[24:27], s33 offen offset:1024
    v_mfma_f32_16x16x32_bf16 a[164:167], v[68:71], v[184:187], a[164:167]
    buffer_load_dwordx4 v[24:27], v222, s[24:27], s33 offen offset:2048
    v_mfma_f32_16x16x32_bf16 a[196:199], v[68:71], v[188:191], a[196:199]
    buffer_load_dwordx4 v[28:31], v222, s[24:27], s33 offen offset:3072
    v_mfma_f32_16x16x32_bf16 a[228:231], v[68:71], v[192:195], a[228:231]
    s_add_u32 s33, s33, 32768
    v_mfma_f32_16x16x32_bf16 v[228:231], v[68:71], v[196:199], v[228:231]
    s_waitcnt vmcnt(16)
    v_mfma_f32_16x16x32_bf16 a[8:11], v[72:75], v[164:167], a[8:11]
    v_perm_b32 v64, v36, v32, s44
    v_mfma_f32_16x16x32_bf16 a[40:43], v[72:75], v[168:171], a[40:43]
    v_perm_b32 v68, v36, v32, s45
    v_mfma_f32_16x16x32_bf16 a[72:75], v[72:75], v[172:175], a[72:75]
    v_perm_b32 v65, v44, v40, s44
    v_mfma_f32_16x16x32_bf16 a[104:107], v[72:75], v[176:179], a[104:107]
    v_perm_b32 v69, v44, v40, s45
    v_mfma_f32_16x16x32_bf16 a[136:139], v[72:75], v[180:183], a[136:139]
    v_perm_b32 v66, v52, v48, s44
    v_mfma_f32_16x16x32_bf16 a[168:171], v[72:75], v[184:187], a[168:171]
    v_perm_b32 v70, v52, v48, s45
    v_mfma_f32_16x16x32_bf16 a[200:203], v[72:75], v[188:191], a[200:203]
    v_perm_b32 v67, v60, v56, s44
    v_mfma_f32_16x16x32_bf16 a[232:235], v[72:75], v[192:195], a[232:235]
    v_perm_b32 v71, v60, v56, s45
    v_mfma_f32_16x16x32_bf16 v[232:235], v[72:75], v[196:199], v[232:235]
    v_mfma_f32_16x16x32_bf16 a[12:15], v[76:79], v[164:167], a[12:15]
    v_mfma_f32_16x16x32_bf16 a[44:47], v[76:79], v[168:171], a[44:47]
    v_mfma_f32_16x16x32_bf16 a[76:79], v[76:79], v[172:175], a[76:79]
    v_mfma_f32_16x16x32_bf16 a[108:111], v[76:79], v[176:179], a[108:111]
    v_mfma_f32_16x16x32_bf16 a[140:143], v[76:79], v[180:183], a[140:143]
    v_mfma_f32_16x16x32_bf16 a[172:175], v[76:79], v[184:187], a[172:175]
    v_mfma_f32_16x16x32_bf16 a[204:207], v[76:79], v[188:191], a[204:207]
    v_mfma_f32_16x16x32_bf16 a[236:239], v[76:79], v[192:195], a[236:239]
    v_mfma_f32_16x16x32_bf16 v[236:239], v[76:79], v[196:199], v[236:239]
    v_mfma_f32_16x16x32_bf16 a[16:19], v[80:83], v[164:167], a[16:19]
    v_perm_b32 v72, v37, v33, s44
    v_mfma_f32_16x16x32_bf16 a[48:51], v[80:83], v[168:171], a[48:51]
    v_perm_b32 v76, v37, v33, s45
    v_mfma_f32_16x16x32_bf16 a[80:83], v[80:83], v[172:175], a[80:83]
    v_perm_b32 v73, v45, v41, s44
    v_mfma_f32_16x16x32_bf16 a[112:115], v[80:83], v[176:179], a[112:115]
    v_perm_b32 v77, v45, v41, s45
    v_mfma_f32_16x16x32_bf16 a[144:147], v[80:83], v[180:183], a[144:147]
    v_perm_b32 v74, v53, v49, s44
    v_mfma_f32_16x16x32_bf16 a[176:179], v[80:83], v[184:187], a[176:179]
    v_perm_b32 v78, v53, v49, s45
    v_mfma_f32_16x16x32_bf16 a[208:211], v[80:83], v[188:191], a[208:211]
    v_perm_b32 v75, v61, v57, s44
    v_mfma_f32_16x16x32_bf16 a[240:243], v[80:83], v[192:195], a[240:243]
    v_perm_b32 v79, v61, v57, s45
    v_mfma_f32_16x16x32_bf16 v[240:243], v[80:83], v[196:199], v[240:243]
    v_mfma_f32_16x16x32_bf16 a[20:23], v[84:87], v[164:167], a[20:23]
    v_mfma_f32_16x16x32_bf16 a[52:55], v[84:87], v[168:171], a[52:55]
    v_mfma_f32_16x16x32_bf16 a[84:87], v[84:87], v[172:175], a[84:87]
    v_mfma_f32_16x16x32_bf16 a[116:119], v[84:87], v[176:179], a[116:119]
    v_mfma_f32_16x16x32_bf16 a[148:151], v[84:87], v[180:183], a[148:151]
    v_mfma_f32_16x16x32_bf16 a[180:183], v[84:87], v[184:187], a[180:183]
    v_mfma_f32_16x16x32_bf16 a[212:215], v[84:87], v[188:191], a[212:215]
    v_mfma_f32_16x16x32_bf16 a[244:247], v[84:87], v[192:195], a[244:247]
    v_mfma_f32_16x16x32_bf16 v[244:247], v[84:87], v[196:199], v[244:247]
    v_mfma_f32_16x16x32_bf16 a[24:27], v[88:91], v[164:167], a[24:27]
    v_perm_b32 v80, v38, v34, s44
    v_mfma_f32_16x16x32_bf16 a[56:59], v[88:91], v[168:171], a[56:59]
    v_perm_b32 v84, v38, v34, s45
    v_mfma_f32_16x16x32_bf16 a[88:91], v[88:91], v[172:175], a[88:91]
    v_perm_b32 v81, v46, v42, s44
    v_mfma_f32_16x16x32_bf16 a[120:123], v[88:91], v[176:179], a[120:123]
    v_perm_b32 v85, v46, v42, s45
    v_mfma_f32_16x16x32_bf16 a[152:155], v[88:91], v[180:183], a[152:155]
    v_perm_b32 v82, v54, v50, s44
    v_mfma_f32_16x16x32_bf16 a[184:187], v[88:91], v[184:187], a[184:187]
    v_perm_b32 v86, v54, v50, s45
    v_mfma_f32_16x16x32_bf16 a[216:219], v[88:91], v[188:191], a[216:219]
    v_perm_b32 v83, v62, v58, s44
    v_mfma_f32_16x16x32_bf16 a[248:251], v[88:91], v[192:195], a[248:251]
    v_perm_b32 v87, v62, v58, s45
    v_mfma_f32_16x16x32_bf16 v[248:251], v[88:91], v[196:199], v[248:251]
    v_mfma_f32_16x16x32_bf16 a[28:31], v[92:95], v[164:167], a[28:31]
    v_mfma_f32_16x16x32_bf16 a[60:63], v[92:95], v[168:171], a[60:63]
    v_mfma_f32_16x16x32_bf16 a[92:95], v[92:95], v[172:175], a[92:95]
    v_mfma_f32_16x16x32_bf16 a[124:127], v[92:95], v[176:179], a[124:127]
    v_mfma_f32_16x16x32_bf16 a[156:159], v[92:95], v[180:183], a[156:159]
    v_mfma_f32_16x16x32_bf16 a[188:191], v[92:95], v[184:187], a[188:191]
    v_mfma_f32_16x16x32_bf16 a[220:223], v[92:95], v[188:191], a[220:223]
    v_mfma_f32_16x16x32_bf16 a[252:255], v[92:95], v[192:195], a[252:255]
    v_mfma_f32_16x16x32_bf16 v[252:255], v[92:95], v[196:199], v[252:255]
    s_waitcnt lgkmcnt(0)
    v_mfma_f32_16x16x32_bf16 a[0:3], v[64:67], v[128:131], a[0:3]
    v_perm_b32 v88, v39, v35, s44
    ds_read_b128 v[164:167], v211 offset:3072
    v_mfma_f32_16x16x32_bf16 a[32:35], v[64:67], v[132:135], a[32:35]
    v_perm_b32 v92, v39, v35, s45
    ds_read_b128 v[168:171], v211 offset:7168
    v_mfma_f32_16x16x32_bf16 a[64:67], v[64:67], v[136:139], a[64:67]
    v_perm_b32 v89, v47, v43, s44
    ds_read_b128 v[172:175], v211 offset:11264
    v_mfma_f32_16x16x32_bf16 a[96:99], v[64:67], v[140:143], a[96:99]
    v_perm_b32 v93, v47, v43, s45
    ds_read_b128 v[176:179], v211 offset:15360
    v_mfma_f32_16x16x32_bf16 a[128:131], v[64:67], v[144:147], a[128:131]
    v_perm_b32 v90, v55, v51, s44
    ds_read_b128 v[180:183], v211 offset:19456
    v_mfma_f32_16x16x32_bf16 a[160:163], v[64:67], v[148:151], a[160:163]
    v_perm_b32 v94, v55, v51, s45
    ds_read_b128 v[184:187], v211 offset:23552
    v_mfma_f32_16x16x32_bf16 a[192:195], v[64:67], v[152:155], a[192:195]
    v_perm_b32 v91, v63, v59, s44
    ds_read_b128 v[188:191], v211 offset:27648
    v_mfma_f32_16x16x32_bf16 a[224:227], v[64:67], v[156:159], a[224:227]
    v_perm_b32 v95, v63, v59, s45
    ds_read_b128 v[192:195], v211 offset:31744
    v_mfma_f32_16x16x32_bf16 v[224:227], v[64:67], v[160:163], v[224:227]
    ds_read_b128 v[196:199], v211 offset:35840
    buffer_load_dwordx4 v[32:35], v220, s[24:27], s33 offen offset:0
    v_mfma_f32_16x16x32_bf16 a[4:7], v[68:71], v[128:131], a[4:7]
    v_add_u32 v211, 36864, v211
    buffer_load_dwordx4 v[36:39], v220, s[24:27], s33 offen offset:1024
    v_mfma_f32_16x16x32_bf16 a[36:39], v[68:71], v[132:135], a[36:39]
    buffer_load_dwordx4 v[40:43], v220, s[24:27], s33 offen offset:2048
    v_mfma_f32_16x16x32_bf16 a[68:71], v[68:71], v[136:139], a[68:71]
    buffer_load_dwordx4 v[44:47], v220, s[24:27], s33 offen offset:3072
    v_mfma_f32_16x16x32_bf16 a[100:103], v[68:71], v[140:143], a[100:103]
    buffer_load_dwordx4 v[48:51], v222, s[24:27], s33 offen offset:0
    v_mfma_f32_16x16x32_bf16 a[132:135], v[68:71], v[144:147], a[132:135]
    buffer_load_dwordx4 v[52:55], v222, s[24:27], s33 offen offset:1024
    v_mfma_f32_16x16x32_bf16 a[164:167], v[68:71], v[148:151], a[164:167]
    buffer_load_dwordx4 v[56:59], v222, s[24:27], s33 offen offset:2048
    v_mfma_f32_16x16x32_bf16 a[196:199], v[68:71], v[152:155], a[196:199]
    buffer_load_dwordx4 v[60:63], v222, s[24:27], s33 offen offset:3072
    v_mfma_f32_16x16x32_bf16 a[228:231], v[68:71], v[156:159], a[228:231]
    s_add_u32 s33, s33, 32768
    v_mfma_f32_16x16x32_bf16 v[228:231], v[68:71], v[160:163], v[228:231]
    s_waitcnt vmcnt(16)
    v_mfma_f32_16x16x32_bf16 a[8:11], v[72:75], v[128:131], a[8:11]
    v_perm_b32 v64, v100, v96, s44
    v_mfma_f32_16x16x32_bf16 a[40:43], v[72:75], v[132:135], a[40:43]
    v_perm_b32 v68, v100, v96, s45
    v_mfma_f32_16x16x32_bf16 a[72:75], v[72:75], v[136:139], a[72:75]
    v_perm_b32 v65, v108, v104, s44
    v_mfma_f32_16x16x32_bf16 a[104:107], v[72:75], v[140:143], a[104:107]
    v_perm_b32 v69, v108, v104, s45
    v_mfma_f32_16x16x32_bf16 a[136:139], v[72:75], v[144:147], a[136:139]
    v_perm_b32 v66, v116, v112, s44
    v_mfma_f32_16x16x32_bf16 a[168:171], v[72:75], v[148:151], a[168:171]
    v_perm_b32 v70, v116, v112, s45
    v_mfma_f32_16x16x32_bf16 a[200:203], v[72:75], v[152:155], a[200:203]
    v_perm_b32 v67, v124, v120, s44
    v_mfma_f32_16x16x32_bf16 a[232:235], v[72:75], v[156:159], a[232:235]
    v_perm_b32 v71, v124, v120, s45
    v_mfma_f32_16x16x32_bf16 v[232:235], v[72:75], v[160:163], v[232:235]
    v_mfma_f32_16x16x32_bf16 a[12:15], v[76:79], v[128:131], a[12:15]
    v_mfma_f32_16x16x32_bf16 a[44:47], v[76:79], v[132:135], a[44:47]
    v_mfma_f32_16x16x32_bf16 a[76:79], v[76:79], v[136:139], a[76:79]
    v_mfma_f32_16x16x32_bf16 a[108:111], v[76:79], v[140:143], a[108:111]
    v_mfma_f32_16x16x32_bf16 a[140:143], v[76:79], v[144:147], a[140:143]
    v_mfma_f32_16x16x32_bf16 a[172:175], v[76:79], v[148:151], a[172:175]
    v_mfma_f32_16x16x32_bf16 a[204:207], v[76:79], v[152:155], a[204:207]
    v_mfma_f32_16x16x32_bf16 a[236:239], v[76:79], v[156:159], a[236:239]
    v_mfma_f32_16x16x32_bf16 v[236:239], v[76:79], v[160:163], v[236:239]
    v_mfma_f32_16x16x32_bf16 a[16:19], v[80:83], v[128:131], a[16:19]
    v_perm_b32 v72, v101, v97, s44
    v_mfma_f32_16x16x32_bf16 a[48:51], v[80:83], v[132:135], a[48:51]
    v_perm_b32 v76, v101, v97, s45
    v_mfma_f32_16x16x32_bf16 a[80:83], v[80:83], v[136:139], a[80:83]
    v_perm_b32 v73, v109, v105, s44
    v_mfma_f32_16x16x32_bf16 a[112:115], v[80:83], v[140:143], a[112:115]
    v_perm_b32 v77, v109, v105, s45
    v_mfma_f32_16x16x32_bf16 a[144:147], v[80:83], v[144:147], a[144:147]
    v_perm_b32 v74, v117, v113, s44
    v_mfma_f32_16x16x32_bf16 a[176:179], v[80:83], v[148:151], a[176:179]
    v_perm_b32 v78, v117, v113, s45
    v_mfma_f32_16x16x32_bf16 a[208:211], v[80:83], v[152:155], a[208:211]
    v_perm_b32 v75, v125, v121, s44
    v_mfma_f32_16x16x32_bf16 a[240:243], v[80:83], v[156:159], a[240:243]
    v_perm_b32 v79, v125, v121, s45
    v_mfma_f32_16x16x32_bf16 v[240:243], v[80:83], v[160:163], v[240:243]
    v_mfma_f32_16x16x32_bf16 a[20:23], v[84:87], v[128:131], a[20:23]
    v_mfma_f32_16x16x32_bf16 a[52:55], v[84:87], v[132:135], a[52:55]
    v_mfma_f32_16x16x32_bf16 a[84:87], v[84:87], v[136:139], a[84:87]
    v_mfma_f32_16x16x32_bf16 a[116:119], v[84:87], v[140:143], a[116:119]
    v_mfma_f32_16x16x32_bf16 a[148:151], v[84:87], v[144:147], a[148:151]
    v_mfma_f32_16x16x32_bf16 a[180:183], v[84:87], v[148:151], a[180:183]
    v_mfma_f32_16x16x32_bf16 a[212:215], v[84:87], v[152:155], a[212:215]
    v_mfma_f32_16x16x32_bf16 a[244:247], v[84:87], v[156:159], a[244:247]
    v_mfma_f32_16x16x32_bf16 v[244:247], v[84:87], v[160:163], v[244:247]
    v_mfma_f32_16x16x32_bf16 a[24:27], v[88:91], v[128:131], a[24:27]
    v_perm_b32 v80, v102, v98, s44
    v_mfma_f32_16x16x32_bf16 a[56:59], v[88:91], v[132:135], a[56:59]
    v_perm_b32 v84, v102, v98, s45
    v_mfma_f32_16x16x32_bf16 a[88:91], v[88:91], v[136:139], a[88:91]
    v_perm_b32 v81, v110, v106, s44
    v_mfma_f32_16x16x32_bf16 a[120:123], v[88:91], v[140:143], a[120:123]
    v_perm_b32 v85, v110, v106, s45
    v_mfma_f32_16x16x32_bf16 a[152:155], v[88:91], v[144:147], a[152:155]
    v_perm_b32 v82, v118, v114, s44
    v_mfma_f32_16x16x32_bf16 a[184:187], v[88:91], v[148:151], a[184:187]
    v_perm_b32 v86, v118, v114, s45
    v_mfma_f32_16x16x32_bf16 a[216:219], v[88:91], v[152:155], a[216:219]
    v_perm_b32 v83, v126, v122, s44
    v_mfma_f32_16x16x32_bf16 a[248:251], v[88:91], v[156:159], a[248:251]
    v_perm_b32 v87, v126, v122, s45
    v_mfma_f32_16x16x32_bf16 v[248:251], v[88:91], v[160:163], v[248:251]
    v_mfma_f32_16x16x32_bf16 a[28:31], v[92:95], v[128:131], a[28:31]
    v_mfma_f32_16x16x32_bf16 a[60:63], v[92:95], v[132:135], a[60:63]
    v_mfma_f32_16x16x32_bf16 a[92:95], v[92:95], v[136:139], a[92:95]
    v_mfma_f32_16x16x32_bf16 a[124:127], v[92:95], v[140:143], a[124:127]
    v_mfma_f32_16x16x32_bf16 a[156:159], v[92:95], v[144:147], a[156:159]
    v_mfma_f32_16x16x32_bf16 a[188:191], v[92:95], v[148:151], a[188:191]
    v_mfma_f32_16x16x32_bf16 a[220:223], v[92:95], v[152:155], a[220:223]
    v_mfma_f32_16x16x32_bf16 a[252:255], v[92:95], v[156:159], a[252:255]
    v_mfma_f32_16x16x32_bf16 v[252:255], v[92:95], v[160:163], v[252:255]
    s_waitcnt lgkmcnt(0)
    v_mfma_f32_16x16x32_bf16 a[0:3], v[64:67], v[164:167], a[0:3]
    v_perm_b32 v88, v103, v99, s44
    ds_read_b128 v[128:131], v211 offset:0
    v_mfma_f32_16x16x32_bf16 a[32:35], v[64:67], v[168:171], a[32:35]
    v_perm_b32 v92, v103, v99, s45
    ds_read_b128 v[132:135], v211 offset:4096
    v_mfma_f32_16x16x32_bf16 a[64:67], v[64:67], v[172:175], a[64:67]
    v_perm_b32 v89, v111, v107, s44
    ds_read_b128 v[136:139], v211 offset:8192
    v_mfma_f32_16x16x32_bf16 a[96:99], v[64:67], v[176:179], a[96:99]
    v_perm_b32 v93, v111, v107, s45
    ds_read_b128 v[140:143], v211 offset:12288
    v_mfma_f32_16x16x32_bf16 a[128:131], v[64:67], v[180:183], a[128:131]
    v_perm_b32 v90, v119, v115, s44
    ds_read_b128 v[144:147], v211 offset:16384
    v_mfma_f32_16x16x32_bf16 a[160:163], v[64:67], v[184:187], a[160:163]
    v_perm_b32 v94, v119, v115, s45
    ds_read_b128 v[148:151], v211 offset:20480
    v_mfma_f32_16x16x32_bf16 a[192:195], v[64:67], v[188:191], a[192:195]
    v_perm_b32 v91, v127, v123, s44
    ds_read_b128 v[152:155], v211 offset:24576
    v_mfma_f32_16x16x32_bf16 a[224:227], v[64:67], v[192:195], a[224:227]
    v_perm_b32 v95, v127, v123, s45
    ds_read_b128 v[156:159], v211 offset:28672
    v_mfma_f32_16x16x32_bf16 v[224:227], v[64:67], v[196:199], v[224:227]
    ds_read_b128 v[160:163], v211 offset:32768
    buffer_load_dwordx4 v[96:99], v220, s[24:27], s33 offen offset:0
    v_mfma_f32_16x16x32_bf16 a[4:7], v[68:71], v[164:167], a[4:7]
    buffer_load_dwordx4 v[100:103], v220, s[24:27], s33 offen offset:1024
    v_mfma_f32_16x16x32_bf16 a[36:39], v[68:71], v[168:171], a[36:39]
    buffer_load_dwordx4 v[104:107], v220, s[24:27], s33 offen offset:2048
    v_mfma_f32_16x16x32_bf16 a[68:71], v[68:71], v[172:175], a[68:71]
    buffer_load_dwordx4 v[108:111], v220, s[24:27], s33 offen offset:3072
    v_mfma_f32_16x16x32_bf16 a[100:103], v[68:71], v[176:179], a[100:103]
    buffer_load_dwordx4 v[112:115], v222, s[24:27], s33 offen offset:0
    v_mfma_f32_16x16x32_bf16 a[132:135], v[68:71], v[180:183], a[132:135]
    buffer_load_dwordx4 v[116:119], v222, s[24:27], s33 offen offset:1024
    v_mfma_f32_16x16x32_bf16 a[164:167], v[68:71], v[184:187], a[164:167]
    buffer_load_dwordx4 v[120:123], v222, s[24:27], s33 offen offset:2048
    v_mfma_f32_16x16x32_bf16 a[196:199], v[68:71], v[188:191], a[196:199]
    buffer_load_dwordx4 v[124:127], v222, s[24:27], s33 offen offset:3072
    v_mfma_f32_16x16x32_bf16 a[228:231], v[68:71], v[192:195], a[228:231]
    s_add_u32 s33, s33, 32768
    v_mfma_f32_16x16x32_bf16 v[228:231], v[68:71], v[196:199], v[228:231]
    s_waitcnt vmcnt(16)
    v_mfma_f32_16x16x32_bf16 a[8:11], v[72:75], v[164:167], a[8:11]
    v_perm_b32 v64, v4, v0, s44
    v_mfma_f32_16x16x32_bf16 a[40:43], v[72:75], v[168:171], a[40:43]
    v_perm_b32 v68, v4, v0, s45
    v_mfma_f32_16x16x32_bf16 a[72:75], v[72:75], v[172:175], a[72:75]
    v_perm_b32 v65, v12, v8, s44
    v_mfma_f32_16x16x32_bf16 a[104:107], v[72:75], v[176:179], a[104:107]
    v_perm_b32 v69, v12, v8, s45
    v_mfma_f32_16x16x32_bf16 a[136:139], v[72:75], v[180:183], a[136:139]
    v_perm_b32 v66, v20, v16, s44
    v_mfma_f32_16x16x32_bf16 a[168:171], v[72:75], v[184:187], a[168:171]
    v_perm_b32 v70, v20, v16, s45
    v_mfma_f32_16x16x32_bf16 a[200:203], v[72:75], v[188:191], a[200:203]
    v_perm_b32 v67, v28, v24, s44
    v_mfma_f32_16x16x32_bf16 a[232:235], v[72:75], v[192:195], a[232:235]
    v_perm_b32 v71, v28, v24, s45
    v_mfma_f32_16x16x32_bf16 v[232:235], v[72:75], v[196:199], v[232:235]
    v_mfma_f32_16x16x32_bf16 a[12:15], v[76:79], v[164:167], a[12:15]
    v_mfma_f32_16x16x32_bf16 a[44:47], v[76:79], v[168:171], a[44:47]
    v_mfma_f32_16x16x32_bf16 a[76:79], v[76:79], v[172:175], a[76:79]
    v_mfma_f32_16x16x32_bf16 a[108:111], v[76:79], v[176:179], a[108:111]
    v_mfma_f32_16x16x32_bf16 a[140:143], v[76:79], v[180:183], a[140:143]
    v_mfma_f32_16x16x32_bf16 a[172:175], v[76:79], v[184:187], a[172:175]
    v_mfma_f32_16x16x32_bf16 a[204:207], v[76:79], v[188:191], a[204:207]
    v_mfma_f32_16x16x32_bf16 a[236:239], v[76:79], v[192:195], a[236:239]
    v_mfma_f32_16x16x32_bf16 v[236:239], v[76:79], v[196:199], v[236:239]
    v_mfma_f32_16x16x32_bf16 a[16:19], v[80:83], v[164:167], a[16:19]
    v_perm_b32 v72, v5, v1, s44
    v_mfma_f32_16x16x32_bf16 a[48:51], v[80:83], v[168:171], a[48:51]
    v_perm_b32 v76, v5, v1, s45
    v_mfma_f32_16x16x32_bf16 a[80:83], v[80:83], v[172:175], a[80:83]
    v_perm_b32 v73, v13, v9, s44
    v_mfma_f32_16x16x32_bf16 a[112:115], v[80:83], v[176:179], a[112:115]
    v_perm_b32 v77, v13, v9, s45
    v_mfma_f32_16x16x32_bf16 a[144:147], v[80:83], v[180:183], a[144:147]
    v_perm_b32 v74, v21, v17, s44
    v_mfma_f32_16x16x32_bf16 a[176:179], v[80:83], v[184:187], a[176:179]
    v_perm_b32 v78, v21, v17, s45
    v_mfma_f32_16x16x32_bf16 a[208:211], v[80:83], v[188:191], a[208:211]
    v_perm_b32 v75, v29, v25, s44
    v_mfma_f32_16x16x32_bf16 a[240:243], v[80:83], v[192:195], a[240:243]
    v_perm_b32 v79, v29, v25, s45
    v_mfma_f32_16x16x32_bf16 v[240:243], v[80:83], v[196:199], v[240:243]
    v_mfma_f32_16x16x32_bf16 a[20:23], v[84:87], v[164:167], a[20:23]
    v_mfma_f32_16x16x32_bf16 a[52:55], v[84:87], v[168:171], a[52:55]
    v_mfma_f32_16x16x32_bf16 a[84:87], v[84:87], v[172:175], a[84:87]
    v_mfma_f32_16x16x32_bf16 a[116:119], v[84:87], v[176:179], a[116:119]
    v_mfma_f32_16x16x32_bf16 a[148:151], v[84:87], v[180:183], a[148:151]
    v_mfma_f32_16x16x32_bf16 a[180:183], v[84:87], v[184:187], a[180:183]
    v_mfma_f32_16x16x32_bf16 a[212:215], v[84:87], v[188:191], a[212:215]
    v_mfma_f32_16x16x32_bf16 a[244:247], v[84:87], v[192:195], a[244:247]
    v_mfma_f32_16x16x32_bf16 v[244:247], v[84:87], v[196:199], v[244:247]
    v_mfma_f32_16x16x32_bf16 a[24:27], v[88:91], v[164:167], a[24:27]
    v_perm_b32 v80, v6, v2, s44
    v_mfma_f32_16x16x32_bf16 a[56:59], v[88:91], v[168:171], a[56:59]
    v_perm_b32 v84, v6, v2, s45
    v_mfma_f32_16x16x32_bf16 a[88:91], v[88:91], v[172:175], a[88:91]
    v_perm_b32 v81, v14, v10, s44
    v_mfma_f32_16x16x32_bf16 a[120:123], v[88:91], v[176:179], a[120:123]
    v_perm_b32 v85, v14, v10, s45
    v_mfma_f32_16x16x32_bf16 a[152:155], v[88:91], v[180:183], a[152:155]
    v_perm_b32 v82, v22, v18, s44
    v_mfma_f32_16x16x32_bf16 a[184:187], v[88:91], v[184:187], a[184:187]
    v_perm_b32 v86, v22, v18, s45
    v_mfma_f32_16x16x32_bf16 a[216:219], v[88:91], v[188:191], a[216:219]
    v_perm_b32 v83, v30, v26, s44
    v_mfma_f32_16x16x32_bf16 a[248:251], v[88:91], v[192:195], a[248:251]
    v_perm_b32 v87, v30, v26, s45
    v_mfma_f32_16x16x32_bf16 v[248:251], v[88:91], v[196:199], v[248:251]
    v_mfma_f32_16x16x32_bf16 a[28:31], v[92:95], v[164:167], a[28:31]
    v_mfma_f32_16x16x32_bf16 a[60:63], v[92:95], v[168:171], a[60:63]
    v_mfma_f32_16x16x32_bf16 a[92:95], v[92:95], v[172:175], a[92:95]
    v_mfma_f32_16x16x32_bf16 a[124:127], v[92:95], v[176:179], a[124:127]
    v_mfma_f32_16x16x32_bf16 a[156:159], v[92:95], v[180:183], a[156:159]
    v_mfma_f32_16x16x32_bf16 a[188:191], v[92:95], v[184:187], a[188:191]
    v_mfma_f32_16x16x32_bf16 a[220:223], v[92:95], v[188:191], a[220:223]
    v_mfma_f32_16x16x32_bf16 a[252:255], v[92:95], v[192:195], a[252:255]
    v_mfma_f32_16x16x32_bf16 v[252:255], v[92:95], v[196:199], v[252:255]
    s_waitcnt lgkmcnt(0)
    v_mfma_f32_16x16x32_bf16 a[0:3], v[64:67], v[128:131], a[0:3]
    v_perm_b32 v88, v7, v3, s44
    ds_read_b128 v[164:167], v211 offset:1024
    v_mfma_f32_16x16x32_bf16 a[32:35], v[64:67], v[132:135], a[32:35]
    v_perm_b32 v92, v7, v3, s45
    ds_read_b128 v[168:171], v211 offset:5120
    v_mfma_f32_16x16x32_bf16 a[64:67], v[64:67], v[136:139], a[64:67]
    v_perm_b32 v89, v15, v11, s44
    ds_read_b128 v[172:175], v211 offset:9216
    v_mfma_f32_16x16x32_bf16 a[96:99], v[64:67], v[140:143], a[96:99]
    v_perm_b32 v93, v15, v11, s45
    ds_read_b128 v[176:179], v211 offset:13312
    v_mfma_f32_16x16x32_bf16 a[128:131], v[64:67], v[144:147], a[128:131]
    v_perm_b32 v90, v23, v19, s44
    ds_read_b128 v[180:183], v211 offset:17408
    v_mfma_f32_16x16x32_bf16 a[160:163], v[64:67], v[148:151], a[160:163]
    v_perm_b32 v94, v23, v19, s45
    ds_read_b128 v[184:187], v211 offset:21504
    v_mfma_f32_16x16x32_bf16 a[192:195], v[64:67], v[152:155], a[192:195]
    v_perm_b32 v91, v31, v27, s44
    ds_read_b128 v[188:191], v211 offset:25600
    v_mfma_f32_16x16x32_bf16 a[224:227], v[64:67], v[156:159], a[224:227]
    v_perm_b32 v95, v31, v27, s45
    ds_read_b128 v[192:195], v211 offset:29696
    v_mfma_f32_16x16x32_bf16 v[224:227], v[64:67], v[160:163], v[224:227]
    ds_read_b128 v[196:199], v211 offset:33792
    buffer_load_dwordx4 v[0:3], v220, s[24:27], s33 offen offset:0
    v_mfma_f32_16x16x32_bf16 a[4:7], v[68:71], v[128:131], a[4:7]
    buffer_load_dwordx4 v[4:7], v220, s[24:27], s33 offen offset:1024
    v_mfma_f32_16x16x32_bf16 a[36:39], v[68:71], v[132:135], a[36:39]
    buffer_load_dwordx4 v[8:11], v220, s[24:27], s33 offen offset:2048
    v_mfma_f32_16x16x32_bf16 a[68:71], v[68:71], v[136:139], a[68:71]
    buffer_load_dwordx4 v[12:15], v220, s[24:27], s33 offen offset:3072
    v_mfma_f32_16x16x32_bf16 a[100:103], v[68:71], v[140:143], a[100:103]
    buffer_load_dwordx4 v[16:19], v222, s[24:27], s33 offen offset:0
    v_mfma_f32_16x16x32_bf16 a[132:135], v[68:71], v[144:147], a[132:135]
    buffer_load_dwordx4 v[20:23], v222, s[24:27], s33 offen offset:1024
    v_mfma_f32_16x16x32_bf16 a[164:167], v[68:71], v[148:151], a[164:167]
    buffer_load_dwordx4 v[24:27], v222, s[24:27], s33 offen offset:2048
    v_mfma_f32_16x16x32_bf16 a[196:199], v[68:71], v[152:155], a[196:199]
    buffer_load_dwordx4 v[28:31], v222, s[24:27], s33 offen offset:3072
    v_mfma_f32_16x16x32_bf16 a[228:231], v[68:71], v[156:159], a[228:231]
    s_add_u32 s33, s33, 32768
    v_mfma_f32_16x16x32_bf16 v[228:231], v[68:71], v[160:163], v[228:231]
    s_waitcnt vmcnt(16)
    v_mfma_f32_16x16x32_bf16 a[8:11], v[72:75], v[128:131], a[8:11]
    v_perm_b32 v64, v36, v32, s44
    v_mfma_f32_16x16x32_bf16 a[40:43], v[72:75], v[132:135], a[40:43]
    v_perm_b32 v68, v36, v32, s45
    v_mfma_f32_16x16x32_bf16 a[72:75], v[72:75], v[136:139], a[72:75]
    v_perm_b32 v65, v44, v40, s44
    v_mfma_f32_16x16x32_bf16 a[104:107], v[72:75], v[140:143], a[104:107]
    v_perm_b32 v69, v44, v40, s45
    v_mfma_f32_16x16x32_bf16 a[136:139], v[72:75], v[144:147], a[136:139]
    v_perm_b32 v66, v52, v48, s44
    v_mfma_f32_16x16x32_bf16 a[168:171], v[72:75], v[148:151], a[168:171]
    v_perm_b32 v70, v52, v48, s45
    v_mfma_f32_16x16x32_bf16 a[200:203], v[72:75], v[152:155], a[200:203]
    v_perm_b32 v67, v60, v56, s44
    v_mfma_f32_16x16x32_bf16 a[232:235], v[72:75], v[156:159], a[232:235]
    v_perm_b32 v71, v60, v56, s45
    v_mfma_f32_16x16x32_bf16 v[232:235], v[72:75], v[160:163], v[232:235]
    v_mfma_f32_16x16x32_bf16 a[12:15], v[76:79], v[128:131], a[12:15]
    v_mfma_f32_16x16x32_bf16 a[44:47], v[76:79], v[132:135], a[44:47]
    v_mfma_f32_16x16x32_bf16 a[76:79], v[76:79], v[136:139], a[76:79]
    v_mfma_f32_16x16x32_bf16 a[108:111], v[76:79], v[140:143], a[108:111]
    v_mfma_f32_16x16x32_bf16 a[140:143], v[76:79], v[144:147], a[140:143]
    v_mfma_f32_16x16x32_bf16 a[172:175], v[76:79], v[148:151], a[172:175]
    v_mfma_f32_16x16x32_bf16 a[204:207], v[76:79], v[152:155], a[204:207]
    v_mfma_f32_16x16x32_bf16 a[236:239], v[76:79], v[156:159], a[236:239]
    v_mfma_f32_16x16x32_bf16 v[236:239], v[76:79], v[160:163], v[236:239]
    v_mfma_f32_16x16x32_bf16 a[16:19], v[80:83], v[128:131], a[16:19]
    v_perm_b32 v72, v37, v33, s44
    v_mfma_f32_16x16x32_bf16 a[48:51], v[80:83], v[132:135], a[48:51]
    v_perm_b32 v76, v37, v33, s45
    v_mfma_f32_16x16x32_bf16 a[80:83], v[80:83], v[136:139], a[80:83]
    v_perm_b32 v73, v45, v41, s44
    v_mfma_f32_16x16x32_bf16 a[112:115], v[80:83], v[140:143], a[112:115]
    v_perm_b32 v77, v45, v41, s45
    v_mfma_f32_16x16x32_bf16 a[144:147], v[80:83], v[144:147], a[144:147]
    v_perm_b32 v74, v53, v49, s44
    v_mfma_f32_16x16x32_bf16 a[176:179], v[80:83], v[148:151], a[176:179]
    v_perm_b32 v78, v53, v49, s45
    v_mfma_f32_16x16x32_bf16 a[208:211], v[80:83], v[152:155], a[208:211]
    v_perm_b32 v75, v61, v57, s44
    v_mfma_f32_16x16x32_bf16 a[240:243], v[80:83], v[156:159], a[240:243]
    v_perm_b32 v79, v61, v57, s45
    v_mfma_f32_16x16x32_bf16 v[240:243], v[80:83], v[160:163], v[240:243]
    v_mfma_f32_16x16x32_bf16 a[20:23], v[84:87], v[128:131], a[20:23]
    v_mfma_f32_16x16x32_bf16 a[52:55], v[84:87], v[132:135], a[52:55]
    v_mfma_f32_16x16x32_bf16 a[84:87], v[84:87], v[136:139], a[84:87]
    v_mfma_f32_16x16x32_bf16 a[116:119], v[84:87], v[140:143], a[116:119]
    v_mfma_f32_16x16x32_bf16 a[148:151], v[84:87], v[144:147], a[148:151]
    v_mfma_f32_16x16x32_bf16 a[180:183], v[84:87], v[148:151], a[180:183]
    v_mfma_f32_16x16x32_bf16 a[212:215], v[84:87], v[152:155], a[212:215]
    v_mfma_f32_16x16x32_bf16 a[244:247], v[84:87], v[156:159], a[244:247]
    v_mfma_f32_16x16x32_bf16 v[244:247], v[84:87], v[160:163], v[244:247]
    v_mfma_f32_16x16x32_bf16 a[24:27], v[88:91], v[128:131], a[24:27]
    v_perm_b32 v80, v38, v34, s44
    v_mfma_f32_16x16x32_bf16 a[56:59], v[88:91], v[132:135], a[56:59]
    v_perm_b32 v84, v38, v34, s45
    v_mfma_f32_16x16x32_bf16 a[88:91], v[88:91], v[136:139], a[88:91]
    v_perm_b32 v81, v46, v42, s44
    v_mfma_f32_16x16x32_bf16 a[120:123], v[88:91], v[140:143], a[120:123]
    v_perm_b32 v85, v46, v42, s45
    v_mfma_f32_16x16x32_bf16 a[152:155], v[88:91], v[144:147], a[152:155]
    v_perm_b32 v82, v54, v50, s44
    v_mfma_f32_16x16x32_bf16 a[184:187], v[88:91], v[148:151], a[184:187]
    v_perm_b32 v86, v54, v50, s45
    v_mfma_f32_16x16x32_bf16 a[216:219], v[88:91], v[152:155], a[216:219]
    v_perm_b32 v83, v62, v58, s44
    v_mfma_f32_16x16x32_bf16 a[248:251], v[88:91], v[156:159], a[248:251]
    v_perm_b32 v87, v62, v58, s45
    v_mfma_f32_16x16x32_bf16 v[248:251], v[88:91], v[160:163], v[248:251]
    v_mfma_f32_16x16x32_bf16 a[28:31], v[92:95], v[128:131], a[28:31]
    v_mfma_f32_16x16x32_bf16 a[60:63], v[92:95], v[132:135], a[60:63]
    v_mfma_f32_16x16x32_bf16 a[92:95], v[92:95], v[136:139], a[92:95]
    v_mfma_f32_16x16x32_bf16 a[124:127], v[92:95], v[140:143], a[124:127]
    v_mfma_f32_16x16x32_bf16 a[156:159], v[92:95], v[144:147], a[156:159]
    v_mfma_f32_16x16x32_bf16 a[188:191], v[92:95], v[148:151], a[188:191]
    v_mfma_f32_16x16x32_bf16 a[220:223], v[92:95], v[152:155], a[220:223]
    v_mfma_f32_16x16x32_bf16 a[252:255], v[92:95], v[156:159], a[252:255]
    v_mfma_f32_16x16x32_bf16 v[252:255], v[92:95], v[160:163], v[252:255]
    s_waitcnt lgkmcnt(0)
    v_mfma_f32_16x16x32_bf16 a[0:3], v[64:67], v[164:167], a[0:3]
    v_perm_b32 v88, v39, v35, s44
    ds_read_b128 v[128:131], v211 offset:2048
    v_mfma_f32_16x16x32_bf16 a[32:35], v[64:67], v[168:171], a[32:35]
    v_perm_b32 v92, v39, v35, s45
    ds_read_b128 v[132:135], v211 offset:6144
    v_mfma_f32_16x16x32_bf16 a[64:67], v[64:67], v[172:175], a[64:67]
    v_perm_b32 v89, v47, v43, s44
    ds_read_b128 v[136:139], v211 offset:10240
    v_mfma_f32_16x16x32_bf16 a[96:99], v[64:67], v[176:179], a[96:99]
    v_perm_b32 v93, v47, v43, s45
    ds_read_b128 v[140:143], v211 offset:14336
    v_mfma_f32_16x16x32_bf16 a[128:131], v[64:67], v[180:183], a[128:131]
    v_perm_b32 v90, v55, v51, s44
    ds_read_b128 v[144:147], v211 offset:18432
    v_mfma_f32_16x16x32_bf16 a[160:163], v[64:67], v[184:187], a[160:163]
    v_perm_b32 v94, v55, v51, s45
    ds_read_b128 v[148:151], v211 offset:22528
    v_mfma_f32_16x16x32_bf16 a[192:195], v[64:67], v[188:191], a[192:195]
    v_perm_b32 v91, v63, v59, s44
    ds_read_b128 v[152:155], v211 offset:26624
    v_mfma_f32_16x16x32_bf16 a[224:227], v[64:67], v[192:195], a[224:227]
    v_perm_b32 v95, v63, v59, s45
    ds_read_b128 v[156:159], v211 offset:30720
    v_mfma_f32_16x16x32_bf16 v[224:227], v[64:67], v[196:199], v[224:227]
    ds_read_b128 v[160:163], v211 offset:34816
    buffer_load_dwordx4 v[32:35], v220, s[24:27], s33 offen offset:0
    v_mfma_f32_16x16x32_bf16 a[4:7], v[68:71], v[164:167], a[4:7]
    buffer_load_dwordx4 v[36:39], v220, s[24:27], s33 offen offset:1024
    v_mfma_f32_16x16x32_bf16 a[36:39], v[68:71], v[168:171], a[36:39]
    buffer_load_dwordx4 v[40:43], v220, s[24:27], s33 offen offset:2048
    v_mfma_f32_16x16x32_bf16 a[68:71], v[68:71], v[172:175], a[68:71]
    buffer_load_dwordx4 v[44:47], v220, s[24:27], s33 offen offset:3072
    v_mfma_f32_16x16x32_bf16 a[100:103], v[68:71], v[176:179], a[100:103]
    buffer_load_dwordx4 v[48:51], v222, s[24:27], s33 offen offset:0
    v_mfma_f32_16x16x32_bf16 a[132:135], v[68:71], v[180:183], a[132:135]
    buffer_load_dwordx4 v[52:55], v222, s[24:27], s33 offen offset:1024
    v_mfma_f32_16x16x32_bf16 a[164:167], v[68:71], v[184:187], a[164:167]
    buffer_load_dwordx4 v[56:59], v222, s[24:27], s33 offen offset:2048
    v_mfma_f32_16x16x32_bf16 a[196:199], v[68:71], v[188:191], a[196:199]
    buffer_load_dwordx4 v[60:63], v222, s[24:27], s33 offen offset:3072
    v_mfma_f32_16x16x32_bf16 a[228:231], v[68:71], v[192:195], a[228:231]
    s_add_u32 s33, s33, 32768
    v_mfma_f32_16x16x32_bf16 v[228:231], v[68:71], v[196:199], v[228:231]
    s_waitcnt vmcnt(16)
    v_mfma_f32_16x16x32_bf16 a[8:11], v[72:75], v[164:167], a[8:11]
    v_perm_b32 v64, v100, v96, s44
    v_mfma_f32_16x16x32_bf16 a[40:43], v[72:75], v[168:171], a[40:43]
    v_perm_b32 v68, v100, v96, s45
    v_mfma_f32_16x16x32_bf16 a[72:75], v[72:75], v[172:175], a[72:75]
    v_perm_b32 v65, v108, v104, s44
    v_mfma_f32_16x16x32_bf16 a[104:107], v[72:75], v[176:179], a[104:107]
    v_perm_b32 v69, v108, v104, s45
    v_mfma_f32_16x16x32_bf16 a[136:139], v[72:75], v[180:183], a[136:139]
    v_perm_b32 v66, v116, v112, s44
    v_mfma_f32_16x16x32_bf16 a[168:171], v[72:75], v[184:187], a[168:171]
    v_perm_b32 v70, v116, v112, s45
    v_mfma_f32_16x16x32_bf16 a[200:203], v[72:75], v[188:191], a[200:203]
    v_perm_b32 v67, v124, v120, s44
    v_mfma_f32_16x16x32_bf16 a[232:235], v[72:75], v[192:195], a[232:235]
    v_perm_b32 v71, v124, v120, s45
    v_mfma_f32_16x16x32_bf16 v[232:235], v[72:75], v[196:199], v[232:235]
    v_mfma_f32_16x16x32_bf16 a[12:15], v[76:79], v[164:167], a[12:15]
    v_mfma_f32_16x16x32_bf16 a[44:47], v[76:79], v[168:171], a[44:47]
    v_mfma_f32_16x16x32_bf16 a[76:79], v[76:79], v[172:175], a[76:79]
    v_mfma_f32_16x16x32_bf16 a[108:111], v[76:79], v[176:179], a[108:111]
    v_mfma_f32_16x16x32_bf16 a[140:143], v[76:79], v[180:183], a[140:143]
    v_mfma_f32_16x16x32_bf16 a[172:175], v[76:79], v[184:187], a[172:175]
    v_mfma_f32_16x16x32_bf16 a[204:207], v[76:79], v[188:191], a[204:207]
    v_mfma_f32_16x16x32_bf16 a[236:239], v[76:79], v[192:195], a[236:239]
    v_mfma_f32_16x16x32_bf16 v[236:239], v[76:79], v[196:199], v[236:239]
    v_mfma_f32_16x16x32_bf16 a[16:19], v[80:83], v[164:167], a[16:19]
    v_perm_b32 v72, v101, v97, s44
    v_mfma_f32_16x16x32_bf16 a[48:51], v[80:83], v[168:171], a[48:51]
    v_perm_b32 v76, v101, v97, s45
    v_mfma_f32_16x16x32_bf16 a[80:83], v[80:83], v[172:175], a[80:83]
    v_perm_b32 v73, v109, v105, s44
    v_mfma_f32_16x16x32_bf16 a[112:115], v[80:83], v[176:179], a[112:115]
    v_perm_b32 v77, v109, v105, s45
    v_mfma_f32_16x16x32_bf16 a[144:147], v[80:83], v[180:183], a[144:147]
    v_perm_b32 v74, v117, v113, s44
    v_mfma_f32_16x16x32_bf16 a[176:179], v[80:83], v[184:187], a[176:179]
    v_perm_b32 v78, v117, v113, s45
    v_mfma_f32_16x16x32_bf16 a[208:211], v[80:83], v[188:191], a[208:211]
    v_perm_b32 v75, v125, v121, s44
    v_mfma_f32_16x16x32_bf16 a[240:243], v[80:83], v[192:195], a[240:243]
    v_perm_b32 v79, v125, v121, s45
    v_mfma_f32_16x16x32_bf16 v[240:243], v[80:83], v[196:199], v[240:243]
    v_mfma_f32_16x16x32_bf16 a[20:23], v[84:87], v[164:167], a[20:23]
    v_mfma_f32_16x16x32_bf16 a[52:55], v[84:87], v[168:171], a[52:55]
    v_mfma_f32_16x16x32_bf16 a[84:87], v[84:87], v[172:175], a[84:87]
    v_mfma_f32_16x16x32_bf16 a[116:119], v[84:87], v[176:179], a[116:119]
    v_mfma_f32_16x16x32_bf16 a[148:151], v[84:87], v[180:183], a[148:151]
    v_mfma_f32_16x16x32_bf16 a[180:183], v[84:87], v[184:187], a[180:183]
    v_mfma_f32_16x16x32_bf16 a[212:215], v[84:87], v[188:191], a[212:215]
    v_mfma_f32_16x16x32_bf16 a[244:247], v[84:87], v[192:195], a[244:247]
    v_mfma_f32_16x16x32_bf16 v[244:247], v[84:87], v[196:199], v[244:247]
    v_mfma_f32_16x16x32_bf16 a[24:27], v[88:91], v[164:167], a[24:27]
    v_perm_b32 v80, v102, v98, s44
    v_mfma_f32_16x16x32_bf16 a[56:59], v[88:91], v[168:171], a[56:59]
    v_perm_b32 v84, v102, v98, s45
    v_mfma_f32_16x16x32_bf16 a[88:91], v[88:91], v[172:175], a[88:91]
    v_perm_b32 v81, v110, v106, s44
    v_mfma_f32_16x16x32_bf16 a[120:123], v[88:91], v[176:179], a[120:123]
    v_perm_b32 v85, v110, v106, s45
    v_mfma_f32_16x16x32_bf16 a[152:155], v[88:91], v[180:183], a[152:155]
    v_perm_b32 v82, v118, v114, s44
    v_mfma_f32_16x16x32_bf16 a[184:187], v[88:91], v[184:187], a[184:187]
    v_perm_b32 v86, v118, v114, s45
    v_mfma_f32_16x16x32_bf16 a[216:219], v[88:91], v[188:191], a[216:219]
    v_perm_b32 v83, v126, v122, s44
    v_mfma_f32_16x16x32_bf16 a[248:251], v[88:91], v[192:195], a[248:251]
    v_perm_b32 v87, v126, v122, s45
    v_mfma_f32_16x16x32_bf16 v[248:251], v[88:91], v[196:199], v[248:251]
    v_mfma_f32_16x16x32_bf16 a[28:31], v[92:95], v[164:167], a[28:31]
    v_mfma_f32_16x16x32_bf16 a[60:63], v[92:95], v[168:171], a[60:63]
    v_mfma_f32_16x16x32_bf16 a[92:95], v[92:95], v[172:175], a[92:95]
    v_mfma_f32_16x16x32_bf16 a[124:127], v[92:95], v[176:179], a[124:127]
    v_mfma_f32_16x16x32_bf16 a[156:159], v[92:95], v[180:183], a[156:159]
    v_mfma_f32_16x16x32_bf16 a[188:191], v[92:95], v[184:187], a[188:191]
    v_mfma_f32_16x16x32_bf16 a[220:223], v[92:95], v[188:191], a[220:223]
    v_mfma_f32_16x16x32_bf16 a[252:255], v[92:95], v[192:195], a[252:255]
    v_mfma_f32_16x16x32_bf16 v[252:255], v[92:95], v[196:199], v[252:255]
    s_waitcnt lgkmcnt(0)
    v_mfma_f32_16x16x32_bf16 a[0:3], v[64:67], v[128:131], a[0:3]
    v_perm_b32 v88, v103, v99, s44
    ds_read_b128 v[164:167], v211 offset:3072
    v_mfma_f32_16x16x32_bf16 a[32:35], v[64:67], v[132:135], a[32:35]
    v_perm_b32 v92, v103, v99, s45
    ds_read_b128 v[168:171], v211 offset:7168
    v_mfma_f32_16x16x32_bf16 a[64:67], v[64:67], v[136:139], a[64:67]
    v_perm_b32 v89, v111, v107, s44
    ds_read_b128 v[172:175], v211 offset:11264
    v_mfma_f32_16x16x32_bf16 a[96:99], v[64:67], v[140:143], a[96:99]
    v_perm_b32 v93, v111, v107, s45
    ds_read_b128 v[176:179], v211 offset:15360
    v_mfma_f32_16x16x32_bf16 a[128:131], v[64:67], v[144:147], a[128:131]
    v_perm_b32 v90, v119, v115, s44
    ds_read_b128 v[180:183], v211 offset:19456
    v_mfma_f32_16x16x32_bf16 a[160:163], v[64:67], v[148:151], a[160:163]
    v_perm_b32 v94, v119, v115, s45
    ds_read_b128 v[184:187], v211 offset:23552
    v_mfma_f32_16x16x32_bf16 a[192:195], v[64:67], v[152:155], a[192:195]
    v_perm_b32 v91, v127, v123, s44
    ds_read_b128 v[188:191], v211 offset:27648
    v_mfma_f32_16x16x32_bf16 a[224:227], v[64:67], v[156:159], a[224:227]
    v_perm_b32 v95, v127, v123, s45
    ds_read_b128 v[192:195], v211 offset:31744
    v_mfma_f32_16x16x32_bf16 v[224:227], v[64:67], v[160:163], v[224:227]
    ds_read_b128 v[196:199], v211 offset:35840
    buffer_load_dwordx4 v[96:99], v220, s[24:27], s33 offen offset:0
    v_mfma_f32_16x16x32_bf16 a[4:7], v[68:71], v[128:131], a[4:7]
    v_add_u32 v211, 36864, v211
    buffer_load_dwordx4 v[100:103], v220, s[24:27], s33 offen offset:1024
    v_mfma_f32_16x16x32_bf16 a[36:39], v[68:71], v[132:135], a[36:39]
    buffer_load_dwordx4 v[104:107], v220, s[24:27], s33 offen offset:2048
    v_mfma_f32_16x16x32_bf16 a[68:71], v[68:71], v[136:139], a[68:71]
    buffer_load_dwordx4 v[108:111], v220, s[24:27], s33 offen offset:3072
    v_mfma_f32_16x16x32_bf16 a[100:103], v[68:71], v[140:143], a[100:103]
    buffer_load_dwordx4 v[112:115], v222, s[24:27], s33 offen offset:0
    v_mfma_f32_16x16x32_bf16 a[132:135], v[68:71], v[144:147], a[132:135]
    buffer_load_dwordx4 v[116:119], v222, s[24:27], s33 offen offset:1024
    v_mfma_f32_16x16x32_bf16 a[164:167], v[68:71], v[148:151], a[164:167]
    buffer_load_dwordx4 v[120:123], v222, s[24:27], s33 offen offset:2048
    v_mfma_f32_16x16x32_bf16 a[196:199], v[68:71], v[152:155], a[196:199]
    buffer_load_dwordx4 v[124:127], v222, s[24:27], s33 offen offset:3072
    v_mfma_f32_16x16x32_bf16 a[228:231], v[68:71], v[156:159], a[228:231]
    s_add_u32 s33, s33, 32768
    v_mfma_f32_16x16x32_bf16 v[228:231], v[68:71], v[160:163], v[228:231]
    s_waitcnt vmcnt(16)
    v_mfma_f32_16x16x32_bf16 a[8:11], v[72:75], v[128:131], a[8:11]
    v_perm_b32 v64, v4, v0, s44
    v_mfma_f32_16x16x32_bf16 a[40:43], v[72:75], v[132:135], a[40:43]
    v_perm_b32 v68, v4, v0, s45
    v_mfma_f32_16x16x32_bf16 a[72:75], v[72:75], v[136:139], a[72:75]
    v_perm_b32 v65, v12, v8, s44
    v_mfma_f32_16x16x32_bf16 a[104:107], v[72:75], v[140:143], a[104:107]
    v_perm_b32 v69, v12, v8, s45
    v_mfma_f32_16x16x32_bf16 a[136:139], v[72:75], v[144:147], a[136:139]
    v_perm_b32 v66, v20, v16, s44
    v_mfma_f32_16x16x32_bf16 a[168:171], v[72:75], v[148:151], a[168:171]
    v_perm_b32 v70, v20, v16, s45
    v_mfma_f32_16x16x32_bf16 a[200:203], v[72:75], v[152:155], a[200:203]
    v_perm_b32 v67, v28, v24, s44
    v_mfma_f32_16x16x32_bf16 a[232:235], v[72:75], v[156:159], a[232:235]
    v_perm_b32 v71, v28, v24, s45
    v_mfma_f32_16x16x32_bf16 v[232:235], v[72:75], v[160:163], v[232:235]
    v_mfma_f32_16x16x32_bf16 a[12:15], v[76:79], v[128:131], a[12:15]
    v_mfma_f32_16x16x32_bf16 a[44:47], v[76:79], v[132:135], a[44:47]
    v_mfma_f32_16x16x32_bf16 a[76:79], v[76:79], v[136:139], a[76:79]
    v_mfma_f32_16x16x32_bf16 a[108:111], v[76:79], v[140:143], a[108:111]
    v_mfma_f32_16x16x32_bf16 a[140:143], v[76:79], v[144:147], a[140:143]
    v_mfma_f32_16x16x32_bf16 a[172:175], v[76:79], v[148:151], a[172:175]
    v_mfma_f32_16x16x32_bf16 a[204:207], v[76:79], v[152:155], a[204:207]
    v_mfma_f32_16x16x32_bf16 a[236:239], v[76:79], v[156:159], a[236:239]
    v_mfma_f32_16x16x32_bf16 v[236:239], v[76:79], v[160:163], v[236:239]
    v_mfma_f32_16x16x32_bf16 a[16:19], v[80:83], v[128:131], a[16:19]
    v_perm_b32 v72, v5, v1, s44
    v_mfma_f32_16x16x32_bf16 a[48:51], v[80:83], v[132:135], a[48:51]
    v_perm_b32 v76, v5, v1, s45
    v_mfma_f32_16x16x32_bf16 a[80:83], v[80:83], v[136:139], a[80:83]
    v_perm_b32 v73, v13, v9, s44
    v_mfma_f32_16x16x32_bf16 a[112:115], v[80:83], v[140:143], a[112:115]
    v_perm_b32 v77, v13, v9, s45
    v_mfma_f32_16x16x32_bf16 a[144:147], v[80:83], v[144:147], a[144:147]
    v_perm_b32 v74, v21, v17, s44
    v_mfma_f32_16x16x32_bf16 a[176:179], v[80:83], v[148:151], a[176:179]
    v_perm_b32 v78, v21, v17, s45
    v_mfma_f32_16x16x32_bf16 a[208:211], v[80:83], v[152:155], a[208:211]
    v_perm_b32 v75, v29, v25, s44
    v_mfma_f32_16x16x32_bf16 a[240:243], v[80:83], v[156:159], a[240:243]
    v_perm_b32 v79, v29, v25, s45
    v_mfma_f32_16x16x32_bf16 v[240:243], v[80:83], v[160:163], v[240:243]
    v_mfma_f32_16x16x32_bf16 a[20:23], v[84:87], v[128:131], a[20:23]
    v_mfma_f32_16x16x32_bf16 a[52:55], v[84:87], v[132:135], a[52:55]
    v_mfma_f32_16x16x32_bf16 a[84:87], v[84:87], v[136:139], a[84:87]
    v_mfma_f32_16x16x32_bf16 a[116:119], v[84:87], v[140:143], a[116:119]
    v_mfma_f32_16x16x32_bf16 a[148:151], v[84:87], v[144:147], a[148:151]
    v_mfma_f32_16x16x32_bf16 a[180:183], v[84:87], v[148:151], a[180:183]
    v_mfma_f32_16x16x32_bf16 a[212:215], v[84:87], v[152:155], a[212:215]
    v_mfma_f32_16x16x32_bf16 a[244:247], v[84:87], v[156:159], a[244:247]
    v_mfma_f32_16x16x32_bf16 v[244:247], v[84:87], v[160:163], v[244:247]
    v_mfma_f32_16x16x32_bf16 a[24:27], v[88:91], v[128:131], a[24:27]
    v_perm_b32 v80, v6, v2, s44
    v_mfma_f32_16x16x32_bf16 a[56:59], v[88:91], v[132:135], a[56:59]
    v_perm_b32 v84, v6, v2, s45
    v_mfma_f32_16x16x32_bf16 a[88:91], v[88:91], v[136:139], a[88:91]
    v_perm_b32 v81, v14, v10, s44
    v_mfma_f32_16x16x32_bf16 a[120:123], v[88:91], v[140:143], a[120:123]
    v_perm_b32 v85, v14, v10, s45
    v_mfma_f32_16x16x32_bf16 a[152:155], v[88:91], v[144:147], a[152:155]
    v_perm_b32 v82, v22, v18, s44
    v_mfma_f32_16x16x32_bf16 a[184:187], v[88:91], v[148:151], a[184:187]
    v_perm_b32 v86, v22, v18, s45
    v_mfma_f32_16x16x32_bf16 a[216:219], v[88:91], v[152:155], a[216:219]
    v_perm_b32 v83, v30, v26, s44
    v_mfma_f32_16x16x32_bf16 a[248:251], v[88:91], v[156:159], a[248:251]
    v_perm_b32 v87, v30, v26, s45
    v_mfma_f32_16x16x32_bf16 v[248:251], v[88:91], v[160:163], v[248:251]
    v_mfma_f32_16x16x32_bf16 a[28:31], v[92:95], v[128:131], a[28:31]
    v_mfma_f32_16x16x32_bf16 a[60:63], v[92:95], v[132:135], a[60:63]
    v_mfma_f32_16x16x32_bf16 a[92:95], v[92:95], v[136:139], a[92:95]
    v_mfma_f32_16x16x32_bf16 a[124:127], v[92:95], v[140:143], a[124:127]
    v_mfma_f32_16x16x32_bf16 a[156:159], v[92:95], v[144:147], a[156:159]
    v_mfma_f32_16x16x32_bf16 a[188:191], v[92:95], v[148:151], a[188:191]
    v_mfma_f32_16x16x32_bf16 a[220:223], v[92:95], v[152:155], a[220:223]
    v_mfma_f32_16x16x32_bf16 a[252:255], v[92:95], v[156:159], a[252:255]
    v_mfma_f32_16x16x32_bf16 v[252:255], v[92:95], v[160:163], v[252:255]
    s_waitcnt lgkmcnt(0)
    v_mfma_f32_16x16x32_bf16 a[0:3], v[64:67], v[164:167], a[0:3]
    v_perm_b32 v88, v7, v3, s44
    ds_read_b128 v[128:131], v211 offset:0
    v_mfma_f32_16x16x32_bf16 a[32:35], v[64:67], v[168:171], a[32:35]
    v_perm_b32 v92, v7, v3, s45
    ds_read_b128 v[132:135], v211 offset:4096
    v_mfma_f32_16x16x32_bf16 a[64:67], v[64:67], v[172:175], a[64:67]
    v_perm_b32 v89, v15, v11, s44
    ds_read_b128 v[136:139], v211 offset:8192
    v_mfma_f32_16x16x32_bf16 a[96:99], v[64:67], v[176:179], a[96:99]
    v_perm_b32 v93, v15, v11, s45
    ds_read_b128 v[140:143], v211 offset:12288
    v_mfma_f32_16x16x32_bf16 a[128:131], v[64:67], v[180:183], a[128:131]
    v_perm_b32 v90, v23, v19, s44
    ds_read_b128 v[144:147], v211 offset:16384
    v_mfma_f32_16x16x32_bf16 a[160:163], v[64:67], v[184:187], a[160:163]
    v_perm_b32 v94, v23, v19, s45
    ds_read_b128 v[148:151], v211 offset:20480
    v_mfma_f32_16x16x32_bf16 a[192:195], v[64:67], v[188:191], a[192:195]
    v_perm_b32 v91, v31, v27, s44
    ds_read_b128 v[152:155], v211 offset:24576
    v_mfma_f32_16x16x32_bf16 a[224:227], v[64:67], v[192:195], a[224:227]
    v_perm_b32 v95, v31, v27, s45
    ds_read_b128 v[156:159], v211 offset:28672
    v_mfma_f32_16x16x32_bf16 v[224:227], v[64:67], v[196:199], v[224:227]
    ds_read_b128 v[160:163], v211 offset:32768
    buffer_load_dwordx4 v[0:3], v220, s[24:27], s33 offen offset:0
    v_mfma_f32_16x16x32_bf16 a[4:7], v[68:71], v[164:167], a[4:7]
    buffer_load_dwordx4 v[4:7], v220, s[24:27], s33 offen offset:1024
    v_mfma_f32_16x16x32_bf16 a[36:39], v[68:71], v[168:171], a[36:39]
    buffer_load_dwordx4 v[8:11], v220, s[24:27], s33 offen offset:2048
    v_mfma_f32_16x16x32_bf16 a[68:71], v[68:71], v[172:175], a[68:71]
    buffer_load_dwordx4 v[12:15], v220, s[24:27], s33 offen offset:3072
    v_mfma_f32_16x16x32_bf16 a[100:103], v[68:71], v[176:179], a[100:103]
    buffer_load_dwordx4 v[16:19], v222, s[24:27], s33 offen offset:0
    v_mfma_f32_16x16x32_bf16 a[132:135], v[68:71], v[180:183], a[132:135]
    buffer_load_dwordx4 v[20:23], v222, s[24:27], s33 offen offset:1024
    v_mfma_f32_16x16x32_bf16 a[164:167], v[68:71], v[184:187], a[164:167]
    buffer_load_dwordx4 v[24:27], v222, s[24:27], s33 offen offset:2048
    v_mfma_f32_16x16x32_bf16 a[196:199], v[68:71], v[188:191], a[196:199]
    buffer_load_dwordx4 v[28:31], v222, s[24:27], s33 offen offset:3072
    v_mfma_f32_16x16x32_bf16 a[228:231], v[68:71], v[192:195], a[228:231]
    s_add_u32 s33, s33, 32768
    v_mfma_f32_16x16x32_bf16 v[228:231], v[68:71], v[196:199], v[228:231]
    s_waitcnt vmcnt(16)
    v_mfma_f32_16x16x32_bf16 a[8:11], v[72:75], v[164:167], a[8:11]
    v_perm_b32 v64, v36, v32, s44
    v_mfma_f32_16x16x32_bf16 a[40:43], v[72:75], v[168:171], a[40:43]
    v_perm_b32 v68, v36, v32, s45
    v_mfma_f32_16x16x32_bf16 a[72:75], v[72:75], v[172:175], a[72:75]
    v_perm_b32 v65, v44, v40, s44
    v_mfma_f32_16x16x32_bf16 a[104:107], v[72:75], v[176:179], a[104:107]
    v_perm_b32 v69, v44, v40, s45
    v_mfma_f32_16x16x32_bf16 a[136:139], v[72:75], v[180:183], a[136:139]
    v_perm_b32 v66, v52, v48, s44
    v_mfma_f32_16x16x32_bf16 a[168:171], v[72:75], v[184:187], a[168:171]
    v_perm_b32 v70, v52, v48, s45
    v_mfma_f32_16x16x32_bf16 a[200:203], v[72:75], v[188:191], a[200:203]
    v_perm_b32 v67, v60, v56, s44
    v_mfma_f32_16x16x32_bf16 a[232:235], v[72:75], v[192:195], a[232:235]
    v_perm_b32 v71, v60, v56, s45
    v_mfma_f32_16x16x32_bf16 v[232:235], v[72:75], v[196:199], v[232:235]
    v_mfma_f32_16x16x32_bf16 a[12:15], v[76:79], v[164:167], a[12:15]
    v_mfma_f32_16x16x32_bf16 a[44:47], v[76:79], v[168:171], a[44:47]
    v_mfma_f32_16x16x32_bf16 a[76:79], v[76:79], v[172:175], a[76:79]
    v_mfma_f32_16x16x32_bf16 a[108:111], v[76:79], v[176:179], a[108:111]
    v_mfma_f32_16x16x32_bf16 a[140:143], v[76:79], v[180:183], a[140:143]
    v_mfma_f32_16x16x32_bf16 a[172:175], v[76:79], v[184:187], a[172:175]
    v_mfma_f32_16x16x32_bf16 a[204:207], v[76:79], v[188:191], a[204:207]
    v_mfma_f32_16x16x32_bf16 a[236:239], v[76:79], v[192:195], a[236:239]
    v_mfma_f32_16x16x32_bf16 v[236:239], v[76:79], v[196:199], v[236:239]
    v_mfma_f32_16x16x32_bf16 a[16:19], v[80:83], v[164:167], a[16:19]
    v_perm_b32 v72, v37, v33, s44
    v_mfma_f32_16x16x32_bf16 a[48:51], v[80:83], v[168:171], a[48:51]
    v_perm_b32 v76, v37, v33, s45
    v_mfma_f32_16x16x32_bf16 a[80:83], v[80:83], v[172:175], a[80:83]
    v_perm_b32 v73, v45, v41, s44
    v_mfma_f32_16x16x32_bf16 a[112:115], v[80:83], v[176:179], a[112:115]
    v_perm_b32 v77, v45, v41, s45
    v_mfma_f32_16x16x32_bf16 a[144:147], v[80:83], v[180:183], a[144:147]
    v_perm_b32 v74, v53, v49, s44
    v_mfma_f32_16x16x32_bf16 a[176:179], v[80:83], v[184:187], a[176:179]
    v_perm_b32 v78, v53, v49, s45
    v_mfma_f32_16x16x32_bf16 a[208:211], v[80:83], v[188:191], a[208:211]
    v_perm_b32 v75, v61, v57, s44
    v_mfma_f32_16x16x32_bf16 a[240:243], v[80:83], v[192:195], a[240:243]
    v_perm_b32 v79, v61, v57, s45
    v_mfma_f32_16x16x32_bf16 v[240:243], v[80:83], v[196:199], v[240:243]
    v_mfma_f32_16x16x32_bf16 a[20:23], v[84:87], v[164:167], a[20:23]
    v_mfma_f32_16x16x32_bf16 a[52:55], v[84:87], v[168:171], a[52:55]
    v_mfma_f32_16x16x32_bf16 a[84:87], v[84:87], v[172:175], a[84:87]
    v_mfma_f32_16x16x32_bf16 a[116:119], v[84:87], v[176:179], a[116:119]
    v_mfma_f32_16x16x32_bf16 a[148:151], v[84:87], v[180:183], a[148:151]
    v_mfma_f32_16x16x32_bf16 a[180:183], v[84:87], v[184:187], a[180:183]
    v_mfma_f32_16x16x32_bf16 a[212:215], v[84:87], v[188:191], a[212:215]
    v_mfma_f32_16x16x32_bf16 a[244:247], v[84:87], v[192:195], a[244:247]
    v_mfma_f32_16x16x32_bf16 v[244:247], v[84:87], v[196:199], v[244:247]
    v_mfma_f32_16x16x32_bf16 a[24:27], v[88:91], v[164:167], a[24:27]
    v_perm_b32 v80, v38, v34, s44
    v_mfma_f32_16x16x32_bf16 a[56:59], v[88:91], v[168:171], a[56:59]
    v_perm_b32 v84, v38, v34, s45
    v_mfma_f32_16x16x32_bf16 a[88:91], v[88:91], v[172:175], a[88:91]
    v_perm_b32 v81, v46, v42, s44
    v_mfma_f32_16x16x32_bf16 a[120:123], v[88:91], v[176:179], a[120:123]
    v_perm_b32 v85, v46, v42, s45
    v_mfma_f32_16x16x32_bf16 a[152:155], v[88:91], v[180:183], a[152:155]
    v_perm_b32 v82, v54, v50, s44
    v_mfma_f32_16x16x32_bf16 a[184:187], v[88:91], v[184:187], a[184:187]
    v_perm_b32 v86, v54, v50, s45
    v_mfma_f32_16x16x32_bf16 a[216:219], v[88:91], v[188:191], a[216:219]
    v_perm_b32 v83, v62, v58, s44
    v_mfma_f32_16x16x32_bf16 a[248:251], v[88:91], v[192:195], a[248:251]
    v_perm_b32 v87, v62, v58, s45
    v_mfma_f32_16x16x32_bf16 v[248:251], v[88:91], v[196:199], v[248:251]
    v_mfma_f32_16x16x32_bf16 a[28:31], v[92:95], v[164:167], a[28:31]
    v_mfma_f32_16x16x32_bf16 a[60:63], v[92:95], v[168:171], a[60:63]
    v_mfma_f32_16x16x32_bf16 a[92:95], v[92:95], v[172:175], a[92:95]
    v_mfma_f32_16x16x32_bf16 a[124:127], v[92:95], v[176:179], a[124:127]
    v_mfma_f32_16x16x32_bf16 a[156:159], v[92:95], v[180:183], a[156:159]
    v_mfma_f32_16x16x32_bf16 a[188:191], v[92:95], v[184:187], a[188:191]
    v_mfma_f32_16x16x32_bf16 a[220:223], v[92:95], v[188:191], a[220:223]
    v_mfma_f32_16x16x32_bf16 a[252:255], v[92:95], v[192:195], a[252:255]
    v_mfma_f32_16x16x32_bf16 v[252:255], v[92:95], v[196:199], v[252:255]
    s_waitcnt lgkmcnt(0)
    v_mfma_f32_16x16x32_bf16 a[0:3], v[64:67], v[128:131], a[0:3]
    v_perm_b32 v88, v39, v35, s44
    ds_read_b128 v[164:167], v211 offset:1024
    v_mfma_f32_16x16x32_bf16 a[32:35], v[64:67], v[132:135], a[32:35]
    v_perm_b32 v92, v39, v35, s45
    ds_read_b128 v[168:171], v211 offset:5120
    v_mfma_f32_16x16x32_bf16 a[64:67], v[64:67], v[136:139], a[64:67]
    v_perm_b32 v89, v47, v43, s44
    ds_read_b128 v[172:175], v211 offset:9216
    v_mfma_f32_16x16x32_bf16 a[96:99], v[64:67], v[140:143], a[96:99]
    v_perm_b32 v93, v47, v43, s45
    ds_read_b128 v[176:179], v211 offset:13312
    v_mfma_f32_16x16x32_bf16 a[128:131], v[64:67], v[144:147], a[128:131]
    v_perm_b32 v90, v55, v51, s44
    ds_read_b128 v[180:183], v211 offset:17408
    v_mfma_f32_16x16x32_bf16 a[160:163], v[64:67], v[148:151], a[160:163]
    v_perm_b32 v94, v55, v51, s45
    ds_read_b128 v[184:187], v211 offset:21504
    v_mfma_f32_16x16x32_bf16 a[192:195], v[64:67], v[152:155], a[192:195]
    v_perm_b32 v91, v63, v59, s44
    ds_read_b128 v[188:191], v211 offset:25600
    v_mfma_f32_16x16x32_bf16 a[224:227], v[64:67], v[156:159], a[224:227]
    v_perm_b32 v95, v63, v59, s45
    ds_read_b128 v[192:195], v211 offset:29696
    v_mfma_f32_16x16x32_bf16 v[224:227], v[64:67], v[160:163], v[224:227]
    ds_read_b128 v[196:199], v211 offset:33792
    buffer_load_dwordx4 v[32:35], v220, s[24:27], s33 offen offset:0
    v_mfma_f32_16x16x32_bf16 a[4:7], v[68:71], v[128:131], a[4:7]
    buffer_load_dwordx4 v[36:39], v220, s[24:27], s33 offen offset:1024
    v_mfma_f32_16x16x32_bf16 a[36:39], v[68:71], v[132:135], a[36:39]
    buffer_load_dwordx4 v[40:43], v220, s[24:27], s33 offen offset:2048
    v_mfma_f32_16x16x32_bf16 a[68:71], v[68:71], v[136:139], a[68:71]
    buffer_load_dwordx4 v[44:47], v220, s[24:27], s33 offen offset:3072
    v_mfma_f32_16x16x32_bf16 a[100:103], v[68:71], v[140:143], a[100:103]
    buffer_load_dwordx4 v[48:51], v222, s[24:27], s33 offen offset:0
    v_mfma_f32_16x16x32_bf16 a[132:135], v[68:71], v[144:147], a[132:135]
    buffer_load_dwordx4 v[52:55], v222, s[24:27], s33 offen offset:1024
    v_mfma_f32_16x16x32_bf16 a[164:167], v[68:71], v[148:151], a[164:167]
    buffer_load_dwordx4 v[56:59], v222, s[24:27], s33 offen offset:2048
    v_mfma_f32_16x16x32_bf16 a[196:199], v[68:71], v[152:155], a[196:199]
    buffer_load_dwordx4 v[60:63], v222, s[24:27], s33 offen offset:3072
    v_mfma_f32_16x16x32_bf16 a[228:231], v[68:71], v[156:159], a[228:231]
    s_add_u32 s33, s33, 32768
    v_mfma_f32_16x16x32_bf16 v[228:231], v[68:71], v[160:163], v[228:231]
    s_waitcnt vmcnt(16)
    v_mfma_f32_16x16x32_bf16 a[8:11], v[72:75], v[128:131], a[8:11]
    v_perm_b32 v64, v100, v96, s44
    v_mfma_f32_16x16x32_bf16 a[40:43], v[72:75], v[132:135], a[40:43]
    v_perm_b32 v68, v100, v96, s45
    v_mfma_f32_16x16x32_bf16 a[72:75], v[72:75], v[136:139], a[72:75]
    v_perm_b32 v65, v108, v104, s44
    v_mfma_f32_16x16x32_bf16 a[104:107], v[72:75], v[140:143], a[104:107]
    v_perm_b32 v69, v108, v104, s45
    v_mfma_f32_16x16x32_bf16 a[136:139], v[72:75], v[144:147], a[136:139]
    v_perm_b32 v66, v116, v112, s44
    v_mfma_f32_16x16x32_bf16 a[168:171], v[72:75], v[148:151], a[168:171]
    v_perm_b32 v70, v116, v112, s45
    v_mfma_f32_16x16x32_bf16 a[200:203], v[72:75], v[152:155], a[200:203]
    v_perm_b32 v67, v124, v120, s44
    v_mfma_f32_16x16x32_bf16 a[232:235], v[72:75], v[156:159], a[232:235]
    v_perm_b32 v71, v124, v120, s45
    v_mfma_f32_16x16x32_bf16 v[232:235], v[72:75], v[160:163], v[232:235]
    v_mfma_f32_16x16x32_bf16 a[12:15], v[76:79], v[128:131], a[12:15]
    v_mfma_f32_16x16x32_bf16 a[44:47], v[76:79], v[132:135], a[44:47]
    v_mfma_f32_16x16x32_bf16 a[76:79], v[76:79], v[136:139], a[76:79]
    v_mfma_f32_16x16x32_bf16 a[108:111], v[76:79], v[140:143], a[108:111]
    v_mfma_f32_16x16x32_bf16 a[140:143], v[76:79], v[144:147], a[140:143]
    v_mfma_f32_16x16x32_bf16 a[172:175], v[76:79], v[148:151], a[172:175]
    v_mfma_f32_16x16x32_bf16 a[204:207], v[76:79], v[152:155], a[204:207]
    v_mfma_f32_16x16x32_bf16 a[236:239], v[76:79], v[156:159], a[236:239]
    v_mfma_f32_16x16x32_bf16 v[236:239], v[76:79], v[160:163], v[236:239]
    v_mfma_f32_16x16x32_bf16 a[16:19], v[80:83], v[128:131], a[16:19]
    v_perm_b32 v72, v101, v97, s44
    v_mfma_f32_16x16x32_bf16 a[48:51], v[80:83], v[132:135], a[48:51]
    v_perm_b32 v76, v101, v97, s45
    v_mfma_f32_16x16x32_bf16 a[80:83], v[80:83], v[136:139], a[80:83]
    v_perm_b32 v73, v109, v105, s44
    v_mfma_f32_16x16x32_bf16 a[112:115], v[80:83], v[140:143], a[112:115]
    v_perm_b32 v77, v109, v105, s45
    v_mfma_f32_16x16x32_bf16 a[144:147], v[80:83], v[144:147], a[144:147]
    v_perm_b32 v74, v117, v113, s44
    v_mfma_f32_16x16x32_bf16 a[176:179], v[80:83], v[148:151], a[176:179]
    v_perm_b32 v78, v117, v113, s45
    v_mfma_f32_16x16x32_bf16 a[208:211], v[80:83], v[152:155], a[208:211]
    v_perm_b32 v75, v125, v121, s44
    v_mfma_f32_16x16x32_bf16 a[240:243], v[80:83], v[156:159], a[240:243]
    v_perm_b32 v79, v125, v121, s45
    v_mfma_f32_16x16x32_bf16 v[240:243], v[80:83], v[160:163], v[240:243]
    v_mfma_f32_16x16x32_bf16 a[20:23], v[84:87], v[128:131], a[20:23]
    v_mfma_f32_16x16x32_bf16 a[52:55], v[84:87], v[132:135], a[52:55]
    v_mfma_f32_16x16x32_bf16 a[84:87], v[84:87], v[136:139], a[84:87]
    v_mfma_f32_16x16x32_bf16 a[116:119], v[84:87], v[140:143], a[116:119]
    v_mfma_f32_16x16x32_bf16 a[148:151], v[84:87], v[144:147], a[148:151]
    v_mfma_f32_16x16x32_bf16 a[180:183], v[84:87], v[148:151], a[180:183]
    v_mfma_f32_16x16x32_bf16 a[212:215], v[84:87], v[152:155], a[212:215]
    v_mfma_f32_16x16x32_bf16 a[244:247], v[84:87], v[156:159], a[244:247]
    v_mfma_f32_16x16x32_bf16 v[244:247], v[84:87], v[160:163], v[244:247]
    v_mfma_f32_16x16x32_bf16 a[24:27], v[88:91], v[128:131], a[24:27]
    v_perm_b32 v80, v102, v98, s44
    v_mfma_f32_16x16x32_bf16 a[56:59], v[88:91], v[132:135], a[56:59]
    v_perm_b32 v84, v102, v98, s45
    v_mfma_f32_16x16x32_bf16 a[88:91], v[88:91], v[136:139], a[88:91]
    v_perm_b32 v81, v110, v106, s44
    v_mfma_f32_16x16x32_bf16 a[120:123], v[88:91], v[140:143], a[120:123]
    v_perm_b32 v85, v110, v106, s45
    v_mfma_f32_16x16x32_bf16 a[152:155], v[88:91], v[144:147], a[152:155]
    v_perm_b32 v82, v118, v114, s44
    v_mfma_f32_16x16x32_bf16 a[184:187], v[88:91], v[148:151], a[184:187]
    v_perm_b32 v86, v118, v114, s45
    v_mfma_f32_16x16x32_bf16 a[216:219], v[88:91], v[152:155], a[216:219]
    v_perm_b32 v83, v126, v122, s44
    v_mfma_f32_16x16x32_bf16 a[248:251], v[88:91], v[156:159], a[248:251]
    v_perm_b32 v87, v126, v122, s45
    v_mfma_f32_16x16x32_bf16 v[248:251], v[88:91], v[160:163], v[248:251]
    v_mfma_f32_16x16x32_bf16 a[28:31], v[92:95], v[128:131], a[28:31]
    v_mfma_f32_16x16x32_bf16 a[60:63], v[92:95], v[132:135], a[60:63]
    v_mfma_f32_16x16x32_bf16 a[92:95], v[92:95], v[136:139], a[92:95]
    v_mfma_f32_16x16x32_bf16 a[124:127], v[92:95], v[140:143], a[124:127]
    v_mfma_f32_16x16x32_bf16 a[156:159], v[92:95], v[144:147], a[156:159]
    v_mfma_f32_16x16x32_bf16 a[188:191], v[92:95], v[148:151], a[188:191]
    v_mfma_f32_16x16x32_bf16 a[220:223], v[92:95], v[152:155], a[220:223]
    v_mfma_f32_16x16x32_bf16 a[252:255], v[92:95], v[156:159], a[252:255]
    v_mfma_f32_16x16x32_bf16 v[252:255], v[92:95], v[160:163], v[252:255]
    s_waitcnt lgkmcnt(0)
    v_mfma_f32_16x16x32_bf16 a[0:3], v[64:67], v[164:167], a[0:3]
    v_perm_b32 v88, v103, v99, s44
    ds_read_b128 v[128:131], v211 offset:2048
    v_mfma_f32_16x16x32_bf16 a[32:35], v[64:67], v[168:171], a[32:35]
    v_perm_b32 v92, v103, v99, s45
    ds_read_b128 v[132:135], v211 offset:6144
    v_mfma_f32_16x16x32_bf16 a[64:67], v[64:67], v[172:175], a[64:67]
    v_perm_b32 v89, v111, v107, s44
    ds_read_b128 v[136:139], v211 offset:10240
    v_mfma_f32_16x16x32_bf16 a[96:99], v[64:67], v[176:179], a[96:99]
    v_perm_b32 v93, v111, v107, s45
    ds_read_b128 v[140:143], v211 offset:14336
    v_mfma_f32_16x16x32_bf16 a[128:131], v[64:67], v[180:183], a[128:131]
    v_perm_b32 v90, v119, v115, s44
    ds_read_b128 v[144:147], v211 offset:18432
    v_mfma_f32_16x16x32_bf16 a[160:163], v[64:67], v[184:187], a[160:163]
    v_perm_b32 v94, v119, v115, s45
    ds_read_b128 v[148:151], v211 offset:22528
    v_mfma_f32_16x16x32_bf16 a[192:195], v[64:67], v[188:191], a[192:195]
    v_perm_b32 v91, v127, v123, s44
    ds_read_b128 v[152:155], v211 offset:26624
    v_mfma_f32_16x16x32_bf16 a[224:227], v[64:67], v[192:195], a[224:227]
    v_perm_b32 v95, v127, v123, s45
    ds_read_b128 v[156:159], v211 offset:30720
    v_mfma_f32_16x16x32_bf16 v[224:227], v[64:67], v[196:199], v[224:227]
    ds_read_b128 v[160:163], v211 offset:34816
    buffer_load_dwordx4 v[96:99], v220, s[24:27], s33 offen offset:0
    v_mfma_f32_16x16x32_bf16 a[4:7], v[68:71], v[164:167], a[4:7]
    buffer_load_dwordx4 v[100:103], v220, s[24:27], s33 offen offset:1024
    v_mfma_f32_16x16x32_bf16 a[36:39], v[68:71], v[168:171], a[36:39]
    buffer_load_dwordx4 v[104:107], v220, s[24:27], s33 offen offset:2048
    v_mfma_f32_16x16x32_bf16 a[68:71], v[68:71], v[172:175], a[68:71]
    buffer_load_dwordx4 v[108:111], v220, s[24:27], s33 offen offset:3072
    v_mfma_f32_16x16x32_bf16 a[100:103], v[68:71], v[176:179], a[100:103]
    buffer_load_dwordx4 v[112:115], v222, s[24:27], s33 offen offset:0
    v_mfma_f32_16x16x32_bf16 a[132:135], v[68:71], v[180:183], a[132:135]
    buffer_load_dwordx4 v[116:119], v222, s[24:27], s33 offen offset:1024
    v_mfma_f32_16x16x32_bf16 a[164:167], v[68:71], v[184:187], a[164:167]
    buffer_load_dwordx4 v[120:123], v222, s[24:27], s33 offen offset:2048
    v_mfma_f32_16x16x32_bf16 a[196:199], v[68:71], v[188:191], a[196:199]
    buffer_load_dwordx4 v[124:127], v222, s[24:27], s33 offen offset:3072
    v_mfma_f32_16x16x32_bf16 a[228:231], v[68:71], v[192:195], a[228:231]
    s_add_u32 s33, s33, 32768
    v_mfma_f32_16x16x32_bf16 v[228:231], v[68:71], v[196:199], v[228:231]
    s_waitcnt vmcnt(16)
    v_mfma_f32_16x16x32_bf16 a[8:11], v[72:75], v[164:167], a[8:11]
    v_perm_b32 v64, v4, v0, s44
    v_mfma_f32_16x16x32_bf16 a[40:43], v[72:75], v[168:171], a[40:43]
    v_perm_b32 v68, v4, v0, s45
    v_mfma_f32_16x16x32_bf16 a[72:75], v[72:75], v[172:175], a[72:75]
    v_perm_b32 v65, v12, v8, s44
    v_mfma_f32_16x16x32_bf16 a[104:107], v[72:75], v[176:179], a[104:107]
    v_perm_b32 v69, v12, v8, s45
    v_mfma_f32_16x16x32_bf16 a[136:139], v[72:75], v[180:183], a[136:139]
    v_perm_b32 v66, v20, v16, s44
    v_mfma_f32_16x16x32_bf16 a[168:171], v[72:75], v[184:187], a[168:171]
    v_perm_b32 v70, v20, v16, s45
    v_mfma_f32_16x16x32_bf16 a[200:203], v[72:75], v[188:191], a[200:203]
    v_perm_b32 v67, v28, v24, s44
    v_mfma_f32_16x16x32_bf16 a[232:235], v[72:75], v[192:195], a[232:235]
    v_perm_b32 v71, v28, v24, s45
    v_mfma_f32_16x16x32_bf16 v[232:235], v[72:75], v[196:199], v[232:235]
    v_mfma_f32_16x16x32_bf16 a[12:15], v[76:79], v[164:167], a[12:15]
    v_mfma_f32_16x16x32_bf16 a[44:47], v[76:79], v[168:171], a[44:47]
    v_mfma_f32_16x16x32_bf16 a[76:79], v[76:79], v[172:175], a[76:79]
    v_mfma_f32_16x16x32_bf16 a[108:111], v[76:79], v[176:179], a[108:111]
    v_mfma_f32_16x16x32_bf16 a[140:143], v[76:79], v[180:183], a[140:143]
    v_mfma_f32_16x16x32_bf16 a[172:175], v[76:79], v[184:187], a[172:175]
    v_mfma_f32_16x16x32_bf16 a[204:207], v[76:79], v[188:191], a[204:207]
    v_mfma_f32_16x16x32_bf16 a[236:239], v[76:79], v[192:195], a[236:239]
    v_mfma_f32_16x16x32_bf16 v[236:239], v[76:79], v[196:199], v[236:239]
    v_mfma_f32_16x16x32_bf16 a[16:19], v[80:83], v[164:167], a[16:19]
    v_perm_b32 v72, v5, v1, s44
    v_mfma_f32_16x16x32_bf16 a[48:51], v[80:83], v[168:171], a[48:51]
    v_perm_b32 v76, v5, v1, s45
    v_mfma_f32_16x16x32_bf16 a[80:83], v[80:83], v[172:175], a[80:83]
    v_perm_b32 v73, v13, v9, s44
    v_mfma_f32_16x16x32_bf16 a[112:115], v[80:83], v[176:179], a[112:115]
    v_perm_b32 v77, v13, v9, s45
    v_mfma_f32_16x16x32_bf16 a[144:147], v[80:83], v[180:183], a[144:147]
    v_perm_b32 v74, v21, v17, s44
    v_mfma_f32_16x16x32_bf16 a[176:179], v[80:83], v[184:187], a[176:179]
    v_perm_b32 v78, v21, v17, s45
    v_mfma_f32_16x16x32_bf16 a[208:211], v[80:83], v[188:191], a[208:211]
    v_perm_b32 v75, v29, v25, s44
    v_mfma_f32_16x16x32_bf16 a[240:243], v[80:83], v[192:195], a[240:243]
    v_perm_b32 v79, v29, v25, s45
    v_mfma_f32_16x16x32_bf16 v[240:243], v[80:83], v[196:199], v[240:243]
    v_mfma_f32_16x16x32_bf16 a[20:23], v[84:87], v[164:167], a[20:23]
    v_mfma_f32_16x16x32_bf16 a[52:55], v[84:87], v[168:171], a[52:55]
    v_mfma_f32_16x16x32_bf16 a[84:87], v[84:87], v[172:175], a[84:87]
    v_mfma_f32_16x16x32_bf16 a[116:119], v[84:87], v[176:179], a[116:119]
    v_mfma_f32_16x16x32_bf16 a[148:151], v[84:87], v[180:183], a[148:151]
    v_mfma_f32_16x16x32_bf16 a[180:183], v[84:87], v[184:187], a[180:183]
    v_mfma_f32_16x16x32_bf16 a[212:215], v[84:87], v[188:191], a[212:215]
    v_mfma_f32_16x16x32_bf16 a[244:247], v[84:87], v[192:195], a[244:247]
    v_mfma_f32_16x16x32_bf16 v[244:247], v[84:87], v[196:199], v[244:247]
    v_mfma_f32_16x16x32_bf16 a[24:27], v[88:91], v[164:167], a[24:27]
    v_perm_b32 v80, v6, v2, s44
    v_mfma_f32_16x16x32_bf16 a[56:59], v[88:91], v[168:171], a[56:59]
    v_perm_b32 v84, v6, v2, s45
    v_mfma_f32_16x16x32_bf16 a[88:91], v[88:91], v[172:175], a[88:91]
    v_perm_b32 v81, v14, v10, s44
    v_mfma_f32_16x16x32_bf16 a[120:123], v[88:91], v[176:179], a[120:123]
    v_perm_b32 v85, v14, v10, s45
    v_mfma_f32_16x16x32_bf16 a[152:155], v[88:91], v[180:183], a[152:155]
    v_perm_b32 v82, v22, v18, s44
    v_mfma_f32_16x16x32_bf16 a[184:187], v[88:91], v[184:187], a[184:187]
    v_perm_b32 v86, v22, v18, s45
    v_mfma_f32_16x16x32_bf16 a[216:219], v[88:91], v[188:191], a[216:219]
    v_perm_b32 v83, v30, v26, s44
    v_mfma_f32_16x16x32_bf16 a[248:251], v[88:91], v[192:195], a[248:251]
    v_perm_b32 v87, v30, v26, s45
    v_mfma_f32_16x16x32_bf16 v[248:251], v[88:91], v[196:199], v[248:251]
    v_mfma_f32_16x16x32_bf16 a[28:31], v[92:95], v[164:167], a[28:31]
    v_mfma_f32_16x16x32_bf16 a[60:63], v[92:95], v[168:171], a[60:63]
    v_mfma_f32_16x16x32_bf16 a[92:95], v[92:95], v[172:175], a[92:95]
    v_mfma_f32_16x16x32_bf16 a[124:127], v[92:95], v[176:179], a[124:127]
    v_mfma_f32_16x16x32_bf16 a[156:159], v[92:95], v[180:183], a[156:159]
    v_mfma_f32_16x16x32_bf16 a[188:191], v[92:95], v[184:187], a[188:191]
    v_mfma_f32_16x16x32_bf16 a[220:223], v[92:95], v[188:191], a[220:223]
    v_mfma_f32_16x16x32_bf16 a[252:255], v[92:95], v[192:195], a[252:255]
    v_mfma_f32_16x16x32_bf16 v[252:255], v[92:95], v[196:199], v[252:255]
    s_waitcnt lgkmcnt(0)
    v_mfma_f32_16x16x32_bf16 a[0:3], v[64:67], v[128:131], a[0:3]
    v_perm_b32 v88, v7, v3, s44
    ds_read_b128 v[164:167], v211 offset:3072
    v_mfma_f32_16x16x32_bf16 a[32:35], v[64:67], v[132:135], a[32:35]
    v_perm_b32 v92, v7, v3, s45
    ds_read_b128 v[168:171], v211 offset:7168
    v_mfma_f32_16x16x32_bf16 a[64:67], v[64:67], v[136:139], a[64:67]
    v_perm_b32 v89, v15, v11, s44
    ds_read_b128 v[172:175], v211 offset:11264
    v_mfma_f32_16x16x32_bf16 a[96:99], v[64:67], v[140:143], a[96:99]
    v_perm_b32 v93, v15, v11, s45
    ds_read_b128 v[176:179], v211 offset:15360
    v_mfma_f32_16x16x32_bf16 a[128:131], v[64:67], v[144:147], a[128:131]
    v_perm_b32 v90, v23, v19, s44
    ds_read_b128 v[180:183], v211 offset:19456
    v_mfma_f32_16x16x32_bf16 a[160:163], v[64:67], v[148:151], a[160:163]
    v_perm_b32 v94, v23, v19, s45
    ds_read_b128 v[184:187], v211 offset:23552
    v_mfma_f32_16x16x32_bf16 a[192:195], v[64:67], v[152:155], a[192:195]
    v_perm_b32 v91, v31, v27, s44
    ds_read_b128 v[188:191], v211 offset:27648
    v_mfma_f32_16x16x32_bf16 a[224:227], v[64:67], v[156:159], a[224:227]
    v_perm_b32 v95, v31, v27, s45
    ds_read_b128 v[192:195], v211 offset:31744
    v_mfma_f32_16x16x32_bf16 v[224:227], v[64:67], v[160:163], v[224:227]
    ds_read_b128 v[196:199], v211 offset:35840
    buffer_load_dwordx4 v[0:3], v220, s[24:27], s33 offen offset:0
    v_mfma_f32_16x16x32_bf16 a[4:7], v[68:71], v[128:131], a[4:7]
    v_add_u32 v211, 36864, v211
    buffer_load_dwordx4 v[4:7], v220, s[24:27], s33 offen offset:1024
    v_mfma_f32_16x16x32_bf16 a[36:39], v[68:71], v[132:135], a[36:39]
    buffer_load_dwordx4 v[8:11], v220, s[24:27], s33 offen offset:2048
    v_mfma_f32_16x16x32_bf16 a[68:71], v[68:71], v[136:139], a[68:71]
    buffer_load_dwordx4 v[12:15], v220, s[24:27], s33 offen offset:3072
    v_mfma_f32_16x16x32_bf16 a[100:103], v[68:71], v[140:143], a[100:103]
    buffer_load_dwordx4 v[16:19], v222, s[24:27], s33 offen offset:0
    v_mfma_f32_16x16x32_bf16 a[132:135], v[68:71], v[144:147], a[132:135]
    buffer_load_dwordx4 v[20:23], v222, s[24:27], s33 offen offset:1024
    v_mfma_f32_16x16x32_bf16 a[164:167], v[68:71], v[148:151], a[164:167]
    buffer_load_dwordx4 v[24:27], v222, s[24:27], s33 offen offset:2048
    v_mfma_f32_16x16x32_bf16 a[196:199], v[68:71], v[152:155], a[196:199]
    buffer_load_dwordx4 v[28:31], v222, s[24:27], s33 offen offset:3072
    v_mfma_f32_16x16x32_bf16 a[228:231], v[68:71], v[156:159], a[228:231]
    s_add_u32 s33, s33, 32768
    v_mfma_f32_16x16x32_bf16 v[228:231], v[68:71], v[160:163], v[228:231]
    s_waitcnt vmcnt(16)
    v_mfma_f32_16x16x32_bf16 a[8:11], v[72:75], v[128:131], a[8:11]
    v_perm_b32 v64, v36, v32, s44
    v_mfma_f32_16x16x32_bf16 a[40:43], v[72:75], v[132:135], a[40:43]
    v_perm_b32 v68, v36, v32, s45
    v_mfma_f32_16x16x32_bf16 a[72:75], v[72:75], v[136:139], a[72:75]
    v_perm_b32 v65, v44, v40, s44
    v_mfma_f32_16x16x32_bf16 a[104:107], v[72:75], v[140:143], a[104:107]
    v_perm_b32 v69, v44, v40, s45
    v_mfma_f32_16x16x32_bf16 a[136:139], v[72:75], v[144:147], a[136:139]
    v_perm_b32 v66, v52, v48, s44
    v_mfma_f32_16x16x32_bf16 a[168:171], v[72:75], v[148:151], a[168:171]
    v_perm_b32 v70, v52, v48, s45
    v_mfma_f32_16x16x32_bf16 a[200:203], v[72:75], v[152:155], a[200:203]
    v_perm_b32 v67, v60, v56, s44
    v_mfma_f32_16x16x32_bf16 a[232:235], v[72:75], v[156:159], a[232:235]
    v_perm_b32 v71, v60, v56, s45
    v_mfma_f32_16x16x32_bf16 v[232:235], v[72:75], v[160:163], v[232:235]
    v_mfma_f32_16x16x32_bf16 a[12:15], v[76:79], v[128:131], a[12:15]
    v_mfma_f32_16x16x32_bf16 a[44:47], v[76:79], v[132:135], a[44:47]
    v_mfma_f32_16x16x32_bf16 a[76:79], v[76:79], v[136:139], a[76:79]
    v_mfma_f32_16x16x32_bf16 a[108:111], v[76:79], v[140:143], a[108:111]
    v_mfma_f32_16x16x32_bf16 a[140:143], v[76:79], v[144:147], a[140:143]
    v_mfma_f32_16x16x32_bf16 a[172:175], v[76:79], v[148:151], a[172:175]
    v_mfma_f32_16x16x32_bf16 a[204:207], v[76:79], v[152:155], a[204:207]
    v_mfma_f32_16x16x32_bf16 a[236:239], v[76:79], v[156:159], a[236:239]
    v_mfma_f32_16x16x32_bf16 v[236:239], v[76:79], v[160:163], v[236:239]
    v_mfma_f32_16x16x32_bf16 a[16:19], v[80:83], v[128:131], a[16:19]
    v_perm_b32 v72, v37, v33, s44
    v_mfma_f32_16x16x32_bf16 a[48:51], v[80:83], v[132:135], a[48:51]
    v_perm_b32 v76, v37, v33, s45
    v_mfma_f32_16x16x32_bf16 a[80:83], v[80:83], v[136:139], a[80:83]
    v_perm_b32 v73, v45, v41, s44
    v_mfma_f32_16x16x32_bf16 a[112:115], v[80:83], v[140:143], a[112:115]
    v_perm_b32 v77, v45, v41, s45
    v_mfma_f32_16x16x32_bf16 a[144:147], v[80:83], v[144:147], a[144:147]
    v_perm_b32 v74, v53, v49, s44
    v_mfma_f32_16x16x32_bf16 a[176:179], v[80:83], v[148:151], a[176:179]
    v_perm_b32 v78, v53, v49, s45
    v_mfma_f32_16x16x32_bf16 a[208:211], v[80:83], v[152:155], a[208:211]
    v_perm_b32 v75, v61, v57, s44
    v_mfma_f32_16x16x32_bf16 a[240:243], v[80:83], v[156:159], a[240:243]
    v_perm_b32 v79, v61, v57, s45
    v_mfma_f32_16x16x32_bf16 v[240:243], v[80:83], v[160:163], v[240:243]
    v_mfma_f32_16x16x32_bf16 a[20:23], v[84:87], v[128:131], a[20:23]
    v_mfma_f32_16x16x32_bf16 a[52:55], v[84:87], v[132:135], a[52:55]
    v_mfma_f32_16x16x32_bf16 a[84:87], v[84:87], v[136:139], a[84:87]
    v_mfma_f32_16x16x32_bf16 a[116:119], v[84:87], v[140:143], a[116:119]
    v_mfma_f32_16x16x32_bf16 a[148:151], v[84:87], v[144:147], a[148:151]
    v_mfma_f32_16x16x32_bf16 a[180:183], v[84:87], v[148:151], a[180:183]
    v_mfma_f32_16x16x32_bf16 a[212:215], v[84:87], v[152:155], a[212:215]
    v_mfma_f32_16x16x32_bf16 a[244:247], v[84:87], v[156:159], a[244:247]
    v_mfma_f32_16x16x32_bf16 v[244:247], v[84:87], v[160:163], v[244:247]
    v_mfma_f32_16x16x32_bf16 a[24:27], v[88:91], v[128:131], a[24:27]
    v_perm_b32 v80, v38, v34, s44
    v_mfma_f32_16x16x32_bf16 a[56:59], v[88:91], v[132:135], a[56:59]
    v_perm_b32 v84, v38, v34, s45
    v_mfma_f32_16x16x32_bf16 a[88:91], v[88:91], v[136:139], a[88:91]
    v_perm_b32 v81, v46, v42, s44
    v_mfma_f32_16x16x32_bf16 a[120:123], v[88:91], v[140:143], a[120:123]
    v_perm_b32 v85, v46, v42, s45
    v_mfma_f32_16x16x32_bf16 a[152:155], v[88:91], v[144:147], a[152:155]
    v_perm_b32 v82, v54, v50, s44
    v_mfma_f32_16x16x32_bf16 a[184:187], v[88:91], v[148:151], a[184:187]
    v_perm_b32 v86, v54, v50, s45
    v_mfma_f32_16x16x32_bf16 a[216:219], v[88:91], v[152:155], a[216:219]
    v_perm_b32 v83, v62, v58, s44
    v_mfma_f32_16x16x32_bf16 a[248:251], v[88:91], v[156:159], a[248:251]
    v_perm_b32 v87, v62, v58, s45
    v_mfma_f32_16x16x32_bf16 v[248:251], v[88:91], v[160:163], v[248:251]
    v_mfma_f32_16x16x32_bf16 a[28:31], v[92:95], v[128:131], a[28:31]
    v_mfma_f32_16x16x32_bf16 a[60:63], v[92:95], v[132:135], a[60:63]
    v_mfma_f32_16x16x32_bf16 a[92:95], v[92:95], v[136:139], a[92:95]
    v_mfma_f32_16x16x32_bf16 a[124:127], v[92:95], v[140:143], a[124:127]
    v_mfma_f32_16x16x32_bf16 a[156:159], v[92:95], v[144:147], a[156:159]
    v_mfma_f32_16x16x32_bf16 a[188:191], v[92:95], v[148:151], a[188:191]
    v_mfma_f32_16x16x32_bf16 a[220:223], v[92:95], v[152:155], a[220:223]
    v_mfma_f32_16x16x32_bf16 a[252:255], v[92:95], v[156:159], a[252:255]
    v_mfma_f32_16x16x32_bf16 v[252:255], v[92:95], v[160:163], v[252:255]
    s_waitcnt lgkmcnt(0)
    v_mfma_f32_16x16x32_bf16 a[0:3], v[64:67], v[164:167], a[0:3]
    v_perm_b32 v88, v39, v35, s44
    ds_read_b128 v[128:131], v211 offset:0
    v_mfma_f32_16x16x32_bf16 a[32:35], v[64:67], v[168:171], a[32:35]
    v_perm_b32 v92, v39, v35, s45
    ds_read_b128 v[132:135], v211 offset:4096
    v_mfma_f32_16x16x32_bf16 a[64:67], v[64:67], v[172:175], a[64:67]
    v_perm_b32 v89, v47, v43, s44
    ds_read_b128 v[136:139], v211 offset:8192
    v_mfma_f32_16x16x32_bf16 a[96:99], v[64:67], v[176:179], a[96:99]
    v_perm_b32 v93, v47, v43, s45
    ds_read_b128 v[140:143], v211 offset:12288
    v_mfma_f32_16x16x32_bf16 a[128:131], v[64:67], v[180:183], a[128:131]
    v_perm_b32 v90, v55, v51, s44
    ds_read_b128 v[144:147], v211 offset:16384
    v_mfma_f32_16x16x32_bf16 a[160:163], v[64:67], v[184:187], a[160:163]
    v_perm_b32 v94, v55, v51, s45
    ds_read_b128 v[148:151], v211 offset:20480
    v_mfma_f32_16x16x32_bf16 a[192:195], v[64:67], v[188:191], a[192:195]
    v_perm_b32 v91, v63, v59, s44
    ds_read_b128 v[152:155], v211 offset:24576
    v_mfma_f32_16x16x32_bf16 a[224:227], v[64:67], v[192:195], a[224:227]
    v_perm_b32 v95, v63, v59, s45
    ds_read_b128 v[156:159], v211 offset:28672
    v_mfma_f32_16x16x32_bf16 v[224:227], v[64:67], v[196:199], v[224:227]
    ds_read_b128 v[160:163], v211 offset:32768
    buffer_load_dwordx4 v[32:35], v220, s[24:27], s33 offen offset:0
    v_mfma_f32_16x16x32_bf16 a[4:7], v[68:71], v[164:167], a[4:7]
    buffer_load_dwordx4 v[36:39], v220, s[24:27], s33 offen offset:1024
    v_mfma_f32_16x16x32_bf16 a[36:39], v[68:71], v[168:171], a[36:39]
    buffer_load_dwordx4 v[40:43], v220, s[24:27], s33 offen offset:2048
    v_mfma_f32_16x16x32_bf16 a[68:71], v[68:71], v[172:175], a[68:71]
    buffer_load_dwordx4 v[44:47], v220, s[24:27], s33 offen offset:3072
    v_mfma_f32_16x16x32_bf16 a[100:103], v[68:71], v[176:179], a[100:103]
    buffer_load_dwordx4 v[48:51], v222, s[24:27], s33 offen offset:0
    v_mfma_f32_16x16x32_bf16 a[132:135], v[68:71], v[180:183], a[132:135]
    buffer_load_dwordx4 v[52:55], v222, s[24:27], s33 offen offset:1024
    v_mfma_f32_16x16x32_bf16 a[164:167], v[68:71], v[184:187], a[164:167]
    buffer_load_dwordx4 v[56:59], v222, s[24:27], s33 offen offset:2048
    v_mfma_f32_16x16x32_bf16 a[196:199], v[68:71], v[188:191], a[196:199]
    buffer_load_dwordx4 v[60:63], v222, s[24:27], s33 offen offset:3072
    v_mfma_f32_16x16x32_bf16 a[228:231], v[68:71], v[192:195], a[228:231]
    s_add_u32 s33, s33, 32768
    v_mfma_f32_16x16x32_bf16 v[228:231], v[68:71], v[196:199], v[228:231]
    s_waitcnt vmcnt(16)
    v_mfma_f32_16x16x32_bf16 a[8:11], v[72:75], v[164:167], a[8:11]
    v_perm_b32 v64, v100, v96, s44
    v_mfma_f32_16x16x32_bf16 a[40:43], v[72:75], v[168:171], a[40:43]
    v_perm_b32 v68, v100, v96, s45
    v_mfma_f32_16x16x32_bf16 a[72:75], v[72:75], v[172:175], a[72:75]
    v_perm_b32 v65, v108, v104, s44
    v_mfma_f32_16x16x32_bf16 a[104:107], v[72:75], v[176:179], a[104:107]
    v_perm_b32 v69, v108, v104, s45
    v_mfma_f32_16x16x32_bf16 a[136:139], v[72:75], v[180:183], a[136:139]
    v_perm_b32 v66, v116, v112, s44
    v_mfma_f32_16x16x32_bf16 a[168:171], v[72:75], v[184:187], a[168:171]
    v_perm_b32 v70, v116, v112, s45
    v_mfma_f32_16x16x32_bf16 a[200:203], v[72:75], v[188:191], a[200:203]
    v_perm_b32 v67, v124, v120, s44
    v_mfma_f32_16x16x32_bf16 a[232:235], v[72:75], v[192:195], a[232:235]
    v_perm_b32 v71, v124, v120, s45
    v_mfma_f32_16x16x32_bf16 v[232:235], v[72:75], v[196:199], v[232:235]
    v_mfma_f32_16x16x32_bf16 a[12:15], v[76:79], v[164:167], a[12:15]
    v_mfma_f32_16x16x32_bf16 a[44:47], v[76:79], v[168:171], a[44:47]
    v_mfma_f32_16x16x32_bf16 a[76:79], v[76:79], v[172:175], a[76:79]
    v_mfma_f32_16x16x32_bf16 a[108:111], v[76:79], v[176:179], a[108:111]
    v_mfma_f32_16x16x32_bf16 a[140:143], v[76:79], v[180:183], a[140:143]
    v_mfma_f32_16x16x32_bf16 a[172:175], v[76:79], v[184:187], a[172:175]
    v_mfma_f32_16x16x32_bf16 a[204:207], v[76:79], v[188:191], a[204:207]
    v_mfma_f32_16x16x32_bf16 a[236:239], v[76:79], v[192:195], a[236:239]
    v_mfma_f32_16x16x32_bf16 v[236:239], v[76:79], v[196:199], v[236:239]
    v_mfma_f32_16x16x32_bf16 a[16:19], v[80:83], v[164:167], a[16:19]
    v_perm_b32 v72, v101, v97, s44
    v_mfma_f32_16x16x32_bf16 a[48:51], v[80:83], v[168:171], a[48:51]
    v_perm_b32 v76, v101, v97, s45
    v_mfma_f32_16x16x32_bf16 a[80:83], v[80:83], v[172:175], a[80:83]
    v_perm_b32 v73, v109, v105, s44
    v_mfma_f32_16x16x32_bf16 a[112:115], v[80:83], v[176:179], a[112:115]
    v_perm_b32 v77, v109, v105, s45
    v_mfma_f32_16x16x32_bf16 a[144:147], v[80:83], v[180:183], a[144:147]
    v_perm_b32 v74, v117, v113, s44
    v_mfma_f32_16x16x32_bf16 a[176:179], v[80:83], v[184:187], a[176:179]
    v_perm_b32 v78, v117, v113, s45
    v_mfma_f32_16x16x32_bf16 a[208:211], v[80:83], v[188:191], a[208:211]
    v_perm_b32 v75, v125, v121, s44
    v_mfma_f32_16x16x32_bf16 a[240:243], v[80:83], v[192:195], a[240:243]
    v_perm_b32 v79, v125, v121, s45
    v_mfma_f32_16x16x32_bf16 v[240:243], v[80:83], v[196:199], v[240:243]
    v_mfma_f32_16x16x32_bf16 a[20:23], v[84:87], v[164:167], a[20:23]
    v_mfma_f32_16x16x32_bf16 a[52:55], v[84:87], v[168:171], a[52:55]
    v_mfma_f32_16x16x32_bf16 a[84:87], v[84:87], v[172:175], a[84:87]
    v_mfma_f32_16x16x32_bf16 a[116:119], v[84:87], v[176:179], a[116:119]
    v_mfma_f32_16x16x32_bf16 a[148:151], v[84:87], v[180:183], a[148:151]
    v_mfma_f32_16x16x32_bf16 a[180:183], v[84:87], v[184:187], a[180:183]
    v_mfma_f32_16x16x32_bf16 a[212:215], v[84:87], v[188:191], a[212:215]
    v_mfma_f32_16x16x32_bf16 a[244:247], v[84:87], v[192:195], a[244:247]
    v_mfma_f32_16x16x32_bf16 v[244:247], v[84:87], v[196:199], v[244:247]
    v_mfma_f32_16x16x32_bf16 a[24:27], v[88:91], v[164:167], a[24:27]
    v_perm_b32 v80, v102, v98, s44
    v_mfma_f32_16x16x32_bf16 a[56:59], v[88:91], v[168:171], a[56:59]
    v_perm_b32 v84, v102, v98, s45
    v_mfma_f32_16x16x32_bf16 a[88:91], v[88:91], v[172:175], a[88:91]
    v_perm_b32 v81, v110, v106, s44
    v_mfma_f32_16x16x32_bf16 a[120:123], v[88:91], v[176:179], a[120:123]
    v_perm_b32 v85, v110, v106, s45
    v_mfma_f32_16x16x32_bf16 a[152:155], v[88:91], v[180:183], a[152:155]
    v_perm_b32 v82, v118, v114, s44
    v_mfma_f32_16x16x32_bf16 a[184:187], v[88:91], v[184:187], a[184:187]
    v_perm_b32 v86, v118, v114, s45
    v_mfma_f32_16x16x32_bf16 a[216:219], v[88:91], v[188:191], a[216:219]
    v_perm_b32 v83, v126, v122, s44
    v_mfma_f32_16x16x32_bf16 a[248:251], v[88:91], v[192:195], a[248:251]
    v_perm_b32 v87, v126, v122, s45
    v_mfma_f32_16x16x32_bf16 v[248:251], v[88:91], v[196:199], v[248:251]
    v_mfma_f32_16x16x32_bf16 a[28:31], v[92:95], v[164:167], a[28:31]
    v_mfma_f32_16x16x32_bf16 a[60:63], v[92:95], v[168:171], a[60:63]
    v_mfma_f32_16x16x32_bf16 a[92:95], v[92:95], v[172:175], a[92:95]
    v_mfma_f32_16x16x32_bf16 a[124:127], v[92:95], v[176:179], a[124:127]
    v_mfma_f32_16x16x32_bf16 a[156:159], v[92:95], v[180:183], a[156:159]
    v_mfma_f32_16x16x32_bf16 a[188:191], v[92:95], v[184:187], a[188:191]
    v_mfma_f32_16x16x32_bf16 a[220:223], v[92:95], v[188:191], a[220:223]
    v_mfma_f32_16x16x32_bf16 a[252:255], v[92:95], v[192:195], a[252:255]
    v_mfma_f32_16x16x32_bf16 v[252:255], v[92:95], v[196:199], v[252:255]
    s_waitcnt lgkmcnt(0)
    v_mfma_f32_16x16x32_bf16 a[0:3], v[64:67], v[128:131], a[0:3]
    v_perm_b32 v88, v103, v99, s44
    ds_read_b128 v[164:167], v211 offset:1024
    v_mfma_f32_16x16x32_bf16 a[32:35], v[64:67], v[132:135], a[32:35]
    v_perm_b32 v92, v103, v99, s45
    ds_read_b128 v[168:171], v211 offset:5120
    v_mfma_f32_16x16x32_bf16 a[64:67], v[64:67], v[136:139], a[64:67]
    v_perm_b32 v89, v111, v107, s44
    ds_read_b128 v[172:175], v211 offset:9216
    v_mfma_f32_16x16x32_bf16 a[96:99], v[64:67], v[140:143], a[96:99]
    v_perm_b32 v93, v111, v107, s45
    ds_read_b128 v[176:179], v211 offset:13312
    v_mfma_f32_16x16x32_bf16 a[128:131], v[64:67], v[144:147], a[128:131]
    v_perm_b32 v90, v119, v115, s44
    ds_read_b128 v[180:183], v211 offset:17408
    v_mfma_f32_16x16x32_bf16 a[160:163], v[64:67], v[148:151], a[160:163]
    v_perm_b32 v94, v119, v115, s45
    ds_read_b128 v[184:187], v211 offset:21504
    v_mfma_f32_16x16x32_bf16 a[192:195], v[64:67], v[152:155], a[192:195]
    v_perm_b32 v91, v127, v123, s44
    ds_read_b128 v[188:191], v211 offset:25600
    v_mfma_f32_16x16x32_bf16 a[224:227], v[64:67], v[156:159], a[224:227]
    v_perm_b32 v95, v127, v123, s45
    ds_read_b128 v[192:195], v211 offset:29696
    v_mfma_f32_16x16x32_bf16 v[224:227], v[64:67], v[160:163], v[224:227]
    ds_read_b128 v[196:199], v211 offset:33792
    buffer_load_dwordx4 v[96:99], v220, s[24:27], s33 offen offset:0
    v_mfma_f32_16x16x32_bf16 a[4:7], v[68:71], v[128:131], a[4:7]
    buffer_load_dwordx4 v[100:103], v220, s[24:27], s33 offen offset:1024
    v_mfma_f32_16x16x32_bf16 a[36:39], v[68:71], v[132:135], a[36:39]
    buffer_load_dwordx4 v[104:107], v220, s[24:27], s33 offen offset:2048
    v_mfma_f32_16x16x32_bf16 a[68:71], v[68:71], v[136:139], a[68:71]
    buffer_load_dwordx4 v[108:111], v220, s[24:27], s33 offen offset:3072
    v_mfma_f32_16x16x32_bf16 a[100:103], v[68:71], v[140:143], a[100:103]
    buffer_load_dwordx4 v[112:115], v222, s[24:27], s33 offen offset:0
    v_mfma_f32_16x16x32_bf16 a[132:135], v[68:71], v[144:147], a[132:135]
    buffer_load_dwordx4 v[116:119], v222, s[24:27], s33 offen offset:1024
    v_mfma_f32_16x16x32_bf16 a[164:167], v[68:71], v[148:151], a[164:167]
    buffer_load_dwordx4 v[120:123], v222, s[24:27], s33 offen offset:2048
    v_mfma_f32_16x16x32_bf16 a[196:199], v[68:71], v[152:155], a[196:199]
    buffer_load_dwordx4 v[124:127], v222, s[24:27], s33 offen offset:3072
    v_mfma_f32_16x16x32_bf16 a[228:231], v[68:71], v[156:159], a[228:231]
    s_add_u32 s33, s33, 32768
    v_mfma_f32_16x16x32_bf16 v[228:231], v[68:71], v[160:163], v[228:231]
    s_waitcnt vmcnt(16)
    v_mfma_f32_16x16x32_bf16 a[8:11], v[72:75], v[128:131], a[8:11]
    v_perm_b32 v64, v4, v0, s44
    v_mfma_f32_16x16x32_bf16 a[40:43], v[72:75], v[132:135], a[40:43]
    v_perm_b32 v68, v4, v0, s45
    v_mfma_f32_16x16x32_bf16 a[72:75], v[72:75], v[136:139], a[72:75]
    v_perm_b32 v65, v12, v8, s44
    v_mfma_f32_16x16x32_bf16 a[104:107], v[72:75], v[140:143], a[104:107]
    v_perm_b32 v69, v12, v8, s45
    v_mfma_f32_16x16x32_bf16 a[136:139], v[72:75], v[144:147], a[136:139]
    v_perm_b32 v66, v20, v16, s44
    v_mfma_f32_16x16x32_bf16 a[168:171], v[72:75], v[148:151], a[168:171]
    v_perm_b32 v70, v20, v16, s45
    v_mfma_f32_16x16x32_bf16 a[200:203], v[72:75], v[152:155], a[200:203]
    v_perm_b32 v67, v28, v24, s44
    v_mfma_f32_16x16x32_bf16 a[232:235], v[72:75], v[156:159], a[232:235]
    v_perm_b32 v71, v28, v24, s45
    v_mfma_f32_16x16x32_bf16 v[232:235], v[72:75], v[160:163], v[232:235]
    v_mfma_f32_16x16x32_bf16 a[12:15], v[76:79], v[128:131], a[12:15]
    v_mfma_f32_16x16x32_bf16 a[44:47], v[76:79], v[132:135], a[44:47]
    v_mfma_f32_16x16x32_bf16 a[76:79], v[76:79], v[136:139], a[76:79]
    v_mfma_f32_16x16x32_bf16 a[108:111], v[76:79], v[140:143], a[108:111]
    v_mfma_f32_16x16x32_bf16 a[140:143], v[76:79], v[144:147], a[140:143]
    v_mfma_f32_16x16x32_bf16 a[172:175], v[76:79], v[148:151], a[172:175]
    v_mfma_f32_16x16x32_bf16 a[204:207], v[76:79], v[152:155], a[204:207]
    v_mfma_f32_16x16x32_bf16 a[236:239], v[76:79], v[156:159], a[236:239]
    v_mfma_f32_16x16x32_bf16 v[236:239], v[76:79], v[160:163], v[236:239]
    v_mfma_f32_16x16x32_bf16 a[16:19], v[80:83], v[128:131], a[16:19]
    v_perm_b32 v72, v5, v1, s44
    v_mfma_f32_16x16x32_bf16 a[48:51], v[80:83], v[132:135], a[48:51]
    v_perm_b32 v76, v5, v1, s45
    v_mfma_f32_16x16x32_bf16 a[80:83], v[80:83], v[136:139], a[80:83]
    v_perm_b32 v73, v13, v9, s44
    v_mfma_f32_16x16x32_bf16 a[112:115], v[80:83], v[140:143], a[112:115]
    v_perm_b32 v77, v13, v9, s45
    v_mfma_f32_16x16x32_bf16 a[144:147], v[80:83], v[144:147], a[144:147]
    v_perm_b32 v74, v21, v17, s44
    v_mfma_f32_16x16x32_bf16 a[176:179], v[80:83], v[148:151], a[176:179]
    v_perm_b32 v78, v21, v17, s45
    v_mfma_f32_16x16x32_bf16 a[208:211], v[80:83], v[152:155], a[208:211]
    v_perm_b32 v75, v29, v25, s44
    v_mfma_f32_16x16x32_bf16 a[240:243], v[80:83], v[156:159], a[240:243]
    v_perm_b32 v79, v29, v25, s45
    v_mfma_f32_16x16x32_bf16 v[240:243], v[80:83], v[160:163], v[240:243]
    v_mfma_f32_16x16x32_bf16 a[20:23], v[84:87], v[128:131], a[20:23]
    v_mfma_f32_16x16x32_bf16 a[52:55], v[84:87], v[132:135], a[52:55]
    v_mfma_f32_16x16x32_bf16 a[84:87], v[84:87], v[136:139], a[84:87]
    v_mfma_f32_16x16x32_bf16 a[116:119], v[84:87], v[140:143], a[116:119]
    v_mfma_f32_16x16x32_bf16 a[148:151], v[84:87], v[144:147], a[148:151]
    v_mfma_f32_16x16x32_bf16 a[180:183], v[84:87], v[148:151], a[180:183]
    v_mfma_f32_16x16x32_bf16 a[212:215], v[84:87], v[152:155], a[212:215]
    v_mfma_f32_16x16x32_bf16 a[244:247], v[84:87], v[156:159], a[244:247]
    v_mfma_f32_16x16x32_bf16 v[244:247], v[84:87], v[160:163], v[244:247]
    v_mfma_f32_16x16x32_bf16 a[24:27], v[88:91], v[128:131], a[24:27]
    v_perm_b32 v80, v6, v2, s44
    v_mfma_f32_16x16x32_bf16 a[56:59], v[88:91], v[132:135], a[56:59]
    v_perm_b32 v84, v6, v2, s45
    v_mfma_f32_16x16x32_bf16 a[88:91], v[88:91], v[136:139], a[88:91]
    v_perm_b32 v81, v14, v10, s44
    v_mfma_f32_16x16x32_bf16 a[120:123], v[88:91], v[140:143], a[120:123]
    v_perm_b32 v85, v14, v10, s45
    v_mfma_f32_16x16x32_bf16 a[152:155], v[88:91], v[144:147], a[152:155]
    v_perm_b32 v82, v22, v18, s44
    v_mfma_f32_16x16x32_bf16 a[184:187], v[88:91], v[148:151], a[184:187]
    v_perm_b32 v86, v22, v18, s45
    v_mfma_f32_16x16x32_bf16 a[216:219], v[88:91], v[152:155], a[216:219]
    v_perm_b32 v83, v30, v26, s44
    v_mfma_f32_16x16x32_bf16 a[248:251], v[88:91], v[156:159], a[248:251]
    v_perm_b32 v87, v30, v26, s45
    v_mfma_f32_16x16x32_bf16 v[248:251], v[88:91], v[160:163], v[248:251]
    v_mfma_f32_16x16x32_bf16 a[28:31], v[92:95], v[128:131], a[28:31]
    v_mfma_f32_16x16x32_bf16 a[60:63], v[92:95], v[132:135], a[60:63]
    v_mfma_f32_16x16x32_bf16 a[92:95], v[92:95], v[136:139], a[92:95]
    v_mfma_f32_16x16x32_bf16 a[124:127], v[92:95], v[140:143], a[124:127]
    v_mfma_f32_16x16x32_bf16 a[156:159], v[92:95], v[144:147], a[156:159]
    v_mfma_f32_16x16x32_bf16 a[188:191], v[92:95], v[148:151], a[188:191]
    v_mfma_f32_16x16x32_bf16 a[220:223], v[92:95], v[152:155], a[220:223]
    v_mfma_f32_16x16x32_bf16 a[252:255], v[92:95], v[156:159], a[252:255]
    v_mfma_f32_16x16x32_bf16 v[252:255], v[92:95], v[160:163], v[252:255]
    s_waitcnt lgkmcnt(0)
    v_mfma_f32_16x16x32_bf16 a[0:3], v[64:67], v[164:167], a[0:3]
    v_perm_b32 v88, v7, v3, s44
    ds_read_b128 v[128:131], v211 offset:2048
    v_mfma_f32_16x16x32_bf16 a[32:35], v[64:67], v[168:171], a[32:35]
    v_perm_b32 v92, v7, v3, s45
    ds_read_b128 v[132:135], v211 offset:6144
    v_mfma_f32_16x16x32_bf16 a[64:67], v[64:67], v[172:175], a[64:67]
    v_perm_b32 v89, v15, v11, s44
    ds_read_b128 v[136:139], v211 offset:10240
    v_mfma_f32_16x16x32_bf16 a[96:99], v[64:67], v[176:179], a[96:99]
    v_perm_b32 v93, v15, v11, s45
    ds_read_b128 v[140:143], v211 offset:14336
    v_mfma_f32_16x16x32_bf16 a[128:131], v[64:67], v[180:183], a[128:131]
    v_perm_b32 v90, v23, v19, s44
    ds_read_b128 v[144:147], v211 offset:18432
    v_mfma_f32_16x16x32_bf16 a[160:163], v[64:67], v[184:187], a[160:163]
    v_perm_b32 v94, v23, v19, s45
    ds_read_b128 v[148:151], v211 offset:22528
    v_mfma_f32_16x16x32_bf16 a[192:195], v[64:67], v[188:191], a[192:195]
    v_perm_b32 v91, v31, v27, s44
    ds_read_b128 v[152:155], v211 offset:26624
    v_mfma_f32_16x16x32_bf16 a[224:227], v[64:67], v[192:195], a[224:227]
    v_perm_b32 v95, v31, v27, s45
    ds_read_b128 v[156:159], v211 offset:30720
    v_mfma_f32_16x16x32_bf16 v[224:227], v[64:67], v[196:199], v[224:227]
    ds_read_b128 v[160:163], v211 offset:34816
    v_mfma_f32_16x16x32_bf16 a[4:7], v[68:71], v[164:167], a[4:7]
    v_mfma_f32_16x16x32_bf16 a[36:39], v[68:71], v[168:171], a[36:39]
    v_mfma_f32_16x16x32_bf16 a[68:71], v[68:71], v[172:175], a[68:71]
    v_mfma_f32_16x16x32_bf16 a[100:103], v[68:71], v[176:179], a[100:103]
    v_mfma_f32_16x16x32_bf16 a[132:135], v[68:71], v[180:183], a[132:135]
    v_mfma_f32_16x16x32_bf16 a[164:167], v[68:71], v[184:187], a[164:167]
    v_mfma_f32_16x16x32_bf16 a[196:199], v[68:71], v[188:191], a[196:199]
    v_mfma_f32_16x16x32_bf16 a[228:231], v[68:71], v[192:195], a[228:231]
    v_mfma_f32_16x16x32_bf16 v[228:231], v[68:71], v[196:199], v[228:231]
    s_waitcnt vmcnt(8)
    v_mfma_f32_16x16x32_bf16 a[8:11], v[72:75], v[164:167], a[8:11]
    v_perm_b32 v64, v36, v32, s44
    v_mfma_f32_16x16x32_bf16 a[40:43], v[72:75], v[168:171], a[40:43]
    v_perm_b32 v68, v36, v32, s45
    v_mfma_f32_16x16x32_bf16 a[72:75], v[72:75], v[172:175], a[72:75]
    v_perm_b32 v65, v44, v40, s44
    v_mfma_f32_16x16x32_bf16 a[104:107], v[72:75], v[176:179], a[104:107]
    v_perm_b32 v69, v44, v40, s45
    v_mfma_f32_16x16x32_bf16 a[136:139], v[72:75], v[180:183], a[136:139]
    v_perm_b32 v66, v52, v48, s44
    v_mfma_f32_16x16x32_bf16 a[168:171], v[72:75], v[184:187], a[168:171]
    v_perm_b32 v70, v52, v48, s45
    v_mfma_f32_16x16x32_bf16 a[200:203], v[72:75], v[188:191], a[200:203]
    v_perm_b32 v67, v60, v56, s44
    v_mfma_f32_16x16x32_bf16 a[232:235], v[72:75], v[192:195], a[232:235]
    v_perm_b32 v71, v60, v56, s45
    v_mfma_f32_16x16x32_bf16 v[232:235], v[72:75], v[196:199], v[232:235]
    v_mfma_f32_16x16x32_bf16 a[12:15], v[76:79], v[164:167], a[12:15]
    v_mfma_f32_16x16x32_bf16 a[44:47], v[76:79], v[168:171], a[44:47]
    v_mfma_f32_16x16x32_bf16 a[76:79], v[76:79], v[172:175], a[76:79]
    v_mfma_f32_16x16x32_bf16 a[108:111], v[76:79], v[176:179], a[108:111]
    v_mfma_f32_16x16x32_bf16 a[140:143], v[76:79], v[180:183], a[140:143]
    v_mfma_f32_16x16x32_bf16 a[172:175], v[76:79], v[184:187], a[172:175]
    v_mfma_f32_16x16x32_bf16 a[204:207], v[76:79], v[188:191], a[204:207]
    v_mfma_f32_16x16x32_bf16 a[236:239], v[76:79], v[192:195], a[236:239]
    v_mfma_f32_16x16x32_bf16 v[236:239], v[76:79], v[196:199], v[236:239]
    v_mfma_f32_16x16x32_bf16 a[16:19], v[80:83], v[164:167], a[16:19]
    v_perm_b32 v72, v37, v33, s44
    v_mfma_f32_16x16x32_bf16 a[48:51], v[80:83], v[168:171], a[48:51]
    v_perm_b32 v76, v37, v33, s45
    v_mfma_f32_16x16x32_bf16 a[80:83], v[80:83], v[172:175], a[80:83]
    v_perm_b32 v73, v45, v41, s44
    v_mfma_f32_16x16x32_bf16 a[112:115], v[80:83], v[176:179], a[112:115]
    v_perm_b32 v77, v45, v41, s45
    v_mfma_f32_16x16x32_bf16 a[144:147], v[80:83], v[180:183], a[144:147]
    v_perm_b32 v74, v53, v49, s44
    v_mfma_f32_16x16x32_bf16 a[176:179], v[80:83], v[184:187], a[176:179]
    v_perm_b32 v78, v53, v49, s45
    v_mfma_f32_16x16x32_bf16 a[208:211], v[80:83], v[188:191], a[208:211]
    v_perm_b32 v75, v61, v57, s44
    v_mfma_f32_16x16x32_bf16 a[240:243], v[80:83], v[192:195], a[240:243]
    v_perm_b32 v79, v61, v57, s45
    v_mfma_f32_16x16x32_bf16 v[240:243], v[80:83], v[196:199], v[240:243]
    v_mfma_f32_16x16x32_bf16 a[20:23], v[84:87], v[164:167], a[20:23]
    v_mfma_f32_16x16x32_bf16 a[52:55], v[84:87], v[168:171], a[52:55]
    v_mfma_f32_16x16x32_bf16 a[84:87], v[84:87], v[172:175], a[84:87]
    v_mfma_f32_16x16x32_bf16 a[116:119], v[84:87], v[176:179], a[116:119]
    v_mfma_f32_16x16x32_bf16 a[148:151], v[84:87], v[180:183], a[148:151]
    v_mfma_f32_16x16x32_bf16 a[180:183], v[84:87], v[184:187], a[180:183]
    v_mfma_f32_16x16x32_bf16 a[212:215], v[84:87], v[188:191], a[212:215]
    v_mfma_f32_16x16x32_bf16 a[244:247], v[84:87], v[192:195], a[244:247]
    v_mfma_f32_16x16x32_bf16 v[244:247], v[84:87], v[196:199], v[244:247]
    v_mfma_f32_16x16x32_bf16 a[24:27], v[88:91], v[164:167], a[24:27]
    v_perm_b32 v80, v38, v34, s44
    v_mfma_f32_16x16x32_bf16 a[56:59], v[88:91], v[168:171], a[56:59]
    v_perm_b32 v84, v38, v34, s45
    v_mfma_f32_16x16x32_bf16 a[88:91], v[88:91], v[172:175], a[88:91]
    v_perm_b32 v81, v46, v42, s44
    v_mfma_f32_16x16x32_bf16 a[120:123], v[88:91], v[176:179], a[120:123]
    v_perm_b32 v85, v46, v42, s45
    v_mfma_f32_16x16x32_bf16 a[152:155], v[88:91], v[180:183], a[152:155]
    v_perm_b32 v82, v54, v50, s44
    v_mfma_f32_16x16x32_bf16 a[184:187], v[88:91], v[184:187], a[184:187]
    v_perm_b32 v86, v54, v50, s45
    v_mfma_f32_16x16x32_bf16 a[216:219], v[88:91], v[188:191], a[216:219]
    v_perm_b32 v83, v62, v58, s44
    v_mfma_f32_16x16x32_bf16 a[248:251], v[88:91], v[192:195], a[248:251]
    v_perm_b32 v87, v62, v58, s45
    v_mfma_f32_16x16x32_bf16 v[248:251], v[88:91], v[196:199], v[248:251]
    v_mfma_f32_16x16x32_bf16 a[28:31], v[92:95], v[164:167], a[28:31]
    v_mfma_f32_16x16x32_bf16 a[60:63], v[92:95], v[168:171], a[60:63]
    v_mfma_f32_16x16x32_bf16 a[92:95], v[92:95], v[172:175], a[92:95]
    v_mfma_f32_16x16x32_bf16 a[124:127], v[92:95], v[176:179], a[124:127]
    v_mfma_f32_16x16x32_bf16 a[156:159], v[92:95], v[180:183], a[156:159]
    v_mfma_f32_16x16x32_bf16 a[188:191], v[92:95], v[184:187], a[188:191]
    v_mfma_f32_16x16x32_bf16 a[220:223], v[92:95], v[188:191], a[220:223]
    v_mfma_f32_16x16x32_bf16 a[252:255], v[92:95], v[192:195], a[252:255]
    v_mfma_f32_16x16x32_bf16 v[252:255], v[92:95], v[196:199], v[252:255]
    s_waitcnt lgkmcnt(0)
    v_mfma_f32_16x16x32_bf16 a[0:3], v[64:67], v[128:131], a[0:3]
    v_perm_b32 v88, v39, v35, s44
    ds_read_b128 v[164:167], v211 offset:3072
    v_mfma_f32_16x16x32_bf16 a[32:35], v[64:67], v[132:135], a[32:35]
    v_perm_b32 v92, v39, v35, s45
    ds_read_b128 v[168:171], v211 offset:7168
    v_mfma_f32_16x16x32_bf16 a[64:67], v[64:67], v[136:139], a[64:67]
    v_perm_b32 v89, v47, v43, s44
    ds_read_b128 v[172:175], v211 offset:11264
    v_mfma_f32_16x16x32_bf16 a[96:99], v[64:67], v[140:143], a[96:99]
    v_perm_b32 v93, v47, v43, s45
    ds_read_b128 v[176:179], v211 offset:15360
    v_mfma_f32_16x16x32_bf16 a[128:131], v[64:67], v[144:147], a[128:131]
    v_perm_b32 v90, v55, v51, s44
    ds_read_b128 v[180:183], v211 offset:19456
    v_mfma_f32_16x16x32_bf16 a[160:163], v[64:67], v[148:151], a[160:163]
    v_perm_b32 v94, v55, v51, s45
    ds_read_b128 v[184:187], v211 offset:23552
    v_mfma_f32_16x16x32_bf16 a[192:195], v[64:67], v[152:155], a[192:195]
    v_perm_b32 v91, v63, v59, s44
    ds_read_b128 v[188:191], v211 offset:27648
    v_mfma_f32_16x16x32_bf16 a[224:227], v[64:67], v[156:159], a[224:227]
    v_perm_b32 v95, v63, v59, s45
    ds_read_b128 v[192:195], v211 offset:31744
    v_mfma_f32_16x16x32_bf16 v[224:227], v[64:67], v[160:163], v[224:227]
    ds_read_b128 v[196:199], v211 offset:35840
    v_mfma_f32_16x16x32_bf16 a[4:7], v[68:71], v[128:131], a[4:7]
    v_add_u32 v211, 36864, v211
    v_mfma_f32_16x16x32_bf16 a[36:39], v[68:71], v[132:135], a[36:39]
    v_mfma_f32_16x16x32_bf16 a[68:71], v[68:71], v[136:139], a[68:71]
    v_mfma_f32_16x16x32_bf16 a[100:103], v[68:71], v[140:143], a[100:103]
    v_mfma_f32_16x16x32_bf16 a[132:135], v[68:71], v[144:147], a[132:135]
    v_mfma_f32_16x16x32_bf16 a[164:167], v[68:71], v[148:151], a[164:167]
    v_mfma_f32_16x16x32_bf16 a[196:199], v[68:71], v[152:155], a[196:199]
    v_mfma_f32_16x16x32_bf16 a[228:231], v[68:71], v[156:159], a[228:231]
    v_mfma_f32_16x16x32_bf16 v[228:231], v[68:71], v[160:163], v[228:231]
    s_waitcnt vmcnt(0)
    v_mfma_f32_16x16x32_bf16 a[8:11], v[72:75], v[128:131], a[8:11]
    v_perm_b32 v64, v100, v96, s44
    v_mfma_f32_16x16x32_bf16 a[40:43], v[72:75], v[132:135], a[40:43]
    v_perm_b32 v68, v100, v96, s45
    v_mfma_f32_16x16x32_bf16 a[72:75], v[72:75], v[136:139], a[72:75]
    v_perm_b32 v65, v108, v104, s44
    v_mfma_f32_16x16x32_bf16 a[104:107], v[72:75], v[140:143], a[104:107]
    v_perm_b32 v69, v108, v104, s45
    v_mfma_f32_16x16x32_bf16 a[136:139], v[72:75], v[144:147], a[136:139]
    v_perm_b32 v66, v116, v112, s44
    v_mfma_f32_16x16x32_bf16 a[168:171], v[72:75], v[148:151], a[168:171]
    v_perm_b32 v70, v116, v112, s45
    v_mfma_f32_16x16x32_bf16 a[200:203], v[72:75], v[152:155], a[200:203]
    v_perm_b32 v67, v124, v120, s44
    v_mfma_f32_16x16x32_bf16 a[232:235], v[72:75], v[156:159], a[232:235]
    v_perm_b32 v71, v124, v120, s45
    v_mfma_f32_16x16x32_bf16 v[232:235], v[72:75], v[160:163], v[232:235]
    v_mfma_f32_16x16x32_bf16 a[12:15], v[76:79], v[128:131], a[12:15]
    v_mfma_f32_16x16x32_bf16 a[44:47], v[76:79], v[132:135], a[44:47]
    v_mfma_f32_16x16x32_bf16 a[76:79], v[76:79], v[136:139], a[76:79]
    v_mfma_f32_16x16x32_bf16 a[108:111], v[76:79], v[140:143], a[108:111]
    v_mfma_f32_16x16x32_bf16 a[140:143], v[76:79], v[144:147], a[140:143]
    v_mfma_f32_16x16x32_bf16 a[172:175], v[76:79], v[148:151], a[172:175]
    v_mfma_f32_16x16x32_bf16 a[204:207], v[76:79], v[152:155], a[204:207]
    v_mfma_f32_16x16x32_bf16 a[236:239], v[76:79], v[156:159], a[236:239]
    v_mfma_f32_16x16x32_bf16 v[236:239], v[76:79], v[160:163], v[236:239]
    v_mfma_f32_16x16x32_bf16 a[16:19], v[80:83], v[128:131], a[16:19]
    v_perm_b32 v72, v101, v97, s44
    v_mfma_f32_16x16x32_bf16 a[48:51], v[80:83], v[132:135], a[48:51]
    v_perm_b32 v76, v101, v97, s45
    v_mfma_f32_16x16x32_bf16 a[80:83], v[80:83], v[136:139], a[80:83]
    v_perm_b32 v73, v109, v105, s44
    v_mfma_f32_16x16x32_bf16 a[112:115], v[80:83], v[140:143], a[112:115]
    v_perm_b32 v77, v109, v105, s45
    v_mfma_f32_16x16x32_bf16 a[144:147], v[80:83], v[144:147], a[144:147]
    v_perm_b32 v74, v117, v113, s44
    v_mfma_f32_16x16x32_bf16 a[176:179], v[80:83], v[148:151], a[176:179]
    v_perm_b32 v78, v117, v113, s45
    v_mfma_f32_16x16x32_bf16 a[208:211], v[80:83], v[152:155], a[208:211]
    v_perm_b32 v75, v125, v121, s44
    v_mfma_f32_16x16x32_bf16 a[240:243], v[80:83], v[156:159], a[240:243]
    v_perm_b32 v79, v125, v121, s45
    v_mfma_f32_16x16x32_bf16 v[240:243], v[80:83], v[160:163], v[240:243]
    v_mfma_f32_16x16x32_bf16 a[20:23], v[84:87], v[128:131], a[20:23]
    v_mfma_f32_16x16x32_bf16 a[52:55], v[84:87], v[132:135], a[52:55]
    v_mfma_f32_16x16x32_bf16 a[84:87], v[84:87], v[136:139], a[84:87]
    v_mfma_f32_16x16x32_bf16 a[116:119], v[84:87], v[140:143], a[116:119]
    v_mfma_f32_16x16x32_bf16 a[148:151], v[84:87], v[144:147], a[148:151]
    v_mfma_f32_16x16x32_bf16 a[180:183], v[84:87], v[148:151], a[180:183]
    v_mfma_f32_16x16x32_bf16 a[212:215], v[84:87], v[152:155], a[212:215]
    v_mfma_f32_16x16x32_bf16 a[244:247], v[84:87], v[156:159], a[244:247]
    v_mfma_f32_16x16x32_bf16 v[244:247], v[84:87], v[160:163], v[244:247]
    v_mfma_f32_16x16x32_bf16 a[24:27], v[88:91], v[128:131], a[24:27]
    v_perm_b32 v80, v102, v98, s44
    v_mfma_f32_16x16x32_bf16 a[56:59], v[88:91], v[132:135], a[56:59]
    v_perm_b32 v84, v102, v98, s45
    v_mfma_f32_16x16x32_bf16 a[88:91], v[88:91], v[136:139], a[88:91]
    v_perm_b32 v81, v110, v106, s44
    v_mfma_f32_16x16x32_bf16 a[120:123], v[88:91], v[140:143], a[120:123]
    v_perm_b32 v85, v110, v106, s45
    v_mfma_f32_16x16x32_bf16 a[152:155], v[88:91], v[144:147], a[152:155]
    v_perm_b32 v82, v118, v114, s44
    v_mfma_f32_16x16x32_bf16 a[184:187], v[88:91], v[148:151], a[184:187]
    v_perm_b32 v86, v118, v114, s45
    v_mfma_f32_16x16x32_bf16 a[216:219], v[88:91], v[152:155], a[216:219]
    v_perm_b32 v83, v126, v122, s44
    v_mfma_f32_16x16x32_bf16 a[248:251], v[88:91], v[156:159], a[248:251]
    v_perm_b32 v87, v126, v122, s45
    v_mfma_f32_16x16x32_bf16 v[248:251], v[88:91], v[160:163], v[248:251]
    v_mfma_f32_16x16x32_bf16 a[28:31], v[92:95], v[128:131], a[28:31]
    v_mfma_f32_16x16x32_bf16 a[60:63], v[92:95], v[132:135], a[60:63]
    v_mfma_f32_16x16x32_bf16 a[92:95], v[92:95], v[136:139], a[92:95]
    v_mfma_f32_16x16x32_bf16 a[124:127], v[92:95], v[140:143], a[124:127]
    v_mfma_f32_16x16x32_bf16 a[156:159], v[92:95], v[144:147], a[156:159]
    v_mfma_f32_16x16x32_bf16 a[188:191], v[92:95], v[148:151], a[188:191]
    v_mfma_f32_16x16x32_bf16 a[220:223], v[92:95], v[152:155], a[220:223]
    v_mfma_f32_16x16x32_bf16 a[252:255], v[92:95], v[156:159], a[252:255]
    v_mfma_f32_16x16x32_bf16 v[252:255], v[92:95], v[160:163], v[252:255]
    s_waitcnt lgkmcnt(0)
    v_perm_b32 v88, v103, v99, s44
    v_perm_b32 v92, v103, v99, s45
    v_mfma_f32_16x16x32_bf16 a[0:3], v[64:67], v[164:167], a[0:3]
    v_perm_b32 v89, v111, v107, s44
    v_perm_b32 v93, v111, v107, s45
    v_mfma_f32_16x16x32_bf16 a[4:7], v[68:71], v[164:167], a[4:7]
    v_perm_b32 v90, v119, v115, s44
    v_perm_b32 v94, v119, v115, s45
    v_mfma_f32_16x16x32_bf16 a[8:11], v[72:75], v[164:167], a[8:11]
    v_perm_b32 v91, v127, v123, s44
    v_perm_b32 v95, v127, v123, s45
    v_mfma_f32_16x16x32_bf16 a[12:15], v[76:79], v[164:167], a[12:15]
    v_mfma_f32_16x16x32_bf16 a[16:19], v[80:83], v[164:167], a[16:19]
    v_mfma_f32_16x16x32_bf16 a[20:23], v[84:87], v[164:167], a[20:23]
    v_mfma_f32_16x16x32_bf16 a[24:27], v[88:91], v[164:167], a[24:27]
    v_mfma_f32_16x16x32_bf16 a[28:31], v[92:95], v[164:167], a[28:31]
    v_mfma_f32_16x16x32_bf16 a[32:35], v[64:67], v[168:171], a[32:35]
    v_mfma_f32_16x16x32_bf16 a[36:39], v[68:71], v[168:171], a[36:39]
    v_accvgpr_read_b32 v96, a0
    v_accvgpr_read_b32 v97, a4
    v_accvgpr_read_b32 v98, a8
    v_accvgpr_read_b32 v99, a12
    v_accvgpr_read_b32 v100, a16
    v_accvgpr_read_b32 v101, a20
    v_accvgpr_read_b32 v102, a24
    v_mfma_f32_16x16x32_bf16 a[40:43], v[72:75], v[168:171], a[40:43]
    v_accvgpr_read_b32 v103, a28
    v_cvt_pk_bf16_f32 v104, v96, v97
    v_cvt_pk_bf16_f32 v105, v98, v99
    v_cvt_pk_bf16_f32 v106, v100, v101
    v_cvt_pk_bf16_f32 v107, v102, v103
    s_mov_b32 s56, 0
    buffer_store_dwordx4 v[104:107], v219, s[28:31], s56 offen sc1
    v_mfma_f32_16x16x32_bf16 a[44:47], v[76:79], v[168:171], a[44:47]
    v_accvgpr_read_b32 v108, a1
    v_accvgpr_read_b32 v109, a5
    v_accvgpr_read_b32 v110, a9
    v_accvgpr_read_b32 v111, a13
    v_accvgpr_read_b32 v112, a17
    v_accvgpr_read_b32 v113, a21
    v_accvgpr_read_b32 v114, a25
    v_mfma_f32_16x16x32_bf16 a[48:51], v[80:83], v[168:171], a[48:51]
    v_accvgpr_read_b32 v115, a29
    v_cvt_pk_bf16_f32 v116, v108, v109
    v_cvt_pk_bf16_f32 v117, v110, v111
    v_cvt_pk_bf16_f32 v118, v112, v113
    v_cvt_pk_bf16_f32 v119, v114, v115
    s_mov_b32 s56, 9216
    buffer_store_dwordx4 v[116:119], v219, s[28:31], s56 offen sc1
    v_mfma_f32_16x16x32_bf16 a[52:55], v[84:87], v[168:171], a[52:55]
    v_accvgpr_read_b32 v0, a2
    v_accvgpr_read_b32 v1, a6
    v_accvgpr_read_b32 v2, a10
    v_accvgpr_read_b32 v3, a14
    v_accvgpr_read_b32 v4, a18
    v_accvgpr_read_b32 v5, a22
    v_accvgpr_read_b32 v6, a26
    v_mfma_f32_16x16x32_bf16 a[56:59], v[88:91], v[168:171], a[56:59]
    v_accvgpr_read_b32 v7, a30
    v_cvt_pk_bf16_f32 v8, v0, v1
    v_cvt_pk_bf16_f32 v9, v2, v3
    v_cvt_pk_bf16_f32 v10, v4, v5
    v_cvt_pk_bf16_f32 v11, v6, v7
    s_mov_b32 s56, 18432
    buffer_store_dwordx4 v[8:11], v219, s[28:31], s56 offen sc1
    v_mfma_f32_16x16x32_bf16 a[60:63], v[92:95], v[168:171], a[60:63]
    v_accvgpr_read_b32 v12, a3
    v_accvgpr_read_b32 v13, a7
    v_accvgpr_read_b32 v14, a11
    v_accvgpr_read_b32 v15, a15
    v_accvgpr_read_b32 v16, a19
    v_accvgpr_read_b32 v17, a23
    v_accvgpr_read_b32 v18, a27
    v_mfma_f32_16x16x32_bf16 a[64:67], v[64:67], v[172:175], a[64:67]
    v_accvgpr_read_b32 v19, a31
    v_cvt_pk_bf16_f32 v20, v12, v13
    v_cvt_pk_bf16_f32 v21, v14, v15
    v_cvt_pk_bf16_f32 v22, v16, v17
    v_cvt_pk_bf16_f32 v23, v18, v19
    s_mov_b32 s56, 27648
    buffer_store_dwordx4 v[20:23], v219, s[28:31], s56 offen sc1
    v_mfma_f32_16x16x32_bf16 a[68:71], v[68:71], v[172:175], a[68:71]
    v_accvgpr_read_b32 v128, a32
    v_accvgpr_read_b32 v129, a36
    v_accvgpr_read_b32 v130, a40
    v_accvgpr_read_b32 v131, a44
    v_accvgpr_read_b32 v132, a48
    v_accvgpr_read_b32 v133, a52
    v_accvgpr_read_b32 v134, a56
    v_mfma_f32_16x16x32_bf16 a[72:75], v[72:75], v[172:175], a[72:75]
    v_accvgpr_read_b32 v135, a60
    v_cvt_pk_bf16_f32 v136, v128, v129
    v_cvt_pk_bf16_f32 v137, v130, v131
    v_cvt_pk_bf16_f32 v138, v132, v133
    v_cvt_pk_bf16_f32 v139, v134, v135
    s_mov_b32 s56, 1024
    buffer_store_dwordx4 v[136:139], v219, s[28:31], s56 offen sc1
    v_mfma_f32_16x16x32_bf16 a[76:79], v[76:79], v[172:175], a[76:79]
    v_accvgpr_read_b32 v140, a33
    v_accvgpr_read_b32 v141, a37
    v_accvgpr_read_b32 v142, a41
    v_accvgpr_read_b32 v143, a45
    v_accvgpr_read_b32 v144, a49
    v_accvgpr_read_b32 v145, a53
    v_accvgpr_read_b32 v146, a57
    v_mfma_f32_16x16x32_bf16 a[80:83], v[80:83], v[172:175], a[80:83]
    v_accvgpr_read_b32 v147, a61
    v_cvt_pk_bf16_f32 v148, v140, v141
    v_cvt_pk_bf16_f32 v149, v142, v143
    v_cvt_pk_bf16_f32 v150, v144, v145
    v_cvt_pk_bf16_f32 v151, v146, v147
    s_mov_b32 s56, 10240
    buffer_store_dwordx4 v[148:151], v219, s[28:31], s56 offen sc1
    v_mfma_f32_16x16x32_bf16 a[84:87], v[84:87], v[172:175], a[84:87]
    v_accvgpr_read_b32 v96, a34
    v_accvgpr_read_b32 v97, a38
    v_accvgpr_read_b32 v98, a42
    v_accvgpr_read_b32 v99, a46
    v_accvgpr_read_b32 v100, a50
    v_accvgpr_read_b32 v101, a54
    v_accvgpr_read_b32 v102, a58
    v_mfma_f32_16x16x32_bf16 a[88:91], v[88:91], v[172:175], a[88:91]
    v_accvgpr_read_b32 v103, a62
    v_cvt_pk_bf16_f32 v104, v96, v97
    v_cvt_pk_bf16_f32 v105, v98, v99
    v_cvt_pk_bf16_f32 v106, v100, v101
    v_cvt_pk_bf16_f32 v107, v102, v103
    s_mov_b32 s56, 19456
    buffer_store_dwordx4 v[104:107], v219, s[28:31], s56 offen sc1
    v_mfma_f32_16x16x32_bf16 a[92:95], v[92:95], v[172:175], a[92:95]
    v_accvgpr_read_b32 v108, a35
    v_accvgpr_read_b32 v109, a39
    v_accvgpr_read_b32 v110, a43
    v_accvgpr_read_b32 v111, a47
    v_accvgpr_read_b32 v112, a51
    v_accvgpr_read_b32 v113, a55
    v_accvgpr_read_b32 v114, a59
    v_mfma_f32_16x16x32_bf16 a[96:99], v[64:67], v[176:179], a[96:99]
    v_accvgpr_read_b32 v115, a63
    v_cvt_pk_bf16_f32 v116, v108, v109
    v_cvt_pk_bf16_f32 v117, v110, v111
    v_cvt_pk_bf16_f32 v118, v112, v113
    v_cvt_pk_bf16_f32 v119, v114, v115
    s_mov_b32 s56, 28672
    buffer_store_dwordx4 v[116:119], v219, s[28:31], s56 offen sc1
    v_mfma_f32_16x16x32_bf16 a[100:103], v[68:71], v[176:179], a[100:103]
    v_accvgpr_read_b32 v0, a64
    v_accvgpr_read_b32 v1, a68
    v_accvgpr_read_b32 v2, a72
    v_accvgpr_read_b32 v3, a76
    v_accvgpr_read_b32 v4, a80
    v_accvgpr_read_b32 v5, a84
    v_accvgpr_read_b32 v6, a88
    v_mfma_f32_16x16x32_bf16 a[104:107], v[72:75], v[176:179], a[104:107]
    v_accvgpr_read_b32 v7, a92
    v_cvt_pk_bf16_f32 v8, v0, v1
    v_cvt_pk_bf16_f32 v9, v2, v3
    v_cvt_pk_bf16_f32 v10, v4, v5
    v_cvt_pk_bf16_f32 v11, v6, v7
    s_mov_b32 s56, 2048
    buffer_store_dwordx4 v[8:11], v219, s[28:31], s56 offen sc1
    v_mfma_f32_16x16x32_bf16 a[108:111], v[76:79], v[176:179], a[108:111]
    v_accvgpr_read_b32 v12, a65
    v_accvgpr_read_b32 v13, a69
    v_accvgpr_read_b32 v14, a73
    v_accvgpr_read_b32 v15, a77
    v_accvgpr_read_b32 v16, a81
    v_accvgpr_read_b32 v17, a85
    v_accvgpr_read_b32 v18, a89
    v_mfma_f32_16x16x32_bf16 a[112:115], v[80:83], v[176:179], a[112:115]
    v_accvgpr_read_b32 v19, a93
    v_cvt_pk_bf16_f32 v20, v12, v13
    v_cvt_pk_bf16_f32 v21, v14, v15
    v_cvt_pk_bf16_f32 v22, v16, v17
    v_cvt_pk_bf16_f32 v23, v18, v19
    s_mov_b32 s56, 11264
    buffer_store_dwordx4 v[20:23], v219, s[28:31], s56 offen sc1
    v_mfma_f32_16x16x32_bf16 a[116:119], v[84:87], v[176:179], a[116:119]
    v_accvgpr_read_b32 v128, a66
    v_accvgpr_read_b32 v129, a70
    v_accvgpr_read_b32 v130, a74
    v_accvgpr_read_b32 v131, a78
    v_accvgpr_read_b32 v132, a82
    v_accvgpr_read_b32 v133, a86
    v_accvgpr_read_b32 v134, a90
    v_mfma_f32_16x16x32_bf16 a[120:123], v[88:91], v[176:179], a[120:123]
    v_accvgpr_read_b32 v135, a94
    v_cvt_pk_bf16_f32 v136, v128, v129
    v_cvt_pk_bf16_f32 v137, v130, v131
    v_cvt_pk_bf16_f32 v138, v132, v133
    v_cvt_pk_bf16_f32 v139, v134, v135
    s_mov_b32 s56, 20480
    buffer_store_dwordx4 v[136:139], v219, s[28:31], s56 offen sc1
    v_mfma_f32_16x16x32_bf16 a[124:127], v[92:95], v[176:179], a[124:127]
    v_accvgpr_read_b32 v140, a67
    v_accvgpr_read_b32 v141, a71
    v_accvgpr_read_b32 v142, a75
    v_accvgpr_read_b32 v143, a79
    v_accvgpr_read_b32 v144, a83
    v_accvgpr_read_b32 v145, a87
    v_accvgpr_read_b32 v146, a91
    v_mfma_f32_16x16x32_bf16 a[128:131], v[64:67], v[180:183], a[128:131]
    v_accvgpr_read_b32 v147, a95
    v_cvt_pk_bf16_f32 v148, v140, v141
    v_cvt_pk_bf16_f32 v149, v142, v143
    v_cvt_pk_bf16_f32 v150, v144, v145
    v_cvt_pk_bf16_f32 v151, v146, v147
    s_mov_b32 s56, 29696
    buffer_store_dwordx4 v[148:151], v219, s[28:31], s56 offen sc1
    v_mfma_f32_16x16x32_bf16 a[132:135], v[68:71], v[180:183], a[132:135]
    v_accvgpr_read_b32 v96, a96
    v_accvgpr_read_b32 v97, a100
    v_accvgpr_read_b32 v98, a104
    v_accvgpr_read_b32 v99, a108
    v_accvgpr_read_b32 v100, a112
    v_accvgpr_read_b32 v101, a116
    v_accvgpr_read_b32 v102, a120
    v_mfma_f32_16x16x32_bf16 a[136:139], v[72:75], v[180:183], a[136:139]
    v_accvgpr_read_b32 v103, a124
    v_cvt_pk_bf16_f32 v104, v96, v97
    v_cvt_pk_bf16_f32 v105, v98, v99
    v_cvt_pk_bf16_f32 v106, v100, v101
    v_cvt_pk_bf16_f32 v107, v102, v103
    s_mov_b32 s56, 3072
    buffer_store_dwordx4 v[104:107], v219, s[28:31], s56 offen sc1
    v_mfma_f32_16x16x32_bf16 a[140:143], v[76:79], v[180:183], a[140:143]
    v_accvgpr_read_b32 v108, a97
    v_accvgpr_read_b32 v109, a101
    v_accvgpr_read_b32 v110, a105
    v_accvgpr_read_b32 v111, a109
    v_accvgpr_read_b32 v112, a113
    v_accvgpr_read_b32 v113, a117
    v_accvgpr_read_b32 v114, a121
    v_mfma_f32_16x16x32_bf16 a[144:147], v[80:83], v[180:183], a[144:147]
    v_accvgpr_read_b32 v115, a125
    v_cvt_pk_bf16_f32 v116, v108, v109
    v_cvt_pk_bf16_f32 v117, v110, v111
    v_cvt_pk_bf16_f32 v118, v112, v113
    v_cvt_pk_bf16_f32 v119, v114, v115
    s_mov_b32 s56, 12288
    buffer_store_dwordx4 v[116:119], v219, s[28:31], s56 offen sc1
    v_mfma_f32_16x16x32_bf16 a[148:151], v[84:87], v[180:183], a[148:151]
    v_accvgpr_read_b32 v0, a98
    v_accvgpr_read_b32 v1, a102
    v_accvgpr_read_b32 v2, a106
    v_accvgpr_read_b32 v3, a110
    v_accvgpr_read_b32 v4, a114
    v_accvgpr_read_b32 v5, a118
    v_accvgpr_read_b32 v6, a122
    v_mfma_f32_16x16x32_bf16 a[152:155], v[88:91], v[180:183], a[152:155]
    v_accvgpr_read_b32 v7, a126
    v_cvt_pk_bf16_f32 v8, v0, v1
    v_cvt_pk_bf16_f32 v9, v2, v3
    v_cvt_pk_bf16_f32 v10, v4, v5
    v_cvt_pk_bf16_f32 v11, v6, v7
    s_mov_b32 s56, 21504
    buffer_store_dwordx4 v[8:11], v219, s[28:31], s56 offen sc1
    v_mfma_f32_16x16x32_bf16 a[156:159], v[92:95], v[180:183], a[156:159]
    v_accvgpr_read_b32 v12, a99
    v_accvgpr_read_b32 v13, a103
    v_accvgpr_read_b32 v14, a107
    v_accvgpr_read_b32 v15, a111
    v_accvgpr_read_b32 v16, a115
    v_accvgpr_read_b32 v17, a119
    v_accvgpr_read_b32 v18, a123
    v_mfma_f32_16x16x32_bf16 a[160:163], v[64:67], v[184:187], a[160:163]
    v_accvgpr_read_b32 v19, a127
    v_cvt_pk_bf16_f32 v20, v12, v13
    v_cvt_pk_bf16_f32 v21, v14, v15
    v_cvt_pk_bf16_f32 v22, v16, v17
    v_cvt_pk_bf16_f32 v23, v18, v19
    s_mov_b32 s56, 30720
    buffer_store_dwordx4 v[20:23], v219, s[28:31], s56 offen sc1
    v_mfma_f32_16x16x32_bf16 a[164:167], v[68:71], v[184:187], a[164:167]
    v_accvgpr_read_b32 v128, a128
    v_accvgpr_read_b32 v129, a132
    v_accvgpr_read_b32 v130, a136
    v_accvgpr_read_b32 v131, a140
    v_accvgpr_read_b32 v132, a144
    v_accvgpr_read_b32 v133, a148
    v_accvgpr_read_b32 v134, a152
    v_mfma_f32_16x16x32_bf16 a[168:171], v[72:75], v[184:187], a[168:171]
    v_accvgpr_read_b32 v135, a156
    v_cvt_pk_bf16_f32 v136, v128, v129
    v_cvt_pk_bf16_f32 v137, v130, v131
    v_cvt_pk_bf16_f32 v138, v132, v133
    v_cvt_pk_bf16_f32 v139, v134, v135
    s_mov_b32 s56, 4096
    buffer_store_dwordx4 v[136:139], v219, s[28:31], s56 offen sc1
    v_mfma_f32_16x16x32_bf16 a[172:175], v[76:79], v[184:187], a[172:175]
    v_accvgpr_read_b32 v140, a129
    v_accvgpr_read_b32 v141, a133
    v_accvgpr_read_b32 v142, a137
    v_accvgpr_read_b32 v143, a141
    v_accvgpr_read_b32 v144, a145
    v_accvgpr_read_b32 v145, a149
    v_accvgpr_read_b32 v146, a153
    v_mfma_f32_16x16x32_bf16 a[176:179], v[80:83], v[184:187], a[176:179]
    v_accvgpr_read_b32 v147, a157
    v_cvt_pk_bf16_f32 v148, v140, v141
    v_cvt_pk_bf16_f32 v149, v142, v143
    v_cvt_pk_bf16_f32 v150, v144, v145
    v_cvt_pk_bf16_f32 v151, v146, v147
    s_mov_b32 s56, 13312
    buffer_store_dwordx4 v[148:151], v219, s[28:31], s56 offen sc1
    v_mfma_f32_16x16x32_bf16 a[180:183], v[84:87], v[184:187], a[180:183]
    v_accvgpr_read_b32 v96, a130
    v_accvgpr_read_b32 v97, a134
    v_accvgpr_read_b32 v98, a138
    v_accvgpr_read_b32 v99, a142
    v_accvgpr_read_b32 v100, a146
    v_accvgpr_read_b32 v101, a150
    v_accvgpr_read_b32 v102, a154
    v_mfma_f32_16x16x32_bf16 a[184:187], v[88:91], v[184:187], a[184:187]
    v_accvgpr_read_b32 v103, a158
    v_cvt_pk_bf16_f32 v104, v96, v97
    v_cvt_pk_bf16_f32 v105, v98, v99
    v_cvt_pk_bf16_f32 v106, v100, v101
    v_cvt_pk_bf16_f32 v107, v102, v103
    s_mov_b32 s56, 22528
    buffer_store_dwordx4 v[104:107], v219, s[28:31], s56 offen sc1
    v_mfma_f32_16x16x32_bf16 a[188:191], v[92:95], v[184:187], a[188:191]
    v_accvgpr_read_b32 v108, a131
    v_accvgpr_read_b32 v109, a135
    v_accvgpr_read_b32 v110, a139
    v_accvgpr_read_b32 v111, a143
    v_accvgpr_read_b32 v112, a147
    v_accvgpr_read_b32 v113, a151
    v_accvgpr_read_b32 v114, a155
    v_mfma_f32_16x16x32_bf16 a[192:195], v[64:67], v[188:191], a[192:195]
    v_accvgpr_read_b32 v115, a159
    v_cvt_pk_bf16_f32 v116, v108, v109
    v_cvt_pk_bf16_f32 v117, v110, v111
    v_cvt_pk_bf16_f32 v118, v112, v113
    v_cvt_pk_bf16_f32 v119, v114, v115
    s_mov_b32 s56, 31744
    buffer_store_dwordx4 v[116:119], v219, s[28:31], s56 offen sc1
    v_mfma_f32_16x16x32_bf16 a[196:199], v[68:71], v[188:191], a[196:199]
    v_accvgpr_read_b32 v0, a160
    v_accvgpr_read_b32 v1, a164
    v_accvgpr_read_b32 v2, a168
    v_accvgpr_read_b32 v3, a172
    v_accvgpr_read_b32 v4, a176
    v_accvgpr_read_b32 v5, a180
    v_accvgpr_read_b32 v6, a184
    v_mfma_f32_16x16x32_bf16 a[200:203], v[72:75], v[188:191], a[200:203]
    v_accvgpr_read_b32 v7, a188
    v_cvt_pk_bf16_f32 v8, v0, v1
    v_cvt_pk_bf16_f32 v9, v2, v3
    v_cvt_pk_bf16_f32 v10, v4, v5
    v_cvt_pk_bf16_f32 v11, v6, v7
    s_mov_b32 s56, 5120
    buffer_store_dwordx4 v[8:11], v219, s[28:31], s56 offen sc1
    v_mfma_f32_16x16x32_bf16 a[204:207], v[76:79], v[188:191], a[204:207]
    v_accvgpr_read_b32 v12, a161
    v_accvgpr_read_b32 v13, a165
    v_accvgpr_read_b32 v14, a169
    v_accvgpr_read_b32 v15, a173
    v_accvgpr_read_b32 v16, a177
    v_accvgpr_read_b32 v17, a181
    v_accvgpr_read_b32 v18, a185
    v_mfma_f32_16x16x32_bf16 a[208:211], v[80:83], v[188:191], a[208:211]
    v_accvgpr_read_b32 v19, a189
    v_cvt_pk_bf16_f32 v20, v12, v13
    v_cvt_pk_bf16_f32 v21, v14, v15
    v_cvt_pk_bf16_f32 v22, v16, v17
    v_cvt_pk_bf16_f32 v23, v18, v19
    s_mov_b32 s56, 14336
    buffer_store_dwordx4 v[20:23], v219, s[28:31], s56 offen sc1
    v_mfma_f32_16x16x32_bf16 a[212:215], v[84:87], v[188:191], a[212:215]
    v_accvgpr_read_b32 v128, a162
    v_accvgpr_read_b32 v129, a166
    v_accvgpr_read_b32 v130, a170
    v_accvgpr_read_b32 v131, a174
    v_accvgpr_read_b32 v132, a178
    v_accvgpr_read_b32 v133, a182
    v_accvgpr_read_b32 v134, a186
    v_mfma_f32_16x16x32_bf16 a[216:219], v[88:91], v[188:191], a[216:219]
    v_accvgpr_read_b32 v135, a190
    v_cvt_pk_bf16_f32 v136, v128, v129
    v_cvt_pk_bf16_f32 v137, v130, v131
    v_cvt_pk_bf16_f32 v138, v132, v133
    v_cvt_pk_bf16_f32 v139, v134, v135
    s_mov_b32 s56, 23552
    buffer_store_dwordx4 v[136:139], v219, s[28:31], s56 offen sc1
    v_mfma_f32_16x16x32_bf16 a[220:223], v[92:95], v[188:191], a[220:223]
    v_accvgpr_read_b32 v140, a163
    v_accvgpr_read_b32 v141, a167
    v_accvgpr_read_b32 v142, a171
    v_accvgpr_read_b32 v143, a175
    v_accvgpr_read_b32 v144, a179
    v_accvgpr_read_b32 v145, a183
    v_accvgpr_read_b32 v146, a187
    v_mfma_f32_16x16x32_bf16 a[224:227], v[64:67], v[192:195], a[224:227]
    v_accvgpr_read_b32 v147, a191
    v_cvt_pk_bf16_f32 v148, v140, v141
    v_cvt_pk_bf16_f32 v149, v142, v143
    v_cvt_pk_bf16_f32 v150, v144, v145
    v_cvt_pk_bf16_f32 v151, v146, v147
    s_mov_b32 s56, 32768
    buffer_store_dwordx4 v[148:151], v219, s[28:31], s56 offen sc1
    v_mfma_f32_16x16x32_bf16 a[228:231], v[68:71], v[192:195], a[228:231]
    v_accvgpr_read_b32 v96, a192
    v_accvgpr_read_b32 v97, a196
    v_accvgpr_read_b32 v98, a200
    v_accvgpr_read_b32 v99, a204
    v_accvgpr_read_b32 v100, a208
    v_accvgpr_read_b32 v101, a212
    v_accvgpr_read_b32 v102, a216
    v_mfma_f32_16x16x32_bf16 a[232:235], v[72:75], v[192:195], a[232:235]
    v_accvgpr_read_b32 v103, a220
    v_cvt_pk_bf16_f32 v104, v96, v97
    v_cvt_pk_bf16_f32 v105, v98, v99
    v_cvt_pk_bf16_f32 v106, v100, v101
    v_cvt_pk_bf16_f32 v107, v102, v103
    s_mov_b32 s56, 6144
    buffer_store_dwordx4 v[104:107], v219, s[28:31], s56 offen sc1
    v_mfma_f32_16x16x32_bf16 a[236:239], v[76:79], v[192:195], a[236:239]
    v_accvgpr_read_b32 v108, a193
    v_accvgpr_read_b32 v109, a197
    v_accvgpr_read_b32 v110, a201
    v_accvgpr_read_b32 v111, a205
    v_accvgpr_read_b32 v112, a209
    v_accvgpr_read_b32 v113, a213
    v_accvgpr_read_b32 v114, a217
    v_mfma_f32_16x16x32_bf16 a[240:243], v[80:83], v[192:195], a[240:243]
    v_accvgpr_read_b32 v115, a221
    v_cvt_pk_bf16_f32 v116, v108, v109
    v_cvt_pk_bf16_f32 v117, v110, v111
    v_cvt_pk_bf16_f32 v118, v112, v113
    v_cvt_pk_bf16_f32 v119, v114, v115
    s_mov_b32 s56, 15360
    buffer_store_dwordx4 v[116:119], v219, s[28:31], s56 offen sc1
    v_mfma_f32_16x16x32_bf16 a[244:247], v[84:87], v[192:195], a[244:247]
    v_accvgpr_read_b32 v0, a194
    v_accvgpr_read_b32 v1, a198
    v_accvgpr_read_b32 v2, a202
    v_accvgpr_read_b32 v3, a206
    v_accvgpr_read_b32 v4, a210
    v_accvgpr_read_b32 v5, a214
    v_accvgpr_read_b32 v6, a218
    v_mfma_f32_16x16x32_bf16 a[248:251], v[88:91], v[192:195], a[248:251]
    v_accvgpr_read_b32 v7, a222
    v_cvt_pk_bf16_f32 v8, v0, v1
    v_cvt_pk_bf16_f32 v9, v2, v3
    v_cvt_pk_bf16_f32 v10, v4, v5
    v_cvt_pk_bf16_f32 v11, v6, v7
    s_mov_b32 s56, 24576
    buffer_store_dwordx4 v[8:11], v219, s[28:31], s56 offen sc1
    v_mfma_f32_16x16x32_bf16 a[252:255], v[92:95], v[192:195], a[252:255]
    v_accvgpr_read_b32 v12, a195
    v_accvgpr_read_b32 v13, a199
    v_accvgpr_read_b32 v14, a203
    v_accvgpr_read_b32 v15, a207
    v_accvgpr_read_b32 v16, a211
    v_accvgpr_read_b32 v17, a215
    v_accvgpr_read_b32 v18, a219
    v_mfma_f32_16x16x32_bf16 v[224:227], v[64:67], v[196:199], v[224:227]
    v_accvgpr_read_b32 v19, a223
    v_cvt_pk_bf16_f32 v20, v12, v13
    v_cvt_pk_bf16_f32 v21, v14, v15
    v_cvt_pk_bf16_f32 v22, v16, v17
    v_cvt_pk_bf16_f32 v23, v18, v19
    s_mov_b32 s56, 33792
    buffer_store_dwordx4 v[20:23], v219, s[28:31], s56 offen sc1
    v_mfma_f32_16x16x32_bf16 v[228:231], v[68:71], v[196:199], v[228:231]
    v_accvgpr_read_b32 v128, a224
    v_accvgpr_read_b32 v129, a228
    v_accvgpr_read_b32 v130, a232
    v_accvgpr_read_b32 v131, a236
    v_accvgpr_read_b32 v132, a240
    v_accvgpr_read_b32 v133, a244
    v_accvgpr_read_b32 v134, a248
    v_accvgpr_read_b32 v135, a252
    v_mfma_f32_16x16x32_bf16 v[232:235], v[72:75], v[196:199], v[232:235]
    v_cvt_pk_bf16_f32 v136, v128, v129
    v_cvt_pk_bf16_f32 v137, v130, v131
    v_cvt_pk_bf16_f32 v138, v132, v133
    v_cvt_pk_bf16_f32 v139, v134, v135
    s_mov_b32 s56, 7168
    buffer_store_dwordx4 v[136:139], v219, s[28:31], s56 offen sc1
    v_accvgpr_read_b32 v140, a225
    v_accvgpr_read_b32 v141, a229
    v_mfma_f32_16x16x32_bf16 v[236:239], v[76:79], v[196:199], v[236:239]
    v_accvgpr_read_b32 v142, a233
    v_accvgpr_read_b32 v143, a237
    v_accvgpr_read_b32 v144, a241
    v_accvgpr_read_b32 v145, a245
    v_accvgpr_read_b32 v146, a249
    v_accvgpr_read_b32 v147, a253
    v_cvt_pk_bf16_f32 v148, v140, v141
    v_cvt_pk_bf16_f32 v149, v142, v143
    v_mfma_f32_16x16x32_bf16 v[240:243], v[80:83], v[196:199], v[240:243]
    v_cvt_pk_bf16_f32 v150, v144, v145
    v_cvt_pk_bf16_f32 v151, v146, v147
    s_mov_b32 s56, 16384
    buffer_store_dwordx4 v[148:151], v219, s[28:31], s56 offen sc1
    v_accvgpr_read_b32 v96, a226
    v_accvgpr_read_b32 v97, a230
    v_accvgpr_read_b32 v98, a234
    v_accvgpr_read_b32 v99, a238
    v_mfma_f32_16x16x32_bf16 v[244:247], v[84:87], v[196:199], v[244:247]
    v_accvgpr_read_b32 v100, a242
    v_accvgpr_read_b32 v101, a246
    v_accvgpr_read_b32 v102, a250
    v_accvgpr_read_b32 v103, a254
    v_cvt_pk_bf16_f32 v104, v96, v97
    v_cvt_pk_bf16_f32 v105, v98, v99
    v_cvt_pk_bf16_f32 v106, v100, v101
    v_cvt_pk_bf16_f32 v107, v102, v103
    v_mfma_f32_16x16x32_bf16 v[248:251], v[88:91], v[196:199], v[248:251]
    s_mov_b32 s56, 25600
    buffer_store_dwordx4 v[104:107], v219, s[28:31], s56 offen sc1
    v_accvgpr_read_b32 v108, a227
    v_accvgpr_read_b32 v109, a231
    v_accvgpr_read_b32 v110, a235
    v_accvgpr_read_b32 v111, a239
    v_accvgpr_read_b32 v112, a243
    v_accvgpr_read_b32 v113, a247
    v_mfma_f32_16x16x32_bf16 v[252:255], v[92:95], v[196:199], v[252:255]
    v_accvgpr_read_b32 v114, a251
    v_accvgpr_read_b32 v115, a255
    v_cvt_pk_bf16_f32 v116, v108, v109
    v_cvt_pk_bf16_f32 v117, v110, v111
    v_cvt_pk_bf16_f32 v118, v112, v113
    v_cvt_pk_bf16_f32 v119, v114, v115
    s_mov_b32 s56, 34816
    buffer_store_dwordx4 v[116:119], v219, s[28:31], s56 offen sc1
    v_cvt_pk_bf16_f32 v8, v224, v228
    v_cvt_pk_bf16_f32 v9, v232, v236
    v_cvt_pk_bf16_f32 v10, v240, v244
    v_cvt_pk_bf16_f32 v11, v248, v252
    s_mov_b32 s56, 8192
    buffer_store_dwordx4 v[8:11], v219, s[28:31], s56 offen sc1
    v_cvt_pk_bf16_f32 v20, v225, v229
    v_cvt_pk_bf16_f32 v21, v233, v237
    v_cvt_pk_bf16_f32 v22, v241, v245
    v_cvt_pk_bf16_f32 v23, v249, v253
    s_mov_b32 s56, 17408
    buffer_store_dwordx4 v[20:23], v219, s[28:31], s56 offen sc1
    v_cvt_pk_bf16_f32 v136, v226, v230
    v_cvt_pk_bf16_f32 v137, v234, v238
    v_cvt_pk_bf16_f32 v138, v242, v246
    v_cvt_pk_bf16_f32 v139, v250, v254
    s_mov_b32 s56, 26624
    buffer_store_dwordx4 v[136:139], v219, s[28:31], s56 offen sc1
    v_cvt_pk_bf16_f32 v148, v227, v231
    v_cvt_pk_bf16_f32 v149, v235, v239
    v_cvt_pk_bf16_f32 v150, v243, v247
    v_cvt_pk_bf16_f32 v151, v251, v255
    s_mov_b32 s56, 35840
    buffer_store_dwordx4 v[148:151], v219, s[28:31], s56 offen sc1
K1_end:
K1_done:
    s_endpgm
K1_rare_o0:
    v_mov_b32 v218, v217
    s_nop 1
    v_permlane16_swap_b32 v218, v217
    s_nop 1
    v_max_f32 v217, v217, v218
    v_mov_b32 v218, v217
    s_nop 1
    v_permlane32_swap_b32 v218, v217
    s_nop 1
    v_max_f32 v217, v217, v218
    v_max_f32 v217, 0, v217
    v_sub_f32 v218, 0, v217
    v_exp_f32 v218, v218
    v_sub_f32 v168, v168, v217
    v_sub_f32 v169, v169, v217
    v_sub_f32 v170, v170, v217
    v_sub_f32 v171, v171, v217
    v_sub_f32 v152, v152, v217
    v_sub_f32 v153, v153, v217
    v_sub_f32 v154, v154, v217
    v_sub_f32 v155, v155, v217
    v_sub_f32 v156, v156, v217
    v_sub_f32 v157, v157, v217
    v_sub_f32 v158, v158, v217
    v_sub_f32 v159, v159, v217
    s_mov_b32 s56, 0xffff
    s_mov_b32 s57, 0x0
    v_cndmask_b32 v217, 1.0, v218, s[56:57]
    v_mul_f32 v204, v204, v217
    v_accvgpr_read_b32 v217, a0
    v_mul_f32 v217, v217, v218
    v_accvgpr_write_b32 a0, v217
    v_accvgpr_read_b32 v217, a1
    v_mul_f32 v217, v217, v218
    v_accvgpr_write_b32 a1, v217
    v_accvgpr_read_b32 v217, a2
    v_mul_f32 v217, v217, v218
    v_accvgpr_write_b32 a2, v217
    v_accvgpr_read_b32 v217, a3
    v_mul_f32 v217, v217, v218
    v_accvgpr_write_b32 a3, v217
    v_accvgpr_read_b32 v217, a4
    v_mul_f32 v217, v217, v218
    v_accvgpr_write_b32 a4, v217
    v_accvgpr_read_b32 v217, a5
    v_mul_f32 v217, v217, v218
    v_accvgpr_write_b32 a5, v217
    v_accvgpr_read_b32 v217, a6
    v_mul_f32 v217, v217, v218
    v_accvgpr_write_b32 a6, v217
    v_accvgpr_read_b32 v217, a7
    v_mul_f32 v217, v217, v218
    v_accvgpr_write_b32 a7, v217
    v_accvgpr_read_b32 v217, a8
    v_mul_f32 v217, v217, v218
    v_accvgpr_write_b32 a8, v217
    v_accvgpr_read_b32 v217, a9
    v_mul_f32 v217, v217, v218
    v_accvgpr_write_b32 a9, v217
    v_accvgpr_read_b32 v217, a10
    v_mul_f32 v217, v217, v218
    v_accvgpr_write_b32 a10, v217
    v_accvgpr_read_b32 v217, a11
    v_mul_f32 v217, v217, v218
    v_accvgpr_write_b32 a11, v217
    v_accvgpr_read_b32 v217, a12
    v_mul_f32 v217, v217, v218
    v_accvgpr_write_b32 a12, v217
    v_accvgpr_read_b32 v217, a13
    v_mul_f32 v217, v217, v218
    v_accvgpr_write_b32 a13, v217
    v_accvgpr_read_b32 v217, a14
    v_mul_f32 v217, v217, v218
    v_accvgpr_write_b32 a14, v217
    v_accvgpr_read_b32 v217, a15
    v_mul_f32 v217, v217, v218
    v_accvgpr_write_b32 a15, v217
    v_accvgpr_read_b32 v217, a16
    v_mul_f32 v217, v217, v218
    v_accvgpr_write_b32 a16, v217
    v_accvgpr_read_b32 v217, a17
    v_mul_f32 v217, v217, v218
    v_accvgpr_write_b32 a17, v217
    v_accvgpr_read_b32 v217, a18
    v_mul_f32 v217, v217, v218
    v_accvgpr_write_b32 a18, v217
    v_accvgpr_read_b32 v217, a19
    v_mul_f32 v217, v217, v218
    v_accvgpr_write_b32 a19, v217
    v_accvgpr_read_b32 v217, a20
    v_mul_f32 v217, v217, v218
    v_accvgpr_write_b32 a20, v217
    v_accvgpr_read_b32 v217, a21
    v_mul_f32 v217, v217, v218
    v_accvgpr_write_b32 a21, v217
    v_accvgpr_read_b32 v217, a22
    v_mul_f32 v217, v217, v218
    v_accvgpr_write_b32 a22, v217
    v_accvgpr_read_b32 v217, a23
    v_mul_f32 v217, v217, v218
    v_accvgpr_write_b32 a23, v217
    v_accvgpr_read_b32 v217, a24
    v_mul_f32 v217, v217, v218
    v_accvgpr_write_b32 a24, v217
    v_accvgpr_read_b32 v217, a25
    v_mul_f32 v217, v217, v218
    v_accvgpr_write_b32 a25, v217
    v_accvgpr_read_b32 v217, a26
    v_mul_f32 v217, v217, v218
    v_accvgpr_write_b32 a26, v217
    v_accvgpr_read_b32 v217, a27
    v_mul_f32 v217, v217, v218
    v_accvgpr_write_b32 a27, v217
    v_accvgpr_read_b32 v217, a28
    v_mul_f32 v217, v217, v218
    v_accvgpr_write_b32 a28, v217
    v_accvgpr_read_b32 v217, a29
    v_mul_f32 v217, v217, v218
    v_accvgpr_write_b32 a29, v217
    v_accvgpr_read_b32 v217, a30
    v_mul_f32 v217, v217, v218
    v_accvgpr_write_b32 a30, v217
    v_accvgpr_read_b32 v217, a31
    v_mul_f32 v217, v217, v218
    v_accvgpr_write_b32 a31, v217
    s_nop 1
    s_branch K1_back_o0
K1_rare_o1:
    v_mov_b32 v218, v217
    s_nop 1
    v_permlane16_swap_b32 v218, v217
    s_nop 1
    v_max_f32 v217, v217, v218
    v_mov_b32 v218, v217
    s_nop 1
    v_permlane32_swap_b32 v218, v217
    s_nop 1
    v_max_f32 v217, v217, v218
    v_max_f32 v217, 0, v217
    v_sub_f32 v218, 0, v217
    v_exp_f32 v218, v218
    v_sub_f32 v172, v172, v217
    v_sub_f32 v173, v173, v217
    v_sub_f32 v174, v174, v217
    v_sub_f32 v175, v175, v217
    v_sub_f32 v144, v144, v217
    v_sub_f32 v145, v145, v217
    v_sub_f32 v146, v146, v217
    v_sub_f32 v147, v147, v217
    v_sub_f32 v148, v148, v217
    v_sub_f32 v149, v149, v217
    v_sub_f32 v150, v150, v217
    v_sub_f32 v151, v151, v217
    s_mov_b32 s56, 0xffff
    s_mov_b32 s57, 0x0
    v_cndmask_b32 v217, 1.0, v218, s[56:57]
    v_mul_f32 v205, v205, v217
    v_accvgpr_read_b32 v217, a32
    v_mul_f32 v217, v217, v218
    v_accvgpr_write_b32 a32, v217
    v_accvgpr_read_b32 v217, a33
    v_mul_f32 v217, v217, v218
    v_accvgpr_write_b32 a33, v217
    v_accvgpr_read_b32 v217, a34
    v_mul_f32 v217, v217, v218
    v_accvgpr_write_b32 a34, v217
    v_accvgpr_read_b32 v217, a35
    v_mul_f32 v217, v217, v218
    v_accvgpr_write_b32 a35, v217
    v_accvgpr_read_b32 v217, a36
    v_mul_f32 v217, v217, v218
    v_accvgpr_write_b32 a36, v217
    v_accvgpr_read_b32 v217, a37
    v_mul_f32 v217, v217, v218
    v_accvgpr_write_b32 a37, v217
    v_accvgpr_read_b32 v217, a38
    v_mul_f32 v217, v217, v218
    v_accvgpr_write_b32 a38, v217
    v_accvgpr_read_b32 v217, a39
    v_mul_f32 v217, v217, v218
    v_accvgpr_write_b32 a39, v217
    v_accvgpr_read_b32 v217, a40
    v_mul_f32 v217, v217, v218
    v_accvgpr_write_b32 a40, v217
    v_accvgpr_read_b32 v217, a41
    v_mul_f32 v217, v217, v218
    v_accvgpr_write_b32 a41, v217
    v_accvgpr_read_b32 v217, a42
    v_mul_f32 v217, v217, v218
    v_accvgpr_write_b32 a42, v217
    v_accvgpr_read_b32 v217, a43
    v_mul_f32 v217, v217, v218
    v_accvgpr_write_b32 a43, v217
    v_accvgpr_read_b32 v217, a44
    v_mul_f32 v217, v217, v218
    v_accvgpr_write_b32 a44, v217
    v_accvgpr_read_b32 v217, a45
    v_mul_f32 v217, v217, v218
    v_accvgpr_write_b32 a45, v217
    v_accvgpr_read_b32 v217, a46
    v_mul_f32 v217, v217, v218
    v_accvgpr_write_b32 a46, v217
    v_accvgpr_read_b32 v217, a47
    v_mul_f32 v217, v217, v218
    v_accvgpr_write_b32 a47, v217
    v_accvgpr_read_b32 v217, a48
    v_mul_f32 v217, v217, v218
    v_accvgpr_write_b32 a48, v217
    v_accvgpr_read_b32 v217, a49
    v_mul_f32 v217, v217, v218
    v_accvgpr_write_b32 a49, v217
    v_accvgpr_read_b32 v217, a50
    v_mul_f32 v217, v217, v218
    v_accvgpr_write_b32 a50, v217
    v_accvgpr_read_b32 v217, a51
    v_mul_f32 v217, v217, v218
    v_accvgpr_write_b32 a51, v217
    v_accvgpr_read_b32 v217, a52
    v_mul_f32 v217, v217, v218
    v_accvgpr_write_b32 a52, v217
    v_accvgpr_read_b32 v217, a53
    v_mul_f32 v217, v217, v218
    v_accvgpr_write_b32 a53, v217
    v_accvgpr_read_b32 v217, a54
    v_mul_f32 v217, v217, v218
    v_accvgpr_write_b32 a54, v217
    v_accvgpr_read_b32 v217, a55
    v_mul_f32 v217, v217, v218
    v_accvgpr_write_b32 a55, v217
    v_accvgpr_read_b32 v217, a56
    v_mul_f32 v217, v217, v218
    v_accvgpr_write_b32 a56, v217
    v_accvgpr_read_b32 v217, a57
    v_mul_f32 v217, v217, v218
    v_accvgpr_write_b32 a57, v217
    v_accvgpr_read_b32 v217, a58
    v_mul_f32 v217, v217, v218
    v_accvgpr_write_b32 a58, v217
    v_accvgpr_read_b32 v217, a59
    v_mul_f32 v217, v217, v218
    v_accvgpr_write_b32 a59, v217
    v_accvgpr_read_b32 v217, a60
    v_mul_f32 v217, v217, v218
    v_accvgpr_write_b32 a60, v217
    v_accvgpr_read_b32 v217, a61
    v_mul_f32 v217, v217, v218
    v_accvgpr_write_b32 a61, v217
    v_accvgpr_read_b32 v217, a62
    v_mul_f32 v217, v217, v218
    v_accvgpr_write_b32 a62, v217
    v_accvgpr_read_b32 v217, a63
    v_mul_f32 v217, v217, v218
    v_accvgpr_write_b32 a63, v217
    s_nop 1
    s_branch K1_back_o1
K1_rare_o2:
    v_mov_b32 v218, v217
    s_nop 1
    v_permlane16_swap_b32 v218, v217
    s_nop 1
    v_max_f32 v217, v217, v218
    v_mov_b32 v218, v217
    s_nop 1
    v_permlane32_swap_b32 v218, v217
    s_nop 1
    v_max_f32 v217, v217, v218
    v_max_f32 v217, 0, v217
    v_sub_f32 v218, 0, v217
    v_exp_f32 v218, v218
    v_sub_f32 v176, v176, v217
    v_sub_f32 v177, v177, v217
    v_sub_f32 v178, v178, v217
    v_sub_f32 v179, v179, v217
    v_sub_f32 v152, v152, v217
    v_sub_f32 v153, v153, v217
    v_sub_f32 v154, v154, v217
    v_sub_f32 v155, v155, v217
    v_sub_f32 v156, v156, v217
    v_sub_f32 v157, v157, v217
    v_sub_f32 v158, v158, v217
    v_sub_f32 v159, v159, v217
    s_mov_b32 s56, 0xffff
    s_mov_b32 s57, 0x0
    v_cndmask_b32 v217, 1.0, v218, s[56:57]
    v_mul_f32 v206, v206, v217
    v_accvgpr_read_b32 v217, a64
    v_mul_f32 v217, v217, v218
    v_accvgpr_write_b32 a64, v217
    v_accvgpr_read_b32 v217, a65
    v_mul_f32 v217, v217, v218
    v_accvgpr_write_b32 a65, v217
    v_accvgpr_read_b32 v217, a66
    v_mul_f32 v217, v217, v218
    v_accvgpr_write_b32 a66, v217
    v_accvgpr_read_b32 v217, a67
    v_mul_f32 v217, v217, v218
    v_accvgpr_write_b32 a67, v217
    v_accvgpr_read_b32 v217, a68
    v_mul_f32 v217, v217, v218
    v_accvgpr_write_b32 a68, v217
    v_accvgpr_read_b32 v217, a69
    v_mul_f32 v217, v217, v218
    v_accvgpr_write_b32 a69, v217
    v_accvgpr_read_b32 v217, a70
    v_mul_f32 v217, v217, v218
    v_accvgpr_write_b32 a70, v217
    v_accvgpr_read_b32 v217, a71
    v_mul_f32 v217, v217, v218
    v_accvgpr_write_b32 a71, v217
    v_accvgpr_read_b32 v217, a72
    v_mul_f32 v217, v217, v218
    v_accvgpr_write_b32 a72, v217
    v_accvgpr_read_b32 v217, a73
    v_mul_f32 v217, v217, v218
    v_accvgpr_write_b32 a73, v217
    v_accvgpr_read_b32 v217, a74
    v_mul_f32 v217, v217, v218
    v_accvgpr_write_b32 a74, v217
    v_accvgpr_read_b32 v217, a75
    v_mul_f32 v217, v217, v218
    v_accvgpr_write_b32 a75, v217
    v_accvgpr_read_b32 v217, a76
    v_mul_f32 v217, v217, v218
    v_accvgpr_write_b32 a76, v217
    v_accvgpr_read_b32 v217, a77
    v_mul_f32 v217, v217, v218
    v_accvgpr_write_b32 a77, v217
    v_accvgpr_read_b32 v217, a78
    v_mul_f32 v217, v217, v218
    v_accvgpr_write_b32 a78, v217
    v_accvgpr_read_b32 v217, a79
    v_mul_f32 v217, v217, v218
    v_accvgpr_write_b32 a79, v217
    v_accvgpr_read_b32 v217, a80
    v_mul_f32 v217, v217, v218
    v_accvgpr_write_b32 a80, v217
    v_accvgpr_read_b32 v217, a81
    v_mul_f32 v217, v217, v218
    v_accvgpr_write_b32 a81, v217
    v_accvgpr_read_b32 v217, a82
    v_mul_f32 v217, v217, v218
    v_accvgpr_write_b32 a82, v217
    v_accvgpr_read_b32 v217, a83
    v_mul_f32 v217, v217, v218
    v_accvgpr_write_b32 a83, v217
    v_accvgpr_read_b32 v217, a84
    v_mul_f32 v217, v217, v218
    v_accvgpr_write_b32 a84, v217
    v_accvgpr_read_b32 v217, a85
    v_mul_f32 v217, v217, v218
    v_accvgpr_write_b32 a85, v217
    v_accvgpr_read_b32 v217, a86
    v_mul_f32 v217, v217, v218
    v_accvgpr_write_b32 a86, v217
    v_accvgpr_read_b32 v217, a87
    v_mul_f32 v217, v217, v218
    v_accvgpr_write_b32 a87, v217
    v_accvgpr_read_b32 v217, a88
    v_mul_f32 v217, v217, v218
    v_accvgpr_write_b32 a88, v217
    v_accvgpr_read_b32 v217, a89
    v_mul_f32 v217, v217, v218
    v_accvgpr_write_b32 a89, v217
    v_accvgpr_read_b32 v217, a90
    v_mul_f32 v217, v217, v218
    v_accvgpr_write_b32 a90, v217
    v_accvgpr_read_b32 v217, a91
    v_mul_f32 v217, v217, v218
    v_accvgpr_write_b32 a91, v217
    v_accvgpr_read_b32 v217, a92
    v_mul_f32 v217, v217, v218
    v_accvgpr_write_b32 a92, v217
    v_accvgpr_read_b32 v217, a93
    v_mul_f32 v217, v217, v218
    v_accvgpr_write_b32 a93, v217
    v_accvgpr_read_b32 v217, a94
    v_mul_f32 v217, v217, v218
    v_accvgpr_write_b32 a94, v217
    v_accvgpr_read_b32 v217, a95
    v_mul_f32 v217, v217, v218
    v_accvgpr_write_b32 a95, v217
    s_nop 1
    s_branch K1_back_o2
K1_rare_o3:
    v_mov_b32 v218, v217
    s_nop 1
    v_permlane16_swap_b32 v218, v217
    s_nop 1
    v_max_f32 v217, v217, v218
    v_mov_b32 v218, v217
    s_nop 1
    v_permlane32_swap_b32 v218, v217
    s_nop 1
    v_max_f32 v217, v217, v218
    v_max_f32 v217, 0, v217
    v_sub_f32 v218, 0, v217
    v_exp_f32 v218, v218
    v_sub_f32 v180, v180, v217
    v_sub_f32 v181, v181, v217
    v_sub_f32 v182, v182, v217
    v_sub_f32 v183, v183, v217
    v_sub_f32 v144, v144, v217
    v_sub_f32 v145, v145, v217
    v_sub_f32 v146, v146, v217
    v_sub_f32 v147, v147, v217
    v_sub_f32 v148, v148, v217
    v_sub_f32 v149, v149, v217
    v_sub_f32 v150, v150, v217
    v_sub_f32 v151, v151, v217
    s_mov_b32 s56, 0xffff
    s_mov_b32 s57, 0x0
    v_cndmask_b32 v217, 1.0, v218, s[56:57]
    v_mul_f32 v207, v207, v217
    v_accvgpr_read_b32 v217, a96
    v_mul_f32 v217, v217, v218
    v_accvgpr_write_b32 a96, v217
    v_accvgpr_read_b32 v217, a97
    v_mul_f32 v217, v217, v218
    v_accvgpr_write_b32 a97, v217
    v_accvgpr_read_b32 v217, a98
    v_mul_f32 v217, v217, v218
    v_accvgpr_write_b32 a98, v217
    v_accvgpr_read_b32 v217, a99
    v_mul_f32 v217, v217, v218
    v_accvgpr_write_b32 a99, v217
    v_accvgpr_read_b32 v217, a100
    v_mul_f32 v217, v217, v218
    v_accvgpr_write_b32 a100, v217
    v_accvgpr_read_b32 v217, a101
    v_mul_f32 v217, v217, v218
    v_accvgpr_write_b32 a101, v217
    v_accvgpr_read_b32 v217, a102
    v_mul_f32 v217, v217, v218
    v_accvgpr_write_b32 a102, v217
    v_accvgpr_read_b32 v217, a103
    v_mul_f32 v217, v217, v218
    v_accvgpr_write_b32 a103, v217
    v_accvgpr_read_b32 v217, a104
    v_mul_f32 v217, v217, v218
    v_accvgpr_write_b32 a104, v217
    v_accvgpr_read_b32 v217, a105
    v_mul_f32 v217, v217, v218
    v_accvgpr_write_b32 a105, v217
    v_accvgpr_read_b32 v217, a106
    v_mul_f32 v217, v217, v218
    v_accvgpr_write_b32 a106, v217
    v_accvgpr_read_b32 v217, a107
    v_mul_f32 v217, v217, v218
    v_accvgpr_write_b32 a107, v217
    v_accvgpr_read_b32 v217, a108
    v_mul_f32 v217, v217, v218
    v_accvgpr_write_b32 a108, v217
    v_accvgpr_read_b32 v217, a109
    v_mul_f32 v217, v217, v218
    v_accvgpr_write_b32 a109, v217
    v_accvgpr_read_b32 v217, a110
    v_mul_f32 v217, v217, v218
    v_accvgpr_write_b32 a110, v217
    v_accvgpr_read_b32 v217, a111
    v_mul_f32 v217, v217, v218
    v_accvgpr_write_b32 a111, v217
    v_accvgpr_read_b32 v217, a112
    v_mul_f32 v217, v217, v218
    v_accvgpr_write_b32 a112, v217
    v_accvgpr_read_b32 v217, a113
    v_mul_f32 v217, v217, v218
    v_accvgpr_write_b32 a113, v217
    v_accvgpr_read_b32 v217, a114
    v_mul_f32 v217, v217, v218
    v_accvgpr_write_b32 a114, v217
    v_accvgpr_read_b32 v217, a115
    v_mul_f32 v217, v217, v218
    v_accvgpr_write_b32 a115, v217
    v_accvgpr_read_b32 v217, a116
    v_mul_f32 v217, v217, v218
    v_accvgpr_write_b32 a116, v217
    v_accvgpr_read_b32 v217, a117
    v_mul_f32 v217, v217, v218
    v_accvgpr_write_b32 a117, v217
    v_accvgpr_read_b32 v217, a118
    v_mul_f32 v217, v217, v218
    v_accvgpr_write_b32 a118, v217
    v_accvgpr_read_b32 v217, a119
    v_mul_f32 v217, v217, v218
    v_accvgpr_write_b32 a119, v217
    v_accvgpr_read_b32 v217, a120
    v_mul_f32 v217, v217, v218
    v_accvgpr_write_b32 a120, v217
    v_accvgpr_read_b32 v217, a121
    v_mul_f32 v217, v217, v218
    v_accvgpr_write_b32 a121, v217
    v_accvgpr_read_b32 v217, a122
    v_mul_f32 v217, v217, v218
    v_accvgpr_write_b32 a122, v217
    v_accvgpr_read_b32 v217, a123
    v_mul_f32 v217, v217, v218
    v_accvgpr_write_b32 a123, v217
    v_accvgpr_read_b32 v217, a124
    v_mul_f32 v217, v217, v218
    v_accvgpr_write_b32 a124, v217
    v_accvgpr_read_b32 v217, a125
    v_mul_f32 v217, v217, v218
    v_accvgpr_write_b32 a125, v217
    v_accvgpr_read_b32 v217, a126
    v_mul_f32 v217, v217, v218
    v_accvgpr_write_b32 a126, v217
    v_accvgpr_read_b32 v217, a127
    v_mul_f32 v217, v217, v218
    v_accvgpr_write_b32 a127, v217
    s_nop 1
    s_branch K1_back_o3
K1_rare_o4:
    v_mov_b32 v218, v217
    s_nop 1
    v_permlane16_swap_b32 v218, v217
    s_nop 1
    v_max_f32 v217, v217, v218
    v_mov_b32 v218, v217
    s_nop 1
    v_permlane32_swap_b32 v218, v217
    s_nop 1
    v_max_f32 v217, v217, v218
    v_max_f32 v217, 0, v217
    v_sub_f32 v218, 0, v217
    v_exp_f32 v218, v218
    v_sub_f32 v184, v184, v217
    v_sub_f32 v185, v185, v217
    v_sub_f32 v186, v186, v217
    v_sub_f32 v187, v187, v217
    v_sub_f32 v152, v152, v217
    v_sub_f32 v153, v153, v217
    v_sub_f32 v154, v154, v217
    v_sub_f32 v155, v155, v217
    v_sub_f32 v156, v156, v217
    v_sub_f32 v157, v157, v217
    v_sub_f32 v158, v158, v217
    v_sub_f32 v159, v159, v217
    s_mov_b32 s56, 0xffff0000
    s_mov_b32 s57, 0x0
    v_cndmask_b32 v217, 1.0, v218, s[56:57]
    v_mul_f32 v204, v204, v217
    v_accvgpr_read_b32 v217, a128
    v_mul_f32 v217, v217, v218
    v_accvgpr_write_b32 a128, v217
    v_accvgpr_read_b32 v217, a129
    v_mul_f32 v217, v217, v218
    v_accvgpr_write_b32 a129, v217
    v_accvgpr_read_b32 v217, a130
    v_mul_f32 v217, v217, v218
    v_accvgpr_write_b32 a130, v217
    v_accvgpr_read_b32 v217, a131
    v_mul_f32 v217, v217, v218
    v_accvgpr_write_b32 a131, v217
    v_accvgpr_read_b32 v217, a132
    v_mul_f32 v217, v217, v218
    v_accvgpr_write_b32 a132, v217
    v_accvgpr_read_b32 v217, a133
    v_mul_f32 v217, v217, v218
    v_accvgpr_write_b32 a133, v217
    v_accvgpr_read_b32 v217, a134
    v_mul_f32 v217, v217, v218
    v_accvgpr_write_b32 a134, v217
    v_accvgpr_read_b32 v217, a135
    v_mul_f32 v217, v217, v218
    v_accvgpr_write_b32 a135, v217
    v_accvgpr_read_b32 v217, a136
    v_mul_f32 v217, v217, v218
    v_accvgpr_write_b32 a136, v217
    v_accvgpr_read_b32 v217, a137
    v_mul_f32 v217, v217, v218
    v_accvgpr_write_b32 a137, v217
    v_accvgpr_read_b32 v217, a138
    v_mul_f32 v217, v217, v218
    v_accvgpr_write_b32 a138, v217
    v_accvgpr_read_b32 v217, a139
    v_mul_f32 v217, v217, v218
    v_accvgpr_write_b32 a139, v217
    v_accvgpr_read_b32 v217, a140
    v_mul_f32 v217, v217, v218
    v_accvgpr_write_b32 a140, v217
    v_accvgpr_read_b32 v217, a141
    v_mul_f32 v217, v217, v218
    v_accvgpr_write_b32 a141, v217
    v_accvgpr_read_b32 v217, a142
    v_mul_f32 v217, v217, v218
    v_accvgpr_write_b32 a142, v217
    v_accvgpr_read_b32 v217, a143
    v_mul_f32 v217, v217, v218
    v_accvgpr_write_b32 a143, v217
    v_accvgpr_read_b32 v217, a144
    v_mul_f32 v217, v217, v218
    v_accvgpr_write_b32 a144, v217
    v_accvgpr_read_b32 v217, a145
    v_mul_f32 v217, v217, v218
    v_accvgpr_write_b32 a145, v217
    v_accvgpr_read_b32 v217, a146
    v_mul_f32 v217, v217, v218
    v_accvgpr_write_b32 a146, v217
    v_accvgpr_read_b32 v217, a147
    v_mul_f32 v217, v217, v218
    v_accvgpr_write_b32 a147, v217
    v_accvgpr_read_b32 v217, a148
    v_mul_f32 v217, v217, v218
    v_accvgpr_write_b32 a148, v217
    v_accvgpr_read_b32 v217, a149
    v_mul_f32 v217, v217, v218
    v_accvgpr_write_b32 a149, v217
    v_accvgpr_read_b32 v217, a150
    v_mul_f32 v217, v217, v218
    v_accvgpr_write_b32 a150, v217
    v_accvgpr_read_b32 v217, a151
    v_mul_f32 v217, v217, v218
    v_accvgpr_write_b32 a151, v217
    v_accvgpr_read_b32 v217, a152
    v_mul_f32 v217, v217, v218
    v_accvgpr_write_b32 a152, v217
    v_accvgpr_read_b32 v217, a153
    v_mul_f32 v217, v217, v218
    v_accvgpr_write_b32 a153, v217
    v_accvgpr_read_b32 v217, a154
    v_mul_f32 v217, v217, v218
    v_accvgpr_write_b32 a154, v217
    v_accvgpr_read_b32 v217, a155
    v_mul_f32 v217, v217, v218
    v_accvgpr_write_b32 a155, v217
    v_accvgpr_read_b32 v217, a156
    v_mul_f32 v217, v217, v218
    v_accvgpr_write_b32 a156, v217
    v_accvgpr_read_b32 v217, a157
    v_mul_f32 v217, v217, v218
    v_accvgpr_write_b32 a157, v217
    v_accvgpr_read_b32 v217, a158
    v_mul_f32 v217, v217, v218
    v_accvgpr_write_b32 a158, v217
    v_accvgpr_read_b32 v217, a159
    v_mul_f32 v217, v217, v218
    v_accvgpr_write_b32 a159, v217
    s_nop 1
    s_branch K1_back_o4
K1_rare_o5:
    v_mov_b32 v218, v217
    s_nop 1
    v_permlane16_swap_b32 v218, v217
    s_nop 1
    v_max_f32 v217, v217, v218
    v_mov_b32 v218, v217
    s_nop 1
    v_permlane32_swap_b32 v218, v217
    s_nop 1
    v_max_f32 v217, v217, v218
    v_max_f32 v217, 0, v217
    v_sub_f32 v218, 0, v217
    v_exp_f32 v218, v218
    v_sub_f32 v188, v188, v217
    v_sub_f32 v189, v189, v217
    v_sub_f32 v190, v190, v217
    v_sub_f32 v191, v191, v217
    v_sub_f32 v144, v144, v217
    v_sub_f32 v145, v145, v217
    v_sub_f32 v146, v146, v217
    v_sub_f32 v147, v147, v217
    v_sub_f32 v148, v148, v217
    v_sub_f32 v149, v149, v217
    v_sub_f32 v150, v150, v217
    v_sub_f32 v151, v151, v217
    s_mov_b32 s56, 0xffff0000
    s_mov_b32 s57, 0x0
    v_cndmask_b32 v217, 1.0, v218, s[56:57]
    v_mul_f32 v205, v205, v217
    v_accvgpr_read_b32 v217, a160
    v_mul_f32 v217, v217, v218
    v_accvgpr_write_b32 a160, v217
    v_accvgpr_read_b32 v217, a161
    v_mul_f32 v217, v217, v218
    v_accvgpr_write_b32 a161, v217
    v_accvgpr_read_b32 v217, a162
    v_mul_f32 v217, v217, v218
    v_accvgpr_write_b32 a162, v217
    v_accvgpr_read_b32 v217, a163
    v_mul_f32 v217, v217, v218
    v_accvgpr_write_b32 a163, v217
    v_accvgpr_read_b32 v217, a164
    v_mul_f32 v217, v217, v218
    v_accvgpr_write_b32 a164, v217
    v_accvgpr_read_b32 v217, a165
    v_mul_f32 v217, v217, v218
    v_accvgpr_write_b32 a165, v217
    v_accvgpr_read_b32 v217, a166
    v_mul_f32 v217, v217, v218
    v_accvgpr_write_b32 a166, v217
    v_accvgpr_read_b32 v217, a167
    v_mul_f32 v217, v217, v218
    v_accvgpr_write_b32 a167, v217
    v_accvgpr_read_b32 v217, a168
    v_mul_f32 v217, v217, v218
    v_accvgpr_write_b32 a168, v217
    v_accvgpr_read_b32 v217, a169
    v_mul_f32 v217, v217, v218
    v_accvgpr_write_b32 a169, v217
    v_accvgpr_read_b32 v217, a170
    v_mul_f32 v217, v217, v218
    v_accvgpr_write_b32 a170, v217
    v_accvgpr_read_b32 v217, a171
    v_mul_f32 v217, v217, v218
    v_accvgpr_write_b32 a171, v217
    v_accvgpr_read_b32 v217, a172
    v_mul_f32 v217, v217, v218
    v_accvgpr_write_b32 a172, v217
    v_accvgpr_read_b32 v217, a173
    v_mul_f32 v217, v217, v218
    v_accvgpr_write_b32 a173, v217
    v_accvgpr_read_b32 v217, a174
    v_mul_f32 v217, v217, v218
    v_accvgpr_write_b32 a174, v217
    v_accvgpr_read_b32 v217, a175
    v_mul_f32 v217, v217, v218
    v_accvgpr_write_b32 a175, v217
    v_accvgpr_read_b32 v217, a176
    v_mul_f32 v217, v217, v218
    v_accvgpr_write_b32 a176, v217
    v_accvgpr_read_b32 v217, a177
    v_mul_f32 v217, v217, v218
    v_accvgpr_write_b32 a177, v217
    v_accvgpr_read_b32 v217, a178
    v_mul_f32 v217, v217, v218
    v_accvgpr_write_b32 a178, v217
    v_accvgpr_read_b32 v217, a179
    v_mul_f32 v217, v217, v218
    v_accvgpr_write_b32 a179, v217
    v_accvgpr_read_b32 v217, a180
    v_mul_f32 v217, v217, v218
    v_accvgpr_write_b32 a180, v217
    v_accvgpr_read_b32 v217, a181
    v_mul_f32 v217, v217, v218
    v_accvgpr_write_b32 a181, v217
    v_accvgpr_read_b32 v217, a182
    v_mul_f32 v217, v217, v218
    v_accvgpr_write_b32 a182, v217
    v_accvgpr_read_b32 v217, a183
    v_mul_f32 v217, v217, v218
    v_accvgpr_write_b32 a183, v217
    v_accvgpr_read_b32 v217, a184
    v_mul_f32 v217, v217, v218
    v_accvgpr_write_b32 a184, v217
    v_accvgpr_read_b32 v217, a185
    v_mul_f32 v217, v217, v218
    v_accvgpr_write_b32 a185, v217
    v_accvgpr_read_b32 v217, a186
    v_mul_f32 v217, v217, v218
    v_accvgpr_write_b32 a186, v217
    v_accvgpr_read_b32 v217, a187
    v_mul_f32 v217, v217, v218
    v_accvgpr_write_b32 a187, v217
    v_accvgpr_read_b32 v217, a188
    v_mul_f32 v217, v217, v218
    v_accvgpr_write_b32 a188, v217
    v_accvgpr_read_b32 v217, a189
    v_mul_f32 v217, v217, v218
    v_accvgpr_write_b32 a189, v217
    v_accvgpr_read_b32 v217, a190
    v_mul_f32 v217, v217, v218
    v_accvgpr_write_b32 a190, v217
    v_accvgpr_read_b32 v217, a191
    v_mul_f32 v217, v217, v218
    v_accvgpr_write_b32 a191, v217
    s_nop 1
    s_branch K1_back_o5
K1_rare_o6:
    v_mov_b32 v218, v217
    s_nop 1
    v_permlane16_swap_b32 v218, v217
    s_nop 1
    v_max_f32 v217, v217, v218
    v_mov_b32 v218, v217
    s_nop 1
    v_permlane32_swap_b32 v218, v217
    s_nop 1
    v_max_f32 v217, v217, v218
    v_max_f32 v217, 0, v217
    v_sub_f32 v218, 0, v217
    v_exp_f32 v218, v218
    v_sub_f32 v192, v192, v217
    v_sub_f32 v193, v193, v217
    v_sub_f32 v194, v194, v217
    v_sub_f32 v195, v195, v217
    v_sub_f32 v152, v152, v217
    v_sub_f32 v153, v153, v217
    v_sub_f32 v154, v154, v217
    v_sub_f32 v155, v155, v217
    v_sub_f32 v156, v156, v217
    v_sub_f32 v157, v157, v217
    v_sub_f32 v158, v158, v217
    v_sub_f32 v159, v159, v217
    s_mov_b32 s56, 0xffff0000
    s_mov_b32 s57, 0x0
    v_cndmask_b32 v217, 1.0, v218, s[56:57]
    v_mul_f32 v206, v206, v217
    v_accvgpr_read_b32 v217, a192
    v_mul_f32 v217, v217, v218
    v_accvgpr_write_b32 a192, v217
    v_accvgpr_read_b32 v217, a193
    v_mul_f32 v217, v217, v218
    v_accvgpr_write_b32 a193, v217
    v_accvgpr_read_b32 v217, a194
    v_mul_f32 v217, v217, v218
    v_accvgpr_write_b32 a194, v217
    v_accvgpr_read_b32 v217, a195
    v_mul_f32 v217, v217, v218
    v_accvgpr_write_b32 a195, v217
    v_accvgpr_read_b32 v217, a196
    v_mul_f32 v217, v217, v218
    v_accvgpr_write_b32 a196, v217
    v_accvgpr_read_b32 v217, a197
    v_mul_f32 v217, v217, v218
    v_accvgpr_write_b32 a197, v217
    v_accvgpr_read_b32 v217, a198
    v_mul_f32 v217, v217, v218
    v_accvgpr_write_b32 a198, v217
    v_accvgpr_read_b32 v217, a199
    v_mul_f32 v217, v217, v218
    v_accvgpr_write_b32 a199, v217
    v_accvgpr_read_b32 v217, a200
    v_mul_f32 v217, v217, v218
    v_accvgpr_write_b32 a200, v217
    v_accvgpr_read_b32 v217, a201
    v_mul_f32 v217, v217, v218
    v_accvgpr_write_b32 a201, v217
    v_accvgpr_read_b32 v217, a202
    v_mul_f32 v217, v217, v218
    v_accvgpr_write_b32 a202, v217
    v_accvgpr_read_b32 v217, a203
    v_mul_f32 v217, v217, v218
    v_accvgpr_write_b32 a203, v217
    v_accvgpr_read_b32 v217, a204
    v_mul_f32 v217, v217, v218
    v_accvgpr_write_b32 a204, v217
    v_accvgpr_read_b32 v217, a205
    v_mul_f32 v217, v217, v218
    v_accvgpr_write_b32 a205, v217
    v_accvgpr_read_b32 v217, a206
    v_mul_f32 v217, v217, v218
    v_accvgpr_write_b32 a206, v217
    v_accvgpr_read_b32 v217, a207
    v_mul_f32 v217, v217, v218
    v_accvgpr_write_b32 a207, v217
    v_accvgpr_read_b32 v217, a208
    v_mul_f32 v217, v217, v218
    v_accvgpr_write_b32 a208, v217
    v_accvgpr_read_b32 v217, a209
    v_mul_f32 v217, v217, v218
    v_accvgpr_write_b32 a209, v217
    v_accvgpr_read_b32 v217, a210
    v_mul_f32 v217, v217, v218
    v_accvgpr_write_b32 a210, v217
    v_accvgpr_read_b32 v217, a211
    v_mul_f32 v217, v217, v218
    v_accvgpr_write_b32 a211, v217
    v_accvgpr_read_b32 v217, a212
    v_mul_f32 v217, v217, v218
    v_accvgpr_write_b32 a212, v217
    v_accvgpr_read_b32 v217, a213
    v_mul_f32 v217, v217, v218
    v_accvgpr_write_b32 a213, v217
    v_accvgpr_read_b32 v217, a214
    v_mul_f32 v217, v217, v218
    v_accvgpr_write_b32 a214, v217
    v_accvgpr_read_b32 v217, a215
    v_mul_f32 v217, v217, v218
    v_accvgpr_write_b32 a215, v217
    v_accvgpr_read_b32 v217, a216
    v_mul_f32 v217, v217, v218
    v_accvgpr_write_b32 a216, v217
    v_accvgpr_read_b32 v217, a217
    v_mul_f32 v217, v217, v218
    v_accvgpr_write_b32 a217, v217
    v_accvgpr_read_b32 v217, a218
    v_mul_f32 v217, v217, v218
    v_accvgpr_write_b32 a218, v217
    v_accvgpr_read_b32 v217, a219
    v_mul_f32 v217, v217, v218
    v_accvgpr_write_b32 a219, v217
    v_accvgpr_read_b32 v217, a220
    v_mul_f32 v217, v217, v218
    v_accvgpr_write_b32 a220, v217
    v_accvgpr_read_b32 v217, a221
    v_mul_f32 v217, v217, v218
    v_accvgpr_write_b32 a221, v217
    v_accvgpr_read_b32 v217, a222
    v_mul_f32 v217, v217, v218
    v_accvgpr_write_b32 a222, v217
    v_accvgpr_read_b32 v217, a223
    v_mul_f32 v217, v217, v218
    v_accvgpr_write_b32 a223, v217
    s_nop 1
    s_branch K1_back_o6
K1_rare_o7:
    v_mov_b32 v218, v217
    s_nop 1
    v_permlane16_swap_b32 v218, v217
    s_nop 1
    v_max_f32 v217, v217, v218
    v_mov_b32 v218, v217
    s_nop 1
    v_permlane32_swap_b32 v218, v217
    s_nop 1
    v_max_f32 v217, v217, v218
    v_max_f32 v217, 0, v217
    v_sub_f32 v218, 0, v217
    v_exp_f32 v218, v218
    v_sub_f32 v196, v196, v217
    v_sub_f32 v197, v197, v217
    v_sub_f32 v198, v198, v217
    v_sub_f32 v199, v199, v217
    v_sub_f32 v144, v144, v217
    v_sub_f32 v145, v145, v217
    v_sub_f32 v146, v146, v217
    v_sub_f32 v147, v147, v217
    v_sub_f32 v148, v148, v217
    v_sub_f32 v149, v149, v217
    v_sub_f32 v150, v150, v217
    v_sub_f32 v151, v151, v217
    s_mov_b32 s56, 0xffff0000
    s_mov_b32 s57, 0x0
    v_cndmask_b32 v217, 1.0, v218, s[56:57]
    v_mul_f32 v207, v207, v217
    v_accvgpr_read_b32 v217, a224
    v_mul_f32 v217, v217, v218
    v_accvgpr_write_b32 a224, v217
    v_accvgpr_read_b32 v217, a225
    v_mul_f32 v217, v217, v218
    v_accvgpr_write_b32 a225, v217
    v_accvgpr_read_b32 v217, a226
    v_mul_f32 v217, v217, v218
    v_accvgpr_write_b32 a226, v217
    v_accvgpr_read_b32 v217, a227
    v_mul_f32 v217, v217, v218
    v_accvgpr_write_b32 a227, v217
    v_accvgpr_read_b32 v217, a228
    v_mul_f32 v217, v217, v218
    v_accvgpr_write_b32 a228, v217
    v_accvgpr_read_b32 v217, a229
    v_mul_f32 v217, v217, v218
    v_accvgpr_write_b32 a229, v217
    v_accvgpr_read_b32 v217, a230
    v_mul_f32 v217, v217, v218
    v_accvgpr_write_b32 a230, v217
    v_accvgpr_read_b32 v217, a231
    v_mul_f32 v217, v217, v218
    v_accvgpr_write_b32 a231, v217
    v_accvgpr_read_b32 v217, a232
    v_mul_f32 v217, v217, v218
    v_accvgpr_write_b32 a232, v217
    v_accvgpr_read_b32 v217, a233
    v_mul_f32 v217, v217, v218
    v_accvgpr_write_b32 a233, v217
    v_accvgpr_read_b32 v217, a234
    v_mul_f32 v217, v217, v218
    v_accvgpr_write_b32 a234, v217
    v_accvgpr_read_b32 v217, a235
    v_mul_f32 v217, v217, v218
    v_accvgpr_write_b32 a235, v217
    v_accvgpr_read_b32 v217, a236
    v_mul_f32 v217, v217, v218
    v_accvgpr_write_b32 a236, v217
    v_accvgpr_read_b32 v217, a237
    v_mul_f32 v217, v217, v218
    v_accvgpr_write_b32 a237, v217
    v_accvgpr_read_b32 v217, a238
    v_mul_f32 v217, v217, v218
    v_accvgpr_write_b32 a238, v217
    v_accvgpr_read_b32 v217, a239
    v_mul_f32 v217, v217, v218
    v_accvgpr_write_b32 a239, v217
    v_accvgpr_read_b32 v217, a240
    v_mul_f32 v217, v217, v218
    v_accvgpr_write_b32 a240, v217
    v_accvgpr_read_b32 v217, a241
    v_mul_f32 v217, v217, v218
    v_accvgpr_write_b32 a241, v217
    v_accvgpr_read_b32 v217, a242
    v_mul_f32 v217, v217, v218
    v_accvgpr_write_b32 a242, v217
    v_accvgpr_read_b32 v217, a243
    v_mul_f32 v217, v217, v218
    v_accvgpr_write_b32 a243, v217
    v_accvgpr_read_b32 v217, a244
    v_mul_f32 v217, v217, v218
    v_accvgpr_write_b32 a244, v217
    v_accvgpr_read_b32 v217, a245
    v_mul_f32 v217, v217, v218
    v_accvgpr_write_b32 a245, v217
    v_accvgpr_read_b32 v217, a246
    v_mul_f32 v217, v217, v218
    v_accvgpr_write_b32 a246, v217
    v_accvgpr_read_b32 v217, a247
    v_mul_f32 v217, v217, v218
    v_accvgpr_write_b32 a247, v217
    v_accvgpr_read_b32 v217, a248
    v_mul_f32 v217, v217, v218
    v_accvgpr_write_b32 a248, v217
    v_accvgpr_read_b32 v217, a249
    v_mul_f32 v217, v217, v218
    v_accvgpr_write_b32 a249, v217
    v_accvgpr_read_b32 v217, a250
    v_mul_f32 v217, v217, v218
    v_accvgpr_write_b32 a250, v217
    v_accvgpr_read_b32 v217, a251
    v_mul_f32 v217, v217, v218
    v_accvgpr_write_b32 a251, v217
    v_accvgpr_read_b32 v217, a252
    v_mul_f32 v217, v217, v218
    v_accvgpr_write_b32 a252, v217
    v_accvgpr_read_b32 v217, a253
    v_mul_f32 v217, v217, v218
    v_accvgpr_write_b32 a253, v217
    v_accvgpr_read_b32 v217, a254
    v_mul_f32 v217, v217, v218
    v_accvgpr_write_b32 a254, v217
    v_accvgpr_read_b32 v217, a255
    v_mul_f32 v217, v217, v218
    v_accvgpr_write_b32 a255, v217
    s_nop 1
    s_branch K1_back_o7
K1_rare_o8:
    v_mov_b32 v218, v217
    s_nop 1
    v_permlane16_swap_b32 v218, v217
    s_nop 1
    v_max_f32 v217, v217, v218
    v_mov_b32 v218, v217
    s_nop 1
    v_permlane32_swap_b32 v218, v217
    s_nop 1
    v_max_f32 v217, v217, v218
    v_max_f32 v217, 0, v217
    v_sub_f32 v218, 0, v217
    v_exp_f32 v218, v218
    v_sub_f32 v200, v200, v217
    v_sub_f32 v201, v201, v217
    v_sub_f32 v202, v202, v217
    v_sub_f32 v203, v203, v217
    v_sub_f32 v152, v152, v217
    v_sub_f32 v153, v153, v217
    v_sub_f32 v154, v154, v217
    v_sub_f32 v155, v155, v217
    v_sub_f32 v156, v156, v217
    v_sub_f32 v157, v157, v217
    v_sub_f32 v158, v158, v217
    v_sub_f32 v159, v159, v217
    s_mov_b32 s56, 0x0
    s_mov_b32 s57, 0xffff
    v_cndmask_b32 v217, 1.0, v218, s[56:57]
    v_mul_f32 v204, v204, v217
    v_mul_f32 v224, v224, v218
    v_mul_f32 v225, v225, v218
    v_mul_f32 v226, v226, v218
    v_mul_f32 v227, v227, v218
    v_mul_f32 v228, v228, v218
    v_mul_f32 v229, v229, v218
    v_mul_f32 v230, v230, v218
    v_mul_f32 v231, v231, v218
    v_mul_f32 v232, v232, v218
    v_mul_f32 v233, v233, v218
    v_mul_f32 v234, v234, v218
    v_mul_f32 v235, v235, v218
    v_mul_f32 v236, v236, v218
    v_mul_f32 v237, v237, v218
    v_mul_f32 v238, v238, v218
    v_mul_f32 v239, v239, v218
    v_mul_f32 v240, v240, v218
    v_mul_f32 v241, v241, v218
    v_mul_f32 v242, v242, v218
    v_mul_f32 v243, v243, v218
    v_mul_f32 v244, v244, v218
    v_mul_f32 v245, v245, v218
    v_mul_f32 v246, v246, v218
    v_mul_f32 v247, v247, v218
    v_mul_f32 v248, v248, v218
    v_mul_f32 v249, v249, v218
    v_mul_f32 v250, v250, v218
    v_mul_f32 v251, v251, v218
    v_mul_f32 v252, v252, v218
    v_mul_f32 v253, v253, v218
    v_mul_f32 v254, v254, v218
    v_mul_f32 v255, v255, v218
    s_nop 1
    s_branch K1_back_o8
K1_rare_e0:
    v_mov_b32 v218, v217
    s_nop 1
    v_permlane16_swap_b32 v218, v217
    s_nop 1
    v_max_f32 v217, v217, v218
    v_mov_b32 v218, v217
    s_nop 1
    v_permlane32_swap_b32 v218, v217
    s_nop 1
    v_max_f32 v217, v217, v218
    v_max_f32 v217, 0, v217
    v_sub_f32 v218, 0, v217
    v_exp_f32 v218, v218
    v_sub_f32 v168, v168, v217
    v_sub_f32 v169, v169, v217
    v_sub_f32 v170, v170, v217
    v_sub_f32 v171, v171, v217
    v_sub_f32 v144, v144, v217
    v_sub_f32 v145, v145, v217
    v_sub_f32 v146, v146, v217
    v_sub_f32 v147, v147, v217
    v_sub_f32 v148, v148, v217
    v_sub_f32 v149, v149, v217
    v_sub_f32 v150, v150, v217
    v_sub_f32 v151, v151, v217
    s_mov_b32 s56, 0xffff
    s_mov_b32 s57, 0x0
    v_cndmask_b32 v217, 1.0, v218, s[56:57]
    v_mul_f32 v204, v204, v217
    v_accvgpr_read_b32 v217, a0
    v_mul_f32 v217, v217, v218
    v_accvgpr_write_b32 a0, v217
    v_accvgpr_read_b32 v217, a1
    v_mul_f32 v217, v217, v218
    v_accvgpr_write_b32 a1, v217
    v_accvgpr_read_b32 v217, a2
    v_mul_f32 v217, v217, v218
    v_accvgpr_write_b32 a2, v217
    v_accvgpr_read_b32 v217, a3
    v_mul_f32 v217, v217, v218
    v_accvgpr_write_b32 a3, v217
    v_accvgpr_read_b32 v217, a4
    v_mul_f32 v217, v217, v218
    v_accvgpr_write_b32 a4, v217
    v_accvgpr_read_b32 v217, a5
    v_mul_f32 v217, v217, v218
    v_accvgpr_write_b32 a5, v217
    v_accvgpr_read_b32 v217, a6
    v_mul_f32 v217, v217, v218
    v_accvgpr_write_b32 a6, v217
    v_accvgpr_read_b32 v217, a7
    v_mul_f32 v217, v217, v218
    v_accvgpr_write_b32 a7, v217
    v_accvgpr_read_b32 v217, a8
    v_mul_f32 v217, v217, v218
    v_accvgpr_write_b32 a8, v217
    v_accvgpr_read_b32 v217, a9
    v_mul_f32 v217, v217, v218
    v_accvgpr_write_b32 a9, v217
    v_accvgpr_read_b32 v217, a10
    v_mul_f32 v217, v217, v218
    v_accvgpr_write_b32 a10, v217
    v_accvgpr_read_b32 v217, a11
    v_mul_f32 v217, v217, v218
    v_accvgpr_write_b32 a11, v217
    v_accvgpr_read_b32 v217, a12
    v_mul_f32 v217, v217, v218
    v_accvgpr_write_b32 a12, v217
    v_accvgpr_read_b32 v217, a13
    v_mul_f32 v217, v217, v218
    v_accvgpr_write_b32 a13, v217
    v_accvgpr_read_b32 v217, a14
    v_mul_f32 v217, v217, v218
    v_accvgpr_write_b32 a14, v217
    v_accvgpr_read_b32 v217, a15
    v_mul_f32 v217, v217, v218
    v_accvgpr_write_b32 a15, v217
    v_accvgpr_read_b32 v217, a16
    v_mul_f32 v217, v217, v218
    v_accvgpr_write_b32 a16, v217
    v_accvgpr_read_b32 v217, a17
    v_mul_f32 v217, v217, v218
    v_accvgpr_write_b32 a17, v217
    v_accvgpr_read_b32 v217, a18
    v_mul_f32 v217, v217, v218
    v_accvgpr_write_b32 a18, v217
    v_accvgpr_read_b32 v217, a19
    v_mul_f32 v217, v217, v218
    v_accvgpr_write_b32 a19, v217
    v_accvgpr_read_b32 v217, a20
    v_mul_f32 v217, v217, v218
    v_accvgpr_write_b32 a20, v217
    v_accvgpr_read_b32 v217, a21
    v_mul_f32 v217, v217, v218
    v_accvgpr_write_b32 a21, v217
    v_accvgpr_read_b32 v217, a22
    v_mul_f32 v217, v217, v218
    v_accvgpr_write_b32 a22, v217
    v_accvgpr_read_b32 v217, a23
    v_mul_f32 v217, v217, v218
    v_accvgpr_write_b32 a23, v217
    v_accvgpr_read_b32 v217, a24
    v_mul_f32 v217, v217, v218
    v_accvgpr_write_b32 a24, v217
    v_accvgpr_read_b32 v217, a25
    v_mul_f32 v217, v217, v218
    v_accvgpr_write_b32 a25, v217
    v_accvgpr_read_b32 v217, a26
    v_mul_f32 v217, v217, v218
    v_accvgpr_write_b32 a26, v217
    v_accvgpr_read_b32 v217, a27
    v_mul_f32 v217, v217, v218
    v_accvgpr_write_b32 a27, v217
    v_accvgpr_read_b32 v217, a28
    v_mul_f32 v217, v217, v218
    v_accvgpr_write_b32 a28, v217
    v_accvgpr_read_b32 v217, a29
    v_mul_f32 v217, v217, v218
    v_accvgpr_write_b32 a29, v217
    v_accvgpr_read_b32 v217, a30
    v_mul_f32 v217, v217, v218
    v_accvgpr_write_b32 a30, v217
    v_accvgpr_read_b32 v217, a31
    v_mul_f32 v217, v217, v218
    v_accvgpr_write_b32 a31, v217
    s_nop 1
    s_branch K1_back_e0
K1_rare_e1:
    v_mov_b32 v218, v217
    s_nop 1
    v_permlane16_swap_b32 v218, v217
    s_nop 1
    v_max_f32 v217, v217, v218
    v_mov_b32 v218, v217
    s_nop 1
    v_permlane32_swap_b32 v218, v217
    s_nop 1
    v_max_f32 v217, v217, v218
    v_max_f32 v217, 0, v217
    v_sub_f32 v218, 0, v217
    v_exp_f32 v218, v218
    v_sub_f32 v172, v172, v217
    v_sub_f32 v173, v173, v217
    v_sub_f32 v174, v174, v217
    v_sub_f32 v175, v175, v217
    v_sub_f32 v152, v152, v217
    v_sub_f32 v153, v153, v217
    v_sub_f32 v154, v154, v217
    v_sub_f32 v155, v155, v217
    v_sub_f32 v156, v156, v217
    v_sub_f32 v157, v157, v217
    v_sub_f32 v158, v158, v217
    v_sub_f32 v159, v159, v217
    s_mov_b32 s56, 0xffff
    s_mov_b32 s57, 0x0
    v_cndmask_b32 v217, 1.0, v218, s[56:57]
    v_mul_f32 v205, v205, v217
    v_accvgpr_read_b32 v217, a32
    v_mul_f32 v217, v217, v218
    v_accvgpr_write_b32 a32, v217
    v_accvgpr_read_b32 v217, a33
    v_mul_f32 v217, v217, v218
    v_accvgpr_write_b32 a33, v217
    v_accvgpr_read_b32 v217, a34
    v_mul_f32 v217, v217, v218
    v_accvgpr_write_b32 a34, v217
    v_accvgpr_read_b32 v217, a35
    v_mul_f32 v217, v217, v218
    v_accvgpr_write_b32 a35, v217
    v_accvgpr_read_b32 v217, a36
    v_mul_f32 v217, v217, v218
    v_accvgpr_write_b32 a36, v217
    v_accvgpr_read_b32 v217, a37
    v_mul_f32 v217, v217, v218
    v_accvgpr_write_b32 a37, v217
    v_accvgpr_read_b32 v217, a38
    v_mul_f32 v217, v217, v218
    v_accvgpr_write_b32 a38, v217
    v_accvgpr_read_b32 v217, a39
    v_mul_f32 v217, v217, v218
    v_accvgpr_write_b32 a39, v217
    v_accvgpr_read_b32 v217, a40
    v_mul_f32 v217, v217, v218
    v_accvgpr_write_b32 a40, v217
    v_accvgpr_read_b32 v217, a41
    v_mul_f32 v217, v217, v218
    v_accvgpr_write_b32 a41, v217
    v_accvgpr_read_b32 v217, a42
    v_mul_f32 v217, v217, v218
    v_accvgpr_write_b32 a42, v217
    v_accvgpr_read_b32 v217, a43
    v_mul_f32 v217, v217, v218
    v_accvgpr_write_b32 a43, v217
    v_accvgpr_read_b32 v217, a44
    v_mul_f32 v217, v217, v218
    v_accvgpr_write_b32 a44, v217
    v_accvgpr_read_b32 v217, a45
    v_mul_f32 v217, v217, v218
    v_accvgpr_write_b32 a45, v217
    v_accvgpr_read_b32 v217, a46
    v_mul_f32 v217, v217, v218
    v_accvgpr_write_b32 a46, v217
    v_accvgpr_read_b32 v217, a47
    v_mul_f32 v217, v217, v218
    v_accvgpr_write_b32 a47, v217
    v_accvgpr_read_b32 v217, a48
    v_mul_f32 v217, v217, v218
    v_accvgpr_write_b32 a48, v217
    v_accvgpr_read_b32 v217, a49
    v_mul_f32 v217, v217, v218
    v_accvgpr_write_b32 a49, v217
    v_accvgpr_read_b32 v217, a50
    v_mul_f32 v217, v217, v218
    v_accvgpr_write_b32 a50, v217
    v_accvgpr_read_b32 v217, a51
    v_mul_f32 v217, v217, v218
    v_accvgpr_write_b32 a51, v217
    v_accvgpr_read_b32 v217, a52
    v_mul_f32 v217, v217, v218
    v_accvgpr_write_b32 a52, v217
    v_accvgpr_read_b32 v217, a53
    v_mul_f32 v217, v217, v218
    v_accvgpr_write_b32 a53, v217
    v_accvgpr_read_b32 v217, a54
    v_mul_f32 v217, v217, v218
    v_accvgpr_write_b32 a54, v217
    v_accvgpr_read_b32 v217, a55
    v_mul_f32 v217, v217, v218
    v_accvgpr_write_b32 a55, v217
    v_accvgpr_read_b32 v217, a56
    v_mul_f32 v217, v217, v218
    v_accvgpr_write_b32 a56, v217
    v_accvgpr_read_b32 v217, a57
    v_mul_f32 v217, v217, v218
    v_accvgpr_write_b32 a57, v217
    v_accvgpr_read_b32 v217, a58
    v_mul_f32 v217, v217, v218
    v_accvgpr_write_b32 a58, v217
    v_accvgpr_read_b32 v217, a59
    v_mul_f32 v217, v217, v218
    v_accvgpr_write_b32 a59, v217
    v_accvgpr_read_b32 v217, a60
    v_mul_f32 v217, v217, v218
    v_accvgpr_write_b32 a60, v217
    v_accvgpr_read_b32 v217, a61
    v_mul_f32 v217, v217, v218
    v_accvgpr_write_b32 a61, v217
    v_accvgpr_read_b32 v217, a62
    v_mul_f32 v217, v217, v218
    v_accvgpr_write_b32 a62, v217
    v_accvgpr_read_b32 v217, a63
    v_mul_f32 v217, v217, v218
    v_accvgpr_write_b32 a63, v217
    s_nop 1
    s_branch K1_back_e1
K1_rare_e2:
    v_mov_b32 v218, v217
    s_nop 1
    v_permlane16_swap_b32 v218, v217
    s_nop 1
    v_max_f32 v217, v217, v218
    v_mov_b32 v218, v217
    s_nop 1
    v_permlane32_swap_b32 v218, v217
    s_nop 1
    v_max_f32 v217, v217, v218
    v_max_f32 v217, 0, v217
    v_sub_f32 v218, 0, v217
    v_exp_f32 v218, v218
    v_sub_f32 v176, v176, v217
    v_sub_f32 v177, v177, v217
    v_sub_f32 v178, v178, v217
    v_sub_f32 v179, v179, v217
    v_sub_f32 v144, v144, v217
    v_sub_f32 v145, v145, v217
    v_sub_f32 v146, v146, v217
    v_sub_f32 v147, v147, v217
    v_sub_f32 v148, v148, v217
    v_sub_f32 v149, v149, v217
    v_sub_f32 v150, v150, v217
    v_sub_f32 v151, v151, v217
    s_mov_b32 s56, 0xffff
    s_mov_b32 s57, 0x0
    v_cndmask_b32 v217, 1.0, v218, s[56:57]
    v_mul_f32 v206, v206, v217
    v_accvgpr_read_b32 v217, a64
    v_mul_f32 v217, v217, v218
    v_accvgpr_write_b32 a64, v217
    v_accvgpr_read_b32 v217, a65
    v_mul_f32 v217, v217, v218
    v_accvgpr_write_b32 a65, v217
    v_accvgpr_read_b32 v217, a66
    v_mul_f32 v217, v217, v218
    v_accvgpr_write_b32 a66, v217
    v_accvgpr_read_b32 v217, a67
    v_mul_f32 v217, v217, v218
    v_accvgpr_write_b32 a67, v217
    v_accvgpr_read_b32 v217, a68
    v_mul_f32 v217, v217, v218
    v_accvgpr_write_b32 a68, v217
    v_accvgpr_read_b32 v217, a69
    v_mul_f32 v217, v217, v218
    v_accvgpr_write_b32 a69, v217
    v_accvgpr_read_b32 v217, a70
    v_mul_f32 v217, v217, v218
    v_accvgpr_write_b32 a70, v217
    v_accvgpr_read_b32 v217, a71
    v_mul_f32 v217, v217, v218
    v_accvgpr_write_b32 a71, v217
    v_accvgpr_read_b32 v217, a72
    v_mul_f32 v217, v217, v218
    v_accvgpr_write_b32 a72, v217
    v_accvgpr_read_b32 v217, a73
    v_mul_f32 v217, v217, v218
    v_accvgpr_write_b32 a73, v217
    v_accvgpr_read_b32 v217, a74
    v_mul_f32 v217, v217, v218
    v_accvgpr_write_b32 a74, v217
    v_accvgpr_read_b32 v217, a75
    v_mul_f32 v217, v217, v218
    v_accvgpr_write_b32 a75, v217
    v_accvgpr_read_b32 v217, a76
    v_mul_f32 v217, v217, v218
    v_accvgpr_write_b32 a76, v217
    v_accvgpr_read_b32 v217, a77
    v_mul_f32 v217, v217, v218
    v_accvgpr_write_b32 a77, v217
    v_accvgpr_read_b32 v217, a78
    v_mul_f32 v217, v217, v218
    v_accvgpr_write_b32 a78, v217
    v_accvgpr_read_b32 v217, a79
    v_mul_f32 v217, v217, v218
    v_accvgpr_write_b32 a79, v217
    v_accvgpr_read_b32 v217, a80
    v_mul_f32 v217, v217, v218
    v_accvgpr_write_b32 a80, v217
    v_accvgpr_read_b32 v217, a81
    v_mul_f32 v217, v217, v218
    v_accvgpr_write_b32 a81, v217
    v_accvgpr_read_b32 v217, a82
    v_mul_f32 v217, v217, v218
    v_accvgpr_write_b32 a82, v217
    v_accvgpr_read_b32 v217, a83
    v_mul_f32 v217, v217, v218
    v_accvgpr_write_b32 a83, v217
    v_accvgpr_read_b32 v217, a84
    v_mul_f32 v217, v217, v218
    v_accvgpr_write_b32 a84, v217
    v_accvgpr_read_b32 v217, a85
    v_mul_f32 v217, v217, v218
    v_accvgpr_write_b32 a85, v217
    v_accvgpr_read_b32 v217, a86
    v_mul_f32 v217, v217, v218
    v_accvgpr_write_b32 a86, v217
    v_accvgpr_read_b32 v217, a87
    v_mul_f32 v217, v217, v218
    v_accvgpr_write_b32 a87, v217
    v_accvgpr_read_b32 v217, a88
    v_mul_f32 v217, v217, v218
    v_accvgpr_write_b32 a88, v217
    v_accvgpr_read_b32 v217, a89
    v_mul_f32 v217, v217, v218
    v_accvgpr_write_b32 a89, v217
    v_accvgpr_read_b32 v217, a90
    v_mul_f32 v217, v217, v218
    v_accvgpr_write_b32 a90, v217
    v_accvgpr_read_b32 v217, a91
    v_mul_f32 v217, v217, v218
    v_accvgpr_write_b32 a91, v217
    v_accvgpr_read_b32 v217, a92
    v_mul_f32 v217, v217, v218
    v_accvgpr_write_b32 a92, v217
    v_accvgpr_read_b32 v217, a93
    v_mul_f32 v217, v217, v218
    v_accvgpr_write_b32 a93, v217
    v_accvgpr_read_b32 v217, a94
    v_mul_f32 v217, v217, v218
    v_accvgpr_write_b32 a94, v217
    v_accvgpr_read_b32 v217, a95
    v_mul_f32 v217, v217, v218
    v_accvgpr_write_b32 a95, v217
    s_nop 1
    s_branch K1_back_e2
K1_rare_e3:
    v_mov_b32 v218, v217
    s_nop 1
    v_permlane16_swap_b32 v218, v217
    s_nop 1
    v_max_f32 v217, v217, v218
    v_mov_b32 v218, v217
    s_nop 1
    v_permlane32_swap_b32 v218, v217
    s_nop 1
    v_max_f32 v217, v217, v218
    v_max_f32 v217, 0, v217
    v_sub_f32 v218, 0, v217
    v_exp_f32 v218, v218
    v_sub_f32 v180, v180, v217
    v_sub_f32 v181, v181, v217
    v_sub_f32 v182, v182, v217
    v_sub_f32 v183, v183, v217
    v_sub_f32 v152, v152, v217
    v_sub_f32 v153, v153, v217
    v_sub_f32 v154, v154, v217
    v_sub_f32 v155, v155, v217
    v_sub_f32 v156, v156, v217
    v_sub_f32 v157, v157, v217
    v_sub_f32 v158, v158, v217
    v_sub_f32 v159, v159, v217
    s_mov_b32 s56, 0xffff
    s_mov_b32 s57, 0x0
    v_cndmask_b32 v217, 1.0, v218, s[56:57]
    v_mul_f32 v207, v207, v217
    v_accvgpr_read_b32 v217, a96
    v_mul_f32 v217, v217, v218
    v_accvgpr_write_b32 a96, v217
    v_accvgpr_read_b32 v217, a97
    v_mul_f32 v217, v217, v218
    v_accvgpr_write_b32 a97, v217
    v_accvgpr_read_b32 v217, a98
    v_mul_f32 v217, v217, v218
    v_accvgpr_write_b32 a98, v217
    v_accvgpr_read_b32 v217, a99
    v_mul_f32 v217, v217, v218
    v_accvgpr_write_b32 a99, v217
    v_accvgpr_read_b32 v217, a100
    v_mul_f32 v217, v217, v218
    v_accvgpr_write_b32 a100, v217
    v_accvgpr_read_b32 v217, a101
    v_mul_f32 v217, v217, v218
    v_accvgpr_write_b32 a101, v217
    v_accvgpr_read_b32 v217, a102
    v_mul_f32 v217, v217, v218
    v_accvgpr_write_b32 a102, v217
    v_accvgpr_read_b32 v217, a103
    v_mul_f32 v217, v217, v218
    v_accvgpr_write_b32 a103, v217
    v_accvgpr_read_b32 v217, a104
    v_mul_f32 v217, v217, v218
    v_accvgpr_write_b32 a104, v217
    v_accvgpr_read_b32 v217, a105
    v_mul_f32 v217, v217, v218
    v_accvgpr_write_b32 a105, v217
    v_accvgpr_read_b32 v217, a106
    v_mul_f32 v217, v217, v218
    v_accvgpr_write_b32 a106, v217
    v_accvgpr_read_b32 v217, a107
    v_mul_f32 v217, v217, v218
    v_accvgpr_write_b32 a107, v217
    v_accvgpr_read_b32 v217, a108
    v_mul_f32 v217, v217, v218
    v_accvgpr_write_b32 a108, v217
    v_accvgpr_read_b32 v217, a109
    v_mul_f32 v217, v217, v218
    v_accvgpr_write_b32 a109, v217
    v_accvgpr_read_b32 v217, a110
    v_mul_f32 v217, v217, v218
    v_accvgpr_write_b32 a110, v217
    v_accvgpr_read_b32 v217, a111
    v_mul_f32 v217, v217, v218
    v_accvgpr_write_b32 a111, v217
    v_accvgpr_read_b32 v217, a112
    v_mul_f32 v217, v217, v218
    v_accvgpr_write_b32 a112, v217
    v_accvgpr_read_b32 v217, a113
    v_mul_f32 v217, v217, v218
    v_accvgpr_write_b32 a113, v217
    v_accvgpr_read_b32 v217, a114
    v_mul_f32 v217, v217, v218
    v_accvgpr_write_b32 a114, v217
    v_accvgpr_read_b32 v217, a115
    v_mul_f32 v217, v217, v218
    v_accvgpr_write_b32 a115, v217
    v_accvgpr_read_b32 v217, a116
    v_mul_f32 v217, v217, v218
    v_accvgpr_write_b32 a116, v217
    v_accvgpr_read_b32 v217, a117
    v_mul_f32 v217, v217, v218
    v_accvgpr_write_b32 a117, v217
    v_accvgpr_read_b32 v217, a118
    v_mul_f32 v217, v217, v218
    v_accvgpr_write_b32 a118, v217
    v_accvgpr_read_b32 v217, a119
    v_mul_f32 v217, v217, v218
    v_accvgpr_write_b32 a119, v217
    v_accvgpr_read_b32 v217, a120
    v_mul_f32 v217, v217, v218
    v_accvgpr_write_b32 a120, v217
    v_accvgpr_read_b32 v217, a121
    v_mul_f32 v217, v217, v218
    v_accvgpr_write_b32 a121, v217
    v_accvgpr_read_b32 v217, a122
    v_mul_f32 v217, v217, v218
    v_accvgpr_write_b32 a122, v217
    v_accvgpr_read_b32 v217, a123
    v_mul_f32 v217, v217, v218
    v_accvgpr_write_b32 a123, v217
    v_accvgpr_read_b32 v217, a124
    v_mul_f32 v217, v217, v218
    v_accvgpr_write_b32 a124, v217
    v_accvgpr_read_b32 v217, a125
    v_mul_f32 v217, v217, v218
    v_accvgpr_write_b32 a125, v217
    v_accvgpr_read_b32 v217, a126
    v_mul_f32 v217, v217, v218
    v_accvgpr_write_b32 a126, v217
    v_accvgpr_read_b32 v217, a127
    v_mul_f32 v217, v217, v218
    v_accvgpr_write_b32 a127, v217
    s_nop 1
    s_branch K1_back_e3
K1_rare_e4:
    v_mov_b32 v218, v217
    s_nop 1
    v_permlane16_swap_b32 v218, v217
    s_nop 1
    v_max_f32 v217, v217, v218
    v_mov_b32 v218, v217
    s_nop 1
    v_permlane32_swap_b32 v218, v217
    s_nop 1
    v_max_f32 v217, v217, v218
    v_max_f32 v217, 0, v217
    v_sub_f32 v218, 0, v217
    v_exp_f32 v218, v218
    v_sub_f32 v184, v184, v217
    v_sub_f32 v185, v185, v217
    v_sub_f32 v186, v186, v217
    v_sub_f32 v187, v187, v217
    v_sub_f32 v144, v144, v217
    v_sub_f32 v145, v145, v217
    v_sub_f32 v146, v146, v217
    v_sub_f32 v147, v147, v217
    v_sub_f32 v148, v148, v217
    v_sub_f32 v149, v149, v217
    v_sub_f32 v150, v150, v217
    v_sub_f32 v151, v151, v217
    s_mov_b32 s56, 0xffff0000
    s_mov_b32 s57, 0x0
    v_cndmask_b32 v217, 1.0, v218, s[56:57]
    v_mul_f32 v204, v204, v217
    v_accvgpr_read_b32 v217, a128
    v_mul_f32 v217, v217, v218
    v_accvgpr_write_b32 a128, v217
    v_accvgpr_read_b32 v217, a129
    v_mul_f32 v217, v217, v218
    v_accvgpr_write_b32 a129, v217
    v_accvgpr_read_b32 v217, a130
    v_mul_f32 v217, v217, v218
    v_accvgpr_write_b32 a130, v217
    v_accvgpr_read_b32 v217, a131
    v_mul_f32 v217, v217, v218
    v_accvgpr_write_b32 a131, v217
    v_accvgpr_read_b32 v217, a132
    v_mul_f32 v217, v217, v218
    v_accvgpr_write_b32 a132, v217
    v_accvgpr_read_b32 v217, a133
    v_mul_f32 v217, v217, v218
    v_accvgpr_write_b32 a133, v217
    v_accvgpr_read_b32 v217, a134
    v_mul_f32 v217, v217, v218
    v_accvgpr_write_b32 a134, v217
    v_accvgpr_read_b32 v217, a135
    v_mul_f32 v217, v217, v218
    v_accvgpr_write_b32 a135, v217
    v_accvgpr_read_b32 v217, a136
    v_mul_f32 v217, v217, v218
    v_accvgpr_write_b32 a136, v217
    v_accvgpr_read_b32 v217, a137
    v_mul_f32 v217, v217, v218
    v_accvgpr_write_b32 a137, v217
    v_accvgpr_read_b32 v217, a138
    v_mul_f32 v217, v217, v218
    v_accvgpr_write_b32 a138, v217
    v_accvgpr_read_b32 v217, a139
    v_mul_f32 v217, v217, v218
    v_accvgpr_write_b32 a139, v217
    v_accvgpr_read_b32 v217, a140
    v_mul_f32 v217, v217, v218
    v_accvgpr_write_b32 a140, v217
    v_accvgpr_read_b32 v217, a141
    v_mul_f32 v217, v217, v218
    v_accvgpr_write_b32 a141, v217
    v_accvgpr_read_b32 v217, a142
    v_mul_f32 v217, v217, v218
    v_accvgpr_write_b32 a142, v217
    v_accvgpr_read_b32 v217, a143
    v_mul_f32 v217, v217, v218
    v_accvgpr_write_b32 a143, v217
    v_accvgpr_read_b32 v217, a144
    v_mul_f32 v217, v217, v218
    v_accvgpr_write_b32 a144, v217
    v_accvgpr_read_b32 v217, a145
    v_mul_f32 v217, v217, v218
    v_accvgpr_write_b32 a145, v217
    v_accvgpr_read_b32 v217, a146
    v_mul_f32 v217, v217, v218
    v_accvgpr_write_b32 a146, v217
    v_accvgpr_read_b32 v217, a147
    v_mul_f32 v217, v217, v218
    v_accvgpr_write_b32 a147, v217
    v_accvgpr_read_b32 v217, a148
    v_mul_f32 v217, v217, v218
    v_accvgpr_write_b32 a148, v217
    v_accvgpr_read_b32 v217, a149
    v_mul_f32 v217, v217, v218
    v_accvgpr_write_b32 a149, v217
    v_accvgpr_read_b32 v217, a150
    v_mul_f32 v217, v217, v218
    v_accvgpr_write_b32 a150, v217
    v_accvgpr_read_b32 v217, a151
    v_mul_f32 v217, v217, v218
    v_accvgpr_write_b32 a151, v217
    v_accvgpr_read_b32 v217, a152
    v_mul_f32 v217, v217, v218
    v_accvgpr_write_b32 a152, v217
    v_accvgpr_read_b32 v217, a153
    v_mul_f32 v217, v217, v218
    v_accvgpr_write_b32 a153, v217
    v_accvgpr_read_b32 v217, a154
    v_mul_f32 v217, v217, v218
    v_accvgpr_write_b32 a154, v217
    v_accvgpr_read_b32 v217, a155
    v_mul_f32 v217, v217, v218
    v_accvgpr_write_b32 a155, v217
    v_accvgpr_read_b32 v217, a156
    v_mul_f32 v217, v217, v218
    v_accvgpr_write_b32 a156, v217
    v_accvgpr_read_b32 v217, a157
    v_mul_f32 v217, v217, v218
    v_accvgpr_write_b32 a157, v217
    v_accvgpr_read_b32 v217, a158
    v_mul_f32 v217, v217, v218
    v_accvgpr_write_b32 a158, v217
    v_accvgpr_read_b32 v217, a159
    v_mul_f32 v217, v217, v218
    v_accvgpr_write_b32 a159, v217
    s_nop 1
    s_branch K1_back_e4
K1_rare_e5:
    v_mov_b32 v218, v217
    s_nop 1
    v_permlane16_swap_b32 v218, v217
    s_nop 1
    v_max_f32 v217, v217, v218
    v_mov_b32 v218, v217
    s_nop 1
    v_permlane32_swap_b32 v218, v217
    s_nop 1
    v_max_f32 v217, v217, v218
    v_max_f32 v217, 0, v217
    v_sub_f32 v218, 0, v217
    v_exp_f32 v218, v218
    v_sub_f32 v188, v188, v217
    v_sub_f32 v189, v189, v217
    v_sub_f32 v190, v190, v217
    v_sub_f32 v191, v191, v217
    v_sub_f32 v152, v152, v217
    v_sub_f32 v153, v153, v217
    v_sub_f32 v154, v154, v217
    v_sub_f32 v155, v155, v217
    v_sub_f32 v156, v156, v217
    v_sub_f32 v157, v157, v217
    v_sub_f32 v158, v158, v217
    v_sub_f32 v159, v159, v217
    s_mov_b32 s56, 0xffff0000
    s_mov_b32 s57, 0x0
    v_cndmask_b32 v217, 1.0, v218, s[56:57]
    v_mul_f32 v205, v205, v217
    v_accvgpr_read_b32 v217, a160
    v_mul_f32 v217, v217, v218
    v_accvgpr_write_b32 a160, v217
    v_accvgpr_read_b32 v217, a161
    v_mul_f32 v217, v217, v218
    v_accvgpr_write_b32 a161, v217
    v_accvgpr_read_b32 v217, a162
    v_mul_f32 v217, v217, v218
    v_accvgpr_write_b32 a162, v217
    v_accvgpr_read_b32 v217, a163
    v_mul_f32 v217, v217, v218
    v_accvgpr_write_b32 a163, v217
    v_accvgpr_read_b32 v217, a164
    v_mul_f32 v217, v217, v218
    v_accvgpr_write_b32 a164, v217
    v_accvgpr_read_b32 v217, a165
    v_mul_f32 v217, v217, v218
    v_accvgpr_write_b32 a165, v217
    v_accvgpr_read_b32 v217, a166
    v_mul_f32 v217, v217, v218
    v_accvgpr_write_b32 a166, v217
    v_accvgpr_read_b32 v217, a167
    v_mul_f32 v217, v217, v218
    v_accvgpr_write_b32 a167, v217
    v_accvgpr_read_b32 v217, a168
    v_mul_f32 v217, v217, v218
    v_accvgpr_write_b32 a168, v217
    v_accvgpr_read_b32 v217, a169
    v_mul_f32 v217, v217, v218
    v_accvgpr_write_b32 a169, v217
    v_accvgpr_read_b32 v217, a170
    v_mul_f32 v217, v217, v218
    v_accvgpr_write_b32 a170, v217
    v_accvgpr_read_b32 v217, a171
    v_mul_f32 v217, v217, v218
    v_accvgpr_write_b32 a171, v217
    v_accvgpr_read_b32 v217, a172
    v_mul_f32 v217, v217, v218
    v_accvgpr_write_b32 a172, v217
    v_accvgpr_read_b32 v217, a173
    v_mul_f32 v217, v217, v218
    v_accvgpr_write_b32 a173, v217
    v_accvgpr_read_b32 v217, a174
    v_mul_f32 v217, v217, v218
    v_accvgpr_write_b32 a174, v217
    v_accvgpr_read_b32 v217, a175
    v_mul_f32 v217, v217, v218
    v_accvgpr_write_b32 a175, v217
    v_accvgpr_read_b32 v217, a176
    v_mul_f32 v217, v217, v218
    v_accvgpr_write_b32 a176, v217
    v_accvgpr_read_b32 v217, a177
    v_mul_f32 v217, v217, v218
    v_accvgpr_write_b32 a177, v217
    v_accvgpr_read_b32 v217, a178
    v_mul_f32 v217, v217, v218
    v_accvgpr_write_b32 a178, v217
    v_accvgpr_read_b32 v217, a179
    v_mul_f32 v217, v217, v218
    v_accvgpr_write_b32 a179, v217
    v_accvgpr_read_b32 v217, a180
    v_mul_f32 v217, v217, v218
    v_accvgpr_write_b32 a180, v217
    v_accvgpr_read_b32 v217, a181
    v_mul_f32 v217, v217, v218
    v_accvgpr_write_b32 a181, v217
    v_accvgpr_read_b32 v217, a182
    v_mul_f32 v217, v217, v218
    v_accvgpr_write_b32 a182, v217
    v_accvgpr_read_b32 v217, a183
    v_mul_f32 v217, v217, v218
    v_accvgpr_write_b32 a183, v217
    v_accvgpr_read_b32 v217, a184
    v_mul_f32 v217, v217, v218
    v_accvgpr_write_b32 a184, v217
    v_accvgpr_read_b32 v217, a185
    v_mul_f32 v217, v217, v218
    v_accvgpr_write_b32 a185, v217
    v_accvgpr_read_b32 v217, a186
    v_mul_f32 v217, v217, v218
    v_accvgpr_write_b32 a186, v217
    v_accvgpr_read_b32 v217, a187
    v_mul_f32 v217, v217, v218
    v_accvgpr_write_b32 a187, v217
    v_accvgpr_read_b32 v217, a188
    v_mul_f32 v217, v217, v218
    v_accvgpr_write_b32 a188, v217
    v_accvgpr_read_b32 v217, a189
    v_mul_f32 v217, v217, v218
    v_accvgpr_write_b32 a189, v217
    v_accvgpr_read_b32 v217, a190
    v_mul_f32 v217, v217, v218
    v_accvgpr_write_b32 a190, v217
    v_accvgpr_read_b32 v217, a191
    v_mul_f32 v217, v217, v218
    v_accvgpr_write_b32 a191, v217
    s_nop 1
    s_branch K1_back_e5
K1_rare_e6:
    v_mov_b32 v218, v217
    s_nop 1
    v_permlane16_swap_b32 v218, v217
    s_nop 1
    v_max_f32 v217, v217, v218
    v_mov_b32 v218, v217
    s_nop 1
    v_permlane32_swap_b32 v218, v217
    s_nop 1
    v_max_f32 v217, v217, v218
    v_max_f32 v217, 0, v217
    v_sub_f32 v218, 0, v217
    v_exp_f32 v218, v218
    v_sub_f32 v192, v192, v217
    v_sub_f32 v193, v193, v217
    v_sub_f32 v194, v194, v217
    v_sub_f32 v195, v195, v217
    v_sub_f32 v144, v144, v217
    v_sub_f32 v145, v145, v217
    v_sub_f32 v146, v146, v217
    v_sub_f32 v147, v147, v217
    v_sub_f32 v148, v148, v217
    v_sub_f32 v149, v149, v217
    v_sub_f32 v150, v150, v217
    v_sub_f32 v151, v151, v217
    s_mov_b32 s56, 0xffff0000
    s_mov_b32 s57, 0x0
    v_cndmask_b32 v217, 1.0, v218, s[56:57]
    v_mul_f32 v206, v206, v217
    v_accvgpr_read_b32 v217, a192
    v_mul_f32 v217, v217, v218
    v_accvgpr_write_b32 a192, v217
    v_accvgpr_read_b32 v217, a193
    v_mul_f32 v217, v217, v218
    v_accvgpr_write_b32 a193, v217
    v_accvgpr_read_b32 v217, a194
    v_mul_f32 v217, v217, v218
    v_accvgpr_write_b32 a194, v217
    v_accvgpr_read_b32 v217, a195
    v_mul_f32 v217, v217, v218
    v_accvgpr_write_b32 a195, v217
    v_accvgpr_read_b32 v217, a196
    v_mul_f32 v217, v217, v218
    v_accvgpr_write_b32 a196, v217
    v_accvgpr_read_b32 v217, a197
    v_mul_f32 v217, v217, v218
    v_accvgpr_write_b32 a197, v217
    v_accvgpr_read_b32 v217, a198
    v_mul_f32 v217, v217, v218
    v_accvgpr_write_b32 a198, v217
    v_accvgpr_read_b32 v217, a199
    v_mul_f32 v217, v217, v218
    v_accvgpr_write_b32 a199, v217
    v_accvgpr_read_b32 v217, a200
    v_mul_f32 v217, v217, v218
    v_accvgpr_write_b32 a200, v217
    v_accvgpr_read_b32 v217, a201
    v_mul_f32 v217, v217, v218
    v_accvgpr_write_b32 a201, v217
    v_accvgpr_read_b32 v217, a202
    v_mul_f32 v217, v217, v218
    v_accvgpr_write_b32 a202, v217
    v_accvgpr_read_b32 v217, a203
    v_mul_f32 v217, v217, v218
    v_accvgpr_write_b32 a203, v217
    v_accvgpr_read_b32 v217, a204
    v_mul_f32 v217, v217, v218
    v_accvgpr_write_b32 a204, v217
    v_accvgpr_read_b32 v217, a205
    v_mul_f32 v217, v217, v218
    v_accvgpr_write_b32 a205, v217
    v_accvgpr_read_b32 v217, a206
    v_mul_f32 v217, v217, v218
    v_accvgpr_write_b32 a206, v217
    v_accvgpr_read_b32 v217, a207
    v_mul_f32 v217, v217, v218
    v_accvgpr_write_b32 a207, v217
    v_accvgpr_read_b32 v217, a208
    v_mul_f32 v217, v217, v218
    v_accvgpr_write_b32 a208, v217
    v_accvgpr_read_b32 v217, a209
    v_mul_f32 v217, v217, v218
    v_accvgpr_write_b32 a209, v217
    v_accvgpr_read_b32 v217, a210
    v_mul_f32 v217, v217, v218
    v_accvgpr_write_b32 a210, v217
    v_accvgpr_read_b32 v217, a211
    v_mul_f32 v217, v217, v218
    v_accvgpr_write_b32 a211, v217
    v_accvgpr_read_b32 v217, a212
    v_mul_f32 v217, v217, v218
    v_accvgpr_write_b32 a212, v217
    v_accvgpr_read_b32 v217, a213
    v_mul_f32 v217, v217, v218
    v_accvgpr_write_b32 a213, v217
    v_accvgpr_read_b32 v217, a214
    v_mul_f32 v217, v217, v218
    v_accvgpr_write_b32 a214, v217
    v_accvgpr_read_b32 v217, a215
    v_mul_f32 v217, v217, v218
    v_accvgpr_write_b32 a215, v217
    v_accvgpr_read_b32 v217, a216
    v_mul_f32 v217, v217, v218
    v_accvgpr_write_b32 a216, v217
    v_accvgpr_read_b32 v217, a217
    v_mul_f32 v217, v217, v218
    v_accvgpr_write_b32 a217, v217
    v_accvgpr_read_b32 v217, a218
    v_mul_f32 v217, v217, v218
    v_accvgpr_write_b32 a218, v217
    v_accvgpr_read_b32 v217, a219
    v_mul_f32 v217, v217, v218
    v_accvgpr_write_b32 a219, v217
    v_accvgpr_read_b32 v217, a220
    v_mul_f32 v217, v217, v218
    v_accvgpr_write_b32 a220, v217
    v_accvgpr_read_b32 v217, a221
    v_mul_f32 v217, v217, v218
    v_accvgpr_write_b32 a221, v217
    v_accvgpr_read_b32 v217, a222
    v_mul_f32 v217, v217, v218
    v_accvgpr_write_b32 a222, v217
    v_accvgpr_read_b32 v217, a223
    v_mul_f32 v217, v217, v218
    v_accvgpr_write_b32 a223, v217
    s_nop 1
    s_branch K1_back_e6
K1_rare_e7:
    v_mov_b32 v218, v217
    s_nop 1
    v_permlane16_swap_b32 v218, v217
    s_nop 1
    v_max_f32 v217, v217, v218
    v_mov_b32 v218, v217
    s_nop 1
    v_permlane32_swap_b32 v218, v217
    s_nop 1
    v_max_f32 v217, v217, v218
    v_max_f32 v217, 0, v217
    v_sub_f32 v218, 0, v217
    v_exp_f32 v218, v218
    v_sub_f32 v196, v196, v217
    v_sub_f32 v197, v197, v217
    v_sub_f32 v198, v198, v217
    v_sub_f32 v199, v199, v217
    v_sub_f32 v152, v152, v217
    v_sub_f32 v153, v153, v217
    v_sub_f32 v154, v154, v217
    v_sub_f32 v155, v155, v217
    v_sub_f32 v156, v156, v217
    v_sub_f32 v157, v157, v217
    v_sub_f32 v158, v158, v217
    v_sub_f32 v159, v159, v217
    s_mov_b32 s56, 0xffff0000
    s_mov_b32 s57, 0x0
    v_cndmask_b32 v217, 1.0, v218, s[56:57]
    v_mul_f32 v207, v207, v217
    v_accvgpr_read_b32 v217, a224
    v_mul_f32 v217, v217, v218
    v_accvgpr_write_b32 a224, v217
    v_accvgpr_read_b32 v217, a225
    v_mul_f32 v217, v217, v218
    v_accvgpr_write_b32 a225, v217
    v_accvgpr_read_b32 v217, a226
    v_mul_f32 v217, v217, v218
    v_accvgpr_write_b32 a226, v217
    v_accvgpr_read_b32 v217, a227
    v_mul_f32 v217, v217, v218
    v_accvgpr_write_b32 a227, v217
    v_accvgpr_read_b32 v217, a228
    v_mul_f32 v217, v217, v218
    v_accvgpr_write_b32 a228, v217
    v_accvgpr_read_b32 v217, a229
    v_mul_f32 v217, v217, v218
    v_accvgpr_write_b32 a229, v217
    v_accvgpr_read_b32 v217, a230
    v_mul_f32 v217, v217, v218
    v_accvgpr_write_b32 a230, v217
    v_accvgpr_read_b32 v217, a231
    v_mul_f32 v217, v217, v218
    v_accvgpr_write_b32 a231, v217
    v_accvgpr_read_b32 v217, a232
    v_mul_f32 v217, v217, v218
    v_accvgpr_write_b32 a232, v217
    v_accvgpr_read_b32 v217, a233
    v_mul_f32 v217, v217, v218
    v_accvgpr_write_b32 a233, v217
    v_accvgpr_read_b32 v217, a234
    v_mul_f32 v217, v217, v218
    v_accvgpr_write_b32 a234, v217
    v_accvgpr_read_b32 v217, a235
    v_mul_f32 v217, v217, v218
    v_accvgpr_write_b32 a235, v217
    v_accvgpr_read_b32 v217, a236
    v_mul_f32 v217, v217, v218
    v_accvgpr_write_b32 a236, v217
    v_accvgpr_read_b32 v217, a237
    v_mul_f32 v217, v217, v218
    v_accvgpr_write_b32 a237, v217
    v_accvgpr_read_b32 v217, a238
    v_mul_f32 v217, v217, v218
    v_accvgpr_write_b32 a238, v217
    v_accvgpr_read_b32 v217, a239
    v_mul_f32 v217, v217, v218
    v_accvgpr_write_b32 a239, v217
    v_accvgpr_read_b32 v217, a240
    v_mul_f32 v217, v217, v218
    v_accvgpr_write_b32 a240, v217
    v_accvgpr_read_b32 v217, a241
    v_mul_f32 v217, v217, v218
    v_accvgpr_write_b32 a241, v217
    v_accvgpr_read_b32 v217, a242
    v_mul_f32 v217, v217, v218
    v_accvgpr_write_b32 a242, v217
    v_accvgpr_read_b32 v217, a243
    v_mul_f32 v217, v217, v218
    v_accvgpr_write_b32 a243, v217
    v_accvgpr_read_b32 v217, a244
    v_mul_f32 v217, v217, v218
    v_accvgpr_write_b32 a244, v217
    v_accvgpr_read_b32 v217, a245
    v_mul_f32 v217, v217, v218
    v_accvgpr_write_b32 a245, v217
    v_accvgpr_read_b32 v217, a246
    v_mul_f32 v217, v217, v218
    v_accvgpr_write_b32 a246, v217
    v_accvgpr_read_b32 v217, a247
    v_mul_f32 v217, v217, v218
    v_accvgpr_write_b32 a247, v217
    v_accvgpr_read_b32 v217, a248
    v_mul_f32 v217, v217, v218
    v_accvgpr_write_b32 a248, v217
    v_accvgpr_read_b32 v217, a249
    v_mul_f32 v217, v217, v218
    v_accvgpr_write_b32 a249, v217
    v_accvgpr_read_b32 v217, a250
    v_mul_f32 v217, v217, v218
    v_accvgpr_write_b32 a250, v217
    v_accvgpr_read_b32 v217, a251
    v_mul_f32 v217, v217, v218
    v_accvgpr_write_b32 a251, v217
    v_accvgpr_read_b32 v217, a252
    v_mul_f32 v217, v217, v218
    v_accvgpr_write_b32 a252, v217
    v_accvgpr_read_b32 v217, a253
    v_mul_f32 v217, v217, v218
    v_accvgpr_write_b32 a253, v217
    v_accvgpr_read_b32 v217, a254
    v_mul_f32 v217, v217, v218
    v_accvgpr_write_b32 a254, v217
    v_accvgpr_read_b32 v217, a255
    v_mul_f32 v217, v217, v218
    v_accvgpr_write_b32 a255, v217
    s_nop 1
    s_branch K1_back_e7
K1_rare_e8:
    v_mov_b32 v218, v217
    s_nop 1
    v_permlane16_swap_b32 v218, v217
    s_nop 1
    v_max_f32 v217, v217, v218
    v_mov_b32 v218, v217
    s_nop 1
    v_permlane32_swap_b32 v218, v217
    s_nop 1
    v_max_f32 v217, v217, v218
    v_max_f32 v217, 0, v217
    v_sub_f32 v218, 0, v217
    v_exp_f32 v218, v218
    v_sub_f32 v200, v200, v217
    v_sub_f32 v201, v201, v217
    v_sub_f32 v202, v202, v217
    v_sub_f32 v203, v203, v217
    v_sub_f32 v144, v144, v217
    v_sub_f32 v145, v145, v217
    v_sub_f32 v146, v146, v217
    v_sub_f32 v147, v147, v217
    v_sub_f32 v148, v148, v217
    v_sub_f32 v149, v149, v217
    v_sub_f32 v150, v150, v217
    v_sub_f32 v151, v151, v217
    s_mov_b32 s56, 0x0
    s_mov_b32 s57, 0xffff
    v_cndmask_b32 v217, 1.0, v218, s[56:57]
    v_mul_f32 v204, v204, v217
    v_mul_f32 v224, v224, v218
    v_mul_f32 v225, v225, v218
    v_mul_f32 v226, v226, v218
    v_mul_f32 v227, v227, v218
    v_mul_f32 v228, v228, v218
    v_mul_f32 v229, v229, v218
    v_mul_f32 v230, v230, v218
    v_mul_f32 v231, v231, v218
    v_mul_f32 v232, v232, v218
    v_mul_f32 v233, v233, v218
    v_mul_f32 v234, v234, v218
    v_mul_f32 v235, v235, v218
    v_mul_f32 v236, v236, v218
    v_mul_f32 v237, v237, v218
    v_mul_f32 v238, v238, v218
    v_mul_f32 v239, v239, v218
    v_mul_f32 v240, v240, v218
    v_mul_f32 v241, v241, v218
    v_mul_f32 v242, v242, v218
    v_mul_f32 v243, v243, v218
    v_mul_f32 v244, v244, v218
    v_mul_f32 v245, v245, v218
    v_mul_f32 v246, v246, v218
    v_mul_f32 v247, v247, v218
    v_mul_f32 v248, v248, v218
    v_mul_f32 v249, v249, v218
    v_mul_f32 v250, v250, v218
    v_mul_f32 v251, v251, v218
    v_mul_f32 v252, v252, v218
    v_mul_f32 v253, v253, v218
    v_mul_f32 v254, v254, v218
    v_mul_f32 v255, v255, v218
    s_nop 1
    s_branch K1_back_e8
K1_rare_l0:
    v_mov_b32 v218, v217
    s_nop 1
    v_permlane16_swap_b32 v218, v217
    s_nop 1
    v_max_f32 v217, v217, v218
    v_mov_b32 v218, v217
    s_nop 1
    v_permlane32_swap_b32 v218, v217
    s_nop 1
    v_max_f32 v217, v217, v218
    v_max_f32 v217, 0, v217
    v_sub_f32 v218, 0, v217
    v_exp_f32 v218, v218
    v_sub_f32 v168, v168, v217
    v_sub_f32 v169, v169, v217
    v_sub_f32 v170, v170, v217
    v_sub_f32 v171, v171, v217
    v_sub_f32 v152, v152, v217
    v_sub_f32 v153, v153, v217
    v_sub_f32 v154, v154, v217
    v_sub_f32 v155, v155, v217
    v_sub_f32 v156, v156, v217
    v_sub_f32 v157, v157, v217
    v_sub_f32 v158, v158, v217
    v_sub_f32 v159, v159, v217
    s_mov_b32 s56, 0xffff
    s_mov_b32 s57, 0x0
    v_cndmask_b32 v217, 1.0, v218, s[56:57]
    v_mul_f32 v204, v204, v217
    v_accvgpr_read_b32 v217, a0
    v_mul_f32 v217, v217, v218
    v_accvgpr_write_b32 a0, v217
    v_accvgpr_read_b32 v217, a1
    v_mul_f32 v217, v217, v218
    v_accvgpr_write_b32 a1, v217
    v_accvgpr_read_b32 v217, a2
    v_mul_f32 v217, v217, v218
    v_accvgpr_write_b32 a2, v217
    v_accvgpr_read_b32 v217, a3
    v_mul_f32 v217, v217, v218
    v_accvgpr_write_b32 a3, v217
    v_accvgpr_read_b32 v217, a4
    v_mul_f32 v217, v217, v218
    v_accvgpr_write_b32 a4, v217
    v_accvgpr_read_b32 v217, a5
    v_mul_f32 v217, v217, v218
    v_accvgpr_write_b32 a5, v217
    v_accvgpr_read_b32 v217, a6
    v_mul_f32 v217, v217, v218
    v_accvgpr_write_b32 a6, v217
    v_accvgpr_read_b32 v217, a7
    v_mul_f32 v217, v217, v218
    v_accvgpr_write_b32 a7, v217
    v_accvgpr_read_b32 v217, a8
    v_mul_f32 v217, v217, v218
    v_accvgpr_write_b32 a8, v217
    v_accvgpr_read_b32 v217, a9
    v_mul_f32 v217, v217, v218
    v_accvgpr_write_b32 a9, v217
    v_accvgpr_read_b32 v217, a10
    v_mul_f32 v217, v217, v218
    v_accvgpr_write_b32 a10, v217
    v_accvgpr_read_b32 v217, a11
    v_mul_f32 v217, v217, v218
    v_accvgpr_write_b32 a11, v217
    v_accvgpr_read_b32 v217, a12
    v_mul_f32 v217, v217, v218
    v_accvgpr_write_b32 a12, v217
    v_accvgpr_read_b32 v217, a13
    v_mul_f32 v217, v217, v218
    v_accvgpr_write_b32 a13, v217
    v_accvgpr_read_b32 v217, a14
    v_mul_f32 v217, v217, v218
    v_accvgpr_write_b32 a14, v217
    v_accvgpr_read_b32 v217, a15
    v_mul_f32 v217, v217, v218
    v_accvgpr_write_b32 a15, v217
    v_accvgpr_read_b32 v217, a16
    v_mul_f32 v217, v217, v218
    v_accvgpr_write_b32 a16, v217
    v_accvgpr_read_b32 v217, a17
    v_mul_f32 v217, v217, v218
    v_accvgpr_write_b32 a17, v217
    v_accvgpr_read_b32 v217, a18
    v_mul_f32 v217, v217, v218
    v_accvgpr_write_b32 a18, v217
    v_accvgpr_read_b32 v217, a19
    v_mul_f32 v217, v217, v218
    v_accvgpr_write_b32 a19, v217
    v_accvgpr_read_b32 v217, a20
    v_mul_f32 v217, v217, v218
    v_accvgpr_write_b32 a20, v217
    v_accvgpr_read_b32 v217, a21
    v_mul_f32 v217, v217, v218
    v_accvgpr_write_b32 a21, v217
    v_accvgpr_read_b32 v217, a22
    v_mul_f32 v217, v217, v218
    v_accvgpr_write_b32 a22, v217
    v_accvgpr_read_b32 v217, a23
    v_mul_f32 v217, v217, v218
    v_accvgpr_write_b32 a23, v217
    v_accvgpr_read_b32 v217, a24
    v_mul_f32 v217, v217, v218
    v_accvgpr_write_b32 a24, v217
    v_accvgpr_read_b32 v217, a25
    v_mul_f32 v217, v217, v218
    v_accvgpr_write_b32 a25, v217
    v_accvgpr_read_b32 v217, a26
    v_mul_f32 v217, v217, v218
    v_accvgpr_write_b32 a26, v217
    v_accvgpr_read_b32 v217, a27
    v_mul_f32 v217, v217, v218
    v_accvgpr_write_b32 a27, v217
    v_accvgpr_read_b32 v217, a28
    v_mul_f32 v217, v217, v218
    v_accvgpr_write_b32 a28, v217
    v_accvgpr_read_b32 v217, a29
    v_mul_f32 v217, v217, v218
    v_accvgpr_write_b32 a29, v217
    v_accvgpr_read_b32 v217, a30
    v_mul_f32 v217, v217, v218
    v_accvgpr_write_b32 a30, v217
    v_accvgpr_read_b32 v217, a31
    v_mul_f32 v217, v217, v218
    v_accvgpr_write_b32 a31, v217
    s_nop 1
    s_branch K1_back_l0
K1_rare_l1:
    v_mov_b32 v218, v217
    s_nop 1
    v_permlane16_swap_b32 v218, v217
    s_nop 1
    v_max_f32 v217, v217, v218
    v_mov_b32 v218, v217
    s_nop 1
    v_permlane32_swap_b32 v218, v217
    s_nop 1
    v_max_f32 v217, v217, v218
    v_max_f32 v217, 0, v217
    v_sub_f32 v218, 0, v217
    v_exp_f32 v218, v218
    v_sub_f32 v172, v172, v217
    v_sub_f32 v173, v173, v217
    v_sub_f32 v174, v174, v217
    v_sub_f32 v175, v175, v217
    v_sub_f32 v144, v144, v217
    v_sub_f32 v145, v145, v217
    v_sub_f32 v146, v146, v217
    v_sub_f32 v147, v147, v217
    v_sub_f32 v148, v148, v217
    v_sub_f32 v149, v149, v217
    v_sub_f32 v150, v150, v217
    v_sub_f32 v151, v151, v217
    s_mov_b32 s56, 0xffff
    s_mov_b32 s57, 0x0
    v_cndmask_b32 v217, 1.0, v218, s[56:57]
    v_mul_f32 v205, v205, v217
    v_accvgpr_read_b32 v217, a32
    v_mul_f32 v217, v217, v218
    v_accvgpr_write_b32 a32, v217
    v_accvgpr_read_b32 v217, a33
    v_mul_f32 v217, v217, v218
    v_accvgpr_write_b32 a33, v217
    v_accvgpr_read_b32 v217, a34
    v_mul_f32 v217, v217, v218
    v_accvgpr_write_b32 a34, v217
    v_accvgpr_read_b32 v217, a35
    v_mul_f32 v217, v217, v218
    v_accvgpr_write_b32 a35, v217
    v_accvgpr_read_b32 v217, a36
    v_mul_f32 v217, v217, v218
    v_accvgpr_write_b32 a36, v217
    v_accvgpr_read_b32 v217, a37
    v_mul_f32 v217, v217, v218
    v_accvgpr_write_b32 a37, v217
    v_accvgpr_read_b32 v217, a38
    v_mul_f32 v217, v217, v218
    v_accvgpr_write_b32 a38, v217
    v_accvgpr_read_b32 v217, a39
    v_mul_f32 v217, v217, v218
    v_accvgpr_write_b32 a39, v217
    v_accvgpr_read_b32 v217, a40
    v_mul_f32 v217, v217, v218
    v_accvgpr_write_b32 a40, v217
    v_accvgpr_read_b32 v217, a41
    v_mul_f32 v217, v217, v218
    v_accvgpr_write_b32 a41, v217
    v_accvgpr_read_b32 v217, a42
    v_mul_f32 v217, v217, v218
    v_accvgpr_write_b32 a42, v217
    v_accvgpr_read_b32 v217, a43
    v_mul_f32 v217, v217, v218
    v_accvgpr_write_b32 a43, v217
    v_accvgpr_read_b32 v217, a44
    v_mul_f32 v217, v217, v218
    v_accvgpr_write_b32 a44, v217
    v_accvgpr_read_b32 v217, a45
    v_mul_f32 v217, v217, v218
    v_accvgpr_write_b32 a45, v217
    v_accvgpr_read_b32 v217, a46
    v_mul_f32 v217, v217, v218
    v_accvgpr_write_b32 a46, v217
    v_accvgpr_read_b32 v217, a47
    v_mul_f32 v217, v217, v218
    v_accvgpr_write_b32 a47, v217
    v_accvgpr_read_b32 v217, a48
    v_mul_f32 v217, v217, v218
    v_accvgpr_write_b32 a48, v217
    v_accvgpr_read_b32 v217, a49
    v_mul_f32 v217, v217, v218
    v_accvgpr_write_b32 a49, v217
    v_accvgpr_read_b32 v217, a50
    v_mul_f32 v217, v217, v218
    v_accvgpr_write_b32 a50, v217
    v_accvgpr_read_b32 v217, a51
    v_mul_f32 v217, v217, v218
    v_accvgpr_write_b32 a51, v217
    v_accvgpr_read_b32 v217, a52
    v_mul_f32 v217, v217, v218
    v_accvgpr_write_b32 a52, v217
    v_accvgpr_read_b32 v217, a53
    v_mul_f32 v217, v217, v218
    v_accvgpr_write_b32 a53, v217
    v_accvgpr_read_b32 v217, a54
    v_mul_f32 v217, v217, v218
    v_accvgpr_write_b32 a54, v217
    v_accvgpr_read_b32 v217, a55
    v_mul_f32 v217, v217, v218
    v_accvgpr_write_b32 a55, v217
    v_accvgpr_read_b32 v217, a56
    v_mul_f32 v217, v217, v218
    v_accvgpr_write_b32 a56, v217
    v_accvgpr_read_b32 v217, a57
    v_mul_f32 v217, v217, v218
    v_accvgpr_write_b32 a57, v217
    v_accvgpr_read_b32 v217, a58
    v_mul_f32 v217, v217, v218
    v_accvgpr_write_b32 a58, v217
    v_accvgpr_read_b32 v217, a59
    v_mul_f32 v217, v217, v218
    v_accvgpr_write_b32 a59, v217
    v_accvgpr_read_b32 v217, a60
    v_mul_f32 v217, v217, v218
    v_accvgpr_write_b32 a60, v217
    v_accvgpr_read_b32 v217, a61
    v_mul_f32 v217, v217, v218
    v_accvgpr_write_b32 a61, v217
    v_accvgpr_read_b32 v217, a62
    v_mul_f32 v217, v217, v218
    v_accvgpr_write_b32 a62, v217
    v_accvgpr_read_b32 v217, a63
    v_mul_f32 v217, v217, v218
    v_accvgpr_write_b32 a63, v217
    s_nop 1
    s_branch K1_back_l1
K1_rare_l2:
    v_mov_b32 v218, v217
    s_nop 1
    v_permlane16_swap_b32 v218, v217
    s_nop 1
    v_max_f32 v217, v217, v218
    v_mov_b32 v218, v217
    s_nop 1
    v_permlane32_swap_b32 v218, v217
    s_nop 1
    v_max_f32 v217, v217, v218
    v_max_f32 v217, 0, v217
    v_sub_f32 v218, 0, v217
    v_exp_f32 v218, v218
    v_sub_f32 v176, v176, v217
    v_sub_f32 v177, v177, v217
    v_sub_f32 v178, v178, v217
    v_sub_f32 v179, v179, v217
    v_sub_f32 v152, v152, v217
    v_sub_f32 v153, v153, v217
    v_sub_f32 v154, v154, v217
    v_sub_f32 v155, v155, v217
    v_sub_f32 v156, v156, v217
    v_sub_f32 v157, v157, v217
    v_sub_f32 v158, v158, v217
    v_sub_f32 v159, v159, v217
    s_mov_b32 s56, 0xffff
    s_mov_b32 s57, 0x0
    v_cndmask_b32 v217, 1.0, v218, s[56:57]
    v_mul_f32 v206, v206, v217
    v_accvgpr_read_b32 v217, a64
    v_mul_f32 v217, v217, v218
    v_accvgpr_write_b32 a64, v217
    v_accvgpr_read_b32 v217, a65
    v_mul_f32 v217, v217, v218
    v_accvgpr_write_b32 a65, v217
    v_accvgpr_read_b32 v217, a66
    v_mul_f32 v217, v217, v218
    v_accvgpr_write_b32 a66, v217
    v_accvgpr_read_b32 v217, a67
    v_mul_f32 v217, v217, v218
    v_accvgpr_write_b32 a67, v217
    v_accvgpr_read_b32 v217, a68
    v_mul_f32 v217, v217, v218
    v_accvgpr_write_b32 a68, v217
    v_accvgpr_read_b32 v217, a69
    v_mul_f32 v217, v217, v218
    v_accvgpr_write_b32 a69, v217
    v_accvgpr_read_b32 v217, a70
    v_mul_f32 v217, v217, v218
    v_accvgpr_write_b32 a70, v217
    v_accvgpr_read_b32 v217, a71
    v_mul_f32 v217, v217, v218
    v_accvgpr_write_b32 a71, v217
    v_accvgpr_read_b32 v217, a72
    v_mul_f32 v217, v217, v218
    v_accvgpr_write_b32 a72, v217
    v_accvgpr_read_b32 v217, a73
    v_mul_f32 v217, v217, v218
    v_accvgpr_write_b32 a73, v217
    v_accvgpr_read_b32 v217, a74
    v_mul_f32 v217, v217, v218
    v_accvgpr_write_b32 a74, v217
    v_accvgpr_read_b32 v217, a75
    v_mul_f32 v217, v217, v218
    v_accvgpr_write_b32 a75, v217
    v_accvgpr_read_b32 v217, a76
    v_mul_f32 v217, v217, v218
    v_accvgpr_write_b32 a76, v217
    v_accvgpr_read_b32 v217, a77
    v_mul_f32 v217, v217, v218
    v_accvgpr_write_b32 a77, v217
    v_accvgpr_read_b32 v217, a78
    v_mul_f32 v217, v217, v218
    v_accvgpr_write_b32 a78, v217
    v_accvgpr_read_b32 v217, a79
    v_mul_f32 v217, v217, v218
    v_accvgpr_write_b32 a79, v217
    v_accvgpr_read_b32 v217, a80
    v_mul_f32 v217, v217, v218
    v_accvgpr_write_b32 a80, v217
    v_accvgpr_read_b32 v217, a81
    v_mul_f32 v217, v217, v218
    v_accvgpr_write_b32 a81, v217
    v_accvgpr_read_b32 v217, a82
    v_mul_f32 v217, v217, v218
    v_accvgpr_write_b32 a82, v217
    v_accvgpr_read_b32 v217, a83
    v_mul_f32 v217, v217, v218
    v_accvgpr_write_b32 a83, v217
    v_accvgpr_read_b32 v217, a84
    v_mul_f32 v217, v217, v218
    v_accvgpr_write_b32 a84, v217
    v_accvgpr_read_b32 v217, a85
    v_mul_f32 v217, v217, v218
    v_accvgpr_write_b32 a85, v217
    v_accvgpr_read_b32 v217, a86
    v_mul_f32 v217, v217, v218
    v_accvgpr_write_b32 a86, v217
    v_accvgpr_read_b32 v217, a87
    v_mul_f32 v217, v217, v218
    v_accvgpr_write_b32 a87, v217
    v_accvgpr_read_b32 v217, a88
    v_mul_f32 v217, v217, v218
    v_accvgpr_write_b32 a88, v217
    v_accvgpr_read_b32 v217, a89
    v_mul_f32 v217, v217, v218
    v_accvgpr_write_b32 a89, v217
    v_accvgpr_read_b32 v217, a90
    v_mul_f32 v217, v217, v218
    v_accvgpr_write_b32 a90, v217
    v_accvgpr_read_b32 v217, a91
    v_mul_f32 v217, v217, v218
    v_accvgpr_write_b32 a91, v217
    v_accvgpr_read_b32 v217, a92
    v_mul_f32 v217, v217, v218
    v_accvgpr_write_b32 a92, v217
    v_accvgpr_read_b32 v217, a93
    v_mul_f32 v217, v217, v218
    v_accvgpr_write_b32 a93, v217
    v_accvgpr_read_b32 v217, a94
    v_mul_f32 v217, v217, v218
    v_accvgpr_write_b32 a94, v217
    v_accvgpr_read_b32 v217, a95
    v_mul_f32 v217, v217, v218
    v_accvgpr_write_b32 a95, v217
    s_nop 1
    s_branch K1_back_l2
K1_rare_l3:
    v_mov_b32 v218, v217
    s_nop 1
    v_permlane16_swap_b32 v218, v217
    s_nop 1
    v_max_f32 v217, v217, v218
    v_mov_b32 v218, v217
    s_nop 1
    v_permlane32_swap_b32 v218, v217
    s_nop 1
    v_max_f32 v217, v217, v218
    v_max_f32 v217, 0, v217
    v_sub_f32 v218, 0, v217
    v_exp_f32 v218, v218
    v_sub_f32 v180, v180, v217
    v_sub_f32 v181, v181, v217
    v_sub_f32 v182, v182, v217
    v_sub_f32 v183, v183, v217
    v_sub_f32 v144, v144, v217
    v_sub_f32 v145, v145, v217
    v_sub_f32 v146, v146, v217
    v_sub_f32 v147, v147, v217
    v_sub_f32 v148, v148, v217
    v_sub_f32 v149, v149, v217
    v_sub_f32 v150, v150, v217
    v_sub_f32 v151, v151, v217
    s_mov_b32 s56, 0xffff
    s_mov_b32 s57, 0x0
    v_cndmask_b32 v217, 1.0, v218, s[56:57]
    v_mul_f32 v207, v207, v217
    v_accvgpr_read_b32 v217, a96
    v_mul_f32 v217, v217, v218
    v_accvgpr_write_b32 a96, v217
    v_accvgpr_read_b32 v217, a97
    v_mul_f32 v217, v217, v218
    v_accvgpr_write_b32 a97, v217
    v_accvgpr_read_b32 v217, a98
    v_mul_f32 v217, v217, v218
    v_accvgpr_write_b32 a98, v217
    v_accvgpr_read_b32 v217, a99
    v_mul_f32 v217, v217, v218
    v_accvgpr_write_b32 a99, v217
    v_accvgpr_read_b32 v217, a100
    v_mul_f32 v217, v217, v218
    v_accvgpr_write_b32 a100, v217
    v_accvgpr_read_b32 v217, a101
    v_mul_f32 v217, v217, v218
    v_accvgpr_write_b32 a101, v217
    v_accvgpr_read_b32 v217, a102
    v_mul_f32 v217, v217, v218
    v_accvgpr_write_b32 a102, v217
    v_accvgpr_read_b32 v217, a103
    v_mul_f32 v217, v217, v218
    v_accvgpr_write_b32 a103, v217
    v_accvgpr_read_b32 v217, a104
    v_mul_f32 v217, v217, v218
    v_accvgpr_write_b32 a104, v217
    v_accvgpr_read_b32 v217, a105
    v_mul_f32 v217, v217, v218
    v_accvgpr_write_b32 a105, v217
    v_accvgpr_read_b32 v217, a106
    v_mul_f32 v217, v217, v218
    v_accvgpr_write_b32 a106, v217
    v_accvgpr_read_b32 v217, a107
    v_mul_f32 v217, v217, v218
    v_accvgpr_write_b32 a107, v217
    v_accvgpr_read_b32 v217, a108
    v_mul_f32 v217, v217, v218
    v_accvgpr_write_b32 a108, v217
    v_accvgpr_read_b32 v217, a109
    v_mul_f32 v217, v217, v218
    v_accvgpr_write_b32 a109, v217
    v_accvgpr_read_b32 v217, a110
    v_mul_f32 v217, v217, v218
    v_accvgpr_write_b32 a110, v217
    v_accvgpr_read_b32 v217, a111
    v_mul_f32 v217, v217, v218
    v_accvgpr_write_b32 a111, v217
    v_accvgpr_read_b32 v217, a112
    v_mul_f32 v217, v217, v218
    v_accvgpr_write_b32 a112, v217
    v_accvgpr_read_b32 v217, a113
    v_mul_f32 v217, v217, v218
    v_accvgpr_write_b32 a113, v217
    v_accvgpr_read_b32 v217, a114
    v_mul_f32 v217, v217, v218
    v_accvgpr_write_b32 a114, v217
    v_accvgpr_read_b32 v217, a115
    v_mul_f32 v217, v217, v218
    v_accvgpr_write_b32 a115, v217
    v_accvgpr_read_b32 v217, a116
    v_mul_f32 v217, v217, v218
    v_accvgpr_write_b32 a116, v217
    v_accvgpr_read_b32 v217, a117
    v_mul_f32 v217, v217, v218
    v_accvgpr_write_b32 a117, v217
    v_accvgpr_read_b32 v217, a118
    v_mul_f32 v217, v217, v218
    v_accvgpr_write_b32 a118, v217
    v_accvgpr_read_b32 v217, a119
    v_mul_f32 v217, v217, v218
    v_accvgpr_write_b32 a119, v217
    v_accvgpr_read_b32 v217, a120
    v_mul_f32 v217, v217, v218
    v_accvgpr_write_b32 a120, v217
    v_accvgpr_read_b32 v217, a121
    v_mul_f32 v217, v217, v218
    v_accvgpr_write_b32 a121, v217
    v_accvgpr_read_b32 v217, a122
    v_mul_f32 v217, v217, v218
    v_accvgpr_write_b32 a122, v217
    v_accvgpr_read_b32 v217, a123
    v_mul_f32 v217, v217, v218
    v_accvgpr_write_b32 a123, v217
    v_accvgpr_read_b32 v217, a124
    v_mul_f32 v217, v217, v218
    v_accvgpr_write_b32 a124, v217
    v_accvgpr_read_b32 v217, a125
    v_mul_f32 v217, v217, v218
    v_accvgpr_write_b32 a125, v217
    v_accvgpr_read_b32 v217, a126
    v_mul_f32 v217, v217, v218
    v_accvgpr_write_b32 a126, v217
    v_accvgpr_read_b32 v217, a127
    v_mul_f32 v217, v217, v218
    v_accvgpr_write_b32 a127, v217
    s_nop 1
    s_branch K1_back_l3
K1_rare_l4:
    v_mov_b32 v218, v217
    s_nop 1
    v_permlane16_swap_b32 v218, v217
    s_nop 1
    v_max_f32 v217, v217, v218
    v_mov_b32 v218, v217
    s_nop 1
    v_permlane32_swap_b32 v218, v217
    s_nop 1
    v_max_f32 v217, v217, v218
    v_max_f32 v217, 0, v217
    v_sub_f32 v218, 0, v217
    v_exp_f32 v218, v218
    v_sub_f32 v184, v184, v217
    v_sub_f32 v185, v185, v217
    v_sub_f32 v186, v186, v217
    v_sub_f32 v187, v187, v217
    v_sub_f32 v152, v152, v217
    v_sub_f32 v153, v153, v217
    v_sub_f32 v154, v154, v217
    v_sub_f32 v155, v155, v217
    v_sub_f32 v156, v156, v217
    v_sub_f32 v157, v157, v217
    v_sub_f32 v158, v158, v217
    v_sub_f32 v159, v159, v217
    s_mov_b32 s56, 0xffff0000
    s_mov_b32 s57, 0x0
    v_cndmask_b32 v217, 1.0, v218, s[56:57]
    v_mul_f32 v204, v204, v217
    v_accvgpr_read_b32 v217, a128
    v_mul_f32 v217, v217, v218
    v_accvgpr_write_b32 a128, v217
    v_accvgpr_read_b32 v217, a129
    v_mul_f32 v217, v217, v218
    v_accvgpr_write_b32 a129, v217
    v_accvgpr_read_b32 v217, a130
    v_mul_f32 v217, v217, v218
    v_accvgpr_write_b32 a130, v217
    v_accvgpr_read_b32 v217, a131
    v_mul_f32 v217, v217, v218
    v_accvgpr_write_b32 a131, v217
    v_accvgpr_read_b32 v217, a132
    v_mul_f32 v217, v217, v218
    v_accvgpr_write_b32 a132, v217
    v_accvgpr_read_b32 v217, a133
    v_mul_f32 v217, v217, v218
    v_accvgpr_write_b32 a133, v217
    v_accvgpr_read_b32 v217, a134
    v_mul_f32 v217, v217, v218
    v_accvgpr_write_b32 a134, v217
    v_accvgpr_read_b32 v217, a135
    v_mul_f32 v217, v217, v218
    v_accvgpr_write_b32 a135, v217
    v_accvgpr_read_b32 v217, a136
    v_mul_f32 v217, v217, v218
    v_accvgpr_write_b32 a136, v217
    v_accvgpr_read_b32 v217, a137
    v_mul_f32 v217, v217, v218
    v_accvgpr_write_b32 a137, v217
    v_accvgpr_read_b32 v217, a138
    v_mul_f32 v217, v217, v218
    v_accvgpr_write_b32 a138, v217
    v_accvgpr_read_b32 v217, a139
    v_mul_f32 v217, v217, v218
    v_accvgpr_write_b32 a139, v217
    v_accvgpr_read_b32 v217, a140
    v_mul_f32 v217, v217, v218
    v_accvgpr_write_b32 a140, v217
    v_accvgpr_read_b32 v217, a141
    v_mul_f32 v217, v217, v218
    v_accvgpr_write_b32 a141, v217
    v_accvgpr_read_b32 v217, a142
    v_mul_f32 v217, v217, v218
    v_accvgpr_write_b32 a142, v217
    v_accvgpr_read_b32 v217, a143
    v_mul_f32 v217, v217, v218
    v_accvgpr_write_b32 a143, v217
    v_accvgpr_read_b32 v217, a144
    v_mul_f32 v217, v217, v218
    v_accvgpr_write_b32 a144, v217
    v_accvgpr_read_b32 v217, a145
    v_mul_f32 v217, v217, v218
    v_accvgpr_write_b32 a145, v217
    v_accvgpr_read_b32 v217, a146
    v_mul_f32 v217, v217, v218
    v_accvgpr_write_b32 a146, v217
    v_accvgpr_read_b32 v217, a147
    v_mul_f32 v217, v217, v218
    v_accvgpr_write_b32 a147, v217
    v_accvgpr_read_b32 v217, a148
    v_mul_f32 v217, v217, v218
    v_accvgpr_write_b32 a148, v217
    v_accvgpr_read_b32 v217, a149
    v_mul_f32 v217, v217, v218
    v_accvgpr_write_b32 a149, v217
    v_accvgpr_read_b32 v217, a150
    v_mul_f32 v217, v217, v218
    v_accvgpr_write_b32 a150, v217
    v_accvgpr_read_b32 v217, a151
    v_mul_f32 v217, v217, v218
    v_accvgpr_write_b32 a151, v217
    v_accvgpr_read_b32 v217, a152
    v_mul_f32 v217, v217, v218
    v_accvgpr_write_b32 a152, v217
    v_accvgpr_read_b32 v217, a153
    v_mul_f32 v217, v217, v218
    v_accvgpr_write_b32 a153, v217
    v_accvgpr_read_b32 v217, a154
    v_mul_f32 v217, v217, v218
    v_accvgpr_write_b32 a154, v217
    v_accvgpr_read_b32 v217, a155
    v_mul_f32 v217, v217, v218
    v_accvgpr_write_b32 a155, v217
    v_accvgpr_read_b32 v217, a156
    v_mul_f32 v217, v217, v218
    v_accvgpr_write_b32 a156, v217
    v_accvgpr_read_b32 v217, a157
    v_mul_f32 v217, v217, v218
    v_accvgpr_write_b32 a157, v217
    v_accvgpr_read_b32 v217, a158
    v_mul_f32 v217, v217, v218
    v_accvgpr_write_b32 a158, v217
    v_accvgpr_read_b32 v217, a159
    v_mul_f32 v217, v217, v218
    v_accvgpr_write_b32 a159, v217
    s_nop 1
    s_branch K1_back_l4
K1_rare_l5:
    v_mov_b32 v218, v217
    s_nop 1
    v_permlane16_swap_b32 v218, v217
    s_nop 1
    v_max_f32 v217, v217, v218
    v_mov_b32 v218, v217
    s_nop 1
    v_permlane32_swap_b32 v218, v217
    s_nop 1
    v_max_f32 v217, v217, v218
    v_max_f32 v217, 0, v217
    v_sub_f32 v218, 0, v217
    v_exp_f32 v218, v218
    v_sub_f32 v188, v188, v217
    v_sub_f32 v189, v189, v217
    v_sub_f32 v190, v190, v217
    v_sub_f32 v191, v191, v217
    v_sub_f32 v144, v144, v217
    v_sub_f32 v145, v145, v217
    v_sub_f32 v146, v146, v217
    v_sub_f32 v147, v147, v217
    v_sub_f32 v148, v148, v217
    v_sub_f32 v149, v149, v217
    v_sub_f32 v150, v150, v217
    v_sub_f32 v151, v151, v217
    s_mov_b32 s56, 0xffff0000
    s_mov_b32 s57, 0x0
    v_cndmask_b32 v217, 1.0, v218, s[56:57]
    v_mul_f32 v205, v205, v217
    v_accvgpr_read_b32 v217, a160
    v_mul_f32 v217, v217, v218
    v_accvgpr_write_b32 a160, v217
    v_accvgpr_read_b32 v217, a161
    v_mul_f32 v217, v217, v218
    v_accvgpr_write_b32 a161, v217
    v_accvgpr_read_b32 v217, a162
    v_mul_f32 v217, v217, v218
    v_accvgpr_write_b32 a162, v217
    v_accvgpr_read_b32 v217, a163
    v_mul_f32 v217, v217, v218
    v_accvgpr_write_b32 a163, v217
    v_accvgpr_read_b32 v217, a164
    v_mul_f32 v217, v217, v218
    v_accvgpr_write_b32 a164, v217
    v_accvgpr_read_b32 v217, a165
    v_mul_f32 v217, v217, v218
    v_accvgpr_write_b32 a165, v217
    v_accvgpr_read_b32 v217, a166
    v_mul_f32 v217, v217, v218
    v_accvgpr_write_b32 a166, v217
    v_accvgpr_read_b32 v217, a167
    v_mul_f32 v217, v217, v218
    v_accvgpr_write_b32 a167, v217
    v_accvgpr_read_b32 v217, a168
    v_mul_f32 v217, v217, v218
    v_accvgpr_write_b32 a168, v217
    v_accvgpr_read_b32 v217, a169
    v_mul_f32 v217, v217, v218
    v_accvgpr_write_b32 a169, v217
    v_accvgpr_read_b32 v217, a170
    v_mul_f32 v217, v217, v218
    v_accvgpr_write_b32 a170, v217
    v_accvgpr_read_b32 v217, a171
    v_mul_f32 v217, v217, v218
    v_accvgpr_write_b32 a171, v217
    v_accvgpr_read_b32 v217, a172
    v_mul_f32 v217, v217, v218
    v_accvgpr_write_b32 a172, v217
    v_accvgpr_read_b32 v217, a173
    v_mul_f32 v217, v217, v218
    v_accvgpr_write_b32 a173, v217
    v_accvgpr_read_b32 v217, a174
    v_mul_f32 v217, v217, v218
    v_accvgpr_write_b32 a174, v217
    v_accvgpr_read_b32 v217, a175
    v_mul_f32 v217, v217, v218
    v_accvgpr_write_b32 a175, v217
    v_accvgpr_read_b32 v217, a176
    v_mul_f32 v217, v217, v218
    v_accvgpr_write_b32 a176, v217
    v_accvgpr_read_b32 v217, a177
    v_mul_f32 v217, v217, v218
    v_accvgpr_write_b32 a177, v217
    v_accvgpr_read_b32 v217, a178
    v_mul_f32 v217, v217, v218
    v_accvgpr_write_b32 a178, v217
    v_accvgpr_read_b32 v217, a179
    v_mul_f32 v217, v217, v218
    v_accvgpr_write_b32 a179, v217
    v_accvgpr_read_b32 v217, a180
    v_mul_f32 v217, v217, v218
    v_accvgpr_write_b32 a180, v217
    v_accvgpr_read_b32 v217, a181
    v_mul_f32 v217, v217, v218
    v_accvgpr_write_b32 a181, v217
    v_accvgpr_read_b32 v217, a182
    v_mul_f32 v217, v217, v218
    v_accvgpr_write_b32 a182, v217
    v_accvgpr_read_b32 v217, a183
    v_mul_f32 v217, v217, v218
    v_accvgpr_write_b32 a183, v217
    v_accvgpr_read_b32 v217, a184
    v_mul_f32 v217, v217, v218
    v_accvgpr_write_b32 a184, v217
    v_accvgpr_read_b32 v217, a185
    v_mul_f32 v217, v217, v218
    v_accvgpr_write_b32 a185, v217
    v_accvgpr_read_b32 v217, a186
    v_mul_f32 v217, v217, v218
    v_accvgpr_write_b32 a186, v217
    v_accvgpr_read_b32 v217, a187
    v_mul_f32 v217, v217, v218
    v_accvgpr_write_b32 a187, v217
    v_accvgpr_read_b32 v217, a188
    v_mul_f32 v217, v217, v218
    v_accvgpr_write_b32 a188, v217
    v_accvgpr_read_b32 v217, a189
    v_mul_f32 v217, v217, v218
    v_accvgpr_write_b32 a189, v217
    v_accvgpr_read_b32 v217, a190
    v_mul_f32 v217, v217, v218
    v_accvgpr_write_b32 a190, v217
    v_accvgpr_read_b32 v217, a191
    v_mul_f32 v217, v217, v218
    v_accvgpr_write_b32 a191, v217
    s_nop 1
    s_branch K1_back_l5
K1_rare_l6:
    v_mov_b32 v218, v217
    s_nop 1
    v_permlane16_swap_b32 v218, v217
    s_nop 1
    v_max_f32 v217, v217, v218
    v_mov_b32 v218, v217
    s_nop 1
    v_permlane32_swap_b32 v218, v217
    s_nop 1
    v_max_f32 v217, v217, v218
    v_max_f32 v217, 0, v217
    v_sub_f32 v218, 0, v217
    v_exp_f32 v218, v218
    v_sub_f32 v192, v192, v217
    v_sub_f32 v193, v193, v217
    v_sub_f32 v194, v194, v217
    v_sub_f32 v195, v195, v217
    v_sub_f32 v152, v152, v217
    v_sub_f32 v153, v153, v217
    v_sub_f32 v154, v154, v217
    v_sub_f32 v155, v155, v217
    v_sub_f32 v156, v156, v217
    v_sub_f32 v157, v157, v217
    v_sub_f32 v158, v158, v217
    v_sub_f32 v159, v159, v217
    s_mov_b32 s56, 0xffff0000
    s_mov_b32 s57, 0x0
    v_cndmask_b32 v217, 1.0, v218, s[56:57]
    v_mul_f32 v206, v206, v217
    v_accvgpr_read_b32 v217, a192
    v_mul_f32 v217, v217, v218
    v_accvgpr_write_b32 a192, v217
    v_accvgpr_read_b32 v217, a193
    v_mul_f32 v217, v217, v218
    v_accvgpr_write_b32 a193, v217
    v_accvgpr_read_b32 v217, a194
    v_mul_f32 v217, v217, v218
    v_accvgpr_write_b32 a194, v217
    v_accvgpr_read_b32 v217, a195
    v_mul_f32 v217, v217, v218
    v_accvgpr_write_b32 a195, v217
    v_accvgpr_read_b32 v217, a196
    v_mul_f32 v217, v217, v218
    v_accvgpr_write_b32 a196, v217
    v_accvgpr_read_b32 v217, a197
    v_mul_f32 v217, v217, v218
    v_accvgpr_write_b32 a197, v217
    v_accvgpr_read_b32 v217, a198
    v_mul_f32 v217, v217, v218
    v_accvgpr_write_b32 a198, v217
    v_accvgpr_read_b32 v217, a199
    v_mul_f32 v217, v217, v218
    v_accvgpr_write_b32 a199, v217
    v_accvgpr_read_b32 v217, a200
    v_mul_f32 v217, v217, v218
    v_accvgpr_write_b32 a200, v217
    v_accvgpr_read_b32 v217, a201
    v_mul_f32 v217, v217, v218
    v_accvgpr_write_b32 a201, v217
    v_accvgpr_read_b32 v217, a202
    v_mul_f32 v217, v217, v218
    v_accvgpr_write_b32 a202, v217
    v_accvgpr_read_b32 v217, a203
    v_mul_f32 v217, v217, v218
    v_accvgpr_write_b32 a203, v217
    v_accvgpr_read_b32 v217, a204
    v_mul_f32 v217, v217, v218
    v_accvgpr_write_b32 a204, v217
    v_accvgpr_read_b32 v217, a205
    v_mul_f32 v217, v217, v218
    v_accvgpr_write_b32 a205, v217
    v_accvgpr_read_b32 v217, a206
    v_mul_f32 v217, v217, v218
    v_accvgpr_write_b32 a206, v217
    v_accvgpr_read_b32 v217, a207
    v_mul_f32 v217, v217, v218
    v_accvgpr_write_b32 a207, v217
    v_accvgpr_read_b32 v217, a208
    v_mul_f32 v217, v217, v218
    v_accvgpr_write_b32 a208, v217
    v_accvgpr_read_b32 v217, a209
    v_mul_f32 v217, v217, v218
    v_accvgpr_write_b32 a209, v217
    v_accvgpr_read_b32 v217, a210
    v_mul_f32 v217, v217, v218
    v_accvgpr_write_b32 a210, v217
    v_accvgpr_read_b32 v217, a211
    v_mul_f32 v217, v217, v218
    v_accvgpr_write_b32 a211, v217
    v_accvgpr_read_b32 v217, a212
    v_mul_f32 v217, v217, v218
    v_accvgpr_write_b32 a212, v217
    v_accvgpr_read_b32 v217, a213
    v_mul_f32 v217, v217, v218
    v_accvgpr_write_b32 a213, v217
    v_accvgpr_read_b32 v217, a214
    v_mul_f32 v217, v217, v218
    v_accvgpr_write_b32 a214, v217
    v_accvgpr_read_b32 v217, a215
    v_mul_f32 v217, v217, v218
    v_accvgpr_write_b32 a215, v217
    v_accvgpr_read_b32 v217, a216
    v_mul_f32 v217, v217, v218
    v_accvgpr_write_b32 a216, v217
    v_accvgpr_read_b32 v217, a217
    v_mul_f32 v217, v217, v218
    v_accvgpr_write_b32 a217, v217
    v_accvgpr_read_b32 v217, a218
    v_mul_f32 v217, v217, v218
    v_accvgpr_write_b32 a218, v217
    v_accvgpr_read_b32 v217, a219
    v_mul_f32 v217, v217, v218
    v_accvgpr_write_b32 a219, v217
    v_accvgpr_read_b32 v217, a220
    v_mul_f32 v217, v217, v218
    v_accvgpr_write_b32 a220, v217
    v_accvgpr_read_b32 v217, a221
    v_mul_f32 v217, v217, v218
    v_accvgpr_write_b32 a221, v217
    v_accvgpr_read_b32 v217, a222
    v_mul_f32 v217, v217, v218
    v_accvgpr_write_b32 a222, v217
    v_accvgpr_read_b32 v217, a223
    v_mul_f32 v217, v217, v218
    v_accvgpr_write_b32 a223, v217
    s_nop 1
    s_branch K1_back_l6
K1_rare_l7:
    v_mov_b32 v218, v217
    s_nop 1
    v_permlane16_swap_b32 v218, v217
    s_nop 1
    v_max_f32 v217, v217, v218
    v_mov_b32 v218, v217
    s_nop 1
    v_permlane32_swap_b32 v218, v217
    s_nop 1
    v_max_f32 v217, v217, v218
    v_max_f32 v217, 0, v217
    v_sub_f32 v218, 0, v217
    v_exp_f32 v218, v218
    v_sub_f32 v196, v196, v217
    v_sub_f32 v197, v197, v217
    v_sub_f32 v198, v198, v217
    v_sub_f32 v199, v199, v217
    v_sub_f32 v144, v144, v217
    v_sub_f32 v145, v145, v217
    v_sub_f32 v146, v146, v217
    v_sub_f32 v147, v147, v217
    v_sub_f32 v148, v148, v217
    v_sub_f32 v149, v149, v217
    v_sub_f32 v150, v150, v217
    v_sub_f32 v151, v151, v217
    s_mov_b32 s56, 0xffff0000
    s_mov_b32 s57, 0x0
    v_cndmask_b32 v217, 1.0, v218, s[56:57]
    v_mul_f32 v207, v207, v217
    v_accvgpr_read_b32 v217, a224
    v_mul_f32 v217, v217, v218
    v_accvgpr_write_b32 a224, v217
    v_accvgpr_read_b32 v217, a225
    v_mul_f32 v217, v217, v218
    v_accvgpr_write_b32 a225, v217
    v_accvgpr_read_b32 v217, a226
    v_mul_f32 v217, v217, v218
    v_accvgpr_write_b32 a226, v217
    v_accvgpr_read_b32 v217, a227
    v_mul_f32 v217, v217, v218
    v_accvgpr_write_b32 a227, v217
    v_accvgpr_read_b32 v217, a228
    v_mul_f32 v217, v217, v218
    v_accvgpr_write_b32 a228, v217
    v_accvgpr_read_b32 v217, a229
    v_mul_f32 v217, v217, v218
    v_accvgpr_write_b32 a229, v217
    v_accvgpr_read_b32 v217, a230
    v_mul_f32 v217, v217, v218
    v_accvgpr_write_b32 a230, v217
    v_accvgpr_read_b32 v217, a231
    v_mul_f32 v217, v217, v218
    v_accvgpr_write_b32 a231, v217
    v_accvgpr_read_b32 v217, a232
    v_mul_f32 v217, v217, v218
    v_accvgpr_write_b32 a232, v217
    v_accvgpr_read_b32 v217, a233
    v_mul_f32 v217, v217, v218
    v_accvgpr_write_b32 a233, v217
    v_accvgpr_read_b32 v217, a234
    v_mul_f32 v217, v217, v218
    v_accvgpr_write_b32 a234, v217
    v_accvgpr_read_b32 v217, a235
    v_mul_f32 v217, v217, v218
    v_accvgpr_write_b32 a235, v217
    v_accvgpr_read_b32 v217, a236
    v_mul_f32 v217, v217, v218
    v_accvgpr_write_b32 a236, v217
    v_accvgpr_read_b32 v217, a237
    v_mul_f32 v217, v217, v218
    v_accvgpr_write_b32 a237, v217
    v_accvgpr_read_b32 v217, a238
    v_mul_f32 v217, v217, v218
    v_accvgpr_write_b32 a238, v217
    v_accvgpr_read_b32 v217, a239
    v_mul_f32 v217, v217, v218
    v_accvgpr_write_b32 a239, v217
    v_accvgpr_read_b32 v217, a240
    v_mul_f32 v217, v217, v218
    v_accvgpr_write_b32 a240, v217
    v_accvgpr_read_b32 v217, a241
    v_mul_f32 v217, v217, v218
    v_accvgpr_write_b32 a241, v217
    v_accvgpr_read_b32 v217, a242
    v_mul_f32 v217, v217, v218
    v_accvgpr_write_b32 a242, v217
    v_accvgpr_read_b32 v217, a243
    v_mul_f32 v217, v217, v218
    v_accvgpr_write_b32 a243, v217
    v_accvgpr_read_b32 v217, a244
    v_mul_f32 v217, v217, v218
    v_accvgpr_write_b32 a244, v217
    v_accvgpr_read_b32 v217, a245
    v_mul_f32 v217, v217, v218
    v_accvgpr_write_b32 a245, v217
    v_accvgpr_read_b32 v217, a246
    v_mul_f32 v217, v217, v218
    v_accvgpr_write_b32 a246, v217
    v_accvgpr_read_b32 v217, a247
    v_mul_f32 v217, v217, v218
    v_accvgpr_write_b32 a247, v217
    v_accvgpr_read_b32 v217, a248
    v_mul_f32 v217, v217, v218
    v_accvgpr_write_b32 a248, v217
    v_accvgpr_read_b32 v217, a249
    v_mul_f32 v217, v217, v218
    v_accvgpr_write_b32 a249, v217
    v_accvgpr_read_b32 v217, a250
    v_mul_f32 v217, v217, v218
    v_accvgpr_write_b32 a250, v217
    v_accvgpr_read_b32 v217, a251
    v_mul_f32 v217, v217, v218
    v_accvgpr_write_b32 a251, v217
    v_accvgpr_read_b32 v217, a252
    v_mul_f32 v217, v217, v218
    v_accvgpr_write_b32 a252, v217
    v_accvgpr_read_b32 v217, a253
    v_mul_f32 v217, v217, v218
    v_accvgpr_write_b32 a253, v217
    v_accvgpr_read_b32 v217, a254
    v_mul_f32 v217, v217, v218
    v_accvgpr_write_b32 a254, v217
    v_accvgpr_read_b32 v217, a255
    v_mul_f32 v217, v217, v218
    v_accvgpr_write_b32 a255, v217
    s_nop 1
    s_branch K1_back_l7
K1_rare_l8:
    v_mov_b32 v218, v217
    s_nop 1
    v_permlane16_swap_b32 v218, v217
    s_nop 1
    v_max_f32 v217, v217, v218
    v_mov_b32 v218, v217
    s_nop 1
    v_permlane32_swap_b32 v218, v217
    s_nop 1
    v_max_f32 v217, v217, v218
    v_max_f32 v217, 0, v217
    v_sub_f32 v218, 0, v217
    v_exp_f32 v218, v218
    v_sub_f32 v200, v200, v217
    v_sub_f32 v201, v201, v217
    v_sub_f32 v202, v202, v217
    v_sub_f32 v203, v203, v217
    v_sub_f32 v152, v152, v217
    v_sub_f32 v153, v153, v217
    v_sub_f32 v154, v154, v217
    v_sub_f32 v155, v155, v217
    v_sub_f32 v156, v156, v217
    v_sub_f32 v157, v157, v217
    v_sub_f32 v158, v158, v217
    v_sub_f32 v159, v159, v217
    s_mov_b32 s56, 0x0
    s_mov_b32 s57, 0xffff
    v_cndmask_b32 v217, 1.0, v218, s[56:57]
    v_mul_f32 v204, v204, v217
    v_mul_f32 v224, v224, v218
    v_mul_f32 v225, v225, v218
    v_mul_f32 v226, v226, v218
    v_mul_f32 v227, v227, v218
    v_mul_f32 v228, v228, v218
    v_mul_f32 v229, v229, v218
    v_mul_f32 v230, v230, v218
    v_mul_f32 v231, v231, v218
    v_mul_f32 v232, v232, v218
    v_mul_f32 v233, v233, v218
    v_mul_f32 v234, v234, v218
    v_mul_f32 v235, v235, v218
    v_mul_f32 v236, v236, v218
    v_mul_f32 v237, v237, v218
    v_mul_f32 v238, v238, v218
    v_mul_f32 v239, v239, v218
    v_mul_f32 v240, v240, v218
    v_mul_f32 v241, v241, v218
    v_mul_f32 v242, v242, v218
    v_mul_f32 v243, v243, v218
    v_mul_f32 v244, v244, v218
    v_mul_f32 v245, v245, v218
    v_mul_f32 v246, v246, v218
    v_mul_f32 v247, v247, v218
    v_mul_f32 v248, v248, v218
    v_mul_f32 v249, v249, v218
    v_mul_f32 v250, v250, v218
    v_mul_f32 v251, v251, v218
    v_mul_f32 v252, v252, v218
    v_mul_f32 v253, v253, v218
    v_mul_f32 v254, v254, v218
    v_mul_f32 v255, v255, v218
    s_nop 1
    s_branch K1_back_l8
.globl reduce_kernel
.p2align 8
.type reduce_kernel,@function
reduce_kernel:
    s_cmp_ge_u32 s2, 1152
    s_cbranch_scc1 K2_done
    s_load_dwordx2 s[64:65], s[0:1], 80
    s_load_dwordx2 s[66:67], s[0:1], 96
    s_lshr_b32 s20, s2, 3
    s_mul_hi_u32 s4, s20, 0x71c71c8
    s_mul_i32 s5, s4, 36
    s_sub_u32 s5, s20, s5
    s_and_b32 s21, s2, 1
    s_lshl_b32 s21, s21, 4
    s_add_u32 s4, s4, s21
    s_lshr_b32 s21, s2, 1
    s_and_b32 s21, s21, 3
    s_lshl_b32 s21, s21, 2
    s_add_u32 s4, s4, s21
    v_lshrrev_b32 v1, 6, v0
    v_and_b32 v2, 63, v0
    s_nop 0
    v_readfirstlane_b32 s6, v1
    s_lshl_b32 s5, s5, 2
    s_add_u32 s5, s5, s6
    s_mul_hi_u32 s7, s5, 0x1c71c71d
    s_mul_i32 s12, s7, 9
    s_sub_u32 s12, s5, s12
    v_lshlrev_b32 v3, 4, v2
    s_waitcnt lgkmcnt(0)
    s_mul_i32 s13, s4, 1179648
    s_lshl_b32 s14, s5, 10
    s_add_u32 s13, s13, s14
    s_add_u32 s8, s66, s13
    s_addc_u32 s9, s67, 0
    s_mov_b32 s10, 1033216
    s_mov_b32 s11, 0x00020000
    s_mov_b32 s15, 0
    buffer_load_dwordx4 v[8:11], v3, s[8:11], s15 offen nt
    s_mov_b32 s15, 147456
    buffer_load_dwordx4 v[12:15], v3, s[8:11], s15 offen nt
    s_mov_b32 s15, 294912
    buffer_load_dwordx4 v[16:19], v3, s[8:11], s15 offen nt
    s_mov_b32 s15, 442368
    buffer_load_dwordx4 v[20:23], v3, s[8:11], s15 offen nt
    s_mov_b32 s15, 589824
    buffer_load_dwordx4 v[24:27], v3, s[8:11], s15 offen nt
    s_mov_b32 s15, 737280
    buffer_load_dwordx4 v[28:31], v3, s[8:11], s15 offen nt
    s_mov_b32 s15, 884736
    buffer_load_dwordx4 v[32:35], v3, s[8:11], s15 offen nt
    s_mov_b32 s15, 1032192
    buffer_load_dwordx4 v[36:39], v3, s[8:11], s15 offen nt
    s_and_b32 s13, s4, 15
    s_lshr_b32 s14, s4, 4
    s_mul_i32 s13, s13, 144
    s_lshl_b32 s12, s12, 4
    s_add_u32 s13, s13, s12
    s_lshl_b32 s13, s13, 11
    s_lshl_b32 s14, s14, 10
    s_add_u32 s13, s13, s14
    s_lshl_b32 s14, s7, 6
    s_add_u32 s13, s13, s14
    v_and_b32 v4, 15, v2
    v_lshrrev_b32 v5, 4, v2
    v_lshlrev_b32 v4, 11, v4
    v_lshl_add_u32 v4, v5, 4, v4
    s_mov_b32 s16, s64
    s_mov_b32 s17, s65
    s_mov_b32 s18, 4718592
    s_mov_b32 s19, 0x00020000
    s_waitcnt vmcnt(7)
    v_lshlrev_b32 v40, 16, v8
    v_and_b32 v41, 0xffff0000, v8
    v_lshlrev_b32 v42, 16, v9
    v_and_b32 v43, 0xffff0000, v9
    v_lshlrev_b32 v44, 16, v10
    v_and_b32 v45, 0xffff0000, v10
    v_lshlrev_b32 v46, 16, v11
    v_and_b32 v47, 0xffff0000, v11
    s_waitcnt vmcnt(6)
    v_lshlrev_b32 v48, 16, v12
    v_and_b32 v49, 0xffff0000, v12
    v_add_f32 v40, v40, v48
    v_add_f32 v41, v41, v49
    v_lshlrev_b32 v48, 16, v13
    v_and_b32 v49, 0xffff0000, v13
    v_add_f32 v42, v42, v48
    v_add_f32 v43, v43, v49
    v_lshlrev_b32 v48, 16, v14
    v_and_b32 v49, 0xffff0000, v14
    v_add_f32 v44, v44, v48
    v_add_f32 v45, v45, v49
    v_lshlrev_b32 v48, 16, v15
    v_and_b32 v49, 0xffff0000, v15
    v_add_f32 v46, v46, v48
    v_add_f32 v47, v47, v49
    s_waitcnt vmcnt(5)
    v_lshlrev_b32 v48, 16, v16
    v_and_b32 v49, 0xffff0000, v16
    v_add_f32 v40, v40, v48
    v_add_f32 v41, v41, v49
    v_lshlrev_b32 v48, 16, v17
    v_and_b32 v49, 0xffff0000, v17
    v_add_f32 v42, v42, v48
    v_add_f32 v43, v43, v49
    v_lshlrev_b32 v48, 16, v18
    v_and_b32 v49, 0xffff0000, v18
    v_add_f32 v44, v44, v48
    v_add_f32 v45, v45, v49
    v_lshlrev_b32 v48, 16, v19
    v_and_b32 v49, 0xffff0000, v19
    v_add_f32 v46, v46, v48
    v_add_f32 v47, v47, v49
    s_waitcnt vmcnt(4)
    v_lshlrev_b32 v48, 16, v20
    v_and_b32 v49, 0xffff0000, v20
    v_add_f32 v40, v40, v48
    v_add_f32 v41, v41, v49
    v_lshlrev_b32 v48, 16, v21
    v_and_b32 v49, 0xffff0000, v21
    v_add_f32 v42, v42, v48
    v_add_f32 v43, v43, v49
    v_lshlrev_b32 v48, 16, v22
    v_and_b32 v49, 0xffff0000, v22
    v_add_f32 v44, v44, v48
    v_add_f32 v45, v45, v49
    v_lshlrev_b32 v48, 16, v23
    v_and_b32 v49, 0xffff0000, v23
    v_add_f32 v46, v46, v48
    v_add_f32 v47, v47, v49
    s_waitcnt vmcnt(3)
    v_lshlrev_b32 v48, 16, v24
    v_and_b32 v49, 0xffff0000, v24
    v_add_f32 v40, v40, v48
    v_add_f32 v41, v41, v49
    v_lshlrev_b32 v48, 16, v25
    v_and_b32 v49, 0xffff0000, v25
    v_add_f32 v42, v42, v48
    v_add_f32 v43, v43, v49
    v_lshlrev_b32 v48, 16, v26
    v_and_b32 v49, 0xffff0000, v26
    v_add_f32 v44, v44, v48
    v_add_f32 v45, v45, v49
    v_lshlrev_b32 v48, 16, v27
    v_and_b32 v49, 0xffff0000, v27
    v_add_f32 v46, v46, v48
    v_add_f32 v47, v47, v49
    s_waitcnt vmcnt(2)
    v_lshlrev_b32 v48, 16, v28
    v_and_b32 v49, 0xffff0000, v28
    v_add_f32 v40, v40, v48
    v_add_f32 v41, v41, v49
    v_lshlrev_b32 v48, 16, v29
    v_and_b32 v49, 0xffff0000, v29
    v_add_f32 v42, v42, v48
    v_add_f32 v43, v43, v49
    v_lshlrev_b32 v48, 16, v30
    v_and_b32 v49, 0xffff0000, v30
    v_add_f32 v44, v44, v48
    v_add_f32 v45, v45, v49
    v_lshlrev_b32 v48, 16, v31
    v_and_b32 v49, 0xffff0000, v31
    v_add_f32 v46, v46, v48
    v_add_f32 v47, v47, v49
    s_waitcnt vmcnt(1)
    v_lshlrev_b32 v48, 16, v32
    v_and_b32 v49, 0xffff0000, v32
    v_add_f32 v40, v40, v48
    v_add_f32 v41, v41, v49
    v_lshlrev_b32 v48, 16, v33
    v_and_b32 v49, 0xffff0000, v33
    v_add_f32 v42, v42, v48
    v_add_f32 v43, v43, v49
    v_lshlrev_b32 v48, 16, v34
    v_and_b32 v49, 0xffff0000, v34
    v_add_f32 v44, v44, v48
    v_add_f32 v45, v45, v49
    v_lshlrev_b32 v48, 16, v35
    v_and_b32 v49, 0xffff0000, v35
    v_add_f32 v46, v46, v48
    v_add_f32 v47, v47, v49
    s_waitcnt vmcnt(0)
    v_lshlrev_b32 v48, 16, v36
    v_and_b32 v49, 0xffff0000, v36
    v_add_f32 v40, v40, v48
    v_add_f32 v41, v41, v49
    v_lshlrev_b32 v48, 16, v37
    v_and_b32 v49, 0xffff0000, v37
    v_add_f32 v42, v42, v48
    v_add_f32 v43, v43, v49
    v_lshlrev_b32 v48, 16, v38
    v_and_b32 v49, 0xffff0000, v38
    v_add_f32 v44, v44, v48
    v_add_f32 v45, v45, v49
    v_lshlrev_b32 v48, 16, v39
    v_and_b32 v49, 0xffff0000, v39
    v_add_f32 v46, v46, v48
    v_add_f32 v47, v47, v49
    v_cvt_pk_bf16_f32 v52, v40, v41
    v_cvt_pk_bf16_f32 v53, v42, v43
    v_cvt_pk_bf16_f32 v54, v44, v45
    v_cvt_pk_bf16_f32 v55, v46, v47
    buffer_store_dwordx4 v[52:55], v4, s[16:19], s13 offen
K2_done:
    s_endpgm
.section .rodata,"a"
.p2align 6
.amdhsa_kernel concat_heads__gqa_block_cached__gqa_block_cached__near_ridge_kernel
  .amdhsa_next_free_vgpr 512
  .amdhsa_next_free_sgpr 102
  .amdhsa_accum_offset 256
  .amdhsa_group_segment_fixed_size 0
  .amdhsa_kernarg_size 104
  .amdhsa_user_sgpr_count 2
  .amdhsa_user_sgpr_kernarg_segment_ptr 1
  .amdhsa_system_sgpr_workgroup_id_x 1
.end_amdhsa_kernel
.p2align 6
.amdhsa_kernel reduce_kernel
  .amdhsa_next_free_vgpr 56
  .amdhsa_next_free_sgpr 102
  .amdhsa_accum_offset 56
  .amdhsa_group_segment_fixed_size 0
  .amdhsa_kernarg_size 104
  .amdhsa_user_sgpr_count 2
  .amdhsa_user_sgpr_kernarg_segment_ptr 1
  .amdhsa_system_sgpr_workgroup_id_x 1
.end_amdhsa_kernel
```
